```python
import torch

def _softmax(x, axis=-1):
    return torch.softmax(x, dim=axis)
def _gelu(x):
    return torch.nn.functional.gelu(x, approximate="tanh")
def _silu(x):
    return torch.nn.functional.silu(x)
def _sigmoid(x):
    return torch.sigmoid(x)
def _layernorm(x, axis=-1, eps=1e-5):
    m = x.mean(dim=axis, keepdim=True)
    v = x.var(dim=axis, keepdim=True, unbiased=False)
    return (x - m) / torch.sqrt(v + eps)
def _scatter_add(tgt, idx, src, axis=0):
    return tgt.clone().index_add_(axis, idx, src)
def _segment_sum(src, seg, n):
    out = torch.zeros((n,) + src.shape[1:], dtype=src.dtype)
    return out.index_add_(0, seg, src)
def _pad(x, pw):
    flat = tuple(v for pair in reversed(pw) for v in pair)
    return torch.nn.functional.pad(x, flat)

kernel_name = 'interleave_layers__sliding_local_dilated__swiglu_ffn__prompt'

def setup_inputs():

    _w = (lambda a: (lambda t: t.to(torch.bfloat16) if t.is_floating_point() else t)(torch.as_tensor(a)))
    def _A_setup():
        B, S, D = 1, 2048, 576
        return {
            "x": _w((lambda *s: torch.randn(*s, dtype=torch.bfloat16) * 0.05)(B, S, D)),
            "wqkv": _w((lambda *s: torch.randn(*s, dtype=torch.bfloat16) * 0.05)(D, 3 * D)),
            "wo": _w((lambda *s: torch.randn(*s, dtype=torch.bfloat16) * 0.05)(D, D)),
        }
    _A_in = _A_setup()

    def _B_setup():
        B, S, D, F = 1, 2048, 576, 4608
        return {
            "x": _w((lambda *s: torch.randn(*s, dtype=torch.bfloat16) * 0.05)(B, S, D)),
            "w_gate": _w((lambda *s: torch.randn(*s, dtype=torch.bfloat16) * 0.05)(D, F)),
            "w_up": _w((lambda *s: torch.randn(*s, dtype=torch.bfloat16) * 0.05)(D, F)),
            "w_down": _w((lambda *s: torch.randn(*s, dtype=torch.bfloat16) * 0.05)(F, D)),
        }
    _B_in = _B_setup()

    return {
        "A_x": _A_in["x"],
        "A_wqkv": _A_in["wqkv"],
        "A_wo": _A_in["wo"],
        "B_x": _B_in["x"],
        "B_w_gate": _B_in["w_gate"],
        "B_w_up": _B_in["w_up"],
        "B_w_down": _B_in["w_down"],
    }

def reference(A_x, A_wqkv, A_wo, B_x, B_w_gate, B_w_up, B_w_down):
    def _A_ref(x, wqkv, wo):
        B, S, D = x.shape
        H = 32; Dh = D // H
        W, dil = 8, 2
        qkv = (lambda x, *d: x.permute(*d))((x @ wqkv).reshape(B, S, 3, H, Dh), 2, 0, 3, 1, 4)
        q, k, v = qkv[0], qkv[1], qkv[2]
        scale = Dh ** -0.5
        pos = torch.arange(S)
        off = torch.arange(W) * dil
        idx = pos[:, None] - off[None, :]
        mask = idx >= 0
        idx_c = torch.where(mask, idx, 0).reshape(-1)
        kg = k[:, :, idx_c, :].reshape(B, H, S, W, Dh)
        vg = v[:, :, idx_c, :].reshape(B, H, S, W, Dh)
        logits = torch.einsum("bhsd,bhswd->bhsw", q, kg) * scale
        logits = torch.where(mask[None, None, :, :], logits, -1e9)
        attn = _softmax(logits, axis=-1)
        o = torch.einsum("bhsw,bhswd->bhsd", attn, vg)
        return (lambda x, *d: x.permute(*d))(o, 0, 2, 1, 3).reshape(B, S, D) @ wo

    def _B_ref(x, w_gate, w_up, w_down):
        g = _silu(x @ w_gate)
        u = x @ w_up
        return (g * u) @ w_down

    x = A_x
    x = x + _A_ref(_layernorm(x, axis=-1), A_wqkv, A_wo)
    x = x + _B_ref(_layernorm(x, axis=-1), B_w_gate, B_w_up, B_w_down)
    x = x + _A_ref(_layernorm(x, axis=-1), A_wqkv, A_wo)
    x = x + _B_ref(_layernorm(x, axis=-1), B_w_gate, B_w_up, B_w_down)
    return x
```

```asm
; @launch kernel=k1a_kernel grid=(256,1,1) block=(256,1,1) lds=153600
; @launch kernel=k2a_kernel grid=(256,1,1) block=(256,1,1) lds=102400
; @launch kernel=k3_kernel grid=(256,1,1) block=(256,1,1) lds=148480
; @launch kernel=k4a_kernel grid=(256,1,1) block=(256,1,1) lds=77824
; @launch kernel=k1b_kernel grid=(256,1,1) block=(256,1,1) lds=153600
; @launch kernel=k2b_kernel grid=(192,1,1) block=(256,1,1) lds=102400
; @launch kernel=k3_kernel grid=(256,1,1) block=(256,1,1) lds=148480
; @launch kernel=k4b_kernel grid=(256,1,1) block=(256,1,1) lds=77824
.amdgcn_target "amdgcn-amd-amdhsa--gfx950"
.text
.globl k1a_kernel
.p2align 8
.type k1a_kernel,@function
k1a_kernel:
    s_cmp_ge_u32 s2, 256
    s_cbranch_scc1 k1a_kernel_end
    s_load_dwordx2 s[4:5], s[0:1], 8
    s_load_dwordx2 s[8:9], s[0:1], 72
    s_load_dwordx2 s[6:7], s[0:1], 0
    s_load_dwordx2 s[48:49], s[0:1], 16
    s_load_dwordx4 s[52:55], s[0:1], 32
    s_load_dwordx2 s[50:51], s[0:1], 48
    v_lshrrev_b32 v1, 6, v0
    v_mov_b32 v2, v0
    v_and_b32 v0, 63, v0
    v_readfirstlane_b32 s20, v1
    s_and_b32 s21, s2, 1
    s_lshl_b32 s21, s21, 2
    s_bfe_u32 s30, s2, 0x20003
    s_add_u32 s21, s21, s30
    s_bfe_u32 s22, s2, 0x20001
    s_lshl_b32 s22, s22, 3
    s_lshr_b32 s30, s2, 5
    s_add_u32 s22, s22, s30
    s_mul_i32 s31, s21, 144
    s_mov_b32 s32, 0x8889
    s_add_u32 s30, s20, 0
    s_min_u32 s30, s30, 14
    s_lshl_b32 s40, s30, 10
    s_add_u32 s40, s40, 92160
    s_lshl_b32 s30, s30, 6
    v_add_u32 v3, s30, v0
    v_mul_lo_u32 v4, v3, s32
    v_lshrrev_b32 v4, 20, v4
    v_mul_u32_u24 v5, 30, v4
    v_sub_u32 v5, v3, v5
    v_min_u32 v5, 26, v5
    v_mul_u32_u24 v6, 57, v5
    v_lshrrev_b32 v6, 9, v6
    v_mul_u32_u24 v7, 9, v6
    v_sub_u32 v5, v5, v7
    v_mul_u32_u24 v4, 3456, v4
    v_mul_u32_u24 v6, 1152, v6
    v_lshlrev_b32 v5, 4, v5
    v_add3_u32 v4, v4, v6, v5
    v_add_u32 v8, s31, v4
    s_add_u32 s30, s20, 4
    s_min_u32 s30, s30, 14
    s_lshl_b32 s41, s30, 10
    s_add_u32 s41, s41, 92160
    s_lshl_b32 s30, s30, 6
    v_add_u32 v3, s30, v0
    v_mul_lo_u32 v4, v3, s32
    v_lshrrev_b32 v4, 20, v4
    v_mul_u32_u24 v5, 30, v4
    v_sub_u32 v5, v3, v5
    v_min_u32 v5, 26, v5
    v_mul_u32_u24 v6, 57, v5
    v_lshrrev_b32 v6, 9, v6
    v_mul_u32_u24 v7, 9, v6
    v_sub_u32 v5, v5, v7
    v_mul_u32_u24 v4, 3456, v4
    v_mul_u32_u24 v6, 1152, v6
    v_lshlrev_b32 v5, 4, v5
    v_add3_u32 v4, v4, v6, v5
    v_add_u32 v9, s31, v4
    s_add_u32 s30, s20, 8
    s_min_u32 s30, s30, 14
    s_lshl_b32 s42, s30, 10
    s_add_u32 s42, s42, 92160
    s_lshl_b32 s30, s30, 6
    v_add_u32 v3, s30, v0
    v_mul_lo_u32 v4, v3, s32
    v_lshrrev_b32 v4, 20, v4
    v_mul_u32_u24 v5, 30, v4
    v_sub_u32 v5, v3, v5
    v_min_u32 v5, 26, v5
    v_mul_u32_u24 v6, 57, v5
    v_lshrrev_b32 v6, 9, v6
    v_mul_u32_u24 v7, 9, v6
    v_sub_u32 v5, v5, v7
    v_mul_u32_u24 v4, 3456, v4
    v_mul_u32_u24 v6, 1152, v6
    v_lshlrev_b32 v5, 4, v5
    v_add3_u32 v4, v4, v6, v5
    v_add_u32 v10, s31, v4
    s_add_u32 s30, s20, 12
    s_min_u32 s30, s30, 14
    s_lshl_b32 s43, s30, 10
    s_add_u32 s43, s43, 92160
    s_lshl_b32 s30, s30, 6
    v_add_u32 v3, s30, v0
    v_mul_lo_u32 v4, v3, s32
    v_lshrrev_b32 v4, 20, v4
    v_mul_u32_u24 v5, 30, v4
    v_sub_u32 v5, v3, v5
    v_min_u32 v5, 26, v5
    v_mul_u32_u24 v6, 57, v5
    v_lshrrev_b32 v6, 9, v6
    v_mul_u32_u24 v7, 9, v6
    v_sub_u32 v5, v5, v7
    v_mul_u32_u24 v4, 3456, v4
    v_mul_u32_u24 v6, 1152, v6
    v_lshlrev_b32 v5, 4, v5
    v_add3_u32 v4, v4, v6, v5
    v_add_u32 v11, s31, v4
    v_lshrrev_b32 v3, 3, v0
    s_lshl_b32 s30, s20, 3
    s_lshl_b32 s31, s22, 6
    s_add_u32 s30, s30, s31
    s_sub_u32 s30, s30, 16
    v_add_u32 v3, s30, v3
    v_and_b32 v4, 7, v0
    v_lshlrev_b32 v4, 4, v4
    v_add_u32 v5, 0, v3
    v_max_i32 v5, 0, v5
    v_min_i32 v5, 2047, v5
    v_mov_b32 v15, v5
    v_mul_u32_u24 v5, 1152, v5
    v_add_u32 v12, v5, v4
    v_add_u32 v5, 32, v3
    v_max_i32 v5, 0, v5
    v_min_i32 v5, 2047, v5
    v_mov_b32 v16, v5
    v_mul_u32_u24 v5, 1152, v5
    v_add_u32 v13, v5, v4
    v_bfe_u32 v5, v0, 3, 2
    s_lshl_b32 s30, s20, 2
    s_add_u32 s30, s30, s31
    s_add_u32 s30, s30, 48
    v_add_u32 v5, s30, v5
    v_max_i32 v5, 0, v5
    v_min_i32 v5, 2047, v5
    v_mov_b32 v17, v5
    v_mul_u32_u24 v5, 1152, v5
    v_add_u32 v14, v5, v4
    s_waitcnt lgkmcnt(0)
    s_mov_b32 s12, s4
    s_and_b32 s13, s5, 0xffff
    s_mov_b32 s14, 1990656
    s_mov_b32 s15, 0x00020000
    s_mov_b32 s16, s8
    s_and_b32 s17, s9, 0xffff
    s_mov_b32 s18, 268435456
    s_mov_b32 s19, 0x00020000
    s_mov_b32 s36, s6
    s_and_b32 s37, s7, 0xffff
    s_mov_b32 s38, 2359296
    s_mov_b32 s39, 0x00020000
    s_mov_b32 s33, 0
    s_mul_i32 s60, s21, 276480
    s_add_u32 s60, s60, 83793920
    v_lshlrev_b32 v1, 4, v0
    buffer_load_dwordx4 v[148:151], v12, s[36:39], s33 offen offset:0
    buffer_load_dwordx4 v[152:155], v12, s[36:39], s33 offen offset:128
    buffer_load_dwordx4 v[156:159], v12, s[36:39], s33 offen offset:256
    buffer_load_dwordx4 v[160:163], v12, s[36:39], s33 offen offset:384
    buffer_load_dwordx4 v[164:167], v12, s[36:39], s33 offen offset:512
    buffer_load_dwordx4 v[168:171], v12, s[36:39], s33 offen offset:640
    buffer_load_dwordx4 v[172:175], v12, s[36:39], s33 offen offset:768
    buffer_load_dwordx4 v[176:179], v12, s[36:39], s33 offen offset:896
    buffer_load_dwordx4 v[180:183], v12, s[36:39], s33 offen offset:1024
    buffer_load_dwordx4 v[184:187], v13, s[36:39], s33 offen offset:0
    buffer_load_dwordx4 v[188:191], v13, s[36:39], s33 offen offset:128
    buffer_load_dwordx4 v[192:195], v13, s[36:39], s33 offen offset:256
    buffer_load_dwordx4 v[196:199], v13, s[36:39], s33 offen offset:384
    buffer_load_dwordx4 v[200:203], v13, s[36:39], s33 offen offset:512
    buffer_load_dwordx4 v[204:207], v13, s[36:39], s33 offen offset:640
    buffer_load_dwordx4 v[208:211], v13, s[36:39], s33 offen offset:768
    buffer_load_dwordx4 v[212:215], v13, s[36:39], s33 offen offset:896
    buffer_load_dwordx4 v[216:219], v13, s[36:39], s33 offen offset:1024
    s_mov_b32 s46, 0x97b5
    s_mul_i32 s31, s21, 144
    s_and_b32 s47, s22, 7
    s_mul_i32 s47, s47, 248832
    s_add_u32 s47, s47, s31
    s_and_b32 s61, s22, 7
    s_mul_i32 s61, s61, 36
    s_add_u32 s61, s61, s20
    s_lshl_b32 s61, s61, 10
    s_add_u32 s61, s61, s60
    s_add_u32 s61, s61, 92160
    v_lshrrev_b32 v3, 3, v0
    s_lshl_b32 s30, s20, 3
    v_add_u32 v3, s30, v3
    v_lshrrev_b32 v4, 4, v3
    v_mul_u32_u24 v4, 18432, v4
    v_and_b32 v5, 15, v3
    v_lshlrev_b32 v5, 4, v5
    v_add_u32 v4, v4, v5
    v_bfe_u32 v5, v0, 2, 1
    v_lshlrev_b32 v5, 10, v5
    v_add_u32 v4, v4, v5
    v_and_b32 v5, 1, v0
    v_lshlrev_b32 v5, 9, v5
    v_add_u32 v4, v4, v5
    v_bfe_u32 v5, v0, 1, 1
    v_lshlrev_b32 v5, 3, v5
    v_add_u32 v18, v4, v5
    s_mov_b32 s34, 0xffff0000
    s_mov_b32 s35, 0x3ae38e39
    s_waitcnt vmcnt(9)
    v_lshlrev_b32 v60, 16, v148
    v_and_b32 v61, s34, v148
    v_lshlrev_b32 v62, 16, v149
    v_and_b32 v63, s34, v149
    v_lshlrev_b32 v64, 16, v150
    v_and_b32 v65, s34, v150
    v_lshlrev_b32 v66, 16, v151
    v_and_b32 v67, s34, v151
    v_lshlrev_b32 v68, 16, v152
    v_and_b32 v69, s34, v152
    v_lshlrev_b32 v70, 16, v153
    v_and_b32 v71, s34, v153
    v_lshlrev_b32 v72, 16, v154
    v_and_b32 v73, s34, v154
    v_lshlrev_b32 v74, 16, v155
    v_and_b32 v75, s34, v155
    v_lshlrev_b32 v76, 16, v156
    v_and_b32 v77, s34, v156
    v_lshlrev_b32 v78, 16, v157
    v_and_b32 v79, s34, v157
    v_lshlrev_b32 v80, 16, v158
    v_and_b32 v81, s34, v158
    v_lshlrev_b32 v82, 16, v159
    v_and_b32 v83, s34, v159
    v_lshlrev_b32 v84, 16, v160
    v_and_b32 v85, s34, v160
    v_lshlrev_b32 v86, 16, v161
    v_and_b32 v87, s34, v161
    v_lshlrev_b32 v88, 16, v162
    v_and_b32 v89, s34, v162
    v_lshlrev_b32 v90, 16, v163
    v_and_b32 v91, s34, v163
    v_lshlrev_b32 v92, 16, v164
    v_and_b32 v93, s34, v164
    v_lshlrev_b32 v94, 16, v165
    v_and_b32 v95, s34, v165
    v_lshlrev_b32 v96, 16, v166
    v_and_b32 v97, s34, v166
    v_lshlrev_b32 v98, 16, v167
    v_and_b32 v99, s34, v167
    v_lshlrev_b32 v100, 16, v168
    v_and_b32 v101, s34, v168
    v_lshlrev_b32 v102, 16, v169
    v_and_b32 v103, s34, v169
    v_lshlrev_b32 v104, 16, v170
    v_and_b32 v105, s34, v170
    v_lshlrev_b32 v106, 16, v171
    v_and_b32 v107, s34, v171
    v_lshlrev_b32 v108, 16, v172
    v_and_b32 v109, s34, v172
    v_lshlrev_b32 v110, 16, v173
    v_and_b32 v111, s34, v173
    v_lshlrev_b32 v112, 16, v174
    v_and_b32 v113, s34, v174
    v_lshlrev_b32 v114, 16, v175
    v_and_b32 v115, s34, v175
    v_lshlrev_b32 v116, 16, v176
    v_and_b32 v117, s34, v176
    v_lshlrev_b32 v118, 16, v177
    v_and_b32 v119, s34, v177
    v_lshlrev_b32 v120, 16, v178
    v_and_b32 v121, s34, v178
    v_lshlrev_b32 v122, 16, v179
    v_and_b32 v123, s34, v179
    v_lshlrev_b32 v124, 16, v180
    v_and_b32 v125, s34, v180
    v_lshlrev_b32 v126, 16, v181
    v_and_b32 v127, s34, v181
    v_lshlrev_b32 v128, 16, v182
    v_and_b32 v129, s34, v182
    v_lshlrev_b32 v130, 16, v183
    v_and_b32 v131, s34, v183
    v_pk_add_f32 v[4:5], v[60:61], v[62:63]
    v_pk_add_f32 v[6:7], v[64:65], v[66:67]
    v_pk_add_f32 v[4:5], v[4:5], v[68:69]
    v_pk_add_f32 v[6:7], v[6:7], v[70:71]
    v_pk_add_f32 v[4:5], v[4:5], v[72:73]
    v_pk_add_f32 v[6:7], v[6:7], v[74:75]
    v_pk_add_f32 v[4:5], v[4:5], v[76:77]
    v_pk_add_f32 v[6:7], v[6:7], v[78:79]
    v_pk_add_f32 v[4:5], v[4:5], v[80:81]
    v_pk_add_f32 v[6:7], v[6:7], v[82:83]
    v_pk_add_f32 v[4:5], v[4:5], v[84:85]
    v_pk_add_f32 v[6:7], v[6:7], v[86:87]
    v_pk_add_f32 v[4:5], v[4:5], v[88:89]
    v_pk_add_f32 v[6:7], v[6:7], v[90:91]
    v_pk_add_f32 v[4:5], v[4:5], v[92:93]
    v_pk_add_f32 v[6:7], v[6:7], v[94:95]
    v_pk_add_f32 v[4:5], v[4:5], v[96:97]
    v_pk_add_f32 v[6:7], v[6:7], v[98:99]
    v_pk_add_f32 v[4:5], v[4:5], v[100:101]
    v_pk_add_f32 v[6:7], v[6:7], v[102:103]
    v_pk_add_f32 v[4:5], v[4:5], v[104:105]
    v_pk_add_f32 v[6:7], v[6:7], v[106:107]
    v_pk_add_f32 v[4:5], v[4:5], v[108:109]
    v_pk_add_f32 v[6:7], v[6:7], v[110:111]
    v_pk_add_f32 v[4:5], v[4:5], v[112:113]
    v_pk_add_f32 v[6:7], v[6:7], v[114:115]
    v_pk_add_f32 v[4:5], v[4:5], v[116:117]
    v_pk_add_f32 v[6:7], v[6:7], v[118:119]
    v_pk_add_f32 v[4:5], v[4:5], v[120:121]
    v_pk_add_f32 v[6:7], v[6:7], v[122:123]
    v_pk_add_f32 v[4:5], v[4:5], v[124:125]
    v_pk_add_f32 v[6:7], v[6:7], v[126:127]
    v_pk_add_f32 v[4:5], v[4:5], v[128:129]
    v_pk_add_f32 v[6:7], v[6:7], v[130:131]
    v_pk_add_f32 v[4:5], v[4:5], v[6:7]
    v_add_f32 v3, v4, v5
    s_nop 1
    v_add_f32_dpp v3, v3, v3 quad_perm:[1,0,3,2] row_mask:0xf bank_mask:0xf
    s_nop 1
    v_add_f32_dpp v3, v3, v3 quad_perm:[2,3,0,1] row_mask:0xf bank_mask:0xf
    s_nop 1
    v_add_f32_dpp v3, v3, v3 row_half_mirror row_mask:0xf bank_mask:0xf
    v_mul_f32 v3, s35, v3
    v_sub_f32 v6, 0, v3
    v_sub_f32 v7, 0, v3
    v_pk_add_f32 v[60:61], v[60:61], v[6:7]
    v_pk_add_f32 v[62:63], v[62:63], v[6:7]
    v_pk_add_f32 v[64:65], v[64:65], v[6:7]
    v_pk_add_f32 v[66:67], v[66:67], v[6:7]
    v_pk_add_f32 v[68:69], v[68:69], v[6:7]
    v_pk_add_f32 v[70:71], v[70:71], v[6:7]
    v_pk_add_f32 v[72:73], v[72:73], v[6:7]
    v_pk_add_f32 v[74:75], v[74:75], v[6:7]
    v_pk_add_f32 v[76:77], v[76:77], v[6:7]
    v_pk_add_f32 v[78:79], v[78:79], v[6:7]
    v_pk_add_f32 v[80:81], v[80:81], v[6:7]
    v_pk_add_f32 v[82:83], v[82:83], v[6:7]
    v_pk_add_f32 v[84:85], v[84:85], v[6:7]
    v_pk_add_f32 v[86:87], v[86:87], v[6:7]
    v_pk_add_f32 v[88:89], v[88:89], v[6:7]
    v_pk_add_f32 v[90:91], v[90:91], v[6:7]
    v_pk_add_f32 v[92:93], v[92:93], v[6:7]
    v_pk_add_f32 v[94:95], v[94:95], v[6:7]
    v_pk_add_f32 v[96:97], v[96:97], v[6:7]
    v_pk_add_f32 v[98:99], v[98:99], v[6:7]
    v_pk_add_f32 v[100:101], v[100:101], v[6:7]
    v_pk_add_f32 v[102:103], v[102:103], v[6:7]
    v_pk_add_f32 v[104:105], v[104:105], v[6:7]
    v_pk_add_f32 v[106:107], v[106:107], v[6:7]
    v_pk_add_f32 v[108:109], v[108:109], v[6:7]
    v_pk_add_f32 v[110:111], v[110:111], v[6:7]
    v_pk_add_f32 v[112:113], v[112:113], v[6:7]
    v_pk_add_f32 v[114:115], v[114:115], v[6:7]
    v_pk_add_f32 v[116:117], v[116:117], v[6:7]
    v_pk_add_f32 v[118:119], v[118:119], v[6:7]
    v_pk_add_f32 v[120:121], v[120:121], v[6:7]
    v_pk_add_f32 v[122:123], v[122:123], v[6:7]
    v_pk_add_f32 v[124:125], v[124:125], v[6:7]
    v_pk_add_f32 v[126:127], v[126:127], v[6:7]
    v_pk_add_f32 v[128:129], v[128:129], v[6:7]
    v_pk_add_f32 v[130:131], v[130:131], v[6:7]
    v_pk_mul_f32 v[4:5], v[60:61], v[60:61]
    v_pk_mul_f32 v[6:7], v[62:63], v[62:63]
    v_pk_fma_f32 v[4:5], v[64:65], v[64:65], v[4:5]
    v_pk_fma_f32 v[6:7], v[66:67], v[66:67], v[6:7]
    v_pk_fma_f32 v[4:5], v[68:69], v[68:69], v[4:5]
    v_pk_fma_f32 v[6:7], v[70:71], v[70:71], v[6:7]
    v_pk_fma_f32 v[4:5], v[72:73], v[72:73], v[4:5]
    v_pk_fma_f32 v[6:7], v[74:75], v[74:75], v[6:7]
    v_pk_fma_f32 v[4:5], v[76:77], v[76:77], v[4:5]
    v_pk_fma_f32 v[6:7], v[78:79], v[78:79], v[6:7]
    v_pk_fma_f32 v[4:5], v[80:81], v[80:81], v[4:5]
    v_pk_fma_f32 v[6:7], v[82:83], v[82:83], v[6:7]
    v_pk_fma_f32 v[4:5], v[84:85], v[84:85], v[4:5]
    v_pk_fma_f32 v[6:7], v[86:87], v[86:87], v[6:7]
    v_pk_fma_f32 v[4:5], v[88:89], v[88:89], v[4:5]
    v_pk_fma_f32 v[6:7], v[90:91], v[90:91], v[6:7]
    v_pk_fma_f32 v[4:5], v[92:93], v[92:93], v[4:5]
    v_pk_fma_f32 v[6:7], v[94:95], v[94:95], v[6:7]
    v_pk_fma_f32 v[4:5], v[96:97], v[96:97], v[4:5]
    v_pk_fma_f32 v[6:7], v[98:99], v[98:99], v[6:7]
    v_pk_fma_f32 v[4:5], v[100:101], v[100:101], v[4:5]
    v_pk_fma_f32 v[6:7], v[102:103], v[102:103], v[6:7]
    v_pk_fma_f32 v[4:5], v[104:105], v[104:105], v[4:5]
    v_pk_fma_f32 v[6:7], v[106:107], v[106:107], v[6:7]
    v_pk_fma_f32 v[4:5], v[108:109], v[108:109], v[4:5]
    v_pk_fma_f32 v[6:7], v[110:111], v[110:111], v[6:7]
    v_pk_fma_f32 v[4:5], v[112:113], v[112:113], v[4:5]
    v_pk_fma_f32 v[6:7], v[114:115], v[114:115], v[6:7]
    v_pk_fma_f32 v[4:5], v[116:117], v[116:117], v[4:5]
    v_pk_fma_f32 v[6:7], v[118:119], v[118:119], v[6:7]
    v_pk_fma_f32 v[4:5], v[120:121], v[120:121], v[4:5]
    v_pk_fma_f32 v[6:7], v[122:123], v[122:123], v[6:7]
    v_pk_fma_f32 v[4:5], v[124:125], v[124:125], v[4:5]
    v_pk_fma_f32 v[6:7], v[126:127], v[126:127], v[6:7]
    v_pk_fma_f32 v[4:5], v[128:129], v[128:129], v[4:5]
    v_pk_fma_f32 v[6:7], v[130:131], v[130:131], v[6:7]
    v_pk_add_f32 v[4:5], v[4:5], v[6:7]
    v_add_f32 v4, v4, v5
    s_nop 1
    v_add_f32_dpp v4, v4, v4 quad_perm:[1,0,3,2] row_mask:0xf bank_mask:0xf
    s_nop 1
    v_add_f32_dpp v4, v4, v4 quad_perm:[2,3,0,1] row_mask:0xf bank_mask:0xf
    s_nop 1
    v_add_f32_dpp v4, v4, v4 row_half_mirror row_mask:0xf bank_mask:0xf
    v_mul_f32 v4, s35, v4
    v_mov_b32 v5, v3
    v_cvt_pk_bf16_f32 v3, v3, v3
    v_lshlrev_b32 v3, 16, v3
    v_cvt_pk_bf16_f32 v4, v4, v4
    v_lshlrev_b32 v4, 16, v4
    v_add_f32 v4, 0x3727c5ac, v4
    v_cvt_pk_bf16_f32 v4, v4, v4
    v_lshlrev_b32 v4, 16, v4
    v_sqrt_f32 v4, v4
    s_nop 0
    v_cvt_pk_bf16_f32 v4, v4, v4
    v_lshlrev_b32 v4, 16, v4
    v_rcp_f32 v4, v4
    s_nop 0
    v_sub_f32 v3, v5, v3
    v_mul_f32 v6, v3, v4
    v_mov_b32 v7, v6
    v_mov_b32 v5, v4
    v_pk_fma_f32 v[60:61], v[60:61], v[4:5], v[6:7]
    v_pk_fma_f32 v[62:63], v[62:63], v[4:5], v[6:7]
    v_pk_fma_f32 v[64:65], v[64:65], v[4:5], v[6:7]
    v_pk_fma_f32 v[66:67], v[66:67], v[4:5], v[6:7]
    v_cvt_pk_bf16_f32 v148, v60, v61
    v_cvt_pk_bf16_f32 v149, v62, v63
    v_cvt_pk_bf16_f32 v150, v64, v65
    v_cvt_pk_bf16_f32 v151, v66, v67
    ds_write_b64 v18, v[148:149] offset:0
    ds_write_b64 v18, v[150:151] offset:256
    buffer_load_dwordx4 v[220:223], v14, s[36:39], s33 offen offset:0
    v_pk_fma_f32 v[68:69], v[68:69], v[4:5], v[6:7]
    v_pk_fma_f32 v[70:71], v[70:71], v[4:5], v[6:7]
    v_pk_fma_f32 v[72:73], v[72:73], v[4:5], v[6:7]
    v_pk_fma_f32 v[74:75], v[74:75], v[4:5], v[6:7]
    v_cvt_pk_bf16_f32 v152, v68, v69
    v_cvt_pk_bf16_f32 v153, v70, v71
    v_cvt_pk_bf16_f32 v154, v72, v73
    v_cvt_pk_bf16_f32 v155, v74, v75
    ds_write_b64 v18, v[152:153] offset:2048
    ds_write_b64 v18, v[154:155] offset:2304
    buffer_load_dwordx4 v[224:227], v14, s[36:39], s33 offen offset:128
    v_pk_fma_f32 v[76:77], v[76:77], v[4:5], v[6:7]
    v_pk_fma_f32 v[78:79], v[78:79], v[4:5], v[6:7]
    v_pk_fma_f32 v[80:81], v[80:81], v[4:5], v[6:7]
    v_pk_fma_f32 v[82:83], v[82:83], v[4:5], v[6:7]
    v_cvt_pk_bf16_f32 v156, v76, v77
    v_cvt_pk_bf16_f32 v157, v78, v79
    v_cvt_pk_bf16_f32 v158, v80, v81
    v_cvt_pk_bf16_f32 v159, v82, v83
    ds_write_b64 v18, v[156:157] offset:4096
    ds_write_b64 v18, v[158:159] offset:4352
    buffer_load_dwordx4 v[228:231], v14, s[36:39], s33 offen offset:256
    v_pk_fma_f32 v[84:85], v[84:85], v[4:5], v[6:7]
    v_pk_fma_f32 v[86:87], v[86:87], v[4:5], v[6:7]
    v_pk_fma_f32 v[88:89], v[88:89], v[4:5], v[6:7]
    v_pk_fma_f32 v[90:91], v[90:91], v[4:5], v[6:7]
    v_cvt_pk_bf16_f32 v160, v84, v85
    v_cvt_pk_bf16_f32 v161, v86, v87
    v_cvt_pk_bf16_f32 v162, v88, v89
    v_cvt_pk_bf16_f32 v163, v90, v91
    ds_write_b64 v18, v[160:161] offset:6144
    ds_write_b64 v18, v[162:163] offset:6400
    buffer_load_dwordx4 v[232:235], v14, s[36:39], s33 offen offset:384
    v_pk_fma_f32 v[92:93], v[92:93], v[4:5], v[6:7]
    v_pk_fma_f32 v[94:95], v[94:95], v[4:5], v[6:7]
    v_pk_fma_f32 v[96:97], v[96:97], v[4:5], v[6:7]
    v_pk_fma_f32 v[98:99], v[98:99], v[4:5], v[6:7]
    v_cvt_pk_bf16_f32 v164, v92, v93
    v_cvt_pk_bf16_f32 v165, v94, v95
    v_cvt_pk_bf16_f32 v166, v96, v97
    v_cvt_pk_bf16_f32 v167, v98, v99
    ds_write_b64 v18, v[164:165] offset:8192
    ds_write_b64 v18, v[166:167] offset:8448
    buffer_load_dwordx4 v[236:239], v14, s[36:39], s33 offen offset:512
    v_pk_fma_f32 v[100:101], v[100:101], v[4:5], v[6:7]
    v_pk_fma_f32 v[102:103], v[102:103], v[4:5], v[6:7]
    v_pk_fma_f32 v[104:105], v[104:105], v[4:5], v[6:7]
    v_pk_fma_f32 v[106:107], v[106:107], v[4:5], v[6:7]
    v_cvt_pk_bf16_f32 v168, v100, v101
    v_cvt_pk_bf16_f32 v169, v102, v103
    v_cvt_pk_bf16_f32 v170, v104, v105
    v_cvt_pk_bf16_f32 v171, v106, v107
    ds_write_b64 v18, v[168:169] offset:10240
    ds_write_b64 v18, v[170:171] offset:10496
    buffer_load_dwordx4 v[240:243], v14, s[36:39], s33 offen offset:640
    v_pk_fma_f32 v[108:109], v[108:109], v[4:5], v[6:7]
    v_pk_fma_f32 v[110:111], v[110:111], v[4:5], v[6:7]
    v_pk_fma_f32 v[112:113], v[112:113], v[4:5], v[6:7]
    v_pk_fma_f32 v[114:115], v[114:115], v[4:5], v[6:7]
    v_cvt_pk_bf16_f32 v172, v108, v109
    v_cvt_pk_bf16_f32 v173, v110, v111
    v_cvt_pk_bf16_f32 v174, v112, v113
    v_cvt_pk_bf16_f32 v175, v114, v115
    ds_write_b64 v18, v[172:173] offset:12288
    ds_write_b64 v18, v[174:175] offset:12544
    buffer_load_dwordx4 v[244:247], v14, s[36:39], s33 offen offset:768
    v_pk_fma_f32 v[116:117], v[116:117], v[4:5], v[6:7]
    v_pk_fma_f32 v[118:119], v[118:119], v[4:5], v[6:7]
    v_pk_fma_f32 v[120:121], v[120:121], v[4:5], v[6:7]
    v_pk_fma_f32 v[122:123], v[122:123], v[4:5], v[6:7]
    v_cvt_pk_bf16_f32 v176, v116, v117
    v_cvt_pk_bf16_f32 v177, v118, v119
    v_cvt_pk_bf16_f32 v178, v120, v121
    v_cvt_pk_bf16_f32 v179, v122, v123
    ds_write_b64 v18, v[176:177] offset:14336
    ds_write_b64 v18, v[178:179] offset:14592
    buffer_load_dwordx4 v[248:251], v14, s[36:39], s33 offen offset:896
    v_pk_fma_f32 v[124:125], v[124:125], v[4:5], v[6:7]
    v_pk_fma_f32 v[126:127], v[126:127], v[4:5], v[6:7]
    v_pk_fma_f32 v[128:129], v[128:129], v[4:5], v[6:7]
    v_pk_fma_f32 v[130:131], v[130:131], v[4:5], v[6:7]
    v_cvt_pk_bf16_f32 v180, v124, v125
    v_cvt_pk_bf16_f32 v181, v126, v127
    v_cvt_pk_bf16_f32 v182, v128, v129
    v_cvt_pk_bf16_f32 v183, v130, v131
    ds_write_b64 v18, v[180:181] offset:16384
    ds_write_b64 v18, v[182:183] offset:16640
    buffer_load_dwordx4 v[252:255], v14, s[36:39], s33 offen offset:1024
    v_add_u32 v19, 36864, v18
    s_waitcnt vmcnt(9)
    v_lshlrev_b32 v60, 16, v184
    v_and_b32 v61, s34, v184
    v_lshlrev_b32 v62, 16, v185
    v_and_b32 v63, s34, v185
    v_lshlrev_b32 v64, 16, v186
    v_and_b32 v65, s34, v186
    v_lshlrev_b32 v66, 16, v187
    v_and_b32 v67, s34, v187
    v_lshlrev_b32 v68, 16, v188
    v_and_b32 v69, s34, v188
    v_lshlrev_b32 v70, 16, v189
    v_and_b32 v71, s34, v189
    v_lshlrev_b32 v72, 16, v190
    v_and_b32 v73, s34, v190
    v_lshlrev_b32 v74, 16, v191
    v_and_b32 v75, s34, v191
    v_lshlrev_b32 v76, 16, v192
    v_and_b32 v77, s34, v192
    v_lshlrev_b32 v78, 16, v193
    v_and_b32 v79, s34, v193
    v_lshlrev_b32 v80, 16, v194
    v_and_b32 v81, s34, v194
    v_lshlrev_b32 v82, 16, v195
    v_and_b32 v83, s34, v195
    v_lshlrev_b32 v84, 16, v196
    v_and_b32 v85, s34, v196
    v_lshlrev_b32 v86, 16, v197
    v_and_b32 v87, s34, v197
    v_lshlrev_b32 v88, 16, v198
    v_and_b32 v89, s34, v198
    v_lshlrev_b32 v90, 16, v199
    v_and_b32 v91, s34, v199
    v_lshlrev_b32 v92, 16, v200
    v_and_b32 v93, s34, v200
    v_lshlrev_b32 v94, 16, v201
    v_and_b32 v95, s34, v201
    v_lshlrev_b32 v96, 16, v202
    v_and_b32 v97, s34, v202
    v_lshlrev_b32 v98, 16, v203
    v_and_b32 v99, s34, v203
    v_lshlrev_b32 v100, 16, v204
    v_and_b32 v101, s34, v204
    v_lshlrev_b32 v102, 16, v205
    v_and_b32 v103, s34, v205
    v_lshlrev_b32 v104, 16, v206
    v_and_b32 v105, s34, v206
    v_lshlrev_b32 v106, 16, v207
    v_and_b32 v107, s34, v207
    v_lshlrev_b32 v108, 16, v208
    v_and_b32 v109, s34, v208
    v_lshlrev_b32 v110, 16, v209
    v_and_b32 v111, s34, v209
    v_lshlrev_b32 v112, 16, v210
    v_and_b32 v113, s34, v210
    v_lshlrev_b32 v114, 16, v211
    v_and_b32 v115, s34, v211
    v_lshlrev_b32 v116, 16, v212
    v_and_b32 v117, s34, v212
    v_lshlrev_b32 v118, 16, v213
    v_and_b32 v119, s34, v213
    v_lshlrev_b32 v120, 16, v214
    v_and_b32 v121, s34, v214
    v_lshlrev_b32 v122, 16, v215
    v_and_b32 v123, s34, v215
    v_lshlrev_b32 v124, 16, v216
    v_and_b32 v125, s34, v216
    v_lshlrev_b32 v126, 16, v217
    v_and_b32 v127, s34, v217
    v_lshlrev_b32 v128, 16, v218
    v_and_b32 v129, s34, v218
    v_lshlrev_b32 v130, 16, v219
    v_and_b32 v131, s34, v219
    v_pk_add_f32 v[4:5], v[60:61], v[62:63]
    v_pk_add_f32 v[6:7], v[64:65], v[66:67]
    v_pk_add_f32 v[4:5], v[4:5], v[68:69]
    v_pk_add_f32 v[6:7], v[6:7], v[70:71]
    v_pk_add_f32 v[4:5], v[4:5], v[72:73]
    v_pk_add_f32 v[6:7], v[6:7], v[74:75]
    v_pk_add_f32 v[4:5], v[4:5], v[76:77]
    v_pk_add_f32 v[6:7], v[6:7], v[78:79]
    v_pk_add_f32 v[4:5], v[4:5], v[80:81]
    v_pk_add_f32 v[6:7], v[6:7], v[82:83]
    v_pk_add_f32 v[4:5], v[4:5], v[84:85]
    v_pk_add_f32 v[6:7], v[6:7], v[86:87]
    v_pk_add_f32 v[4:5], v[4:5], v[88:89]
    v_pk_add_f32 v[6:7], v[6:7], v[90:91]
    v_pk_add_f32 v[4:5], v[4:5], v[92:93]
    v_pk_add_f32 v[6:7], v[6:7], v[94:95]
    v_pk_add_f32 v[4:5], v[4:5], v[96:97]
    v_pk_add_f32 v[6:7], v[6:7], v[98:99]
    v_pk_add_f32 v[4:5], v[4:5], v[100:101]
    v_pk_add_f32 v[6:7], v[6:7], v[102:103]
    v_pk_add_f32 v[4:5], v[4:5], v[104:105]
    v_pk_add_f32 v[6:7], v[6:7], v[106:107]
    v_pk_add_f32 v[4:5], v[4:5], v[108:109]
    v_pk_add_f32 v[6:7], v[6:7], v[110:111]
    v_pk_add_f32 v[4:5], v[4:5], v[112:113]
    v_pk_add_f32 v[6:7], v[6:7], v[114:115]
    v_pk_add_f32 v[4:5], v[4:5], v[116:117]
    v_pk_add_f32 v[6:7], v[6:7], v[118:119]
    v_pk_add_f32 v[4:5], v[4:5], v[120:121]
    v_pk_add_f32 v[6:7], v[6:7], v[122:123]
    v_pk_add_f32 v[4:5], v[4:5], v[124:125]
    v_pk_add_f32 v[6:7], v[6:7], v[126:127]
    v_pk_add_f32 v[4:5], v[4:5], v[128:129]
    v_pk_add_f32 v[6:7], v[6:7], v[130:131]
    v_pk_add_f32 v[4:5], v[4:5], v[6:7]
    v_add_f32 v3, v4, v5
    s_nop 1
    v_add_f32_dpp v3, v3, v3 quad_perm:[1,0,3,2] row_mask:0xf bank_mask:0xf
    s_nop 1
    v_add_f32_dpp v3, v3, v3 quad_perm:[2,3,0,1] row_mask:0xf bank_mask:0xf
    s_nop 1
    v_add_f32_dpp v3, v3, v3 row_half_mirror row_mask:0xf bank_mask:0xf
    v_mul_f32 v3, s35, v3
    v_sub_f32 v6, 0, v3
    v_sub_f32 v7, 0, v3
    v_pk_add_f32 v[60:61], v[60:61], v[6:7]
    v_pk_add_f32 v[62:63], v[62:63], v[6:7]
    v_pk_add_f32 v[64:65], v[64:65], v[6:7]
    v_pk_add_f32 v[66:67], v[66:67], v[6:7]
    v_pk_add_f32 v[68:69], v[68:69], v[6:7]
    v_pk_add_f32 v[70:71], v[70:71], v[6:7]
    v_pk_add_f32 v[72:73], v[72:73], v[6:7]
    v_pk_add_f32 v[74:75], v[74:75], v[6:7]
    v_pk_add_f32 v[76:77], v[76:77], v[6:7]
    v_pk_add_f32 v[78:79], v[78:79], v[6:7]
    v_pk_add_f32 v[80:81], v[80:81], v[6:7]
    v_pk_add_f32 v[82:83], v[82:83], v[6:7]
    v_pk_add_f32 v[84:85], v[84:85], v[6:7]
    v_pk_add_f32 v[86:87], v[86:87], v[6:7]
    v_pk_add_f32 v[88:89], v[88:89], v[6:7]
    v_pk_add_f32 v[90:91], v[90:91], v[6:7]
    v_pk_add_f32 v[92:93], v[92:93], v[6:7]
    v_pk_add_f32 v[94:95], v[94:95], v[6:7]
    v_pk_add_f32 v[96:97], v[96:97], v[6:7]
    v_pk_add_f32 v[98:99], v[98:99], v[6:7]
    v_pk_add_f32 v[100:101], v[100:101], v[6:7]
    v_pk_add_f32 v[102:103], v[102:103], v[6:7]
    v_pk_add_f32 v[104:105], v[104:105], v[6:7]
    v_pk_add_f32 v[106:107], v[106:107], v[6:7]
    v_pk_add_f32 v[108:109], v[108:109], v[6:7]
    v_pk_add_f32 v[110:111], v[110:111], v[6:7]
    v_pk_add_f32 v[112:113], v[112:113], v[6:7]
    v_pk_add_f32 v[114:115], v[114:115], v[6:7]
    v_pk_add_f32 v[116:117], v[116:117], v[6:7]
    v_pk_add_f32 v[118:119], v[118:119], v[6:7]
    v_pk_add_f32 v[120:121], v[120:121], v[6:7]
    v_pk_add_f32 v[122:123], v[122:123], v[6:7]
    v_pk_add_f32 v[124:125], v[124:125], v[6:7]
    v_pk_add_f32 v[126:127], v[126:127], v[6:7]
    v_pk_add_f32 v[128:129], v[128:129], v[6:7]
    v_pk_add_f32 v[130:131], v[130:131], v[6:7]
    v_pk_mul_f32 v[4:5], v[60:61], v[60:61]
    v_pk_mul_f32 v[6:7], v[62:63], v[62:63]
    v_pk_fma_f32 v[4:5], v[64:65], v[64:65], v[4:5]
    v_pk_fma_f32 v[6:7], v[66:67], v[66:67], v[6:7]
    v_pk_fma_f32 v[4:5], v[68:69], v[68:69], v[4:5]
    v_pk_fma_f32 v[6:7], v[70:71], v[70:71], v[6:7]
    v_pk_fma_f32 v[4:5], v[72:73], v[72:73], v[4:5]
    v_pk_fma_f32 v[6:7], v[74:75], v[74:75], v[6:7]
    v_pk_fma_f32 v[4:5], v[76:77], v[76:77], v[4:5]
    v_pk_fma_f32 v[6:7], v[78:79], v[78:79], v[6:7]
    v_pk_fma_f32 v[4:5], v[80:81], v[80:81], v[4:5]
    v_pk_fma_f32 v[6:7], v[82:83], v[82:83], v[6:7]
    v_pk_fma_f32 v[4:5], v[84:85], v[84:85], v[4:5]
    v_pk_fma_f32 v[6:7], v[86:87], v[86:87], v[6:7]
    v_pk_fma_f32 v[4:5], v[88:89], v[88:89], v[4:5]
    v_pk_fma_f32 v[6:7], v[90:91], v[90:91], v[6:7]
    v_pk_fma_f32 v[4:5], v[92:93], v[92:93], v[4:5]
    v_pk_fma_f32 v[6:7], v[94:95], v[94:95], v[6:7]
    v_pk_fma_f32 v[4:5], v[96:97], v[96:97], v[4:5]
    v_pk_fma_f32 v[6:7], v[98:99], v[98:99], v[6:7]
    v_pk_fma_f32 v[4:5], v[100:101], v[100:101], v[4:5]
    v_pk_fma_f32 v[6:7], v[102:103], v[102:103], v[6:7]
    v_pk_fma_f32 v[4:5], v[104:105], v[104:105], v[4:5]
    v_pk_fma_f32 v[6:7], v[106:107], v[106:107], v[6:7]
    v_pk_fma_f32 v[4:5], v[108:109], v[108:109], v[4:5]
    v_pk_fma_f32 v[6:7], v[110:111], v[110:111], v[6:7]
    v_pk_fma_f32 v[4:5], v[112:113], v[112:113], v[4:5]
    v_pk_fma_f32 v[6:7], v[114:115], v[114:115], v[6:7]
    v_pk_fma_f32 v[4:5], v[116:117], v[116:117], v[4:5]
    v_pk_fma_f32 v[6:7], v[118:119], v[118:119], v[6:7]
    v_pk_fma_f32 v[4:5], v[120:121], v[120:121], v[4:5]
    v_pk_fma_f32 v[6:7], v[122:123], v[122:123], v[6:7]
    v_pk_fma_f32 v[4:5], v[124:125], v[124:125], v[4:5]
    v_pk_fma_f32 v[6:7], v[126:127], v[126:127], v[6:7]
    v_pk_fma_f32 v[4:5], v[128:129], v[128:129], v[4:5]
    v_pk_fma_f32 v[6:7], v[130:131], v[130:131], v[6:7]
    v_pk_add_f32 v[4:5], v[4:5], v[6:7]
    v_add_f32 v4, v4, v5
    s_nop 1
    v_add_f32_dpp v4, v4, v4 quad_perm:[1,0,3,2] row_mask:0xf bank_mask:0xf
    s_nop 1
    v_add_f32_dpp v4, v4, v4 quad_perm:[2,3,0,1] row_mask:0xf bank_mask:0xf
    s_nop 1
    v_add_f32_dpp v4, v4, v4 row_half_mirror row_mask:0xf bank_mask:0xf
    v_mul_f32 v4, s35, v4
    v_mov_b32 v5, v3
    v_cvt_pk_bf16_f32 v3, v3, v3
    v_lshlrev_b32 v3, 16, v3
    v_cvt_pk_bf16_f32 v4, v4, v4
    v_lshlrev_b32 v4, 16, v4
    v_add_f32 v4, 0x3727c5ac, v4
    v_cvt_pk_bf16_f32 v4, v4, v4
    v_lshlrev_b32 v4, 16, v4
    v_sqrt_f32 v4, v4
    s_nop 0
    v_cvt_pk_bf16_f32 v4, v4, v4
    v_lshlrev_b32 v4, 16, v4
    v_rcp_f32 v4, v4
    s_nop 0
    v_sub_f32 v3, v5, v3
    v_mul_f32 v6, v3, v4
    v_mov_b32 v7, v6
    v_mov_b32 v5, v4
    v_pk_fma_f32 v[60:61], v[60:61], v[4:5], v[6:7]
    v_pk_fma_f32 v[62:63], v[62:63], v[4:5], v[6:7]
    v_pk_fma_f32 v[64:65], v[64:65], v[4:5], v[6:7]
    v_pk_fma_f32 v[66:67], v[66:67], v[4:5], v[6:7]
    v_cvt_pk_bf16_f32 v184, v60, v61
    v_cvt_pk_bf16_f32 v185, v62, v63
    v_cvt_pk_bf16_f32 v186, v64, v65
    v_cvt_pk_bf16_f32 v187, v66, v67
    ds_write_b64 v19, v[184:185] offset:0
    ds_write_b64 v19, v[186:187] offset:256
    s_add_u32 m0, s40, 0
    s_mov_b32 s25, 0
    buffer_load_dwordx4 v8, s[12:15], s25 offen lds
    s_add_u32 m0, s41, 0
    s_mov_b32 s25, 0
    buffer_load_dwordx4 v9, s[12:15], s25 offen lds
    v_pk_fma_f32 v[68:69], v[68:69], v[4:5], v[6:7]
    v_pk_fma_f32 v[70:71], v[70:71], v[4:5], v[6:7]
    v_pk_fma_f32 v[72:73], v[72:73], v[4:5], v[6:7]
    v_pk_fma_f32 v[74:75], v[74:75], v[4:5], v[6:7]
    v_cvt_pk_bf16_f32 v188, v68, v69
    v_cvt_pk_bf16_f32 v189, v70, v71
    v_cvt_pk_bf16_f32 v190, v72, v73
    v_cvt_pk_bf16_f32 v191, v74, v75
    ds_write_b64 v19, v[188:189] offset:2048
    ds_write_b64 v19, v[190:191] offset:2304
    s_add_u32 m0, s42, 0
    s_mov_b32 s25, 0
    buffer_load_dwordx4 v10, s[12:15], s25 offen lds
    s_add_u32 m0, s43, 0
    s_mov_b32 s25, 0
    buffer_load_dwordx4 v11, s[12:15], s25 offen lds
    v_pk_fma_f32 v[76:77], v[76:77], v[4:5], v[6:7]
    v_pk_fma_f32 v[78:79], v[78:79], v[4:5], v[6:7]
    v_pk_fma_f32 v[80:81], v[80:81], v[4:5], v[6:7]
    v_pk_fma_f32 v[82:83], v[82:83], v[4:5], v[6:7]
    v_cvt_pk_bf16_f32 v192, v76, v77
    v_cvt_pk_bf16_f32 v193, v78, v79
    v_cvt_pk_bf16_f32 v194, v80, v81
    v_cvt_pk_bf16_f32 v195, v82, v83
    ds_write_b64 v19, v[192:193] offset:4096
    ds_write_b64 v19, v[194:195] offset:4352
    v_add_u32 v56, 0, v2
    v_min_u32 v56, 1943, v56
    v_mul_lo_u32 v57, v56, s46
    v_lshrrev_b32 v57, 20, v57
    v_mul_u32_u24 v58, 27, v57
    v_sub_u32 v58, v56, v58
    v_mul_u32_u24 v59, 57, v58
    v_lshrrev_b32 v59, 9, v59
    v_mul_u32_u24 v56, 9, v59
    v_sub_u32 v58, v58, v56
    v_mul_u32_u24 v57, 3456, v57
    v_mul_u32_u24 v59, 1152, v59
    v_lshlrev_b32 v58, 4, v58
    v_add3_u32 v56, v57, v59, v58
    buffer_load_dwordx4 v[132:135], v56, s[12:15], s47 offen
    v_add_u32 v56, 256, v2
    v_min_u32 v56, 1943, v56
    v_mul_lo_u32 v57, v56, s46
    v_lshrrev_b32 v57, 20, v57
    v_mul_u32_u24 v58, 27, v57
    v_sub_u32 v58, v56, v58
    v_mul_u32_u24 v59, 57, v58
    v_lshrrev_b32 v59, 9, v59
    v_mul_u32_u24 v56, 9, v59
    v_sub_u32 v58, v58, v56
    v_mul_u32_u24 v57, 3456, v57
    v_mul_u32_u24 v59, 1152, v59
    v_lshlrev_b32 v58, 4, v58
    v_add3_u32 v56, v57, v59, v58
    buffer_load_dwordx4 v[132:135], v56, s[12:15], s47 offen
    v_pk_fma_f32 v[84:85], v[84:85], v[4:5], v[6:7]
    v_pk_fma_f32 v[86:87], v[86:87], v[4:5], v[6:7]
    v_pk_fma_f32 v[88:89], v[88:89], v[4:5], v[6:7]
    v_pk_fma_f32 v[90:91], v[90:91], v[4:5], v[6:7]
    v_cvt_pk_bf16_f32 v196, v84, v85
    v_cvt_pk_bf16_f32 v197, v86, v87
    v_cvt_pk_bf16_f32 v198, v88, v89
    v_cvt_pk_bf16_f32 v199, v90, v91
    ds_write_b64 v19, v[196:197] offset:6144
    ds_write_b64 v19, v[198:199] offset:6400
    v_add_u32 v56, 512, v2
    v_min_u32 v56, 1943, v56
    v_mul_lo_u32 v57, v56, s46
    v_lshrrev_b32 v57, 20, v57
    v_mul_u32_u24 v58, 27, v57
    v_sub_u32 v58, v56, v58
    v_mul_u32_u24 v59, 57, v58
    v_lshrrev_b32 v59, 9, v59
    v_mul_u32_u24 v56, 9, v59
    v_sub_u32 v58, v58, v56
    v_mul_u32_u24 v57, 3456, v57
    v_mul_u32_u24 v59, 1152, v59
    v_lshlrev_b32 v58, 4, v58
    v_add3_u32 v56, v57, v59, v58
    buffer_load_dwordx4 v[132:135], v56, s[12:15], s47 offen
    v_add_u32 v56, 768, v2
    v_min_u32 v56, 1943, v56
    v_mul_lo_u32 v57, v56, s46
    v_lshrrev_b32 v57, 20, v57
    v_mul_u32_u24 v58, 27, v57
    v_sub_u32 v58, v56, v58
    v_mul_u32_u24 v59, 57, v58
    v_lshrrev_b32 v59, 9, v59
    v_mul_u32_u24 v56, 9, v59
    v_sub_u32 v58, v58, v56
    v_mul_u32_u24 v57, 3456, v57
    v_mul_u32_u24 v59, 1152, v59
    v_lshlrev_b32 v58, 4, v58
    v_add3_u32 v56, v57, v59, v58
    buffer_load_dwordx4 v[132:135], v56, s[12:15], s47 offen
    v_pk_fma_f32 v[92:93], v[92:93], v[4:5], v[6:7]
    v_pk_fma_f32 v[94:95], v[94:95], v[4:5], v[6:7]
    v_pk_fma_f32 v[96:97], v[96:97], v[4:5], v[6:7]
    v_pk_fma_f32 v[98:99], v[98:99], v[4:5], v[6:7]
    v_cvt_pk_bf16_f32 v200, v92, v93
    v_cvt_pk_bf16_f32 v201, v94, v95
    v_cvt_pk_bf16_f32 v202, v96, v97
    v_cvt_pk_bf16_f32 v203, v98, v99
    ds_write_b64 v19, v[200:201] offset:8192
    ds_write_b64 v19, v[202:203] offset:8448
    v_add_u32 v56, 1024, v2
    v_min_u32 v56, 1943, v56
    v_mul_lo_u32 v57, v56, s46
    v_lshrrev_b32 v57, 20, v57
    v_mul_u32_u24 v58, 27, v57
    v_sub_u32 v58, v56, v58
    v_mul_u32_u24 v59, 57, v58
    v_lshrrev_b32 v59, 9, v59
    v_mul_u32_u24 v56, 9, v59
    v_sub_u32 v58, v58, v56
    v_mul_u32_u24 v57, 3456, v57
    v_mul_u32_u24 v59, 1152, v59
    v_lshlrev_b32 v58, 4, v58
    v_add3_u32 v56, v57, v59, v58
    buffer_load_dwordx4 v[132:135], v56, s[12:15], s47 offen
    v_add_u32 v56, 1280, v2
    v_min_u32 v56, 1943, v56
    v_mul_lo_u32 v57, v56, s46
    v_lshrrev_b32 v57, 20, v57
    v_mul_u32_u24 v58, 27, v57
    v_sub_u32 v58, v56, v58
    v_mul_u32_u24 v59, 57, v58
    v_lshrrev_b32 v59, 9, v59
    v_mul_u32_u24 v56, 9, v59
    v_sub_u32 v58, v58, v56
    v_mul_u32_u24 v57, 3456, v57
    v_mul_u32_u24 v59, 1152, v59
    v_lshlrev_b32 v58, 4, v58
    v_add3_u32 v56, v57, v59, v58
    buffer_load_dwordx4 v[132:135], v56, s[12:15], s47 offen
    v_pk_fma_f32 v[100:101], v[100:101], v[4:5], v[6:7]
    v_pk_fma_f32 v[102:103], v[102:103], v[4:5], v[6:7]
    v_pk_fma_f32 v[104:105], v[104:105], v[4:5], v[6:7]
    v_pk_fma_f32 v[106:107], v[106:107], v[4:5], v[6:7]
    v_cvt_pk_bf16_f32 v204, v100, v101
    v_cvt_pk_bf16_f32 v205, v102, v103
    v_cvt_pk_bf16_f32 v206, v104, v105
    v_cvt_pk_bf16_f32 v207, v106, v107
    ds_write_b64 v19, v[204:205] offset:10240
    ds_write_b64 v19, v[206:207] offset:10496
    v_add_u32 v56, 1536, v2
    v_min_u32 v56, 1943, v56
    v_mul_lo_u32 v57, v56, s46
    v_lshrrev_b32 v57, 20, v57
    v_mul_u32_u24 v58, 27, v57
    v_sub_u32 v58, v56, v58
    v_mul_u32_u24 v59, 57, v58
    v_lshrrev_b32 v59, 9, v59
    v_mul_u32_u24 v56, 9, v59
    v_sub_u32 v58, v58, v56
    v_mul_u32_u24 v57, 3456, v57
    v_mul_u32_u24 v59, 1152, v59
    v_lshlrev_b32 v58, 4, v58
    v_add3_u32 v56, v57, v59, v58
    buffer_load_dwordx4 v[132:135], v56, s[12:15], s47 offen
    v_add_u32 v56, 1792, v2
    v_min_u32 v56, 1943, v56
    v_mul_lo_u32 v57, v56, s46
    v_lshrrev_b32 v57, 20, v57
    v_mul_u32_u24 v58, 27, v57
    v_sub_u32 v58, v56, v58
    v_mul_u32_u24 v59, 57, v58
    v_lshrrev_b32 v59, 9, v59
    v_mul_u32_u24 v56, 9, v59
    v_sub_u32 v58, v58, v56
    v_mul_u32_u24 v57, 3456, v57
    v_mul_u32_u24 v59, 1152, v59
    v_lshlrev_b32 v58, 4, v58
    v_add3_u32 v56, v57, v59, v58
    buffer_load_dwordx4 v[132:135], v56, s[12:15], s47 offen
    v_pk_fma_f32 v[108:109], v[108:109], v[4:5], v[6:7]
    v_pk_fma_f32 v[110:111], v[110:111], v[4:5], v[6:7]
    v_pk_fma_f32 v[112:113], v[112:113], v[4:5], v[6:7]
    v_pk_fma_f32 v[114:115], v[114:115], v[4:5], v[6:7]
    v_cvt_pk_bf16_f32 v208, v108, v109
    v_cvt_pk_bf16_f32 v209, v110, v111
    v_cvt_pk_bf16_f32 v210, v112, v113
    v_cvt_pk_bf16_f32 v211, v114, v115
    ds_write_b64 v19, v[208:209] offset:12288
    ds_write_b64 v19, v[210:211] offset:12544
    s_add_u32 m0, s40, 15360
    s_mov_b32 s25, 110592
    buffer_load_dwordx4 v8, s[12:15], s25 offen lds
    s_add_u32 m0, s41, 15360
    s_mov_b32 s25, 110592
    buffer_load_dwordx4 v9, s[12:15], s25 offen lds
    v_pk_fma_f32 v[116:117], v[116:117], v[4:5], v[6:7]
    v_pk_fma_f32 v[118:119], v[118:119], v[4:5], v[6:7]
    v_pk_fma_f32 v[120:121], v[120:121], v[4:5], v[6:7]
    v_pk_fma_f32 v[122:123], v[122:123], v[4:5], v[6:7]
    v_cvt_pk_bf16_f32 v212, v116, v117
    v_cvt_pk_bf16_f32 v213, v118, v119
    v_cvt_pk_bf16_f32 v214, v120, v121
    v_cvt_pk_bf16_f32 v215, v122, v123
    ds_write_b64 v19, v[212:213] offset:14336
    ds_write_b64 v19, v[214:215] offset:14592
    s_add_u32 m0, s42, 15360
    s_mov_b32 s25, 110592
    buffer_load_dwordx4 v10, s[12:15], s25 offen lds
    s_add_u32 m0, s43, 15360
    s_mov_b32 s25, 110592
    buffer_load_dwordx4 v11, s[12:15], s25 offen lds
    v_pk_fma_f32 v[124:125], v[124:125], v[4:5], v[6:7]
    v_pk_fma_f32 v[126:127], v[126:127], v[4:5], v[6:7]
    v_pk_fma_f32 v[128:129], v[128:129], v[4:5], v[6:7]
    v_pk_fma_f32 v[130:131], v[130:131], v[4:5], v[6:7]
    v_cvt_pk_bf16_f32 v216, v124, v125
    v_cvt_pk_bf16_f32 v217, v126, v127
    v_cvt_pk_bf16_f32 v218, v128, v129
    v_cvt_pk_bf16_f32 v219, v130, v131
    ds_write_b64 v19, v[216:217] offset:16384
    ds_write_b64 v19, v[218:219] offset:16640
    s_add_u32 m0, s40, 30720
    s_mov_b32 s25, 221184
    buffer_load_dwordx4 v8, s[12:15], s25 offen lds
    s_add_u32 m0, s41, 30720
    s_mov_b32 s25, 221184
    buffer_load_dwordx4 v9, s[12:15], s25 offen lds
    v_lshrrev_b32 v3, 3, v0
    s_lshl_b32 s30, s20, 3
    v_add_u32 v3, s30, v3
    v_lshrrev_b32 v4, 4, v3
    v_mul_u32_u24 v4, 18432, v4
    v_and_b32 v5, 15, v3
    v_lshlrev_b32 v5, 4, v5
    v_add_u32 v4, v4, v5
    v_sub_u32 v19, v18, v4
    v_bfe_u32 v5, v0, 3, 2
    s_lshl_b32 s30, s20, 2
    v_add_u32 v5, s30, v5
    v_lshlrev_b32 v5, 4, v5
    v_add3_u32 v19, v19, v5, 0
    v_add_u32 v19, 73728, v19
    s_waitcnt vmcnt(18)
    v_lshlrev_b32 v60, 16, v220
    v_and_b32 v61, s34, v220
    v_lshlrev_b32 v62, 16, v221
    v_and_b32 v63, s34, v221
    v_lshlrev_b32 v64, 16, v222
    v_and_b32 v65, s34, v222
    v_lshlrev_b32 v66, 16, v223
    v_and_b32 v67, s34, v223
    v_lshlrev_b32 v68, 16, v224
    v_and_b32 v69, s34, v224
    v_lshlrev_b32 v70, 16, v225
    v_and_b32 v71, s34, v225
    v_lshlrev_b32 v72, 16, v226
    v_and_b32 v73, s34, v226
    v_lshlrev_b32 v74, 16, v227
    v_and_b32 v75, s34, v227
    v_lshlrev_b32 v76, 16, v228
    v_and_b32 v77, s34, v228
    v_lshlrev_b32 v78, 16, v229
    v_and_b32 v79, s34, v229
    v_lshlrev_b32 v80, 16, v230
    v_and_b32 v81, s34, v230
    v_lshlrev_b32 v82, 16, v231
    v_and_b32 v83, s34, v231
    v_lshlrev_b32 v84, 16, v232
    v_and_b32 v85, s34, v232
    v_lshlrev_b32 v86, 16, v233
    v_and_b32 v87, s34, v233
    v_lshlrev_b32 v88, 16, v234
    v_and_b32 v89, s34, v234
    v_lshlrev_b32 v90, 16, v235
    v_and_b32 v91, s34, v235
    v_lshlrev_b32 v92, 16, v236
    v_and_b32 v93, s34, v236
    v_lshlrev_b32 v94, 16, v237
    v_and_b32 v95, s34, v237
    v_lshlrev_b32 v96, 16, v238
    v_and_b32 v97, s34, v238
    v_lshlrev_b32 v98, 16, v239
    v_and_b32 v99, s34, v239
    v_lshlrev_b32 v100, 16, v240
    v_and_b32 v101, s34, v240
    v_lshlrev_b32 v102, 16, v241
    v_and_b32 v103, s34, v241
    v_lshlrev_b32 v104, 16, v242
    v_and_b32 v105, s34, v242
    v_lshlrev_b32 v106, 16, v243
    v_and_b32 v107, s34, v243
    v_lshlrev_b32 v108, 16, v244
    v_and_b32 v109, s34, v244
    v_lshlrev_b32 v110, 16, v245
    v_and_b32 v111, s34, v245
    v_lshlrev_b32 v112, 16, v246
    v_and_b32 v113, s34, v246
    v_lshlrev_b32 v114, 16, v247
    v_and_b32 v115, s34, v247
    v_lshlrev_b32 v116, 16, v248
    v_and_b32 v117, s34, v248
    v_lshlrev_b32 v118, 16, v249
    v_and_b32 v119, s34, v249
    v_lshlrev_b32 v120, 16, v250
    v_and_b32 v121, s34, v250
    v_lshlrev_b32 v122, 16, v251
    v_and_b32 v123, s34, v251
    v_lshlrev_b32 v124, 16, v252
    v_and_b32 v125, s34, v252
    v_lshlrev_b32 v126, 16, v253
    v_and_b32 v127, s34, v253
    v_lshlrev_b32 v128, 16, v254
    v_and_b32 v129, s34, v254
    v_lshlrev_b32 v130, 16, v255
    v_and_b32 v131, s34, v255
    v_pk_add_f32 v[4:5], v[60:61], v[62:63]
    v_pk_add_f32 v[6:7], v[64:65], v[66:67]
    v_pk_add_f32 v[4:5], v[4:5], v[68:69]
    v_pk_add_f32 v[6:7], v[6:7], v[70:71]
    v_pk_add_f32 v[4:5], v[4:5], v[72:73]
    v_pk_add_f32 v[6:7], v[6:7], v[74:75]
    v_pk_add_f32 v[4:5], v[4:5], v[76:77]
    v_pk_add_f32 v[6:7], v[6:7], v[78:79]
    v_pk_add_f32 v[4:5], v[4:5], v[80:81]
    v_pk_add_f32 v[6:7], v[6:7], v[82:83]
    v_pk_add_f32 v[4:5], v[4:5], v[84:85]
    v_pk_add_f32 v[6:7], v[6:7], v[86:87]
    v_pk_add_f32 v[4:5], v[4:5], v[88:89]
    v_pk_add_f32 v[6:7], v[6:7], v[90:91]
    v_pk_add_f32 v[4:5], v[4:5], v[92:93]
    v_pk_add_f32 v[6:7], v[6:7], v[94:95]
    v_pk_add_f32 v[4:5], v[4:5], v[96:97]
    v_pk_add_f32 v[6:7], v[6:7], v[98:99]
    v_pk_add_f32 v[4:5], v[4:5], v[100:101]
    v_pk_add_f32 v[6:7], v[6:7], v[102:103]
    v_pk_add_f32 v[4:5], v[4:5], v[104:105]
    v_pk_add_f32 v[6:7], v[6:7], v[106:107]
    v_pk_add_f32 v[4:5], v[4:5], v[108:109]
    v_pk_add_f32 v[6:7], v[6:7], v[110:111]
    v_pk_add_f32 v[4:5], v[4:5], v[112:113]
    v_pk_add_f32 v[6:7], v[6:7], v[114:115]
    v_pk_add_f32 v[4:5], v[4:5], v[116:117]
    v_pk_add_f32 v[6:7], v[6:7], v[118:119]
    v_pk_add_f32 v[4:5], v[4:5], v[120:121]
    v_pk_add_f32 v[6:7], v[6:7], v[122:123]
    v_pk_add_f32 v[4:5], v[4:5], v[124:125]
    v_pk_add_f32 v[6:7], v[6:7], v[126:127]
    v_pk_add_f32 v[4:5], v[4:5], v[128:129]
    v_pk_add_f32 v[6:7], v[6:7], v[130:131]
    v_pk_add_f32 v[4:5], v[4:5], v[6:7]
    v_add_f32 v3, v4, v5
    s_nop 1
    v_add_f32_dpp v3, v3, v3 quad_perm:[1,0,3,2] row_mask:0xf bank_mask:0xf
    s_nop 1
    v_add_f32_dpp v3, v3, v3 quad_perm:[2,3,0,1] row_mask:0xf bank_mask:0xf
    s_nop 1
    v_add_f32_dpp v3, v3, v3 row_half_mirror row_mask:0xf bank_mask:0xf
    v_mul_f32 v3, s35, v3
    v_sub_f32 v6, 0, v3
    v_sub_f32 v7, 0, v3
    v_pk_add_f32 v[60:61], v[60:61], v[6:7]
    v_pk_add_f32 v[62:63], v[62:63], v[6:7]
    v_pk_add_f32 v[64:65], v[64:65], v[6:7]
    v_pk_add_f32 v[66:67], v[66:67], v[6:7]
    v_pk_add_f32 v[68:69], v[68:69], v[6:7]
    v_pk_add_f32 v[70:71], v[70:71], v[6:7]
    v_pk_add_f32 v[72:73], v[72:73], v[6:7]
    v_pk_add_f32 v[74:75], v[74:75], v[6:7]
    v_pk_add_f32 v[76:77], v[76:77], v[6:7]
    v_pk_add_f32 v[78:79], v[78:79], v[6:7]
    v_pk_add_f32 v[80:81], v[80:81], v[6:7]
    v_pk_add_f32 v[82:83], v[82:83], v[6:7]
    v_pk_add_f32 v[84:85], v[84:85], v[6:7]
    v_pk_add_f32 v[86:87], v[86:87], v[6:7]
    v_pk_add_f32 v[88:89], v[88:89], v[6:7]
    v_pk_add_f32 v[90:91], v[90:91], v[6:7]
    v_pk_add_f32 v[92:93], v[92:93], v[6:7]
    v_pk_add_f32 v[94:95], v[94:95], v[6:7]
    v_pk_add_f32 v[96:97], v[96:97], v[6:7]
    v_pk_add_f32 v[98:99], v[98:99], v[6:7]
    v_pk_add_f32 v[100:101], v[100:101], v[6:7]
    v_pk_add_f32 v[102:103], v[102:103], v[6:7]
    v_pk_add_f32 v[104:105], v[104:105], v[6:7]
    v_pk_add_f32 v[106:107], v[106:107], v[6:7]
    v_pk_add_f32 v[108:109], v[108:109], v[6:7]
    v_pk_add_f32 v[110:111], v[110:111], v[6:7]
    v_pk_add_f32 v[112:113], v[112:113], v[6:7]
    v_pk_add_f32 v[114:115], v[114:115], v[6:7]
    v_pk_add_f32 v[116:117], v[116:117], v[6:7]
    v_pk_add_f32 v[118:119], v[118:119], v[6:7]
    v_pk_add_f32 v[120:121], v[120:121], v[6:7]
    v_pk_add_f32 v[122:123], v[122:123], v[6:7]
    v_pk_add_f32 v[124:125], v[124:125], v[6:7]
    v_pk_add_f32 v[126:127], v[126:127], v[6:7]
    v_pk_add_f32 v[128:129], v[128:129], v[6:7]
    v_pk_add_f32 v[130:131], v[130:131], v[6:7]
    v_pk_mul_f32 v[4:5], v[60:61], v[60:61]
    v_pk_mul_f32 v[6:7], v[62:63], v[62:63]
    v_pk_fma_f32 v[4:5], v[64:65], v[64:65], v[4:5]
    v_pk_fma_f32 v[6:7], v[66:67], v[66:67], v[6:7]
    v_pk_fma_f32 v[4:5], v[68:69], v[68:69], v[4:5]
    v_pk_fma_f32 v[6:7], v[70:71], v[70:71], v[6:7]
    v_pk_fma_f32 v[4:5], v[72:73], v[72:73], v[4:5]
    v_pk_fma_f32 v[6:7], v[74:75], v[74:75], v[6:7]
    v_pk_fma_f32 v[4:5], v[76:77], v[76:77], v[4:5]
    v_pk_fma_f32 v[6:7], v[78:79], v[78:79], v[6:7]
    v_pk_fma_f32 v[4:5], v[80:81], v[80:81], v[4:5]
    v_pk_fma_f32 v[6:7], v[82:83], v[82:83], v[6:7]
    v_pk_fma_f32 v[4:5], v[84:85], v[84:85], v[4:5]
    v_pk_fma_f32 v[6:7], v[86:87], v[86:87], v[6:7]
    v_pk_fma_f32 v[4:5], v[88:89], v[88:89], v[4:5]
    v_pk_fma_f32 v[6:7], v[90:91], v[90:91], v[6:7]
    v_pk_fma_f32 v[4:5], v[92:93], v[92:93], v[4:5]
    v_pk_fma_f32 v[6:7], v[94:95], v[94:95], v[6:7]
    v_pk_fma_f32 v[4:5], v[96:97], v[96:97], v[4:5]
    v_pk_fma_f32 v[6:7], v[98:99], v[98:99], v[6:7]
    v_pk_fma_f32 v[4:5], v[100:101], v[100:101], v[4:5]
    v_pk_fma_f32 v[6:7], v[102:103], v[102:103], v[6:7]
    v_pk_fma_f32 v[4:5], v[104:105], v[104:105], v[4:5]
    v_pk_fma_f32 v[6:7], v[106:107], v[106:107], v[6:7]
    v_pk_fma_f32 v[4:5], v[108:109], v[108:109], v[4:5]
    v_pk_fma_f32 v[6:7], v[110:111], v[110:111], v[6:7]
    v_pk_fma_f32 v[4:5], v[112:113], v[112:113], v[4:5]
    v_pk_fma_f32 v[6:7], v[114:115], v[114:115], v[6:7]
    v_pk_fma_f32 v[4:5], v[116:117], v[116:117], v[4:5]
    v_pk_fma_f32 v[6:7], v[118:119], v[118:119], v[6:7]
    v_pk_fma_f32 v[4:5], v[120:121], v[120:121], v[4:5]
    v_pk_fma_f32 v[6:7], v[122:123], v[122:123], v[6:7]
    v_pk_fma_f32 v[4:5], v[124:125], v[124:125], v[4:5]
    v_pk_fma_f32 v[6:7], v[126:127], v[126:127], v[6:7]
    v_pk_fma_f32 v[4:5], v[128:129], v[128:129], v[4:5]
    v_pk_fma_f32 v[6:7], v[130:131], v[130:131], v[6:7]
    v_pk_add_f32 v[4:5], v[4:5], v[6:7]
    v_add_f32 v4, v4, v5
    s_nop 1
    v_add_f32_dpp v4, v4, v4 quad_perm:[1,0,3,2] row_mask:0xf bank_mask:0xf
    s_nop 1
    v_add_f32_dpp v4, v4, v4 quad_perm:[2,3,0,1] row_mask:0xf bank_mask:0xf
    s_nop 1
    v_add_f32_dpp v4, v4, v4 row_half_mirror row_mask:0xf bank_mask:0xf
    v_mul_f32 v4, s35, v4
    v_mov_b32 v5, v3
    v_cvt_pk_bf16_f32 v3, v3, v3
    v_lshlrev_b32 v3, 16, v3
    v_cvt_pk_bf16_f32 v4, v4, v4
    v_lshlrev_b32 v4, 16, v4
    v_add_f32 v4, 0x3727c5ac, v4
    v_cvt_pk_bf16_f32 v4, v4, v4
    v_lshlrev_b32 v4, 16, v4
    v_sqrt_f32 v4, v4
    s_nop 0
    v_cvt_pk_bf16_f32 v4, v4, v4
    v_lshlrev_b32 v4, 16, v4
    v_rcp_f32 v4, v4
    s_nop 0
    v_sub_f32 v3, v5, v3
    v_mul_f32 v6, v3, v4
    v_mov_b32 v7, v6
    v_mov_b32 v5, v4
    v_pk_fma_f32 v[60:61], v[60:61], v[4:5], v[6:7]
    v_pk_fma_f32 v[62:63], v[62:63], v[4:5], v[6:7]
    v_pk_fma_f32 v[64:65], v[64:65], v[4:5], v[6:7]
    v_pk_fma_f32 v[66:67], v[66:67], v[4:5], v[6:7]
    v_cvt_pk_bf16_f32 v220, v60, v61
    v_cvt_pk_bf16_f32 v221, v62, v63
    v_cvt_pk_bf16_f32 v222, v64, v65
    v_cvt_pk_bf16_f32 v223, v66, v67
    ds_write_b64 v19, v[220:221] offset:0
    ds_write_b64 v19, v[222:223] offset:256
    s_add_u32 m0, s42, 30720
    s_mov_b32 s25, 221184
    buffer_load_dwordx4 v10, s[12:15], s25 offen lds
    s_add_u32 m0, s43, 30720
    s_mov_b32 s25, 221184
    buffer_load_dwordx4 v11, s[12:15], s25 offen lds
    v_pk_fma_f32 v[68:69], v[68:69], v[4:5], v[6:7]
    v_pk_fma_f32 v[70:71], v[70:71], v[4:5], v[6:7]
    v_pk_fma_f32 v[72:73], v[72:73], v[4:5], v[6:7]
    v_pk_fma_f32 v[74:75], v[74:75], v[4:5], v[6:7]
    v_cvt_pk_bf16_f32 v224, v68, v69
    v_cvt_pk_bf16_f32 v225, v70, v71
    v_cvt_pk_bf16_f32 v226, v72, v73
    v_cvt_pk_bf16_f32 v227, v74, v75
    ds_write_b64 v19, v[224:225] offset:2048
    ds_write_b64 v19, v[226:227] offset:2304
    v_pk_fma_f32 v[76:77], v[76:77], v[4:5], v[6:7]
    v_pk_fma_f32 v[78:79], v[78:79], v[4:5], v[6:7]
    v_pk_fma_f32 v[80:81], v[80:81], v[4:5], v[6:7]
    v_pk_fma_f32 v[82:83], v[82:83], v[4:5], v[6:7]
    v_cvt_pk_bf16_f32 v228, v76, v77
    v_cvt_pk_bf16_f32 v229, v78, v79
    v_cvt_pk_bf16_f32 v230, v80, v81
    v_cvt_pk_bf16_f32 v231, v82, v83
    ds_write_b64 v19, v[228:229] offset:4096
    ds_write_b64 v19, v[230:231] offset:4352
    v_pk_fma_f32 v[84:85], v[84:85], v[4:5], v[6:7]
    v_pk_fma_f32 v[86:87], v[86:87], v[4:5], v[6:7]
    v_pk_fma_f32 v[88:89], v[88:89], v[4:5], v[6:7]
    v_pk_fma_f32 v[90:91], v[90:91], v[4:5], v[6:7]
    v_cvt_pk_bf16_f32 v232, v84, v85
    v_cvt_pk_bf16_f32 v233, v86, v87
    v_cvt_pk_bf16_f32 v234, v88, v89
    v_cvt_pk_bf16_f32 v235, v90, v91
    ds_write_b64 v19, v[232:233] offset:6144
    ds_write_b64 v19, v[234:235] offset:6400
    v_pk_fma_f32 v[92:93], v[92:93], v[4:5], v[6:7]
    v_pk_fma_f32 v[94:95], v[94:95], v[4:5], v[6:7]
    v_pk_fma_f32 v[96:97], v[96:97], v[4:5], v[6:7]
    v_pk_fma_f32 v[98:99], v[98:99], v[4:5], v[6:7]
    v_cvt_pk_bf16_f32 v236, v92, v93
    v_cvt_pk_bf16_f32 v237, v94, v95
    v_cvt_pk_bf16_f32 v238, v96, v97
    v_cvt_pk_bf16_f32 v239, v98, v99
    ds_write_b64 v19, v[236:237] offset:8192
    ds_write_b64 v19, v[238:239] offset:8448
    v_pk_fma_f32 v[100:101], v[100:101], v[4:5], v[6:7]
    v_pk_fma_f32 v[102:103], v[102:103], v[4:5], v[6:7]
    v_pk_fma_f32 v[104:105], v[104:105], v[4:5], v[6:7]
    v_pk_fma_f32 v[106:107], v[106:107], v[4:5], v[6:7]
    v_cvt_pk_bf16_f32 v240, v100, v101
    v_cvt_pk_bf16_f32 v241, v102, v103
    v_cvt_pk_bf16_f32 v242, v104, v105
    v_cvt_pk_bf16_f32 v243, v106, v107
    ds_write_b64 v19, v[240:241] offset:10240
    ds_write_b64 v19, v[242:243] offset:10496
    v_pk_fma_f32 v[108:109], v[108:109], v[4:5], v[6:7]
    v_pk_fma_f32 v[110:111], v[110:111], v[4:5], v[6:7]
    v_pk_fma_f32 v[112:113], v[112:113], v[4:5], v[6:7]
    v_pk_fma_f32 v[114:115], v[114:115], v[4:5], v[6:7]
    v_cvt_pk_bf16_f32 v244, v108, v109
    v_cvt_pk_bf16_f32 v245, v110, v111
    v_cvt_pk_bf16_f32 v246, v112, v113
    v_cvt_pk_bf16_f32 v247, v114, v115
    ds_write_b64 v19, v[244:245] offset:12288
    ds_write_b64 v19, v[246:247] offset:12544
    v_pk_fma_f32 v[116:117], v[116:117], v[4:5], v[6:7]
    v_pk_fma_f32 v[118:119], v[118:119], v[4:5], v[6:7]
    v_pk_fma_f32 v[120:121], v[120:121], v[4:5], v[6:7]
    v_pk_fma_f32 v[122:123], v[122:123], v[4:5], v[6:7]
    v_cvt_pk_bf16_f32 v248, v116, v117
    v_cvt_pk_bf16_f32 v249, v118, v119
    v_cvt_pk_bf16_f32 v250, v120, v121
    v_cvt_pk_bf16_f32 v251, v122, v123
    ds_write_b64 v19, v[248:249] offset:14336
    ds_write_b64 v19, v[250:251] offset:14592
    v_pk_fma_f32 v[124:125], v[124:125], v[4:5], v[6:7]
    v_pk_fma_f32 v[126:127], v[126:127], v[4:5], v[6:7]
    v_pk_fma_f32 v[128:129], v[128:129], v[4:5], v[6:7]
    v_pk_fma_f32 v[130:131], v[130:131], v[4:5], v[6:7]
    v_cvt_pk_bf16_f32 v252, v124, v125
    v_cvt_pk_bf16_f32 v253, v126, v127
    v_cvt_pk_bf16_f32 v254, v128, v129
    v_cvt_pk_bf16_f32 v255, v130, v131
    ds_write_b64 v19, v[252:253] offset:16384
    ds_write_b64 v19, v[254:255] offset:16640
k1a_kernel_lnskip:
    s_waitcnt lgkmcnt(0)
    v_lshrrev_b32 v3, 4, v0
    v_lshlrev_b32 v3, 2, v3
    v_bfe_u32 v4, v0, 2, 2
    v_add_u32 v3, v3, v4
    v_mul_u32_u24 v3, 480, v3
    v_and_b32 v4, 3, v0
    v_lshlrev_b32 v4, 3, v4
    v_add_u32 v3, v3, v4
    s_lshl_b32 s30, s20, 5
    s_add_u32 s30, s30, 92160
    v_add_u32 v19, s30, v3
    s_add_u32 s30, s20, 12
    s_min_u32 s30, s30, 13
    s_lshl_b32 s30, s30, 5
    s_add_u32 s30, s30, 92160
    v_add_u32 v20, s30, v3
    v_lshlrev_b32 v21, 4, v0
    v_add_u32 v22, 55296, v21
    s_waitcnt vmcnt(16)
    s_barrier
    ds_read_b128 v[96:99], v21 offset:0
    ds_read_b128 v[100:103], v21 offset:18432
    ds_read_b128 v[104:107], v21 offset:36864
    ds_read_b128 v[108:111], v22 offset:0
    ds_read_b128 v[112:115], v22 offset:18432
    ds_read_b64_tr_b16 v[136:137], v19 offset:0
    ds_read_b64_tr_b16 v[138:139], v19 offset:7680
    ds_read_b64_tr_b16 v[140:141], v19 offset:128
    ds_read_b64_tr_b16 v[142:143], v19 offset:7808
    ds_read_b64_tr_b16 v[144:145], v19 offset:256
    ds_read_b64_tr_b16 v[146:147], v19 offset:7936
    ds_read_b64_tr_b16 v[148:149], v20 offset:0
    ds_read_b64_tr_b16 v[150:151], v20 offset:7680
    s_waitcnt lgkmcnt(0)
    s_waitcnt vmcnt(4)
    s_barrier
    s_cmp_lg_u32 s22, 0
    s_cbranch_scc1 k1a_kernel_nocp0
    v_add_u32 v3, s40, v1
    ds_read_b128 v[248:251], v3 offset:0
    v_add_u32 v3, s41, v1
    ds_read_b128 v[64:67], v3 offset:0
    v_add_u32 v3, s42, v1
    ds_read_b128 v[68:71], v3 offset:0
    v_add_u32 v3, s43, v1
    ds_read_b128 v[72:75], v3 offset:0
    s_waitcnt lgkmcnt(0)
    s_add_u32 s25, s60, s40
    s_add_u32 s25, s25, 0
    buffer_store_dwordx4 v[248:251], v1, s[16:19], s25 offen
    s_add_u32 s25, s60, s41
    s_add_u32 s25, s25, 0
    buffer_store_dwordx4 v[64:67], v1, s[16:19], s25 offen
    s_add_u32 s25, s60, s42
    s_add_u32 s25, s25, 0
    buffer_store_dwordx4 v[68:71], v1, s[16:19], s25 offen
    s_add_u32 s25, s60, s43
    s_add_u32 s25, s25, 0
    buffer_store_dwordx4 v[72:75], v1, s[16:19], s25 offen
k1a_kernel_nocp0:
    v_mfma_f32_16x16x32_bf16 v[168:171], v[136:139], v[96:99], 0
    ds_read_b128 v[116:119], v21 offset:1024
    v_mfma_f32_16x16x32_bf16 v[172:175], v[136:139], v[100:103], 0
    ds_read_b128 v[120:123], v21 offset:19456
    v_mfma_f32_16x16x32_bf16 v[176:179], v[136:139], v[104:107], 0
    ds_read_b128 v[124:127], v21 offset:37888
    v_mfma_f32_16x16x32_bf16 v[180:183], v[136:139], v[108:111], 0
    ds_read_b128 v[128:131], v22 offset:1024
    v_mfma_f32_16x16x32_bf16 v[184:187], v[136:139], v[112:115], 0
    ds_read_b128 v[132:135], v22 offset:19456
    v_mfma_f32_16x16x32_bf16 v[188:191], v[140:143], v[96:99], 0
    ds_read_b64_tr_b16 v[152:153], v19 offset:15360
    v_mfma_f32_16x16x32_bf16 v[192:195], v[140:143], v[100:103], 0
    ds_read_b64_tr_b16 v[154:155], v19 offset:23040
    v_mfma_f32_16x16x32_bf16 v[196:199], v[140:143], v[104:107], 0
    ds_read_b64_tr_b16 v[156:157], v19 offset:15488
    v_mfma_f32_16x16x32_bf16 v[200:203], v[140:143], v[108:111], 0
    ds_read_b64_tr_b16 v[158:159], v19 offset:23168
    v_mfma_f32_16x16x32_bf16 v[204:207], v[140:143], v[112:115], 0
    ds_read_b64_tr_b16 v[160:161], v19 offset:15616
    v_mfma_f32_16x16x32_bf16 v[208:211], v[144:147], v[96:99], 0
    ds_read_b64_tr_b16 v[162:163], v19 offset:23296
    v_mfma_f32_16x16x32_bf16 v[212:215], v[144:147], v[100:103], 0
    ds_read_b64_tr_b16 v[164:165], v20 offset:15360
    v_mfma_f32_16x16x32_bf16 v[216:219], v[144:147], v[104:107], 0
    ds_read_b64_tr_b16 v[166:167], v20 offset:23040
    v_mfma_f32_16x16x32_bf16 v[220:223], v[144:147], v[108:111], 0
    s_add_u32 m0, s40, 46080
    s_mov_b32 s25, 331776
    buffer_load_dwordx4 v8, s[12:15], s25 offen lds
    v_mfma_f32_16x16x32_bf16 v[224:227], v[144:147], v[112:115], 0
    s_add_u32 m0, s41, 46080
    s_mov_b32 s25, 331776
    buffer_load_dwordx4 v9, s[12:15], s25 offen lds
    v_mfma_f32_16x16x32_bf16 v[228:231], v[148:151], v[96:99], 0
    s_add_u32 m0, s42, 46080
    s_mov_b32 s25, 331776
    buffer_load_dwordx4 v10, s[12:15], s25 offen lds
    v_mfma_f32_16x16x32_bf16 v[232:235], v[148:151], v[100:103], 0
    s_add_u32 m0, s43, 46080
    s_mov_b32 s25, 331776
    buffer_load_dwordx4 v11, s[12:15], s25 offen lds
    v_mfma_f32_16x16x32_bf16 v[236:239], v[148:151], v[104:107], 0
    v_mfma_f32_16x16x32_bf16 v[240:243], v[148:151], v[108:111], 0
    v_mfma_f32_16x16x32_bf16 v[244:247], v[148:151], v[112:115], 0
    s_waitcnt lgkmcnt(0)
    s_waitcnt vmcnt(4)
    s_barrier
    s_cmp_lg_u32 s22, 1
    s_cbranch_scc1 k1a_kernel_nocp1
    v_add_u32 v3, s40, v1
    ds_read_b128 v[248:251], v3 offset:15360
    v_add_u32 v3, s41, v1
    ds_read_b128 v[64:67], v3 offset:15360
    v_add_u32 v3, s42, v1
    ds_read_b128 v[68:71], v3 offset:15360
    v_add_u32 v3, s43, v1
    ds_read_b128 v[72:75], v3 offset:15360
    s_waitcnt lgkmcnt(0)
    s_add_u32 s25, s60, s40
    s_add_u32 s25, s25, 15360
    buffer_store_dwordx4 v[248:251], v1, s[16:19], s25 offen
    s_add_u32 s25, s60, s41
    s_add_u32 s25, s25, 15360
    buffer_store_dwordx4 v[64:67], v1, s[16:19], s25 offen
    s_add_u32 s25, s60, s42
    s_add_u32 s25, s25, 15360
    buffer_store_dwordx4 v[68:71], v1, s[16:19], s25 offen
    s_add_u32 s25, s60, s43
    s_add_u32 s25, s25, 15360
    buffer_store_dwordx4 v[72:75], v1, s[16:19], s25 offen
k1a_kernel_nocp1:
    v_mfma_f32_16x16x32_bf16 v[168:171], v[152:155], v[116:119], v[168:171]
    ds_read_b128 v[96:99], v21 offset:2048
    v_mfma_f32_16x16x32_bf16 v[172:175], v[152:155], v[120:123], v[172:175]
    ds_read_b128 v[100:103], v21 offset:20480
    v_mfma_f32_16x16x32_bf16 v[176:179], v[152:155], v[124:127], v[176:179]
    ds_read_b128 v[104:107], v21 offset:38912
    v_mfma_f32_16x16x32_bf16 v[180:183], v[152:155], v[128:131], v[180:183]
    ds_read_b128 v[108:111], v22 offset:2048
    v_mfma_f32_16x16x32_bf16 v[184:187], v[152:155], v[132:135], v[184:187]
    ds_read_b128 v[112:115], v22 offset:20480
    v_mfma_f32_16x16x32_bf16 v[188:191], v[156:159], v[116:119], v[188:191]
    ds_read_b64_tr_b16 v[136:137], v19 offset:30720
    v_mfma_f32_16x16x32_bf16 v[192:195], v[156:159], v[120:123], v[192:195]
    ds_read_b64_tr_b16 v[138:139], v19 offset:38400
    v_mfma_f32_16x16x32_bf16 v[196:199], v[156:159], v[124:127], v[196:199]
    ds_read_b64_tr_b16 v[140:141], v19 offset:30848
    v_mfma_f32_16x16x32_bf16 v[200:203], v[156:159], v[128:131], v[200:203]
    ds_read_b64_tr_b16 v[142:143], v19 offset:38528
    v_mfma_f32_16x16x32_bf16 v[204:207], v[156:159], v[132:135], v[204:207]
    ds_read_b64_tr_b16 v[144:145], v19 offset:30976
    v_mfma_f32_16x16x32_bf16 v[208:211], v[160:163], v[116:119], v[208:211]
    ds_read_b64_tr_b16 v[146:147], v19 offset:38656
    v_mfma_f32_16x16x32_bf16 v[212:215], v[160:163], v[120:123], v[212:215]
    ds_read_b64_tr_b16 v[148:149], v20 offset:30720
    v_mfma_f32_16x16x32_bf16 v[216:219], v[160:163], v[124:127], v[216:219]
    ds_read_b64_tr_b16 v[150:151], v20 offset:38400
    v_mfma_f32_16x16x32_bf16 v[220:223], v[160:163], v[128:131], v[220:223]
    s_add_u32 m0, s40, 0
    s_mov_b32 s25, 442368
    buffer_load_dwordx4 v8, s[12:15], s25 offen lds
    v_mfma_f32_16x16x32_bf16 v[224:227], v[160:163], v[132:135], v[224:227]
    s_add_u32 m0, s41, 0
    s_mov_b32 s25, 442368
    buffer_load_dwordx4 v9, s[12:15], s25 offen lds
    v_mfma_f32_16x16x32_bf16 v[228:231], v[164:167], v[116:119], v[228:231]
    s_add_u32 m0, s42, 0
    s_mov_b32 s25, 442368
    buffer_load_dwordx4 v10, s[12:15], s25 offen lds
    v_mfma_f32_16x16x32_bf16 v[232:235], v[164:167], v[120:123], v[232:235]
    s_add_u32 m0, s43, 0
    s_mov_b32 s25, 442368
    buffer_load_dwordx4 v11, s[12:15], s25 offen lds
    v_mfma_f32_16x16x32_bf16 v[236:239], v[164:167], v[124:127], v[236:239]
    v_mfma_f32_16x16x32_bf16 v[240:243], v[164:167], v[128:131], v[240:243]
    v_mfma_f32_16x16x32_bf16 v[244:247], v[164:167], v[132:135], v[244:247]
    s_waitcnt lgkmcnt(0)
    s_waitcnt vmcnt(4)
    s_barrier
    s_cmp_lg_u32 s22, 2
    s_cbranch_scc1 k1a_kernel_nocp2
    v_add_u32 v3, s40, v1
    ds_read_b128 v[248:251], v3 offset:30720
    v_add_u32 v3, s41, v1
    ds_read_b128 v[64:67], v3 offset:30720
    v_add_u32 v3, s42, v1
    ds_read_b128 v[68:71], v3 offset:30720
    v_add_u32 v3, s43, v1
    ds_read_b128 v[72:75], v3 offset:30720
    s_waitcnt lgkmcnt(0)
    s_add_u32 s25, s60, s40
    s_add_u32 s25, s25, 30720
    buffer_store_dwordx4 v[248:251], v1, s[16:19], s25 offen
    s_add_u32 s25, s60, s41
    s_add_u32 s25, s25, 30720
    buffer_store_dwordx4 v[64:67], v1, s[16:19], s25 offen
    s_add_u32 s25, s60, s42
    s_add_u32 s25, s25, 30720
    buffer_store_dwordx4 v[68:71], v1, s[16:19], s25 offen
    s_add_u32 s25, s60, s43
    s_add_u32 s25, s25, 30720
    buffer_store_dwordx4 v[72:75], v1, s[16:19], s25 offen
k1a_kernel_nocp2:
    v_mfma_f32_16x16x32_bf16 v[168:171], v[136:139], v[96:99], v[168:171]
    ds_read_b128 v[116:119], v21 offset:3072
    v_mfma_f32_16x16x32_bf16 v[172:175], v[136:139], v[100:103], v[172:175]
    ds_read_b128 v[120:123], v21 offset:21504
    v_mfma_f32_16x16x32_bf16 v[176:179], v[136:139], v[104:107], v[176:179]
    ds_read_b128 v[124:127], v21 offset:39936
    v_mfma_f32_16x16x32_bf16 v[180:183], v[136:139], v[108:111], v[180:183]
    ds_read_b128 v[128:131], v22 offset:3072
    v_mfma_f32_16x16x32_bf16 v[184:187], v[136:139], v[112:115], v[184:187]
    ds_read_b128 v[132:135], v22 offset:21504
    v_mfma_f32_16x16x32_bf16 v[188:191], v[140:143], v[96:99], v[188:191]
    ds_read_b64_tr_b16 v[152:153], v19 offset:46080
    v_mfma_f32_16x16x32_bf16 v[192:195], v[140:143], v[100:103], v[192:195]
    ds_read_b64_tr_b16 v[154:155], v19 offset:53760
    v_mfma_f32_16x16x32_bf16 v[196:199], v[140:143], v[104:107], v[196:199]
    ds_read_b64_tr_b16 v[156:157], v19 offset:46208
    v_mfma_f32_16x16x32_bf16 v[200:203], v[140:143], v[108:111], v[200:203]
    ds_read_b64_tr_b16 v[158:159], v19 offset:53888
    v_mfma_f32_16x16x32_bf16 v[204:207], v[140:143], v[112:115], v[204:207]
    ds_read_b64_tr_b16 v[160:161], v19 offset:46336
    v_mfma_f32_16x16x32_bf16 v[208:211], v[144:147], v[96:99], v[208:211]
    ds_read_b64_tr_b16 v[162:163], v19 offset:54016
    v_mfma_f32_16x16x32_bf16 v[212:215], v[144:147], v[100:103], v[212:215]
    ds_read_b64_tr_b16 v[164:165], v20 offset:46080
    v_mfma_f32_16x16x32_bf16 v[216:219], v[144:147], v[104:107], v[216:219]
    ds_read_b64_tr_b16 v[166:167], v20 offset:53760
    v_mfma_f32_16x16x32_bf16 v[220:223], v[144:147], v[108:111], v[220:223]
    s_add_u32 m0, s40, 15360
    s_mov_b32 s25, 552960
    buffer_load_dwordx4 v8, s[12:15], s25 offen lds
    v_mfma_f32_16x16x32_bf16 v[224:227], v[144:147], v[112:115], v[224:227]
    s_add_u32 m0, s41, 15360
    s_mov_b32 s25, 552960
    buffer_load_dwordx4 v9, s[12:15], s25 offen lds
    v_mfma_f32_16x16x32_bf16 v[228:231], v[148:151], v[96:99], v[228:231]
    s_add_u32 m0, s42, 15360
    s_mov_b32 s25, 552960
    buffer_load_dwordx4 v10, s[12:15], s25 offen lds
    v_mfma_f32_16x16x32_bf16 v[232:235], v[148:151], v[100:103], v[232:235]
    s_add_u32 m0, s43, 15360
    s_mov_b32 s25, 552960
    buffer_load_dwordx4 v11, s[12:15], s25 offen lds
    v_mfma_f32_16x16x32_bf16 v[236:239], v[148:151], v[104:107], v[236:239]
    v_mfma_f32_16x16x32_bf16 v[240:243], v[148:151], v[108:111], v[240:243]
    v_mfma_f32_16x16x32_bf16 v[244:247], v[148:151], v[112:115], v[244:247]
    s_waitcnt lgkmcnt(0)
    s_waitcnt vmcnt(4)
    s_barrier
    s_cmp_lg_u32 s22, 3
    s_cbranch_scc1 k1a_kernel_nocp3
    v_add_u32 v3, s40, v1
    ds_read_b128 v[248:251], v3 offset:46080
    v_add_u32 v3, s41, v1
    ds_read_b128 v[64:67], v3 offset:46080
    v_add_u32 v3, s42, v1
    ds_read_b128 v[68:71], v3 offset:46080
    v_add_u32 v3, s43, v1
    ds_read_b128 v[72:75], v3 offset:46080
    s_waitcnt lgkmcnt(0)
    s_add_u32 s25, s60, s40
    s_add_u32 s25, s25, 46080
    buffer_store_dwordx4 v[248:251], v1, s[16:19], s25 offen
    s_add_u32 s25, s60, s41
    s_add_u32 s25, s25, 46080
    buffer_store_dwordx4 v[64:67], v1, s[16:19], s25 offen
    s_add_u32 s25, s60, s42
    s_add_u32 s25, s25, 46080
    buffer_store_dwordx4 v[68:71], v1, s[16:19], s25 offen
    s_add_u32 s25, s60, s43
    s_add_u32 s25, s25, 46080
    buffer_store_dwordx4 v[72:75], v1, s[16:19], s25 offen
k1a_kernel_nocp3:
    v_mfma_f32_16x16x32_bf16 v[168:171], v[152:155], v[116:119], v[168:171]
    ds_read_b128 v[96:99], v21 offset:4096
    v_mfma_f32_16x16x32_bf16 v[172:175], v[152:155], v[120:123], v[172:175]
    ds_read_b128 v[100:103], v21 offset:22528
    v_mfma_f32_16x16x32_bf16 v[176:179], v[152:155], v[124:127], v[176:179]
    ds_read_b128 v[104:107], v21 offset:40960
    v_mfma_f32_16x16x32_bf16 v[180:183], v[152:155], v[128:131], v[180:183]
    ds_read_b128 v[108:111], v22 offset:4096
    v_mfma_f32_16x16x32_bf16 v[184:187], v[152:155], v[132:135], v[184:187]
    ds_read_b128 v[112:115], v22 offset:22528
    v_mfma_f32_16x16x32_bf16 v[188:191], v[156:159], v[116:119], v[188:191]
    ds_read_b64_tr_b16 v[136:137], v19 offset:0
    v_mfma_f32_16x16x32_bf16 v[192:195], v[156:159], v[120:123], v[192:195]
    ds_read_b64_tr_b16 v[138:139], v19 offset:7680
    v_mfma_f32_16x16x32_bf16 v[196:199], v[156:159], v[124:127], v[196:199]
    ds_read_b64_tr_b16 v[140:141], v19 offset:128
    v_mfma_f32_16x16x32_bf16 v[200:203], v[156:159], v[128:131], v[200:203]
    ds_read_b64_tr_b16 v[142:143], v19 offset:7808
    v_mfma_f32_16x16x32_bf16 v[204:207], v[156:159], v[132:135], v[204:207]
    ds_read_b64_tr_b16 v[144:145], v19 offset:256
    v_mfma_f32_16x16x32_bf16 v[208:211], v[160:163], v[116:119], v[208:211]
    ds_read_b64_tr_b16 v[146:147], v19 offset:7936
    v_mfma_f32_16x16x32_bf16 v[212:215], v[160:163], v[120:123], v[212:215]
    ds_read_b64_tr_b16 v[148:149], v20 offset:0
    v_mfma_f32_16x16x32_bf16 v[216:219], v[160:163], v[124:127], v[216:219]
    ds_read_b64_tr_b16 v[150:151], v20 offset:7680
    v_mfma_f32_16x16x32_bf16 v[220:223], v[160:163], v[128:131], v[220:223]
    s_add_u32 m0, s40, 30720
    s_mov_b32 s25, 663552
    buffer_load_dwordx4 v8, s[12:15], s25 offen lds
    v_mfma_f32_16x16x32_bf16 v[224:227], v[160:163], v[132:135], v[224:227]
    s_add_u32 m0, s41, 30720
    s_mov_b32 s25, 663552
    buffer_load_dwordx4 v9, s[12:15], s25 offen lds
    v_mfma_f32_16x16x32_bf16 v[228:231], v[164:167], v[116:119], v[228:231]
    s_add_u32 m0, s42, 30720
    s_mov_b32 s25, 663552
    buffer_load_dwordx4 v10, s[12:15], s25 offen lds
    v_mfma_f32_16x16x32_bf16 v[232:235], v[164:167], v[120:123], v[232:235]
    s_add_u32 m0, s43, 30720
    s_mov_b32 s25, 663552
    buffer_load_dwordx4 v11, s[12:15], s25 offen lds
    v_mfma_f32_16x16x32_bf16 v[236:239], v[164:167], v[124:127], v[236:239]
    v_mfma_f32_16x16x32_bf16 v[240:243], v[164:167], v[128:131], v[240:243]
    v_mfma_f32_16x16x32_bf16 v[244:247], v[164:167], v[132:135], v[244:247]
    s_waitcnt lgkmcnt(0)
    s_waitcnt vmcnt(4)
    s_barrier
    s_cmp_lg_u32 s22, 4
    s_cbranch_scc1 k1a_kernel_nocp4
    v_add_u32 v3, s40, v1
    ds_read_b128 v[248:251], v3 offset:0
    v_add_u32 v3, s41, v1
    ds_read_b128 v[64:67], v3 offset:0
    v_add_u32 v3, s42, v1
    ds_read_b128 v[68:71], v3 offset:0
    v_add_u32 v3, s43, v1
    ds_read_b128 v[72:75], v3 offset:0
    s_waitcnt lgkmcnt(0)
    s_add_u32 s25, s60, s40
    s_add_u32 s25, s25, 61440
    buffer_store_dwordx4 v[248:251], v1, s[16:19], s25 offen
    s_add_u32 s25, s60, s41
    s_add_u32 s25, s25, 61440
    buffer_store_dwordx4 v[64:67], v1, s[16:19], s25 offen
    s_add_u32 s25, s60, s42
    s_add_u32 s25, s25, 61440
    buffer_store_dwordx4 v[68:71], v1, s[16:19], s25 offen
    s_add_u32 s25, s60, s43
    s_add_u32 s25, s25, 61440
    buffer_store_dwordx4 v[72:75], v1, s[16:19], s25 offen
k1a_kernel_nocp4:
    v_mfma_f32_16x16x32_bf16 v[168:171], v[136:139], v[96:99], v[168:171]
    ds_read_b128 v[116:119], v21 offset:5120
    v_mfma_f32_16x16x32_bf16 v[172:175], v[136:139], v[100:103], v[172:175]
    ds_read_b128 v[120:123], v21 offset:23552
    v_mfma_f32_16x16x32_bf16 v[176:179], v[136:139], v[104:107], v[176:179]
    ds_read_b128 v[124:127], v21 offset:41984
    v_mfma_f32_16x16x32_bf16 v[180:183], v[136:139], v[108:111], v[180:183]
    ds_read_b128 v[128:131], v22 offset:5120
    v_mfma_f32_16x16x32_bf16 v[184:187], v[136:139], v[112:115], v[184:187]
    ds_read_b128 v[132:135], v22 offset:23552
    v_mfma_f32_16x16x32_bf16 v[188:191], v[140:143], v[96:99], v[188:191]
    ds_read_b64_tr_b16 v[152:153], v19 offset:15360
    v_mfma_f32_16x16x32_bf16 v[192:195], v[140:143], v[100:103], v[192:195]
    ds_read_b64_tr_b16 v[154:155], v19 offset:23040
    v_mfma_f32_16x16x32_bf16 v[196:199], v[140:143], v[104:107], v[196:199]
    ds_read_b64_tr_b16 v[156:157], v19 offset:15488
    v_mfma_f32_16x16x32_bf16 v[200:203], v[140:143], v[108:111], v[200:203]
    ds_read_b64_tr_b16 v[158:159], v19 offset:23168
    v_mfma_f32_16x16x32_bf16 v[204:207], v[140:143], v[112:115], v[204:207]
    ds_read_b64_tr_b16 v[160:161], v19 offset:15616
    v_mfma_f32_16x16x32_bf16 v[208:211], v[144:147], v[96:99], v[208:211]
    ds_read_b64_tr_b16 v[162:163], v19 offset:23296
    v_mfma_f32_16x16x32_bf16 v[212:215], v[144:147], v[100:103], v[212:215]
    ds_read_b64_tr_b16 v[164:165], v20 offset:15360
    v_mfma_f32_16x16x32_bf16 v[216:219], v[144:147], v[104:107], v[216:219]
    ds_read_b64_tr_b16 v[166:167], v20 offset:23040
    v_mfma_f32_16x16x32_bf16 v[220:223], v[144:147], v[108:111], v[220:223]
    s_add_u32 m0, s40, 46080
    s_mov_b32 s25, 774144
    buffer_load_dwordx4 v8, s[12:15], s25 offen lds
    v_mfma_f32_16x16x32_bf16 v[224:227], v[144:147], v[112:115], v[224:227]
    s_add_u32 m0, s41, 46080
    s_mov_b32 s25, 774144
    buffer_load_dwordx4 v9, s[12:15], s25 offen lds
    v_mfma_f32_16x16x32_bf16 v[228:231], v[148:151], v[96:99], v[228:231]
    s_add_u32 m0, s42, 46080
    s_mov_b32 s25, 774144
    buffer_load_dwordx4 v10, s[12:15], s25 offen lds
    v_mfma_f32_16x16x32_bf16 v[232:235], v[148:151], v[100:103], v[232:235]
    s_add_u32 m0, s43, 46080
    s_mov_b32 s25, 774144
    buffer_load_dwordx4 v11, s[12:15], s25 offen lds
    v_mfma_f32_16x16x32_bf16 v[236:239], v[148:151], v[104:107], v[236:239]
    v_mfma_f32_16x16x32_bf16 v[240:243], v[148:151], v[108:111], v[240:243]
    v_mfma_f32_16x16x32_bf16 v[244:247], v[148:151], v[112:115], v[244:247]
    s_waitcnt lgkmcnt(0)
    s_waitcnt vmcnt(4)
    s_barrier
    s_cmp_lg_u32 s22, 5
    s_cbranch_scc1 k1a_kernel_nocp5
    v_add_u32 v3, s40, v1
    ds_read_b128 v[248:251], v3 offset:15360
    v_add_u32 v3, s41, v1
    ds_read_b128 v[64:67], v3 offset:15360
    v_add_u32 v3, s42, v1
    ds_read_b128 v[68:71], v3 offset:15360
    v_add_u32 v3, s43, v1
    ds_read_b128 v[72:75], v3 offset:15360
    s_waitcnt lgkmcnt(0)
    s_add_u32 s25, s60, s40
    s_add_u32 s25, s25, 76800
    buffer_store_dwordx4 v[248:251], v1, s[16:19], s25 offen
    s_add_u32 s25, s60, s41
    s_add_u32 s25, s25, 76800
    buffer_store_dwordx4 v[64:67], v1, s[16:19], s25 offen
    s_add_u32 s25, s60, s42
    s_add_u32 s25, s25, 76800
    buffer_store_dwordx4 v[68:71], v1, s[16:19], s25 offen
    s_add_u32 s25, s60, s43
    s_add_u32 s25, s25, 76800
    buffer_store_dwordx4 v[72:75], v1, s[16:19], s25 offen
k1a_kernel_nocp5:
    v_mfma_f32_16x16x32_bf16 v[168:171], v[152:155], v[116:119], v[168:171]
    ds_read_b128 v[96:99], v21 offset:6144
    v_mfma_f32_16x16x32_bf16 v[172:175], v[152:155], v[120:123], v[172:175]
    ds_read_b128 v[100:103], v21 offset:24576
    v_mfma_f32_16x16x32_bf16 v[176:179], v[152:155], v[124:127], v[176:179]
    ds_read_b128 v[104:107], v21 offset:43008
    v_mfma_f32_16x16x32_bf16 v[180:183], v[152:155], v[128:131], v[180:183]
    ds_read_b128 v[108:111], v22 offset:6144
    v_mfma_f32_16x16x32_bf16 v[184:187], v[152:155], v[132:135], v[184:187]
    ds_read_b128 v[112:115], v22 offset:24576
    v_mfma_f32_16x16x32_bf16 v[188:191], v[156:159], v[116:119], v[188:191]
    ds_read_b64_tr_b16 v[136:137], v19 offset:30720
    v_mfma_f32_16x16x32_bf16 v[192:195], v[156:159], v[120:123], v[192:195]
    ds_read_b64_tr_b16 v[138:139], v19 offset:38400
    v_mfma_f32_16x16x32_bf16 v[196:199], v[156:159], v[124:127], v[196:199]
    ds_read_b64_tr_b16 v[140:141], v19 offset:30848
    v_mfma_f32_16x16x32_bf16 v[200:203], v[156:159], v[128:131], v[200:203]
    ds_read_b64_tr_b16 v[142:143], v19 offset:38528
    v_mfma_f32_16x16x32_bf16 v[204:207], v[156:159], v[132:135], v[204:207]
    ds_read_b64_tr_b16 v[144:145], v19 offset:30976
    v_mfma_f32_16x16x32_bf16 v[208:211], v[160:163], v[116:119], v[208:211]
    ds_read_b64_tr_b16 v[146:147], v19 offset:38656
    v_mfma_f32_16x16x32_bf16 v[212:215], v[160:163], v[120:123], v[212:215]
    ds_read_b64_tr_b16 v[148:149], v20 offset:30720
    v_mfma_f32_16x16x32_bf16 v[216:219], v[160:163], v[124:127], v[216:219]
    ds_read_b64_tr_b16 v[150:151], v20 offset:38400
    v_mfma_f32_16x16x32_bf16 v[220:223], v[160:163], v[128:131], v[220:223]
    s_add_u32 m0, s40, 0
    s_mov_b32 s25, 884736
    buffer_load_dwordx4 v8, s[12:15], s25 offen lds
    v_mfma_f32_16x16x32_bf16 v[224:227], v[160:163], v[132:135], v[224:227]
    s_add_u32 m0, s41, 0
    s_mov_b32 s25, 884736
    buffer_load_dwordx4 v9, s[12:15], s25 offen lds
    v_mfma_f32_16x16x32_bf16 v[228:231], v[164:167], v[116:119], v[228:231]
    s_add_u32 m0, s42, 0
    s_mov_b32 s25, 884736
    buffer_load_dwordx4 v10, s[12:15], s25 offen lds
    v_mfma_f32_16x16x32_bf16 v[232:235], v[164:167], v[120:123], v[232:235]
    s_add_u32 m0, s43, 0
    s_mov_b32 s25, 884736
    buffer_load_dwordx4 v11, s[12:15], s25 offen lds
    v_mfma_f32_16x16x32_bf16 v[236:239], v[164:167], v[124:127], v[236:239]
    v_mfma_f32_16x16x32_bf16 v[240:243], v[164:167], v[128:131], v[240:243]
    v_mfma_f32_16x16x32_bf16 v[244:247], v[164:167], v[132:135], v[244:247]
    s_waitcnt lgkmcnt(0)
    s_waitcnt vmcnt(4)
    s_barrier
    s_cmp_lg_u32 s22, 6
    s_cbranch_scc1 k1a_kernel_nocp6
    v_add_u32 v3, s40, v1
    ds_read_b128 v[248:251], v3 offset:30720
    v_add_u32 v3, s41, v1
    ds_read_b128 v[64:67], v3 offset:30720
    v_add_u32 v3, s42, v1
    ds_read_b128 v[68:71], v3 offset:30720
    v_add_u32 v3, s43, v1
    ds_read_b128 v[72:75], v3 offset:30720
    s_waitcnt lgkmcnt(0)
    s_add_u32 s25, s60, s40
    s_add_u32 s25, s25, 92160
    buffer_store_dwordx4 v[248:251], v1, s[16:19], s25 offen
    s_add_u32 s25, s60, s41
    s_add_u32 s25, s25, 92160
    buffer_store_dwordx4 v[64:67], v1, s[16:19], s25 offen
    s_add_u32 s25, s60, s42
    s_add_u32 s25, s25, 92160
    buffer_store_dwordx4 v[68:71], v1, s[16:19], s25 offen
    s_add_u32 s25, s60, s43
    s_add_u32 s25, s25, 92160
    buffer_store_dwordx4 v[72:75], v1, s[16:19], s25 offen
k1a_kernel_nocp6:
    v_mfma_f32_16x16x32_bf16 v[168:171], v[136:139], v[96:99], v[168:171]
    ds_read_b128 v[116:119], v21 offset:7168
    v_mfma_f32_16x16x32_bf16 v[172:175], v[136:139], v[100:103], v[172:175]
    ds_read_b128 v[120:123], v21 offset:25600
    v_mfma_f32_16x16x32_bf16 v[176:179], v[136:139], v[104:107], v[176:179]
    ds_read_b128 v[124:127], v21 offset:44032
    v_mfma_f32_16x16x32_bf16 v[180:183], v[136:139], v[108:111], v[180:183]
    ds_read_b128 v[128:131], v22 offset:7168
    v_mfma_f32_16x16x32_bf16 v[184:187], v[136:139], v[112:115], v[184:187]
    ds_read_b128 v[132:135], v22 offset:25600
    v_mfma_f32_16x16x32_bf16 v[188:191], v[140:143], v[96:99], v[188:191]
    ds_read_b64_tr_b16 v[152:153], v19 offset:46080
    v_mfma_f32_16x16x32_bf16 v[192:195], v[140:143], v[100:103], v[192:195]
    ds_read_b64_tr_b16 v[154:155], v19 offset:53760
    v_mfma_f32_16x16x32_bf16 v[196:199], v[140:143], v[104:107], v[196:199]
    ds_read_b64_tr_b16 v[156:157], v19 offset:46208
    v_mfma_f32_16x16x32_bf16 v[200:203], v[140:143], v[108:111], v[200:203]
    ds_read_b64_tr_b16 v[158:159], v19 offset:53888
    v_mfma_f32_16x16x32_bf16 v[204:207], v[140:143], v[112:115], v[204:207]
    ds_read_b64_tr_b16 v[160:161], v19 offset:46336
    v_mfma_f32_16x16x32_bf16 v[208:211], v[144:147], v[96:99], v[208:211]
    ds_read_b64_tr_b16 v[162:163], v19 offset:54016
    v_mfma_f32_16x16x32_bf16 v[212:215], v[144:147], v[100:103], v[212:215]
    ds_read_b64_tr_b16 v[164:165], v20 offset:46080
    v_mfma_f32_16x16x32_bf16 v[216:219], v[144:147], v[104:107], v[216:219]
    ds_read_b64_tr_b16 v[166:167], v20 offset:53760
    v_mfma_f32_16x16x32_bf16 v[220:223], v[144:147], v[108:111], v[220:223]
    s_add_u32 m0, s40, 15360
    s_mov_b32 s25, 995328
    buffer_load_dwordx4 v8, s[12:15], s25 offen lds
    v_mfma_f32_16x16x32_bf16 v[224:227], v[144:147], v[112:115], v[224:227]
    s_add_u32 m0, s41, 15360
    s_mov_b32 s25, 995328
    buffer_load_dwordx4 v9, s[12:15], s25 offen lds
    v_mfma_f32_16x16x32_bf16 v[228:231], v[148:151], v[96:99], v[228:231]
    s_add_u32 m0, s42, 15360
    s_mov_b32 s25, 995328
    buffer_load_dwordx4 v10, s[12:15], s25 offen lds
    v_mfma_f32_16x16x32_bf16 v[232:235], v[148:151], v[100:103], v[232:235]
    s_add_u32 m0, s43, 15360
    s_mov_b32 s25, 995328
    buffer_load_dwordx4 v11, s[12:15], s25 offen lds
    v_mfma_f32_16x16x32_bf16 v[236:239], v[148:151], v[104:107], v[236:239]
    v_mfma_f32_16x16x32_bf16 v[240:243], v[148:151], v[108:111], v[240:243]
    v_mfma_f32_16x16x32_bf16 v[244:247], v[148:151], v[112:115], v[244:247]
    s_waitcnt lgkmcnt(0)
    s_waitcnt vmcnt(4)
    s_barrier
    s_cmp_lg_u32 s22, 7
    s_cbranch_scc1 k1a_kernel_nocp7
    v_add_u32 v3, s40, v1
    ds_read_b128 v[248:251], v3 offset:46080
    v_add_u32 v3, s41, v1
    ds_read_b128 v[64:67], v3 offset:46080
    v_add_u32 v3, s42, v1
    ds_read_b128 v[68:71], v3 offset:46080
    v_add_u32 v3, s43, v1
    ds_read_b128 v[72:75], v3 offset:46080
    s_waitcnt lgkmcnt(0)
    s_add_u32 s25, s60, s40
    s_add_u32 s25, s25, 107520
    buffer_store_dwordx4 v[248:251], v1, s[16:19], s25 offen
    s_add_u32 s25, s60, s41
    s_add_u32 s25, s25, 107520
    buffer_store_dwordx4 v[64:67], v1, s[16:19], s25 offen
    s_add_u32 s25, s60, s42
    s_add_u32 s25, s25, 107520
    buffer_store_dwordx4 v[68:71], v1, s[16:19], s25 offen
    s_add_u32 s25, s60, s43
    s_add_u32 s25, s25, 107520
    buffer_store_dwordx4 v[72:75], v1, s[16:19], s25 offen
k1a_kernel_nocp7:
    v_mfma_f32_16x16x32_bf16 v[168:171], v[152:155], v[116:119], v[168:171]
    ds_read_b128 v[96:99], v21 offset:8192
    v_mfma_f32_16x16x32_bf16 v[172:175], v[152:155], v[120:123], v[172:175]
    ds_read_b128 v[100:103], v21 offset:26624
    v_mfma_f32_16x16x32_bf16 v[176:179], v[152:155], v[124:127], v[176:179]
    ds_read_b128 v[104:107], v21 offset:45056
    v_mfma_f32_16x16x32_bf16 v[180:183], v[152:155], v[128:131], v[180:183]
    ds_read_b128 v[108:111], v22 offset:8192
    v_mfma_f32_16x16x32_bf16 v[184:187], v[152:155], v[132:135], v[184:187]
    ds_read_b128 v[112:115], v22 offset:26624
    v_mfma_f32_16x16x32_bf16 v[188:191], v[156:159], v[116:119], v[188:191]
    ds_read_b64_tr_b16 v[136:137], v19 offset:0
    v_mfma_f32_16x16x32_bf16 v[192:195], v[156:159], v[120:123], v[192:195]
    ds_read_b64_tr_b16 v[138:139], v19 offset:7680
    v_mfma_f32_16x16x32_bf16 v[196:199], v[156:159], v[124:127], v[196:199]
    ds_read_b64_tr_b16 v[140:141], v19 offset:128
    v_mfma_f32_16x16x32_bf16 v[200:203], v[156:159], v[128:131], v[200:203]
    ds_read_b64_tr_b16 v[142:143], v19 offset:7808
    v_mfma_f32_16x16x32_bf16 v[204:207], v[156:159], v[132:135], v[204:207]
    ds_read_b64_tr_b16 v[144:145], v19 offset:256
    v_mfma_f32_16x16x32_bf16 v[208:211], v[160:163], v[116:119], v[208:211]
    ds_read_b64_tr_b16 v[146:147], v19 offset:7936
    v_mfma_f32_16x16x32_bf16 v[212:215], v[160:163], v[120:123], v[212:215]
    ds_read_b64_tr_b16 v[148:149], v20 offset:0
    v_mfma_f32_16x16x32_bf16 v[216:219], v[160:163], v[124:127], v[216:219]
    ds_read_b64_tr_b16 v[150:151], v20 offset:7680
    v_mfma_f32_16x16x32_bf16 v[220:223], v[160:163], v[128:131], v[220:223]
    s_add_u32 m0, s40, 30720
    s_mov_b32 s25, 1105920
    buffer_load_dwordx4 v8, s[12:15], s25 offen lds
    v_mfma_f32_16x16x32_bf16 v[224:227], v[160:163], v[132:135], v[224:227]
    s_add_u32 m0, s41, 30720
    s_mov_b32 s25, 1105920
    buffer_load_dwordx4 v9, s[12:15], s25 offen lds
    v_mfma_f32_16x16x32_bf16 v[228:231], v[164:167], v[116:119], v[228:231]
    s_add_u32 m0, s42, 30720
    s_mov_b32 s25, 1105920
    buffer_load_dwordx4 v10, s[12:15], s25 offen lds
    v_mfma_f32_16x16x32_bf16 v[232:235], v[164:167], v[120:123], v[232:235]
    s_add_u32 m0, s43, 30720
    s_mov_b32 s25, 1105920
    buffer_load_dwordx4 v11, s[12:15], s25 offen lds
    v_mfma_f32_16x16x32_bf16 v[236:239], v[164:167], v[124:127], v[236:239]
    v_mfma_f32_16x16x32_bf16 v[240:243], v[164:167], v[128:131], v[240:243]
    v_mfma_f32_16x16x32_bf16 v[244:247], v[164:167], v[132:135], v[244:247]
    s_waitcnt lgkmcnt(0)
    s_waitcnt vmcnt(4)
    s_barrier
    s_cmp_lg_u32 s22, 8
    s_cbranch_scc1 k1a_kernel_nocp8
    v_add_u32 v3, s40, v1
    ds_read_b128 v[248:251], v3 offset:0
    v_add_u32 v3, s41, v1
    ds_read_b128 v[64:67], v3 offset:0
    v_add_u32 v3, s42, v1
    ds_read_b128 v[68:71], v3 offset:0
    v_add_u32 v3, s43, v1
    ds_read_b128 v[72:75], v3 offset:0
    s_waitcnt lgkmcnt(0)
    s_add_u32 s25, s60, s40
    s_add_u32 s25, s25, 122880
    buffer_store_dwordx4 v[248:251], v1, s[16:19], s25 offen
    s_add_u32 s25, s60, s41
    s_add_u32 s25, s25, 122880
    buffer_store_dwordx4 v[64:67], v1, s[16:19], s25 offen
    s_add_u32 s25, s60, s42
    s_add_u32 s25, s25, 122880
    buffer_store_dwordx4 v[68:71], v1, s[16:19], s25 offen
    s_add_u32 s25, s60, s43
    s_add_u32 s25, s25, 122880
    buffer_store_dwordx4 v[72:75], v1, s[16:19], s25 offen
k1a_kernel_nocp8:
    v_mfma_f32_16x16x32_bf16 v[168:171], v[136:139], v[96:99], v[168:171]
    ds_read_b128 v[116:119], v21 offset:9216
    v_mfma_f32_16x16x32_bf16 v[172:175], v[136:139], v[100:103], v[172:175]
    ds_read_b128 v[120:123], v21 offset:27648
    v_mfma_f32_16x16x32_bf16 v[176:179], v[136:139], v[104:107], v[176:179]
    ds_read_b128 v[124:127], v21 offset:46080
    v_mfma_f32_16x16x32_bf16 v[180:183], v[136:139], v[108:111], v[180:183]
    ds_read_b128 v[128:131], v22 offset:9216
    v_mfma_f32_16x16x32_bf16 v[184:187], v[136:139], v[112:115], v[184:187]
    ds_read_b128 v[132:135], v22 offset:27648
    v_mfma_f32_16x16x32_bf16 v[188:191], v[140:143], v[96:99], v[188:191]
    ds_read_b64_tr_b16 v[152:153], v19 offset:15360
    v_mfma_f32_16x16x32_bf16 v[192:195], v[140:143], v[100:103], v[192:195]
    ds_read_b64_tr_b16 v[154:155], v19 offset:23040
    v_mfma_f32_16x16x32_bf16 v[196:199], v[140:143], v[104:107], v[196:199]
    ds_read_b64_tr_b16 v[156:157], v19 offset:15488
    v_mfma_f32_16x16x32_bf16 v[200:203], v[140:143], v[108:111], v[200:203]
    ds_read_b64_tr_b16 v[158:159], v19 offset:23168
    v_mfma_f32_16x16x32_bf16 v[204:207], v[140:143], v[112:115], v[204:207]
    ds_read_b64_tr_b16 v[160:161], v19 offset:15616
    v_mfma_f32_16x16x32_bf16 v[208:211], v[144:147], v[96:99], v[208:211]
    ds_read_b64_tr_b16 v[162:163], v19 offset:23296
    v_mfma_f32_16x16x32_bf16 v[212:215], v[144:147], v[100:103], v[212:215]
    ds_read_b64_tr_b16 v[164:165], v20 offset:15360
    v_mfma_f32_16x16x32_bf16 v[216:219], v[144:147], v[104:107], v[216:219]
    ds_read_b64_tr_b16 v[166:167], v20 offset:23040
    v_mfma_f32_16x16x32_bf16 v[220:223], v[144:147], v[108:111], v[220:223]
    s_add_u32 m0, s40, 46080
    s_mov_b32 s25, 1216512
    buffer_load_dwordx4 v8, s[12:15], s25 offen lds
    v_mfma_f32_16x16x32_bf16 v[224:227], v[144:147], v[112:115], v[224:227]
    s_add_u32 m0, s41, 46080
    s_mov_b32 s25, 1216512
    buffer_load_dwordx4 v9, s[12:15], s25 offen lds
    v_mfma_f32_16x16x32_bf16 v[228:231], v[148:151], v[96:99], v[228:231]
    s_add_u32 m0, s42, 46080
    s_mov_b32 s25, 1216512
    buffer_load_dwordx4 v10, s[12:15], s25 offen lds
    v_mfma_f32_16x16x32_bf16 v[232:235], v[148:151], v[100:103], v[232:235]
    s_add_u32 m0, s43, 46080
    s_mov_b32 s25, 1216512
    buffer_load_dwordx4 v11, s[12:15], s25 offen lds
    v_mfma_f32_16x16x32_bf16 v[236:239], v[148:151], v[104:107], v[236:239]
    v_mfma_f32_16x16x32_bf16 v[240:243], v[148:151], v[108:111], v[240:243]
    v_mfma_f32_16x16x32_bf16 v[244:247], v[148:151], v[112:115], v[244:247]
    s_waitcnt lgkmcnt(0)
    s_waitcnt vmcnt(4)
    s_barrier
    s_cmp_lg_u32 s22, 9
    s_cbranch_scc1 k1a_kernel_nocp9
    v_add_u32 v3, s40, v1
    ds_read_b128 v[248:251], v3 offset:15360
    v_add_u32 v3, s41, v1
    ds_read_b128 v[64:67], v3 offset:15360
    v_add_u32 v3, s42, v1
    ds_read_b128 v[68:71], v3 offset:15360
    v_add_u32 v3, s43, v1
    ds_read_b128 v[72:75], v3 offset:15360
    s_waitcnt lgkmcnt(0)
    s_add_u32 s25, s60, s40
    s_add_u32 s25, s25, 138240
    buffer_store_dwordx4 v[248:251], v1, s[16:19], s25 offen
    s_add_u32 s25, s60, s41
    s_add_u32 s25, s25, 138240
    buffer_store_dwordx4 v[64:67], v1, s[16:19], s25 offen
    s_add_u32 s25, s60, s42
    s_add_u32 s25, s25, 138240
    buffer_store_dwordx4 v[68:71], v1, s[16:19], s25 offen
    s_add_u32 s25, s60, s43
    s_add_u32 s25, s25, 138240
    buffer_store_dwordx4 v[72:75], v1, s[16:19], s25 offen
k1a_kernel_nocp9:
    v_mfma_f32_16x16x32_bf16 v[168:171], v[152:155], v[116:119], v[168:171]
    ds_read_b128 v[96:99], v21 offset:10240
    v_mfma_f32_16x16x32_bf16 v[172:175], v[152:155], v[120:123], v[172:175]
    ds_read_b128 v[100:103], v21 offset:28672
    v_mfma_f32_16x16x32_bf16 v[176:179], v[152:155], v[124:127], v[176:179]
    ds_read_b128 v[104:107], v21 offset:47104
    v_mfma_f32_16x16x32_bf16 v[180:183], v[152:155], v[128:131], v[180:183]
    ds_read_b128 v[108:111], v22 offset:10240
    v_mfma_f32_16x16x32_bf16 v[184:187], v[152:155], v[132:135], v[184:187]
    ds_read_b128 v[112:115], v22 offset:28672
    v_mfma_f32_16x16x32_bf16 v[188:191], v[156:159], v[116:119], v[188:191]
    ds_read_b64_tr_b16 v[136:137], v19 offset:30720
    v_mfma_f32_16x16x32_bf16 v[192:195], v[156:159], v[120:123], v[192:195]
    ds_read_b64_tr_b16 v[138:139], v19 offset:38400
    v_mfma_f32_16x16x32_bf16 v[196:199], v[156:159], v[124:127], v[196:199]
    ds_read_b64_tr_b16 v[140:141], v19 offset:30848
    v_mfma_f32_16x16x32_bf16 v[200:203], v[156:159], v[128:131], v[200:203]
    ds_read_b64_tr_b16 v[142:143], v19 offset:38528
    v_mfma_f32_16x16x32_bf16 v[204:207], v[156:159], v[132:135], v[204:207]
    ds_read_b64_tr_b16 v[144:145], v19 offset:30976
    v_mfma_f32_16x16x32_bf16 v[208:211], v[160:163], v[116:119], v[208:211]
    ds_read_b64_tr_b16 v[146:147], v19 offset:38656
    v_mfma_f32_16x16x32_bf16 v[212:215], v[160:163], v[120:123], v[212:215]
    ds_read_b64_tr_b16 v[148:149], v20 offset:30720
    v_mfma_f32_16x16x32_bf16 v[216:219], v[160:163], v[124:127], v[216:219]
    ds_read_b64_tr_b16 v[150:151], v20 offset:38400
    v_mfma_f32_16x16x32_bf16 v[220:223], v[160:163], v[128:131], v[220:223]
    s_add_u32 m0, s40, 0
    s_mov_b32 s25, 1327104
    buffer_load_dwordx4 v8, s[12:15], s25 offen lds
    v_mfma_f32_16x16x32_bf16 v[224:227], v[160:163], v[132:135], v[224:227]
    s_add_u32 m0, s41, 0
    s_mov_b32 s25, 1327104
    buffer_load_dwordx4 v9, s[12:15], s25 offen lds
    v_mfma_f32_16x16x32_bf16 v[228:231], v[164:167], v[116:119], v[228:231]
    s_add_u32 m0, s42, 0
    s_mov_b32 s25, 1327104
    buffer_load_dwordx4 v10, s[12:15], s25 offen lds
    v_mfma_f32_16x16x32_bf16 v[232:235], v[164:167], v[120:123], v[232:235]
    s_add_u32 m0, s43, 0
    s_mov_b32 s25, 1327104
    buffer_load_dwordx4 v11, s[12:15], s25 offen lds
    v_mfma_f32_16x16x32_bf16 v[236:239], v[164:167], v[124:127], v[236:239]
    v_mfma_f32_16x16x32_bf16 v[240:243], v[164:167], v[128:131], v[240:243]
    v_mfma_f32_16x16x32_bf16 v[244:247], v[164:167], v[132:135], v[244:247]
    s_waitcnt lgkmcnt(0)
    s_waitcnt vmcnt(4)
    s_barrier
    s_cmp_lg_u32 s22, 10
    s_cbranch_scc1 k1a_kernel_nocp10
    v_add_u32 v3, s40, v1
    ds_read_b128 v[248:251], v3 offset:30720
    v_add_u32 v3, s41, v1
    ds_read_b128 v[64:67], v3 offset:30720
    v_add_u32 v3, s42, v1
    ds_read_b128 v[68:71], v3 offset:30720
    v_add_u32 v3, s43, v1
    ds_read_b128 v[72:75], v3 offset:30720
    s_waitcnt lgkmcnt(0)
    s_add_u32 s25, s60, s40
    s_add_u32 s25, s25, 153600
    buffer_store_dwordx4 v[248:251], v1, s[16:19], s25 offen
    s_add_u32 s25, s60, s41
    s_add_u32 s25, s25, 153600
    buffer_store_dwordx4 v[64:67], v1, s[16:19], s25 offen
    s_add_u32 s25, s60, s42
    s_add_u32 s25, s25, 153600
    buffer_store_dwordx4 v[68:71], v1, s[16:19], s25 offen
    s_add_u32 s25, s60, s43
    s_add_u32 s25, s25, 153600
    buffer_store_dwordx4 v[72:75], v1, s[16:19], s25 offen
k1a_kernel_nocp10:
    v_mfma_f32_16x16x32_bf16 v[168:171], v[136:139], v[96:99], v[168:171]
    ds_read_b128 v[116:119], v21 offset:11264
    v_mfma_f32_16x16x32_bf16 v[172:175], v[136:139], v[100:103], v[172:175]
    ds_read_b128 v[120:123], v21 offset:29696
    v_mfma_f32_16x16x32_bf16 v[176:179], v[136:139], v[104:107], v[176:179]
    ds_read_b128 v[124:127], v21 offset:48128
    v_mfma_f32_16x16x32_bf16 v[180:183], v[136:139], v[108:111], v[180:183]
    ds_read_b128 v[128:131], v22 offset:11264
    v_mfma_f32_16x16x32_bf16 v[184:187], v[136:139], v[112:115], v[184:187]
    ds_read_b128 v[132:135], v22 offset:29696
    v_mfma_f32_16x16x32_bf16 v[188:191], v[140:143], v[96:99], v[188:191]
    ds_read_b64_tr_b16 v[152:153], v19 offset:46080
    v_mfma_f32_16x16x32_bf16 v[192:195], v[140:143], v[100:103], v[192:195]
    ds_read_b64_tr_b16 v[154:155], v19 offset:53760
    v_mfma_f32_16x16x32_bf16 v[196:199], v[140:143], v[104:107], v[196:199]
    ds_read_b64_tr_b16 v[156:157], v19 offset:46208
    v_mfma_f32_16x16x32_bf16 v[200:203], v[140:143], v[108:111], v[200:203]
    ds_read_b64_tr_b16 v[158:159], v19 offset:53888
    v_mfma_f32_16x16x32_bf16 v[204:207], v[140:143], v[112:115], v[204:207]
    ds_read_b64_tr_b16 v[160:161], v19 offset:46336
    v_mfma_f32_16x16x32_bf16 v[208:211], v[144:147], v[96:99], v[208:211]
    ds_read_b64_tr_b16 v[162:163], v19 offset:54016
    v_mfma_f32_16x16x32_bf16 v[212:215], v[144:147], v[100:103], v[212:215]
    ds_read_b64_tr_b16 v[164:165], v20 offset:46080
    v_mfma_f32_16x16x32_bf16 v[216:219], v[144:147], v[104:107], v[216:219]
    ds_read_b64_tr_b16 v[166:167], v20 offset:53760
    v_mfma_f32_16x16x32_bf16 v[220:223], v[144:147], v[108:111], v[220:223]
    s_add_u32 m0, s40, 15360
    s_mov_b32 s25, 1437696
    buffer_load_dwordx4 v8, s[12:15], s25 offen lds
    v_mfma_f32_16x16x32_bf16 v[224:227], v[144:147], v[112:115], v[224:227]
    s_add_u32 m0, s41, 15360
    s_mov_b32 s25, 1437696
    buffer_load_dwordx4 v9, s[12:15], s25 offen lds
    v_mfma_f32_16x16x32_bf16 v[228:231], v[148:151], v[96:99], v[228:231]
    s_add_u32 m0, s42, 15360
    s_mov_b32 s25, 1437696
    buffer_load_dwordx4 v10, s[12:15], s25 offen lds
    v_mfma_f32_16x16x32_bf16 v[232:235], v[148:151], v[100:103], v[232:235]
    s_add_u32 m0, s43, 15360
    s_mov_b32 s25, 1437696
    buffer_load_dwordx4 v11, s[12:15], s25 offen lds
    v_mfma_f32_16x16x32_bf16 v[236:239], v[148:151], v[104:107], v[236:239]
    v_mfma_f32_16x16x32_bf16 v[240:243], v[148:151], v[108:111], v[240:243]
    v_mfma_f32_16x16x32_bf16 v[244:247], v[148:151], v[112:115], v[244:247]
    s_waitcnt lgkmcnt(0)
    s_waitcnt vmcnt(4)
    s_barrier
    s_cmp_lg_u32 s22, 11
    s_cbranch_scc1 k1a_kernel_nocp11
    v_add_u32 v3, s40, v1
    ds_read_b128 v[248:251], v3 offset:46080
    v_add_u32 v3, s41, v1
    ds_read_b128 v[64:67], v3 offset:46080
    v_add_u32 v3, s42, v1
    ds_read_b128 v[68:71], v3 offset:46080
    v_add_u32 v3, s43, v1
    ds_read_b128 v[72:75], v3 offset:46080
    s_waitcnt lgkmcnt(0)
    s_add_u32 s25, s60, s40
    s_add_u32 s25, s25, 168960
    buffer_store_dwordx4 v[248:251], v1, s[16:19], s25 offen
    s_add_u32 s25, s60, s41
    s_add_u32 s25, s25, 168960
    buffer_store_dwordx4 v[64:67], v1, s[16:19], s25 offen
    s_add_u32 s25, s60, s42
    s_add_u32 s25, s25, 168960
    buffer_store_dwordx4 v[68:71], v1, s[16:19], s25 offen
    s_add_u32 s25, s60, s43
    s_add_u32 s25, s25, 168960
    buffer_store_dwordx4 v[72:75], v1, s[16:19], s25 offen
k1a_kernel_nocp11:
    v_mfma_f32_16x16x32_bf16 v[168:171], v[152:155], v[116:119], v[168:171]
    ds_read_b128 v[96:99], v21 offset:12288
    v_mfma_f32_16x16x32_bf16 v[172:175], v[152:155], v[120:123], v[172:175]
    ds_read_b128 v[100:103], v21 offset:30720
    v_mfma_f32_16x16x32_bf16 v[176:179], v[152:155], v[124:127], v[176:179]
    ds_read_b128 v[104:107], v21 offset:49152
    v_mfma_f32_16x16x32_bf16 v[180:183], v[152:155], v[128:131], v[180:183]
    ds_read_b128 v[108:111], v22 offset:12288
    v_mfma_f32_16x16x32_bf16 v[184:187], v[152:155], v[132:135], v[184:187]
    ds_read_b128 v[112:115], v22 offset:30720
    v_mfma_f32_16x16x32_bf16 v[188:191], v[156:159], v[116:119], v[188:191]
    ds_read_b64_tr_b16 v[136:137], v19 offset:0
    v_mfma_f32_16x16x32_bf16 v[192:195], v[156:159], v[120:123], v[192:195]
    ds_read_b64_tr_b16 v[138:139], v19 offset:7680
    v_mfma_f32_16x16x32_bf16 v[196:199], v[156:159], v[124:127], v[196:199]
    ds_read_b64_tr_b16 v[140:141], v19 offset:128
    v_mfma_f32_16x16x32_bf16 v[200:203], v[156:159], v[128:131], v[200:203]
    ds_read_b64_tr_b16 v[142:143], v19 offset:7808
    v_mfma_f32_16x16x32_bf16 v[204:207], v[156:159], v[132:135], v[204:207]
    ds_read_b64_tr_b16 v[144:145], v19 offset:256
    v_mfma_f32_16x16x32_bf16 v[208:211], v[160:163], v[116:119], v[208:211]
    ds_read_b64_tr_b16 v[146:147], v19 offset:7936
    v_mfma_f32_16x16x32_bf16 v[212:215], v[160:163], v[120:123], v[212:215]
    ds_read_b64_tr_b16 v[148:149], v20 offset:0
    v_mfma_f32_16x16x32_bf16 v[216:219], v[160:163], v[124:127], v[216:219]
    ds_read_b64_tr_b16 v[150:151], v20 offset:7680
    v_mfma_f32_16x16x32_bf16 v[220:223], v[160:163], v[128:131], v[220:223]
    s_add_u32 m0, s40, 30720
    s_mov_b32 s25, 1548288
    buffer_load_dwordx4 v8, s[12:15], s25 offen lds
    v_mfma_f32_16x16x32_bf16 v[224:227], v[160:163], v[132:135], v[224:227]
    s_add_u32 m0, s41, 30720
    s_mov_b32 s25, 1548288
    buffer_load_dwordx4 v9, s[12:15], s25 offen lds
    v_mfma_f32_16x16x32_bf16 v[228:231], v[164:167], v[116:119], v[228:231]
    s_add_u32 m0, s42, 30720
    s_mov_b32 s25, 1548288
    buffer_load_dwordx4 v10, s[12:15], s25 offen lds
    v_mfma_f32_16x16x32_bf16 v[232:235], v[164:167], v[120:123], v[232:235]
    s_add_u32 m0, s43, 30720
    s_mov_b32 s25, 1548288
    buffer_load_dwordx4 v11, s[12:15], s25 offen lds
    v_mfma_f32_16x16x32_bf16 v[236:239], v[164:167], v[124:127], v[236:239]
    v_mfma_f32_16x16x32_bf16 v[240:243], v[164:167], v[128:131], v[240:243]
    v_mfma_f32_16x16x32_bf16 v[244:247], v[164:167], v[132:135], v[244:247]
    s_waitcnt lgkmcnt(0)
    s_waitcnt vmcnt(4)
    s_barrier
    s_cmp_lg_u32 s22, 12
    s_cbranch_scc1 k1a_kernel_nocp12
    v_add_u32 v3, s40, v1
    ds_read_b128 v[248:251], v3 offset:0
    v_add_u32 v3, s41, v1
    ds_read_b128 v[64:67], v3 offset:0
    v_add_u32 v3, s42, v1
    ds_read_b128 v[68:71], v3 offset:0
    v_add_u32 v3, s43, v1
    ds_read_b128 v[72:75], v3 offset:0
    s_waitcnt lgkmcnt(0)
    s_add_u32 s25, s60, s40
    s_add_u32 s25, s25, 184320
    buffer_store_dwordx4 v[248:251], v1, s[16:19], s25 offen
    s_add_u32 s25, s60, s41
    s_add_u32 s25, s25, 184320
    buffer_store_dwordx4 v[64:67], v1, s[16:19], s25 offen
    s_add_u32 s25, s60, s42
    s_add_u32 s25, s25, 184320
    buffer_store_dwordx4 v[68:71], v1, s[16:19], s25 offen
    s_add_u32 s25, s60, s43
    s_add_u32 s25, s25, 184320
    buffer_store_dwordx4 v[72:75], v1, s[16:19], s25 offen
k1a_kernel_nocp12:
    v_mfma_f32_16x16x32_bf16 v[168:171], v[136:139], v[96:99], v[168:171]
    ds_read_b128 v[116:119], v21 offset:13312
    v_mfma_f32_16x16x32_bf16 v[172:175], v[136:139], v[100:103], v[172:175]
    ds_read_b128 v[120:123], v21 offset:31744
    v_mfma_f32_16x16x32_bf16 v[176:179], v[136:139], v[104:107], v[176:179]
    ds_read_b128 v[124:127], v21 offset:50176
    v_mfma_f32_16x16x32_bf16 v[180:183], v[136:139], v[108:111], v[180:183]
    ds_read_b128 v[128:131], v22 offset:13312
    v_mfma_f32_16x16x32_bf16 v[184:187], v[136:139], v[112:115], v[184:187]
    ds_read_b128 v[132:135], v22 offset:31744
    v_mfma_f32_16x16x32_bf16 v[188:191], v[140:143], v[96:99], v[188:191]
    ds_read_b64_tr_b16 v[152:153], v19 offset:15360
    v_mfma_f32_16x16x32_bf16 v[192:195], v[140:143], v[100:103], v[192:195]
    ds_read_b64_tr_b16 v[154:155], v19 offset:23040
    v_mfma_f32_16x16x32_bf16 v[196:199], v[140:143], v[104:107], v[196:199]
    ds_read_b64_tr_b16 v[156:157], v19 offset:15488
    v_mfma_f32_16x16x32_bf16 v[200:203], v[140:143], v[108:111], v[200:203]
    ds_read_b64_tr_b16 v[158:159], v19 offset:23168
    v_mfma_f32_16x16x32_bf16 v[204:207], v[140:143], v[112:115], v[204:207]
    ds_read_b64_tr_b16 v[160:161], v19 offset:15616
    v_mfma_f32_16x16x32_bf16 v[208:211], v[144:147], v[96:99], v[208:211]
    ds_read_b64_tr_b16 v[162:163], v19 offset:23296
    v_mfma_f32_16x16x32_bf16 v[212:215], v[144:147], v[100:103], v[212:215]
    ds_read_b64_tr_b16 v[164:165], v20 offset:15360
    v_mfma_f32_16x16x32_bf16 v[216:219], v[144:147], v[104:107], v[216:219]
    ds_read_b64_tr_b16 v[166:167], v20 offset:23040
    v_mfma_f32_16x16x32_bf16 v[220:223], v[144:147], v[108:111], v[220:223]
    s_add_u32 m0, s40, 46080
    s_mov_b32 s25, 1658880
    buffer_load_dwordx4 v8, s[12:15], s25 offen lds
    v_mfma_f32_16x16x32_bf16 v[224:227], v[144:147], v[112:115], v[224:227]
    s_add_u32 m0, s41, 46080
    s_mov_b32 s25, 1658880
    buffer_load_dwordx4 v9, s[12:15], s25 offen lds
    v_mfma_f32_16x16x32_bf16 v[228:231], v[148:151], v[96:99], v[228:231]
    s_add_u32 m0, s42, 46080
    s_mov_b32 s25, 1658880
    buffer_load_dwordx4 v10, s[12:15], s25 offen lds
    v_mfma_f32_16x16x32_bf16 v[232:235], v[148:151], v[100:103], v[232:235]
    s_add_u32 m0, s43, 46080
    s_mov_b32 s25, 1658880
    buffer_load_dwordx4 v11, s[12:15], s25 offen lds
    v_mfma_f32_16x16x32_bf16 v[236:239], v[148:151], v[104:107], v[236:239]
    v_mfma_f32_16x16x32_bf16 v[240:243], v[148:151], v[108:111], v[240:243]
    v_mfma_f32_16x16x32_bf16 v[244:247], v[148:151], v[112:115], v[244:247]
    s_waitcnt lgkmcnt(0)
    s_waitcnt vmcnt(4)
    s_barrier
    s_cmp_lg_u32 s22, 13
    s_cbranch_scc1 k1a_kernel_nocp13
    v_add_u32 v3, s40, v1
    ds_read_b128 v[248:251], v3 offset:15360
    v_add_u32 v3, s41, v1
    ds_read_b128 v[64:67], v3 offset:15360
    v_add_u32 v3, s42, v1
    ds_read_b128 v[68:71], v3 offset:15360
    v_add_u32 v3, s43, v1
    ds_read_b128 v[72:75], v3 offset:15360
    s_waitcnt lgkmcnt(0)
    s_add_u32 s25, s60, s40
    s_add_u32 s25, s25, 199680
    buffer_store_dwordx4 v[248:251], v1, s[16:19], s25 offen
    s_add_u32 s25, s60, s41
    s_add_u32 s25, s25, 199680
    buffer_store_dwordx4 v[64:67], v1, s[16:19], s25 offen
    s_add_u32 s25, s60, s42
    s_add_u32 s25, s25, 199680
    buffer_store_dwordx4 v[68:71], v1, s[16:19], s25 offen
    s_add_u32 s25, s60, s43
    s_add_u32 s25, s25, 199680
    buffer_store_dwordx4 v[72:75], v1, s[16:19], s25 offen
k1a_kernel_nocp13:
    v_mfma_f32_16x16x32_bf16 v[168:171], v[152:155], v[116:119], v[168:171]
    ds_read_b128 v[96:99], v21 offset:14336
    v_mfma_f32_16x16x32_bf16 v[172:175], v[152:155], v[120:123], v[172:175]
    ds_read_b128 v[100:103], v21 offset:32768
    v_mfma_f32_16x16x32_bf16 v[176:179], v[152:155], v[124:127], v[176:179]
    ds_read_b128 v[104:107], v21 offset:51200
    v_mfma_f32_16x16x32_bf16 v[180:183], v[152:155], v[128:131], v[180:183]
    ds_read_b128 v[108:111], v22 offset:14336
    v_mfma_f32_16x16x32_bf16 v[184:187], v[152:155], v[132:135], v[184:187]
    ds_read_b128 v[112:115], v22 offset:32768
    v_mfma_f32_16x16x32_bf16 v[188:191], v[156:159], v[116:119], v[188:191]
    ds_read_b64_tr_b16 v[136:137], v19 offset:30720
    v_mfma_f32_16x16x32_bf16 v[192:195], v[156:159], v[120:123], v[192:195]
    ds_read_b64_tr_b16 v[138:139], v19 offset:38400
    v_mfma_f32_16x16x32_bf16 v[196:199], v[156:159], v[124:127], v[196:199]
    ds_read_b64_tr_b16 v[140:141], v19 offset:30848
    v_mfma_f32_16x16x32_bf16 v[200:203], v[156:159], v[128:131], v[200:203]
    ds_read_b64_tr_b16 v[142:143], v19 offset:38528
    v_mfma_f32_16x16x32_bf16 v[204:207], v[156:159], v[132:135], v[204:207]
    ds_read_b64_tr_b16 v[144:145], v19 offset:30976
    v_mfma_f32_16x16x32_bf16 v[208:211], v[160:163], v[116:119], v[208:211]
    ds_read_b64_tr_b16 v[146:147], v19 offset:38656
    v_mfma_f32_16x16x32_bf16 v[212:215], v[160:163], v[120:123], v[212:215]
    ds_read_b64_tr_b16 v[148:149], v20 offset:30720
    v_mfma_f32_16x16x32_bf16 v[216:219], v[160:163], v[124:127], v[216:219]
    ds_read_b64_tr_b16 v[150:151], v20 offset:38400
    v_mfma_f32_16x16x32_bf16 v[220:223], v[160:163], v[128:131], v[220:223]
    s_add_u32 m0, s40, 0
    s_mov_b32 s25, 1769472
    buffer_load_dwordx4 v8, s[12:15], s25 offen lds
    v_mfma_f32_16x16x32_bf16 v[224:227], v[160:163], v[132:135], v[224:227]
    s_add_u32 m0, s41, 0
    s_mov_b32 s25, 1769472
    buffer_load_dwordx4 v9, s[12:15], s25 offen lds
    v_mfma_f32_16x16x32_bf16 v[228:231], v[164:167], v[116:119], v[228:231]
    s_add_u32 m0, s42, 0
    s_mov_b32 s25, 1769472
    buffer_load_dwordx4 v10, s[12:15], s25 offen lds
    v_mfma_f32_16x16x32_bf16 v[232:235], v[164:167], v[120:123], v[232:235]
    s_add_u32 m0, s43, 0
    s_mov_b32 s25, 1769472
    buffer_load_dwordx4 v11, s[12:15], s25 offen lds
    v_mfma_f32_16x16x32_bf16 v[236:239], v[164:167], v[124:127], v[236:239]
    v_mfma_f32_16x16x32_bf16 v[240:243], v[164:167], v[128:131], v[240:243]
    v_mfma_f32_16x16x32_bf16 v[244:247], v[164:167], v[132:135], v[244:247]
    s_waitcnt lgkmcnt(0)
    s_waitcnt vmcnt(4)
    s_barrier
    s_cmp_lg_u32 s22, 14
    s_cbranch_scc1 k1a_kernel_nocp14
    v_add_u32 v3, s40, v1
    ds_read_b128 v[248:251], v3 offset:30720
    v_add_u32 v3, s41, v1
    ds_read_b128 v[64:67], v3 offset:30720
    v_add_u32 v3, s42, v1
    ds_read_b128 v[68:71], v3 offset:30720
    v_add_u32 v3, s43, v1
    ds_read_b128 v[72:75], v3 offset:30720
    s_waitcnt lgkmcnt(0)
    s_add_u32 s25, s60, s40
    s_add_u32 s25, s25, 215040
    buffer_store_dwordx4 v[248:251], v1, s[16:19], s25 offen
    s_add_u32 s25, s60, s41
    s_add_u32 s25, s25, 215040
    buffer_store_dwordx4 v[64:67], v1, s[16:19], s25 offen
    s_add_u32 s25, s60, s42
    s_add_u32 s25, s25, 215040
    buffer_store_dwordx4 v[68:71], v1, s[16:19], s25 offen
    s_add_u32 s25, s60, s43
    s_add_u32 s25, s25, 215040
    buffer_store_dwordx4 v[72:75], v1, s[16:19], s25 offen
k1a_kernel_nocp14:
    v_mfma_f32_16x16x32_bf16 v[168:171], v[136:139], v[96:99], v[168:171]
    ds_read_b128 v[116:119], v21 offset:15360
    v_mfma_f32_16x16x32_bf16 v[172:175], v[136:139], v[100:103], v[172:175]
    ds_read_b128 v[120:123], v21 offset:33792
    v_mfma_f32_16x16x32_bf16 v[176:179], v[136:139], v[104:107], v[176:179]
    ds_read_b128 v[124:127], v21 offset:52224
    v_mfma_f32_16x16x32_bf16 v[180:183], v[136:139], v[108:111], v[180:183]
    ds_read_b128 v[128:131], v22 offset:15360
    v_mfma_f32_16x16x32_bf16 v[184:187], v[136:139], v[112:115], v[184:187]
    ds_read_b128 v[132:135], v22 offset:33792
    v_mfma_f32_16x16x32_bf16 v[188:191], v[140:143], v[96:99], v[188:191]
    ds_read_b64_tr_b16 v[152:153], v19 offset:46080
    v_mfma_f32_16x16x32_bf16 v[192:195], v[140:143], v[100:103], v[192:195]
    ds_read_b64_tr_b16 v[154:155], v19 offset:53760
    v_mfma_f32_16x16x32_bf16 v[196:199], v[140:143], v[104:107], v[196:199]
    ds_read_b64_tr_b16 v[156:157], v19 offset:46208
    v_mfma_f32_16x16x32_bf16 v[200:203], v[140:143], v[108:111], v[200:203]
    ds_read_b64_tr_b16 v[158:159], v19 offset:53888
    v_mfma_f32_16x16x32_bf16 v[204:207], v[140:143], v[112:115], v[204:207]
    ds_read_b64_tr_b16 v[160:161], v19 offset:46336
    v_mfma_f32_16x16x32_bf16 v[208:211], v[144:147], v[96:99], v[208:211]
    ds_read_b64_tr_b16 v[162:163], v19 offset:54016
    v_mfma_f32_16x16x32_bf16 v[212:215], v[144:147], v[100:103], v[212:215]
    ds_read_b64_tr_b16 v[164:165], v20 offset:46080
    v_mfma_f32_16x16x32_bf16 v[216:219], v[144:147], v[104:107], v[216:219]
    ds_read_b64_tr_b16 v[166:167], v20 offset:53760
    v_mfma_f32_16x16x32_bf16 v[220:223], v[144:147], v[108:111], v[220:223]
    s_add_u32 m0, s40, 15360
    s_mov_b32 s25, 1880064
    buffer_load_dwordx4 v8, s[12:15], s25 offen lds
    v_mfma_f32_16x16x32_bf16 v[224:227], v[144:147], v[112:115], v[224:227]
    s_add_u32 m0, s41, 15360
    s_mov_b32 s25, 1880064
    buffer_load_dwordx4 v9, s[12:15], s25 offen lds
    v_mfma_f32_16x16x32_bf16 v[228:231], v[148:151], v[96:99], v[228:231]
    s_add_u32 m0, s42, 15360
    s_mov_b32 s25, 1880064
    buffer_load_dwordx4 v10, s[12:15], s25 offen lds
    v_mfma_f32_16x16x32_bf16 v[232:235], v[148:151], v[100:103], v[232:235]
    s_add_u32 m0, s43, 15360
    s_mov_b32 s25, 1880064
    buffer_load_dwordx4 v11, s[12:15], s25 offen lds
    v_mfma_f32_16x16x32_bf16 v[236:239], v[148:151], v[104:107], v[236:239]
    v_mfma_f32_16x16x32_bf16 v[240:243], v[148:151], v[108:111], v[240:243]
    v_mfma_f32_16x16x32_bf16 v[244:247], v[148:151], v[112:115], v[244:247]
    s_waitcnt lgkmcnt(0)
    s_waitcnt vmcnt(4)
    s_barrier
    s_cmp_lg_u32 s22, 15
    s_cbranch_scc1 k1a_kernel_nocp15
    v_add_u32 v3, s40, v1
    ds_read_b128 v[248:251], v3 offset:46080
    v_add_u32 v3, s41, v1
    ds_read_b128 v[64:67], v3 offset:46080
    v_add_u32 v3, s42, v1
    ds_read_b128 v[68:71], v3 offset:46080
    v_add_u32 v3, s43, v1
    ds_read_b128 v[72:75], v3 offset:46080
    s_waitcnt lgkmcnt(0)
    s_add_u32 s25, s60, s40
    s_add_u32 s25, s25, 230400
    buffer_store_dwordx4 v[248:251], v1, s[16:19], s25 offen
    s_add_u32 s25, s60, s41
    s_add_u32 s25, s25, 230400
    buffer_store_dwordx4 v[64:67], v1, s[16:19], s25 offen
    s_add_u32 s25, s60, s42
    s_add_u32 s25, s25, 230400
    buffer_store_dwordx4 v[68:71], v1, s[16:19], s25 offen
    s_add_u32 s25, s60, s43
    s_add_u32 s25, s25, 230400
    buffer_store_dwordx4 v[72:75], v1, s[16:19], s25 offen
k1a_kernel_nocp15:
    v_mfma_f32_16x16x32_bf16 v[168:171], v[152:155], v[116:119], v[168:171]
    ds_read_b128 v[96:99], v21 offset:16384
    v_mfma_f32_16x16x32_bf16 v[172:175], v[152:155], v[120:123], v[172:175]
    ds_read_b128 v[100:103], v21 offset:34816
    v_mfma_f32_16x16x32_bf16 v[176:179], v[152:155], v[124:127], v[176:179]
    ds_read_b128 v[104:107], v21 offset:53248
    v_mfma_f32_16x16x32_bf16 v[180:183], v[152:155], v[128:131], v[180:183]
    ds_read_b128 v[108:111], v22 offset:16384
    v_mfma_f32_16x16x32_bf16 v[184:187], v[152:155], v[132:135], v[184:187]
    ds_read_b128 v[112:115], v22 offset:34816
    v_mfma_f32_16x16x32_bf16 v[188:191], v[156:159], v[116:119], v[188:191]
    ds_read_b64_tr_b16 v[136:137], v19 offset:0
    v_mfma_f32_16x16x32_bf16 v[192:195], v[156:159], v[120:123], v[192:195]
    ds_read_b64_tr_b16 v[138:139], v19 offset:7680
    v_mfma_f32_16x16x32_bf16 v[196:199], v[156:159], v[124:127], v[196:199]
    ds_read_b64_tr_b16 v[140:141], v19 offset:128
    v_mfma_f32_16x16x32_bf16 v[200:203], v[156:159], v[128:131], v[200:203]
    ds_read_b64_tr_b16 v[142:143], v19 offset:7808
    v_mfma_f32_16x16x32_bf16 v[204:207], v[156:159], v[132:135], v[204:207]
    ds_read_b64_tr_b16 v[144:145], v19 offset:256
    v_mfma_f32_16x16x32_bf16 v[208:211], v[160:163], v[116:119], v[208:211]
    ds_read_b64_tr_b16 v[146:147], v19 offset:7936
    v_mfma_f32_16x16x32_bf16 v[212:215], v[160:163], v[120:123], v[212:215]
    ds_read_b64_tr_b16 v[148:149], v20 offset:0
    v_mfma_f32_16x16x32_bf16 v[216:219], v[160:163], v[124:127], v[216:219]
    ds_read_b64_tr_b16 v[150:151], v20 offset:7680
    v_mfma_f32_16x16x32_bf16 v[220:223], v[160:163], v[128:131], v[220:223]
    v_mfma_f32_16x16x32_bf16 v[224:227], v[160:163], v[132:135], v[224:227]
    v_mfma_f32_16x16x32_bf16 v[228:231], v[164:167], v[116:119], v[228:231]
    v_mfma_f32_16x16x32_bf16 v[232:235], v[164:167], v[120:123], v[232:235]
    v_mfma_f32_16x16x32_bf16 v[236:239], v[164:167], v[124:127], v[236:239]
    v_mfma_f32_16x16x32_bf16 v[240:243], v[164:167], v[128:131], v[240:243]
    v_mfma_f32_16x16x32_bf16 v[244:247], v[164:167], v[132:135], v[244:247]
    s_waitcnt lgkmcnt(0)
    s_waitcnt vmcnt(0)
    s_barrier
    s_cmp_lg_u32 s22, 16
    s_cbranch_scc1 k1a_kernel_nocp16
    v_add_u32 v3, s40, v1
    ds_read_b128 v[248:251], v3 offset:0
    v_add_u32 v3, s41, v1
    ds_read_b128 v[64:67], v3 offset:0
    v_add_u32 v3, s42, v1
    ds_read_b128 v[68:71], v3 offset:0
    v_add_u32 v3, s43, v1
    ds_read_b128 v[72:75], v3 offset:0
    s_waitcnt lgkmcnt(0)
    s_add_u32 s25, s60, s40
    s_add_u32 s25, s25, 245760
    buffer_store_dwordx4 v[248:251], v1, s[16:19], s25 offen
    s_add_u32 s25, s60, s41
    s_add_u32 s25, s25, 245760
    buffer_store_dwordx4 v[64:67], v1, s[16:19], s25 offen
    s_add_u32 s25, s60, s42
    s_add_u32 s25, s25, 245760
    buffer_store_dwordx4 v[68:71], v1, s[16:19], s25 offen
    s_add_u32 s25, s60, s43
    s_add_u32 s25, s25, 245760
    buffer_store_dwordx4 v[72:75], v1, s[16:19], s25 offen
k1a_kernel_nocp16:
    v_mfma_f32_16x16x32_bf16 v[168:171], v[136:139], v[96:99], v[168:171]
    ds_read_b128 v[116:119], v21 offset:17408
    v_mfma_f32_16x16x32_bf16 v[172:175], v[136:139], v[100:103], v[172:175]
    ds_read_b128 v[120:123], v21 offset:35840
    v_mfma_f32_16x16x32_bf16 v[176:179], v[136:139], v[104:107], v[176:179]
    ds_read_b128 v[124:127], v21 offset:54272
    v_mfma_f32_16x16x32_bf16 v[180:183], v[136:139], v[108:111], v[180:183]
    ds_read_b128 v[128:131], v22 offset:17408
    v_mfma_f32_16x16x32_bf16 v[184:187], v[136:139], v[112:115], v[184:187]
    ds_read_b128 v[132:135], v22 offset:35840
    v_mfma_f32_16x16x32_bf16 v[188:191], v[140:143], v[96:99], v[188:191]
    ds_read_b64_tr_b16 v[152:153], v19 offset:15360
    v_mfma_f32_16x16x32_bf16 v[192:195], v[140:143], v[100:103], v[192:195]
    ds_read_b64_tr_b16 v[154:155], v19 offset:23040
    v_mfma_f32_16x16x32_bf16 v[196:199], v[140:143], v[104:107], v[196:199]
    ds_read_b64_tr_b16 v[156:157], v19 offset:15488
    v_mfma_f32_16x16x32_bf16 v[200:203], v[140:143], v[108:111], v[200:203]
    ds_read_b64_tr_b16 v[158:159], v19 offset:23168
    v_mfma_f32_16x16x32_bf16 v[204:207], v[140:143], v[112:115], v[204:207]
    ds_read_b64_tr_b16 v[160:161], v19 offset:15616
    v_mfma_f32_16x16x32_bf16 v[208:211], v[144:147], v[96:99], v[208:211]
    ds_read_b64_tr_b16 v[162:163], v19 offset:23296
    v_mfma_f32_16x16x32_bf16 v[212:215], v[144:147], v[100:103], v[212:215]
    ds_read_b64_tr_b16 v[164:165], v20 offset:15360
    v_mfma_f32_16x16x32_bf16 v[216:219], v[144:147], v[104:107], v[216:219]
    ds_read_b64_tr_b16 v[166:167], v20 offset:23040
    v_mfma_f32_16x16x32_bf16 v[220:223], v[144:147], v[108:111], v[220:223]
    v_mfma_f32_16x16x32_bf16 v[224:227], v[144:147], v[112:115], v[224:227]
    v_mfma_f32_16x16x32_bf16 v[228:231], v[148:151], v[96:99], v[228:231]
    v_mfma_f32_16x16x32_bf16 v[232:235], v[148:151], v[100:103], v[232:235]
    v_mfma_f32_16x16x32_bf16 v[236:239], v[148:151], v[104:107], v[236:239]
    v_mfma_f32_16x16x32_bf16 v[240:243], v[148:151], v[108:111], v[240:243]
    v_mfma_f32_16x16x32_bf16 v[244:247], v[148:151], v[112:115], v[244:247]
    s_waitcnt lgkmcnt(0)
    s_cmp_lg_u32 s22, 17
    s_cbranch_scc1 k1a_kernel_nocp17
    v_add_u32 v3, s40, v1
    ds_read_b128 v[248:251], v3 offset:15360
    v_add_u32 v3, s41, v1
    ds_read_b128 v[64:67], v3 offset:15360
    v_add_u32 v3, s42, v1
    ds_read_b128 v[68:71], v3 offset:15360
    v_add_u32 v3, s43, v1
    ds_read_b128 v[72:75], v3 offset:15360
    s_waitcnt lgkmcnt(0)
    s_add_u32 s25, s60, s40
    s_add_u32 s25, s25, 261120
    buffer_store_dwordx4 v[248:251], v1, s[16:19], s25 offen
    s_add_u32 s25, s60, s41
    s_add_u32 s25, s25, 261120
    buffer_store_dwordx4 v[64:67], v1, s[16:19], s25 offen
    s_add_u32 s25, s60, s42
    s_add_u32 s25, s25, 261120
    buffer_store_dwordx4 v[68:71], v1, s[16:19], s25 offen
    s_add_u32 s25, s60, s43
    s_add_u32 s25, s25, 261120
    buffer_store_dwordx4 v[72:75], v1, s[16:19], s25 offen
k1a_kernel_nocp17:
    v_mfma_f32_16x16x32_bf16 v[168:171], v[152:155], v[116:119], v[168:171]
    v_mfma_f32_16x16x32_bf16 v[172:175], v[152:155], v[120:123], v[172:175]
    v_mfma_f32_16x16x32_bf16 v[176:179], v[152:155], v[124:127], v[176:179]
    v_mfma_f32_16x16x32_bf16 v[180:183], v[152:155], v[128:131], v[180:183]
    v_mfma_f32_16x16x32_bf16 v[184:187], v[152:155], v[132:135], v[184:187]
    v_mfma_f32_16x16x32_bf16 v[188:191], v[156:159], v[116:119], v[188:191]
    v_mfma_f32_16x16x32_bf16 v[192:195], v[156:159], v[120:123], v[192:195]
    v_mfma_f32_16x16x32_bf16 v[196:199], v[156:159], v[124:127], v[196:199]
    v_mfma_f32_16x16x32_bf16 v[200:203], v[156:159], v[128:131], v[200:203]
    v_mfma_f32_16x16x32_bf16 v[204:207], v[156:159], v[132:135], v[204:207]
    v_mfma_f32_16x16x32_bf16 v[208:211], v[160:163], v[116:119], v[208:211]
    v_mfma_f32_16x16x32_bf16 v[212:215], v[160:163], v[120:123], v[212:215]
    v_mfma_f32_16x16x32_bf16 v[216:219], v[160:163], v[124:127], v[216:219]
    v_mfma_f32_16x16x32_bf16 v[220:223], v[160:163], v[128:131], v[220:223]
    v_mfma_f32_16x16x32_bf16 v[224:227], v[160:163], v[132:135], v[224:227]
    v_mfma_f32_16x16x32_bf16 v[228:231], v[164:167], v[116:119], v[228:231]
    v_mfma_f32_16x16x32_bf16 v[232:235], v[164:167], v[120:123], v[232:235]
    v_mfma_f32_16x16x32_bf16 v[236:239], v[164:167], v[124:127], v[236:239]
    v_mfma_f32_16x16x32_bf16 v[240:243], v[164:167], v[128:131], v[240:243]
    v_mfma_f32_16x16x32_bf16 v[244:247], v[164:167], v[132:135], v[244:247]
    s_lshl_b32 s30, s2, 2
    s_add_u32 s30, s30, s20
    s_lshl_b32 s30, s30, 10
    v_lshlrev_b32 v3, 4, v0
    v_add_u32 v3, s30, v3
    s_mov_b32 s56, s48
    s_and_b32 s57, s49, 0xffff
    s_mov_b32 s58, 663552
    s_mov_b32 s59, 0x00020000
    s_mov_b32 s31, 0
    buffer_load_dwordx4 v[248:251], v3, s[56:59], s31 offen
    s_barrier
    v_and_b32 v3, 15, v0
    v_mul_u32_u24 v3, 1056, v3
    v_lshrrev_b32 v4, 4, v0
    v_lshlrev_b32 v4, 4, v4
    v_add_u32 v3, v3, v4
    s_lshl_b32 s30, s20, 6
    v_add_u32 v3, s30, v3
    v_add_u32 v4, 50688, v3
    v_cvt_pk_bf16_f32 v5, v168, v169
    v_cvt_pk_bf16_f32 v6, v170, v171
    v_lshlrev_b32 v168, 16, v5
    v_and_b32 v169, s34, v5
    v_lshlrev_b32 v170, 16, v6
    v_and_b32 v171, s34, v6
    ds_write_b128 v3, v[168:171] offset:0
    v_cvt_pk_bf16_f32 v5, v172, v173
    v_cvt_pk_bf16_f32 v6, v174, v175
    v_lshlrev_b32 v172, 16, v5
    v_and_b32 v173, s34, v5
    v_lshlrev_b32 v174, 16, v6
    v_and_b32 v175, s34, v6
    ds_write_b128 v3, v[172:175] offset:16896
    v_cvt_pk_bf16_f32 v5, v176, v177
    v_cvt_pk_bf16_f32 v6, v178, v179
    v_lshlrev_b32 v176, 16, v5
    v_and_b32 v177, s34, v5
    v_lshlrev_b32 v178, 16, v6
    v_and_b32 v179, s34, v6
    ds_write_b128 v3, v[176:179] offset:33792
    v_cvt_pk_bf16_f32 v5, v180, v181
    v_cvt_pk_bf16_f32 v6, v182, v183
    v_lshlrev_b32 v180, 16, v5
    v_and_b32 v181, s34, v5
    v_lshlrev_b32 v182, 16, v6
    v_and_b32 v183, s34, v6
    ds_write_b128 v4, v[180:183] offset:0
    v_cvt_pk_bf16_f32 v5, v184, v185
    v_cvt_pk_bf16_f32 v6, v186, v187
    v_lshlrev_b32 v184, 16, v5
    v_and_b32 v185, s34, v5
    v_lshlrev_b32 v186, 16, v6
    v_and_b32 v187, s34, v6
    ds_write_b128 v4, v[184:187] offset:16896
    v_cvt_pk_bf16_f32 v5, v188, v189
    v_cvt_pk_bf16_f32 v6, v190, v191
    v_lshlrev_b32 v188, 16, v5
    v_and_b32 v189, s34, v5
    v_lshlrev_b32 v190, 16, v6
    v_and_b32 v191, s34, v6
    ds_write_b128 v3, v[188:191] offset:256
    v_cvt_pk_bf16_f32 v5, v192, v193
    v_cvt_pk_bf16_f32 v6, v194, v195
    v_lshlrev_b32 v192, 16, v5
    v_and_b32 v193, s34, v5
    v_lshlrev_b32 v194, 16, v6
    v_and_b32 v195, s34, v6
    ds_write_b128 v3, v[192:195] offset:17152
    v_cvt_pk_bf16_f32 v5, v196, v197
    v_cvt_pk_bf16_f32 v6, v198, v199
    v_lshlrev_b32 v196, 16, v5
    v_and_b32 v197, s34, v5
    v_lshlrev_b32 v198, 16, v6
    v_and_b32 v199, s34, v6
    ds_write_b128 v3, v[196:199] offset:34048
    v_cvt_pk_bf16_f32 v5, v200, v201
    v_cvt_pk_bf16_f32 v6, v202, v203
    v_lshlrev_b32 v200, 16, v5
    v_and_b32 v201, s34, v5
    v_lshlrev_b32 v202, 16, v6
    v_and_b32 v203, s34, v6
    ds_write_b128 v4, v[200:203] offset:256
    v_cvt_pk_bf16_f32 v5, v204, v205
    v_cvt_pk_bf16_f32 v6, v206, v207
    v_lshlrev_b32 v204, 16, v5
    v_and_b32 v205, s34, v5
    v_lshlrev_b32 v206, 16, v6
    v_and_b32 v207, s34, v6
    ds_write_b128 v4, v[204:207] offset:17152
    v_cvt_pk_bf16_f32 v5, v208, v209
    v_cvt_pk_bf16_f32 v6, v210, v211
    v_lshlrev_b32 v208, 16, v5
    v_and_b32 v209, s34, v5
    v_lshlrev_b32 v210, 16, v6
    v_and_b32 v211, s34, v6
    ds_write_b128 v3, v[208:211] offset:512
    v_cvt_pk_bf16_f32 v5, v212, v213
    v_cvt_pk_bf16_f32 v6, v214, v215
    v_lshlrev_b32 v212, 16, v5
    v_and_b32 v213, s34, v5
    v_lshlrev_b32 v214, 16, v6
    v_and_b32 v215, s34, v6
    ds_write_b128 v3, v[212:215] offset:17408
    v_cvt_pk_bf16_f32 v5, v216, v217
    v_cvt_pk_bf16_f32 v6, v218, v219
    v_lshlrev_b32 v216, 16, v5
    v_and_b32 v217, s34, v5
    v_lshlrev_b32 v218, 16, v6
    v_and_b32 v219, s34, v6
    ds_write_b128 v3, v[216:219] offset:34304
    v_cvt_pk_bf16_f32 v5, v220, v221
    v_cvt_pk_bf16_f32 v6, v222, v223
    v_lshlrev_b32 v220, 16, v5
    v_and_b32 v221, s34, v5
    v_lshlrev_b32 v222, 16, v6
    v_and_b32 v223, s34, v6
    ds_write_b128 v4, v[220:223] offset:512
    v_cvt_pk_bf16_f32 v5, v224, v225
    v_cvt_pk_bf16_f32 v6, v226, v227
    v_lshlrev_b32 v224, 16, v5
    v_and_b32 v225, s34, v5
    v_lshlrev_b32 v226, 16, v6
    v_and_b32 v227, s34, v6
    ds_write_b128 v4, v[224:227] offset:17408
    s_cmp_ge_u32 s20, 2
    s_cbranch_scc1 k1a_kernel_qskip
    s_mov_b64 s[44:45], exec
    s_cmp_eq_u32 s20, 1
    s_cselect_b32 s46, 0, -1
    s_mov_b32 exec_hi, s46
    v_cvt_pk_bf16_f32 v5, v228, v229
    v_cvt_pk_bf16_f32 v6, v230, v231
    v_lshlrev_b32 v228, 16, v5
    v_and_b32 v229, s34, v5
    v_lshlrev_b32 v230, 16, v6
    v_and_b32 v231, s34, v6
    ds_write_b128 v3, v[228:231] offset:768
    v_cvt_pk_bf16_f32 v5, v232, v233
    v_cvt_pk_bf16_f32 v6, v234, v235
    v_lshlrev_b32 v232, 16, v5
    v_and_b32 v233, s34, v5
    v_lshlrev_b32 v234, 16, v6
    v_and_b32 v235, s34, v6
    ds_write_b128 v3, v[232:235] offset:17664
    v_cvt_pk_bf16_f32 v5, v236, v237
    v_cvt_pk_bf16_f32 v6, v238, v239
    v_lshlrev_b32 v236, 16, v5
    v_and_b32 v237, s34, v5
    v_lshlrev_b32 v238, 16, v6
    v_and_b32 v239, s34, v6
    ds_write_b128 v3, v[236:239] offset:34560
    v_cvt_pk_bf16_f32 v5, v240, v241
    v_cvt_pk_bf16_f32 v6, v242, v243
    v_lshlrev_b32 v240, 16, v5
    v_and_b32 v241, s34, v5
    v_lshlrev_b32 v242, 16, v6
    v_and_b32 v243, s34, v6
    ds_write_b128 v4, v[240:243] offset:768
    v_cvt_pk_bf16_f32 v5, v244, v245
    v_cvt_pk_bf16_f32 v6, v246, v247
    v_lshlrev_b32 v244, 16, v5
    v_and_b32 v245, s34, v5
    v_lshlrev_b32 v246, 16, v6
    v_and_b32 v247, s34, v6
    ds_write_b128 v4, v[244:247] offset:17664
    s_mov_b64 exec, s[44:45]
k1a_kernel_qskip:
    s_waitcnt lgkmcnt(0)
    s_barrier
    v_lshrrev_b32 v3, 2, v2
    v_and_b32 v4, 3, v2
    v_mul_u32_u24 v5, 1056, v3
    v_mul_u32_u24 v6, 72, v4
    v_add_u32 v5, v5, v6
    s_lshl_b32 s30, s22, 6
    v_add_u32 v7, s30, v3
    ds_read_b64 v[20:21], v5 offset:16896
    ds_read_b64 v[22:23], v5 offset:16904
    ds_read_b64 v[24:25], v5 offset:16912
    ds_read_b64 v[26:27], v5 offset:16920
    ds_read_b64 v[28:29], v5 offset:16928
    ds_read_b64 v[30:31], v5 offset:16936
    ds_read_b64 v[32:33], v5 offset:16944
    ds_read_b64 v[34:35], v5 offset:16952
    ds_read_b64 v[36:37], v5 offset:16960
    ds_read_b64 v[40:41], v5 offset:17184
    ds_read_b64 v[42:43], v5 offset:17192
    ds_read_b64 v[44:45], v5 offset:17200
    ds_read_b64 v[46:47], v5 offset:17208
    ds_read_b64 v[48:49], v5 offset:17216
    ds_read_b64 v[50:51], v5 offset:17224
    ds_read_b64 v[52:53], v5 offset:17232
    ds_read_b64 v[54:55], v5 offset:17240
    ds_read_b64 v[56:57], v5 offset:17248
    s_mov_b32 s31, 0x3e715bef
    ds_read_b64 v[58:59], v5 offset:15072
    ds_read_b64 v[60:61], v5 offset:15080
    ds_read_b64 v[62:63], v5 offset:15088
    ds_read_b64 v[64:65], v5 offset:15096
    ds_read_b64 v[66:67], v5 offset:15104
    ds_read_b64 v[68:69], v5 offset:15112
    ds_read_b64 v[70:71], v5 offset:15120
    ds_read_b64 v[72:73], v5 offset:15128
    ds_read_b64 v[74:75], v5 offset:15136
    s_waitcnt lgkmcnt(9)
    v_mul_f32 v112, v20, v40
    v_mul_f32 v8, v21, v41
    v_fma_f32 v112, v22, v42, v112
    v_fma_f32 v8, v23, v43, v8
    v_fma_f32 v112, v24, v44, v112
    v_fma_f32 v8, v25, v45, v8
    v_fma_f32 v112, v26, v46, v112
    v_fma_f32 v8, v27, v47, v8
    v_fma_f32 v112, v28, v48, v112
    v_fma_f32 v8, v29, v49, v8
    v_fma_f32 v112, v30, v50, v112
    v_fma_f32 v8, v31, v51, v8
    v_fma_f32 v112, v32, v52, v112
    v_fma_f32 v8, v33, v53, v8
    v_fma_f32 v112, v34, v54, v112
    v_fma_f32 v8, v35, v55, v8
    v_fma_f32 v112, v36, v56, v112
    v_fma_f32 v8, v37, v57, v8
    v_add_f32 v112, v112, v8
    v_cvt_pk_bf16_f32 v112, v112, v112
    v_lshlrev_b32 v112, 16, v112
    v_mul_f32 v112, s31, v112
    v_cvt_pk_bf16_f32 v112, v112, v112
    v_lshlrev_b32 v112, 16, v112
    ds_read_b64 v[40:41], v5 offset:12960
    ds_read_b64 v[42:43], v5 offset:12968
    ds_read_b64 v[44:45], v5 offset:12976
    ds_read_b64 v[46:47], v5 offset:12984
    ds_read_b64 v[48:49], v5 offset:12992
    ds_read_b64 v[50:51], v5 offset:13000
    ds_read_b64 v[52:53], v5 offset:13008
    ds_read_b64 v[54:55], v5 offset:13016
    ds_read_b64 v[56:57], v5 offset:13024
    s_waitcnt lgkmcnt(9)
    v_mul_f32 v113, v20, v58
    v_mul_f32 v8, v21, v59
    v_fma_f32 v113, v22, v60, v113
    v_fma_f32 v8, v23, v61, v8
    v_fma_f32 v113, v24, v62, v113
    v_fma_f32 v8, v25, v63, v8
    v_fma_f32 v113, v26, v64, v113
    v_fma_f32 v8, v27, v65, v8
    v_fma_f32 v113, v28, v66, v113
    v_fma_f32 v8, v29, v67, v8
    v_fma_f32 v113, v30, v68, v113
    v_fma_f32 v8, v31, v69, v8
    v_fma_f32 v113, v32, v70, v113
    v_fma_f32 v8, v33, v71, v8
    v_fma_f32 v113, v34, v72, v113
    v_fma_f32 v8, v35, v73, v8
    v_fma_f32 v113, v36, v74, v113
    v_fma_f32 v8, v37, v75, v8
    v_add_f32 v113, v113, v8
    v_cvt_pk_bf16_f32 v113, v113, v113
    v_lshlrev_b32 v113, 16, v113
    v_mul_f32 v113, s31, v113
    v_cvt_pk_bf16_f32 v113, v113, v113
    v_lshlrev_b32 v113, 16, v113
    v_cmp_le_u32 vcc, 2, v7
    v_mov_b32 v8, 0xce6e6b28
    s_nop 0
    v_cndmask_b32 v113, v8, v113, vcc
    ds_read_b64 v[58:59], v5 offset:10848
    ds_read_b64 v[60:61], v5 offset:10856
    ds_read_b64 v[62:63], v5 offset:10864
    ds_read_b64 v[64:65], v5 offset:10872
    ds_read_b64 v[66:67], v5 offset:10880
    ds_read_b64 v[68:69], v5 offset:10888
    ds_read_b64 v[70:71], v5 offset:10896
    ds_read_b64 v[72:73], v5 offset:10904
    ds_read_b64 v[74:75], v5 offset:10912
    s_waitcnt lgkmcnt(9)
    v_mul_f32 v114, v20, v40
    v_mul_f32 v8, v21, v41
    v_fma_f32 v114, v22, v42, v114
    v_fma_f32 v8, v23, v43, v8
    v_fma_f32 v114, v24, v44, v114
    v_fma_f32 v8, v25, v45, v8
    v_fma_f32 v114, v26, v46, v114
    v_fma_f32 v8, v27, v47, v8
    v_fma_f32 v114, v28, v48, v114
    v_fma_f32 v8, v29, v49, v8
    v_fma_f32 v114, v30, v50, v114
    v_fma_f32 v8, v31, v51, v8
    v_fma_f32 v114, v32, v52, v114
    v_fma_f32 v8, v33, v53, v8
    v_fma_f32 v114, v34, v54, v114
    v_fma_f32 v8, v35, v55, v8
    v_fma_f32 v114, v36, v56, v114
    v_fma_f32 v8, v37, v57, v8
    v_add_f32 v114, v114, v8
    v_cvt_pk_bf16_f32 v114, v114, v114
    v_lshlrev_b32 v114, 16, v114
    v_mul_f32 v114, s31, v114
    v_cvt_pk_bf16_f32 v114, v114, v114
    v_lshlrev_b32 v114, 16, v114
    v_cmp_le_u32 vcc, 4, v7
    v_mov_b32 v8, 0xce6e6b28
    s_nop 0
    v_cndmask_b32 v114, v8, v114, vcc
    ds_read_b64 v[40:41], v5 offset:8736
    ds_read_b64 v[42:43], v5 offset:8744
    ds_read_b64 v[44:45], v5 offset:8752
    ds_read_b64 v[46:47], v5 offset:8760
    ds_read_b64 v[48:49], v5 offset:8768
    ds_read_b64 v[50:51], v5 offset:8776
    ds_read_b64 v[52:53], v5 offset:8784
    ds_read_b64 v[54:55], v5 offset:8792
    ds_read_b64 v[56:57], v5 offset:8800
    s_waitcnt lgkmcnt(9)
    v_mul_f32 v115, v20, v58
    v_mul_f32 v8, v21, v59
    v_fma_f32 v115, v22, v60, v115
    v_fma_f32 v8, v23, v61, v8
    v_fma_f32 v115, v24, v62, v115
    v_fma_f32 v8, v25, v63, v8
    v_fma_f32 v115, v26, v64, v115
    v_fma_f32 v8, v27, v65, v8
    v_fma_f32 v115, v28, v66, v115
    v_fma_f32 v8, v29, v67, v8
    v_fma_f32 v115, v30, v68, v115
    v_fma_f32 v8, v31, v69, v8
    v_fma_f32 v115, v32, v70, v115
    v_fma_f32 v8, v33, v71, v8
    v_fma_f32 v115, v34, v72, v115
    v_fma_f32 v8, v35, v73, v8
    v_fma_f32 v115, v36, v74, v115
    v_fma_f32 v8, v37, v75, v8
    v_add_f32 v115, v115, v8
    v_cvt_pk_bf16_f32 v115, v115, v115
    v_lshlrev_b32 v115, 16, v115
    v_mul_f32 v115, s31, v115
    v_cvt_pk_bf16_f32 v115, v115, v115
    v_lshlrev_b32 v115, 16, v115
    v_cmp_le_u32 vcc, 6, v7
    v_mov_b32 v8, 0xce6e6b28
    s_nop 0
    v_cndmask_b32 v115, v8, v115, vcc
    ds_read_b64 v[58:59], v5 offset:6624
    ds_read_b64 v[60:61], v5 offset:6632
    ds_read_b64 v[62:63], v5 offset:6640
    ds_read_b64 v[64:65], v5 offset:6648
    ds_read_b64 v[66:67], v5 offset:6656
    ds_read_b64 v[68:69], v5 offset:6664
    ds_read_b64 v[70:71], v5 offset:6672
    ds_read_b64 v[72:73], v5 offset:6680
    ds_read_b64 v[74:75], v5 offset:6688
    s_waitcnt lgkmcnt(9)
    v_mul_f32 v116, v20, v40
    v_mul_f32 v8, v21, v41
    v_fma_f32 v116, v22, v42, v116
    v_fma_f32 v8, v23, v43, v8
    v_fma_f32 v116, v24, v44, v116
    v_fma_f32 v8, v25, v45, v8
    v_fma_f32 v116, v26, v46, v116
    v_fma_f32 v8, v27, v47, v8
    v_fma_f32 v116, v28, v48, v116
    v_fma_f32 v8, v29, v49, v8
    v_fma_f32 v116, v30, v50, v116
    v_fma_f32 v8, v31, v51, v8
    v_fma_f32 v116, v32, v52, v116
    v_fma_f32 v8, v33, v53, v8
    v_fma_f32 v116, v34, v54, v116
    v_fma_f32 v8, v35, v55, v8
    v_fma_f32 v116, v36, v56, v116
    v_fma_f32 v8, v37, v57, v8
    v_add_f32 v116, v116, v8
    v_cvt_pk_bf16_f32 v116, v116, v116
    v_lshlrev_b32 v116, 16, v116
    v_mul_f32 v116, s31, v116
    v_cvt_pk_bf16_f32 v116, v116, v116
    v_lshlrev_b32 v116, 16, v116
    v_cmp_le_u32 vcc, 8, v7
    v_mov_b32 v8, 0xce6e6b28
    s_nop 0
    v_cndmask_b32 v116, v8, v116, vcc
    ds_read_b64 v[40:41], v5 offset:4512
    ds_read_b64 v[42:43], v5 offset:4520
    ds_read_b64 v[44:45], v5 offset:4528
    ds_read_b64 v[46:47], v5 offset:4536
    ds_read_b64 v[48:49], v5 offset:4544
    ds_read_b64 v[50:51], v5 offset:4552
    ds_read_b64 v[52:53], v5 offset:4560
    ds_read_b64 v[54:55], v5 offset:4568
    ds_read_b64 v[56:57], v5 offset:4576
    s_waitcnt lgkmcnt(9)
    v_mul_f32 v117, v20, v58
    v_mul_f32 v8, v21, v59
    v_fma_f32 v117, v22, v60, v117
    v_fma_f32 v8, v23, v61, v8
    v_fma_f32 v117, v24, v62, v117
    v_fma_f32 v8, v25, v63, v8
    v_fma_f32 v117, v26, v64, v117
    v_fma_f32 v8, v27, v65, v8
    v_fma_f32 v117, v28, v66, v117
    v_fma_f32 v8, v29, v67, v8
    v_fma_f32 v117, v30, v68, v117
    v_fma_f32 v8, v31, v69, v8
    v_fma_f32 v117, v32, v70, v117
    v_fma_f32 v8, v33, v71, v8
    v_fma_f32 v117, v34, v72, v117
    v_fma_f32 v8, v35, v73, v8
    v_fma_f32 v117, v36, v74, v117
    v_fma_f32 v8, v37, v75, v8
    v_add_f32 v117, v117, v8
    v_cvt_pk_bf16_f32 v117, v117, v117
    v_lshlrev_b32 v117, 16, v117
    v_mul_f32 v117, s31, v117
    v_cvt_pk_bf16_f32 v117, v117, v117
    v_lshlrev_b32 v117, 16, v117
    v_cmp_le_u32 vcc, 10, v7
    v_mov_b32 v8, 0xce6e6b28
    s_nop 0
    v_cndmask_b32 v117, v8, v117, vcc
    ds_read_b64 v[58:59], v5 offset:2400
    ds_read_b64 v[60:61], v5 offset:2408
    ds_read_b64 v[62:63], v5 offset:2416
    ds_read_b64 v[64:65], v5 offset:2424
    ds_read_b64 v[66:67], v5 offset:2432
    ds_read_b64 v[68:69], v5 offset:2440
    ds_read_b64 v[70:71], v5 offset:2448
    ds_read_b64 v[72:73], v5 offset:2456
    ds_read_b64 v[74:75], v5 offset:2464
    s_waitcnt lgkmcnt(9)
    v_mul_f32 v118, v20, v40
    v_mul_f32 v8, v21, v41
    v_fma_f32 v118, v22, v42, v118
    v_fma_f32 v8, v23, v43, v8
    v_fma_f32 v118, v24, v44, v118
    v_fma_f32 v8, v25, v45, v8
    v_fma_f32 v118, v26, v46, v118
    v_fma_f32 v8, v27, v47, v8
    v_fma_f32 v118, v28, v48, v118
    v_fma_f32 v8, v29, v49, v8
    v_fma_f32 v118, v30, v50, v118
    v_fma_f32 v8, v31, v51, v8
    v_fma_f32 v118, v32, v52, v118
    v_fma_f32 v8, v33, v53, v8
    v_fma_f32 v118, v34, v54, v118
    v_fma_f32 v8, v35, v55, v8
    v_fma_f32 v118, v36, v56, v118
    v_fma_f32 v8, v37, v57, v8
    v_add_f32 v118, v118, v8
    v_cvt_pk_bf16_f32 v118, v118, v118
    v_lshlrev_b32 v118, 16, v118
    v_mul_f32 v118, s31, v118
    v_cvt_pk_bf16_f32 v118, v118, v118
    v_lshlrev_b32 v118, 16, v118
    v_cmp_le_u32 vcc, 12, v7
    v_mov_b32 v8, 0xce6e6b28
    s_nop 0
    v_cndmask_b32 v118, v8, v118, vcc
    ds_read_b64 v[40:41], v5 offset:17472
    ds_read_b64 v[42:43], v5 offset:17480
    ds_read_b64 v[44:45], v5 offset:17488
    ds_read_b64 v[46:47], v5 offset:17496
    ds_read_b64 v[48:49], v5 offset:17504
    ds_read_b64 v[50:51], v5 offset:17512
    ds_read_b64 v[52:53], v5 offset:17520
    ds_read_b64 v[54:55], v5 offset:17528
    ds_read_b64 v[56:57], v5 offset:17536
    s_waitcnt lgkmcnt(9)
    v_mul_f32 v119, v20, v58
    v_mul_f32 v8, v21, v59
    v_fma_f32 v119, v22, v60, v119
    v_fma_f32 v8, v23, v61, v8
    v_fma_f32 v119, v24, v62, v119
    v_fma_f32 v8, v25, v63, v8
    v_fma_f32 v119, v26, v64, v119
    v_fma_f32 v8, v27, v65, v8
    v_fma_f32 v119, v28, v66, v119
    v_fma_f32 v8, v29, v67, v8
    v_fma_f32 v119, v30, v68, v119
    v_fma_f32 v8, v31, v69, v8
    v_fma_f32 v119, v32, v70, v119
    v_fma_f32 v8, v33, v71, v8
    v_fma_f32 v119, v34, v72, v119
    v_fma_f32 v8, v35, v73, v8
    v_fma_f32 v119, v36, v74, v119
    v_fma_f32 v8, v37, v75, v8
    v_add_f32 v119, v119, v8
    v_cvt_pk_bf16_f32 v119, v119, v119
    v_lshlrev_b32 v119, 16, v119
    v_mul_f32 v119, s31, v119
    v_cvt_pk_bf16_f32 v119, v119, v119
    v_lshlrev_b32 v119, 16, v119
    v_cmp_le_u32 vcc, 14, v7
    v_mov_b32 v8, 0xce6e6b28
    s_nop 0
    v_cndmask_b32 v119, v8, v119, vcc
    v_max_f32 v8, v112, v113
    v_max_f32 v8, v8, v114
    v_max_f32 v8, v8, v115
    v_max_f32 v8, v8, v116
    v_max_f32 v8, v8, v117
    v_max_f32 v8, v8, v118
    v_max_f32 v8, v8, v119
    s_mov_b32 s31, 0x3fb8aa3b
    v_sub_f32 v112, v112, v8
    v_mul_f32 v112, s31, v112
    v_exp_f32 v112, v112
    v_sub_f32 v113, v113, v8
    v_mul_f32 v113, s31, v113
    v_exp_f32 v113, v113
    v_sub_f32 v114, v114, v8
    v_mul_f32 v114, s31, v114
    v_exp_f32 v114, v114
    v_sub_f32 v115, v115, v8
    v_mul_f32 v115, s31, v115
    v_exp_f32 v115, v115
    v_sub_f32 v116, v116, v8
    v_mul_f32 v116, s31, v116
    v_exp_f32 v116, v116
    v_sub_f32 v117, v117, v8
    v_mul_f32 v117, s31, v117
    v_exp_f32 v117, v117
    v_sub_f32 v118, v118, v8
    v_mul_f32 v118, s31, v118
    v_exp_f32 v118, v118
    v_sub_f32 v119, v119, v8
    v_mul_f32 v119, s31, v119
    v_exp_f32 v119, v119
    s_nop 0
    v_add_f32 v8, v112, v113
    v_add_f32 v8, v8, v114
    v_add_f32 v8, v8, v115
    v_add_f32 v8, v8, v116
    v_add_f32 v8, v8, v117
    v_add_f32 v8, v8, v118
    v_add_f32 v8, v8, v119
    v_rcp_f32 v8, v8
    s_nop 0
    v_mul_f32 v112, v112, v8
    v_cvt_pk_bf16_f32 v112, v112, v112
    v_lshlrev_b32 v112, 16, v112
    v_mul_f32 v113, v113, v8
    v_cvt_pk_bf16_f32 v113, v113, v113
    v_lshlrev_b32 v113, 16, v113
    v_mul_f32 v114, v114, v8
    v_cvt_pk_bf16_f32 v114, v114, v114
    v_lshlrev_b32 v114, 16, v114
    v_mul_f32 v115, v115, v8
    v_cvt_pk_bf16_f32 v115, v115, v115
    v_lshlrev_b32 v115, 16, v115
    v_mul_f32 v116, v116, v8
    v_cvt_pk_bf16_f32 v116, v116, v116
    v_lshlrev_b32 v116, 16, v116
    v_mul_f32 v117, v117, v8
    v_cvt_pk_bf16_f32 v117, v117, v117
    v_lshlrev_b32 v117, 16, v117
    v_mul_f32 v118, v118, v8
    v_cvt_pk_bf16_f32 v118, v118, v118
    v_lshlrev_b32 v118, 16, v118
    v_mul_f32 v119, v119, v8
    v_cvt_pk_bf16_f32 v119, v119, v119
    v_lshlrev_b32 v119, 16, v119
    ds_read_b64 v[58:59], v5 offset:15360
    ds_read_b64 v[60:61], v5 offset:15368
    ds_read_b64 v[62:63], v5 offset:15376
    ds_read_b64 v[64:65], v5 offset:15384
    ds_read_b64 v[66:67], v5 offset:15392
    ds_read_b64 v[68:69], v5 offset:15400
    ds_read_b64 v[70:71], v5 offset:15408
    ds_read_b64 v[72:73], v5 offset:15416
    ds_read_b64 v[74:75], v5 offset:15424
    s_waitcnt lgkmcnt(9)
    v_mul_f32 v120, v112, v40
    v_mul_f32 v121, v112, v41
    v_mul_f32 v122, v112, v42
    v_mul_f32 v123, v112, v43
    v_mul_f32 v124, v112, v44
    v_mul_f32 v125, v112, v45
    v_mul_f32 v126, v112, v46
    v_mul_f32 v127, v112, v47
    v_mul_f32 v128, v112, v48
    v_mul_f32 v129, v112, v49
    v_mul_f32 v130, v112, v50
    v_mul_f32 v131, v112, v51
    v_mul_f32 v132, v112, v52
    v_mul_f32 v133, v112, v53
    v_mul_f32 v134, v112, v54
    v_mul_f32 v135, v112, v55
    v_mul_f32 v136, v112, v56
    v_mul_f32 v137, v112, v57
    ds_read_b64 v[40:41], v5 offset:13248
    ds_read_b64 v[42:43], v5 offset:13256
    ds_read_b64 v[44:45], v5 offset:13264
    ds_read_b64 v[46:47], v5 offset:13272
    ds_read_b64 v[48:49], v5 offset:13280
    ds_read_b64 v[50:51], v5 offset:13288
    ds_read_b64 v[52:53], v5 offset:13296
    ds_read_b64 v[54:55], v5 offset:13304
    ds_read_b64 v[56:57], v5 offset:13312
    s_waitcnt lgkmcnt(9)
    v_fma_f32 v120, v113, v58, v120
    v_fma_f32 v121, v113, v59, v121
    v_fma_f32 v122, v113, v60, v122
    v_fma_f32 v123, v113, v61, v123
    v_fma_f32 v124, v113, v62, v124
    v_fma_f32 v125, v113, v63, v125
    v_fma_f32 v126, v113, v64, v126
    v_fma_f32 v127, v113, v65, v127
    v_fma_f32 v128, v113, v66, v128
    v_fma_f32 v129, v113, v67, v129
    v_fma_f32 v130, v113, v68, v130
    v_fma_f32 v131, v113, v69, v131
    v_fma_f32 v132, v113, v70, v132
    v_fma_f32 v133, v113, v71, v133
    v_fma_f32 v134, v113, v72, v134
    v_fma_f32 v135, v113, v73, v135
    v_fma_f32 v136, v113, v74, v136
    v_fma_f32 v137, v113, v75, v137
    ds_read_b64 v[58:59], v5 offset:11136
    ds_read_b64 v[60:61], v5 offset:11144
    ds_read_b64 v[62:63], v5 offset:11152
    ds_read_b64 v[64:65], v5 offset:11160
    ds_read_b64 v[66:67], v5 offset:11168
    ds_read_b64 v[68:69], v5 offset:11176
    ds_read_b64 v[70:71], v5 offset:11184
    ds_read_b64 v[72:73], v5 offset:11192
    ds_read_b64 v[74:75], v5 offset:11200
    s_waitcnt lgkmcnt(9)
    v_fma_f32 v120, v114, v40, v120
    v_fma_f32 v121, v114, v41, v121
    v_fma_f32 v122, v114, v42, v122
    v_fma_f32 v123, v114, v43, v123
    v_fma_f32 v124, v114, v44, v124
    v_fma_f32 v125, v114, v45, v125
    v_fma_f32 v126, v114, v46, v126
    v_fma_f32 v127, v114, v47, v127
    v_fma_f32 v128, v114, v48, v128
    v_fma_f32 v129, v114, v49, v129
    v_fma_f32 v130, v114, v50, v130
    v_fma_f32 v131, v114, v51, v131
    v_fma_f32 v132, v114, v52, v132
    v_fma_f32 v133, v114, v53, v133
    v_fma_f32 v134, v114, v54, v134
    v_fma_f32 v135, v114, v55, v135
    v_fma_f32 v136, v114, v56, v136
    v_fma_f32 v137, v114, v57, v137
    ds_read_b64 v[40:41], v5 offset:9024
    ds_read_b64 v[42:43], v5 offset:9032
    ds_read_b64 v[44:45], v5 offset:9040
    ds_read_b64 v[46:47], v5 offset:9048
    ds_read_b64 v[48:49], v5 offset:9056
    ds_read_b64 v[50:51], v5 offset:9064
    ds_read_b64 v[52:53], v5 offset:9072
    ds_read_b64 v[54:55], v5 offset:9080
    ds_read_b64 v[56:57], v5 offset:9088
    s_waitcnt lgkmcnt(9)
    v_fma_f32 v120, v115, v58, v120
    v_fma_f32 v121, v115, v59, v121
    v_fma_f32 v122, v115, v60, v122
    v_fma_f32 v123, v115, v61, v123
    v_fma_f32 v124, v115, v62, v124
    v_fma_f32 v125, v115, v63, v125
    v_fma_f32 v126, v115, v64, v126
    v_fma_f32 v127, v115, v65, v127
    v_fma_f32 v128, v115, v66, v128
    v_fma_f32 v129, v115, v67, v129
    v_fma_f32 v130, v115, v68, v130
    v_fma_f32 v131, v115, v69, v131
    v_fma_f32 v132, v115, v70, v132
    v_fma_f32 v133, v115, v71, v133
    v_fma_f32 v134, v115, v72, v134
    v_fma_f32 v135, v115, v73, v135
    v_fma_f32 v136, v115, v74, v136
    v_fma_f32 v137, v115, v75, v137
    ds_read_b64 v[58:59], v5 offset:6912
    ds_read_b64 v[60:61], v5 offset:6920
    ds_read_b64 v[62:63], v5 offset:6928
    ds_read_b64 v[64:65], v5 offset:6936
    ds_read_b64 v[66:67], v5 offset:6944
    ds_read_b64 v[68:69], v5 offset:6952
    ds_read_b64 v[70:71], v5 offset:6960
    ds_read_b64 v[72:73], v5 offset:6968
    ds_read_b64 v[74:75], v5 offset:6976
    s_waitcnt lgkmcnt(9)
    v_fma_f32 v120, v116, v40, v120
    v_fma_f32 v121, v116, v41, v121
    v_fma_f32 v122, v116, v42, v122
    v_fma_f32 v123, v116, v43, v123
    v_fma_f32 v124, v116, v44, v124
    v_fma_f32 v125, v116, v45, v125
    v_fma_f32 v126, v116, v46, v126
    v_fma_f32 v127, v116, v47, v127
    v_fma_f32 v128, v116, v48, v128
    v_fma_f32 v129, v116, v49, v129
    v_fma_f32 v130, v116, v50, v130
    v_fma_f32 v131, v116, v51, v131
    v_fma_f32 v132, v116, v52, v132
    v_fma_f32 v133, v116, v53, v133
    v_fma_f32 v134, v116, v54, v134
    v_fma_f32 v135, v116, v55, v135
    v_fma_f32 v136, v116, v56, v136
    v_fma_f32 v137, v116, v57, v137
    ds_read_b64 v[40:41], v5 offset:4800
    ds_read_b64 v[42:43], v5 offset:4808
    ds_read_b64 v[44:45], v5 offset:4816
    ds_read_b64 v[46:47], v5 offset:4824
    ds_read_b64 v[48:49], v5 offset:4832
    ds_read_b64 v[50:51], v5 offset:4840
    ds_read_b64 v[52:53], v5 offset:4848
    ds_read_b64 v[54:55], v5 offset:4856
    ds_read_b64 v[56:57], v5 offset:4864
    s_waitcnt lgkmcnt(9)
    v_fma_f32 v120, v117, v58, v120
    v_fma_f32 v121, v117, v59, v121
    v_fma_f32 v122, v117, v60, v122
    v_fma_f32 v123, v117, v61, v123
    v_fma_f32 v124, v117, v62, v124
    v_fma_f32 v125, v117, v63, v125
    v_fma_f32 v126, v117, v64, v126
    v_fma_f32 v127, v117, v65, v127
    v_fma_f32 v128, v117, v66, v128
    v_fma_f32 v129, v117, v67, v129
    v_fma_f32 v130, v117, v68, v130
    v_fma_f32 v131, v117, v69, v131
    v_fma_f32 v132, v117, v70, v132
    v_fma_f32 v133, v117, v71, v133
    v_fma_f32 v134, v117, v72, v134
    v_fma_f32 v135, v117, v73, v135
    v_fma_f32 v136, v117, v74, v136
    v_fma_f32 v137, v117, v75, v137
    ds_read_b64 v[58:59], v5 offset:2688
    ds_read_b64 v[60:61], v5 offset:2696
    ds_read_b64 v[62:63], v5 offset:2704
    ds_read_b64 v[64:65], v5 offset:2712
    ds_read_b64 v[66:67], v5 offset:2720
    ds_read_b64 v[68:69], v5 offset:2728
    ds_read_b64 v[70:71], v5 offset:2736
    ds_read_b64 v[72:73], v5 offset:2744
    ds_read_b64 v[74:75], v5 offset:2752
    s_waitcnt lgkmcnt(9)
    v_fma_f32 v120, v118, v40, v120
    v_fma_f32 v121, v118, v41, v121
    v_fma_f32 v122, v118, v42, v122
    v_fma_f32 v123, v118, v43, v123
    v_fma_f32 v124, v118, v44, v124
    v_fma_f32 v125, v118, v45, v125
    v_fma_f32 v126, v118, v46, v126
    v_fma_f32 v127, v118, v47, v127
    v_fma_f32 v128, v118, v48, v128
    v_fma_f32 v129, v118, v49, v129
    v_fma_f32 v130, v118, v50, v130
    v_fma_f32 v131, v118, v51, v131
    v_fma_f32 v132, v118, v52, v132
    v_fma_f32 v133, v118, v53, v133
    v_fma_f32 v134, v118, v54, v134
    v_fma_f32 v135, v118, v55, v135
    v_fma_f32 v136, v118, v56, v136
    v_fma_f32 v137, v118, v57, v137
    s_waitcnt lgkmcnt(0)
    v_fma_f32 v120, v119, v58, v120
    v_fma_f32 v121, v119, v59, v121
    v_fma_f32 v122, v119, v60, v122
    v_fma_f32 v123, v119, v61, v123
    v_fma_f32 v124, v119, v62, v124
    v_fma_f32 v125, v119, v63, v125
    v_fma_f32 v126, v119, v64, v126
    v_fma_f32 v127, v119, v65, v127
    v_fma_f32 v128, v119, v66, v128
    v_fma_f32 v129, v119, v67, v129
    v_fma_f32 v130, v119, v68, v130
    v_fma_f32 v131, v119, v69, v131
    v_fma_f32 v132, v119, v70, v132
    v_fma_f32 v133, v119, v71, v133
    v_fma_f32 v134, v119, v72, v134
    v_fma_f32 v135, v119, v73, v135
    v_fma_f32 v136, v119, v74, v136
    v_fma_f32 v137, v119, v75, v137
    v_cvt_pk_bf16_f32 v20, v120, v121
    v_cvt_pk_bf16_f32 v21, v122, v123
    v_cvt_pk_bf16_f32 v22, v124, v125
    v_cvt_pk_bf16_f32 v23, v126, v127
    v_cvt_pk_bf16_f32 v24, v128, v129
    v_cvt_pk_bf16_f32 v25, v130, v131
    v_cvt_pk_bf16_f32 v26, v132, v133
    v_cvt_pk_bf16_f32 v27, v134, v135
    v_cvt_pk_bf16_f32 v28, v136, v137
    v_mul_u32_u24 v5, 160, v3
    v_mul_u32_u24 v6, 36, v4
    s_mov_b32 s30, 92160
    v_add3_u32 v5, v5, v6, s30
    ds_write_b32 v5, v20 offset:0
    ds_write_b32 v5, v21 offset:4
    ds_write_b32 v5, v22 offset:8
    ds_write_b32 v5, v23 offset:12
    ds_write_b32 v5, v24 offset:16
    ds_write_b32 v5, v25 offset:20
    ds_write_b32 v5, v26 offset:24
    ds_write_b32 v5, v27 offset:28
    ds_write_b32 v5, v28 offset:32
    s_waitcnt lgkmcnt(0)
    s_barrier
    s_mov_b32 s32, 0x1c72
    s_mul_i32 s31, s21, 9
    s_mov_b32 s33, 2621440
    v_add_u32 v3, 0, v2
    v_mul_lo_u32 v4, v3, s32
    v_lshrrev_b32 v4, 16, v4
    v_mul_u32_u24 v5, 9, v4
    v_sub_u32 v5, v3, v5
    v_mul_u32_u24 v6, 160, v4
    v_lshlrev_b32 v8, 4, v5
    v_add3_u32 v6, v6, v8, s30
    ds_read_b128 v[20:23], v6
    v_add_u32 v5, s31, v5
    s_lshl_b32 s35, s22, 6
    v_add_u32 v4, s35, v4
    v_lshrrev_b32 v6, 5, v4
    v_mul_u32_u24 v6, 36, v6
    v_lshrrev_b32 v8, 1, v5
    v_add_u32 v6, v6, v8
    v_lshlrev_b32 v6, 10, v6
    v_and_b32 v8, 1, v5
    v_lshlrev_b32 v8, 5, v8
    v_and_b32 v4, 31, v4
    v_add_u32 v8, v8, v4
    v_lshlrev_b32 v8, 4, v8
    v_add_u32 v32, v6, v8
    s_waitcnt lgkmcnt(0)
    buffer_store_dwordx4 v[20:23], v32, s[16:19], s33 offen
    v_add_u32 v3, 256, v2
    v_mul_lo_u32 v4, v3, s32
    v_lshrrev_b32 v4, 16, v4
    v_mul_u32_u24 v5, 9, v4
    v_sub_u32 v5, v3, v5
    v_mul_u32_u24 v6, 160, v4
    v_lshlrev_b32 v8, 4, v5
    v_add3_u32 v6, v6, v8, s30
    ds_read_b128 v[24:27], v6
    v_add_u32 v5, s31, v5
    s_lshl_b32 s35, s22, 6
    v_add_u32 v4, s35, v4
    v_lshrrev_b32 v6, 5, v4
    v_mul_u32_u24 v6, 36, v6
    v_lshrrev_b32 v8, 1, v5
    v_add_u32 v6, v6, v8
    v_lshlrev_b32 v6, 10, v6
    v_and_b32 v8, 1, v5
    v_lshlrev_b32 v8, 5, v8
    v_and_b32 v4, 31, v4
    v_add_u32 v8, v8, v4
    v_lshlrev_b32 v8, 4, v8
    v_add_u32 v33, v6, v8
    s_waitcnt lgkmcnt(0)
    buffer_store_dwordx4 v[24:27], v33, s[16:19], s33 offen
    v_add_u32 v3, 512, v2
    v_mul_lo_u32 v4, v3, s32
    v_lshrrev_b32 v4, 16, v4
    v_mul_u32_u24 v5, 9, v4
    v_sub_u32 v5, v3, v5
    v_mul_u32_u24 v6, 160, v4
    v_lshlrev_b32 v8, 4, v5
    v_add3_u32 v6, v6, v8, s30
    v_cmp_gt_u32 vcc, 64, v2
    s_and_saveexec_b64 s[44:45], vcc
    s_cbranch_execz k1a_kernel_end
    ds_read_b128 v[28:31], v6
    v_add_u32 v5, s31, v5
    s_lshl_b32 s35, s22, 6
    v_add_u32 v4, s35, v4
    v_lshrrev_b32 v6, 5, v4
    v_mul_u32_u24 v6, 36, v6
    v_lshrrev_b32 v8, 1, v5
    v_add_u32 v6, v6, v8
    v_lshlrev_b32 v6, 10, v6
    v_and_b32 v8, 1, v5
    v_lshlrev_b32 v8, 5, v8
    v_and_b32 v4, 31, v4
    v_add_u32 v8, v8, v4
    v_lshlrev_b32 v8, 4, v8
    v_add_u32 v34, v6, v8
    s_waitcnt lgkmcnt(0)
    buffer_store_dwordx4 v[28:31], v34, s[16:19], s33 offen
k1a_kernel_end:
    s_endpgm
.globl k2a_kernel
.p2align 8
.type k2a_kernel,@function
k2a_kernel:
    s_cmp_ge_u32 s2, 256
    s_cbranch_scc1 k2a_kernel_end
    s_cmp_ge_u32 s2, 192
    s_cbranch_scc1 k2a_kernel_relayout
    s_load_dwordx2 s[4:5], s[0:1], 16
    s_load_dwordx2 s[8:9], s[0:1], 72
    s_load_dwordx2 s[6:7], s[0:1], 0
    v_lshrrev_b32 v1, 6, v0
    v_mov_b32 v13, v0
    v_and_b32 v0, 63, v0
    v_readfirstlane_b32 s20, v1
    s_lshr_b32 s21, s2, 3
    s_mul_i32 s22, s21, 43
    s_lshr_b32 s22, s22, 8
    s_mul_i32 s23, s22, 6
    s_sub_u32 s21, s21, s23
    s_and_b32 s23, s2, 7
    s_lshl_b32 s23, s23, 2
    s_add_u32 s22, s22, s23
    s_mul_i32 s23, s22, 73728
    s_lshl_b32 s24, s20, 10
    s_add_u32 s23, s23, s24
    s_add_u32 s23, s23, 2621440
    s_mul_i32 s26, s20, 18432
    s_mul_i32 s27, s20, 24576
    s_mul_i32 s30, s21, 192
    s_mov_b32 s31, 0x5556
    v_add_u32 v2, 0, v0
    v_mul_lo_u32 v3, v2, s31
    v_lshrrev_b32 v3, 18, v3
    v_mul_u32_u24 v4, 12, v3
    v_sub_u32 v4, v2, v4
    v_mul_u32_u24 v3, 1152, v3
    v_lshlrev_b32 v4, 4, v4
    v_add3_u32 v8, v3, v4, s30
    v_add_u32 v2, 64, v0
    v_mul_lo_u32 v3, v2, s31
    v_lshrrev_b32 v3, 18, v3
    v_mul_u32_u24 v4, 12, v3
    v_sub_u32 v4, v2, v4
    v_mul_u32_u24 v3, 1152, v3
    v_lshlrev_b32 v4, 4, v4
    v_add3_u32 v9, v3, v4, s30
    v_add_u32 v2, 128, v0
    v_mul_lo_u32 v3, v2, s31
    v_lshrrev_b32 v3, 18, v3
    v_mul_u32_u24 v4, 12, v3
    v_sub_u32 v4, v2, v4
    v_mul_u32_u24 v3, 1152, v3
    v_lshlrev_b32 v4, 4, v4
    v_add3_u32 v10, v3, v4, s30
    v_lshrrev_b32 v2, 5, v0
    v_lshlrev_b32 v2, 3, v2
    v_bfe_u32 v3, v0, 2, 2
    v_add_u32 v2, v2, v3
    v_mul_u32_u24 v2, 192, v2
    v_bfe_u32 v3, v0, 4, 1
    v_lshlrev_b32 v3, 5, v3
    v_add_u32 v2, v2, v3
    v_and_b32 v3, 3, v0
    v_lshlrev_b32 v3, 3, v3
    v_add3_u32 v11, v2, v3, s27
    v_lshlrev_b32 v12, 4, v0
    s_waitcnt lgkmcnt(0)
    s_mov_b32 s12, s4
    s_and_b32 s13, s5, 0xffff
    s_mov_b32 s14, 663552
    s_mov_b32 s15, 0x00020000
    s_mov_b32 s16, s8
    s_and_b32 s17, s9, 0xffff
    s_mov_b32 s18, 268435456
    s_mov_b32 s19, 0x00020000
    s_mov_b32 s36, s6
    s_and_b32 s37, s7, 0xffff
    s_mov_b32 s38, 2359296
    s_mov_b32 s39, 0x00020000
    s_add_u32 s24, s23, 0
    buffer_load_dwordx4 v[32:35], v12, s[16:19], s24 offen
    s_add_u32 s24, s23, 36864
    buffer_load_dwordx4 v[36:39], v12, s[16:19], s24 offen
    s_add_u32 s25, s26, 0
    s_add_u32 m0, s27, 0
    s_nop 0
    buffer_load_dwordx4 v8, s[12:15], s25 offen lds
    s_add_u32 m0, s27, 1024
    s_nop 0
    buffer_load_dwordx4 v9, s[12:15], s25 offen lds
    s_add_u32 m0, s27, 2048
    s_nop 0
    buffer_load_dwordx4 v10, s[12:15], s25 offen lds
    s_add_u32 s24, s23, 4096
    buffer_load_dwordx4 v[40:43], v12, s[16:19], s24 offen
    s_add_u32 s24, s23, 40960
    buffer_load_dwordx4 v[44:47], v12, s[16:19], s24 offen
    s_add_u32 s25, s26, 73728
    s_add_u32 m0, s27, 3072
    s_nop 0
    buffer_load_dwordx4 v8, s[12:15], s25 offen lds
    s_add_u32 m0, s27, 4096
    s_nop 0
    buffer_load_dwordx4 v9, s[12:15], s25 offen lds
    s_add_u32 m0, s27, 5120
    s_nop 0
    buffer_load_dwordx4 v10, s[12:15], s25 offen lds
    s_add_u32 s24, s23, 8192
    buffer_load_dwordx4 v[48:51], v12, s[16:19], s24 offen
    s_add_u32 s24, s23, 45056
    buffer_load_dwordx4 v[52:55], v12, s[16:19], s24 offen
    s_add_u32 s25, s26, 147456
    s_add_u32 m0, s27, 6144
    s_nop 0
    buffer_load_dwordx4 v8, s[12:15], s25 offen lds
    s_add_u32 m0, s27, 7168
    s_nop 0
    buffer_load_dwordx4 v9, s[12:15], s25 offen lds
    s_add_u32 m0, s27, 8192
    s_nop 0
    buffer_load_dwordx4 v10, s[12:15], s25 offen lds
    s_add_u32 s24, s23, 12288
    buffer_load_dwordx4 v[56:59], v12, s[16:19], s24 offen
    s_add_u32 s24, s23, 49152
    buffer_load_dwordx4 v[60:63], v12, s[16:19], s24 offen
    s_add_u32 s25, s26, 221184
    s_add_u32 m0, s27, 9216
    s_nop 0
    buffer_load_dwordx4 v8, s[12:15], s25 offen lds
    s_add_u32 m0, s27, 10240
    s_nop 0
    buffer_load_dwordx4 v9, s[12:15], s25 offen lds
    s_add_u32 m0, s27, 11264
    s_nop 0
    buffer_load_dwordx4 v10, s[12:15], s25 offen lds
    s_add_u32 s24, s23, 16384
    buffer_load_dwordx4 v[64:67], v12, s[16:19], s24 offen
    s_add_u32 s24, s23, 53248
    buffer_load_dwordx4 v[68:71], v12, s[16:19], s24 offen
    s_add_u32 s25, s26, 294912
    s_add_u32 m0, s27, 12288
    s_nop 0
    buffer_load_dwordx4 v8, s[12:15], s25 offen lds
    s_add_u32 m0, s27, 13312
    s_nop 0
    buffer_load_dwordx4 v9, s[12:15], s25 offen lds
    s_add_u32 m0, s27, 14336
    s_nop 0
    buffer_load_dwordx4 v10, s[12:15], s25 offen lds
    s_add_u32 s24, s23, 20480
    buffer_load_dwordx4 v[72:75], v12, s[16:19], s24 offen
    s_add_u32 s24, s23, 57344
    buffer_load_dwordx4 v[76:79], v12, s[16:19], s24 offen
    s_add_u32 s25, s26, 368640
    s_add_u32 m0, s27, 15360
    s_nop 0
    buffer_load_dwordx4 v8, s[12:15], s25 offen lds
    s_add_u32 m0, s27, 16384
    s_nop 0
    buffer_load_dwordx4 v9, s[12:15], s25 offen lds
    s_add_u32 m0, s27, 17408
    s_nop 0
    buffer_load_dwordx4 v10, s[12:15], s25 offen lds
    s_add_u32 s24, s23, 24576
    buffer_load_dwordx4 v[80:83], v12, s[16:19], s24 offen
    s_add_u32 s24, s23, 61440
    buffer_load_dwordx4 v[84:87], v12, s[16:19], s24 offen
    s_add_u32 s25, s26, 442368
    s_add_u32 m0, s27, 18432
    s_nop 0
    buffer_load_dwordx4 v8, s[12:15], s25 offen lds
    s_add_u32 m0, s27, 19456
    s_nop 0
    buffer_load_dwordx4 v9, s[12:15], s25 offen lds
    s_add_u32 m0, s27, 20480
    s_nop 0
    buffer_load_dwordx4 v10, s[12:15], s25 offen lds
    s_waitcnt vmcnt(30)
    ds_read_b64_tr_b16 v[96:97], v11 offset:0
    ds_read_b64_tr_b16 v[98:99], v11 offset:768
    ds_read_b64_tr_b16 v[100:101], v11 offset:64
    ds_read_b64_tr_b16 v[102:103], v11 offset:832
    ds_read_b64_tr_b16 v[104:105], v11 offset:128
    ds_read_b64_tr_b16 v[106:107], v11 offset:896
    s_waitcnt lgkmcnt(0)
    s_waitcnt vmcnt(25)
    v_mfma_f32_32x32x16_bf16 v[128:143], v[96:99], v[32:35], 0
    ds_read_b64_tr_b16 v[108:109], v11 offset:3072
    ds_read_b64_tr_b16 v[110:111], v11 offset:3840
    v_mfma_f32_32x32x16_bf16 v[144:159], v[96:99], v[36:39], 0
    ds_read_b64_tr_b16 v[112:113], v11 offset:3136
    ds_read_b64_tr_b16 v[114:115], v11 offset:3904
    v_mfma_f32_32x32x16_bf16 v[160:175], v[100:103], v[32:35], 0
    ds_read_b64_tr_b16 v[116:117], v11 offset:3200
    ds_read_b64_tr_b16 v[118:119], v11 offset:3968
    v_mfma_f32_32x32x16_bf16 v[176:191], v[100:103], v[36:39], 0
    s_add_u32 s24, s23, 28672
    buffer_load_dwordx4 v[88:91], v12, s[16:19], s24 offen
    s_add_u32 s24, s23, 65536
    buffer_load_dwordx4 v[92:95], v12, s[16:19], s24 offen
    s_add_u32 s25, s26, 516096
    s_add_u32 m0, s27, 21504
    s_nop 0
    buffer_load_dwordx4 v8, s[12:15], s25 offen lds
    s_add_u32 m0, s27, 22528
    s_nop 0
    buffer_load_dwordx4 v9, s[12:15], s25 offen lds
    s_add_u32 m0, s27, 23552
    s_nop 0
    buffer_load_dwordx4 v10, s[12:15], s25 offen lds
    v_mfma_f32_32x32x16_bf16 v[192:207], v[104:107], v[32:35], 0
    v_mfma_f32_32x32x16_bf16 v[208:223], v[104:107], v[36:39], 0
    s_waitcnt lgkmcnt(0)
    s_waitcnt vmcnt(25)
    v_mfma_f32_32x32x16_bf16 v[128:143], v[108:111], v[40:43], v[128:143]
    ds_read_b64_tr_b16 v[96:97], v11 offset:6144
    ds_read_b64_tr_b16 v[98:99], v11 offset:6912
    v_mfma_f32_32x32x16_bf16 v[144:159], v[108:111], v[44:47], v[144:159]
    ds_read_b64_tr_b16 v[100:101], v11 offset:6208
    ds_read_b64_tr_b16 v[102:103], v11 offset:6976
    v_mfma_f32_32x32x16_bf16 v[160:175], v[112:115], v[40:43], v[160:175]
    ds_read_b64_tr_b16 v[104:105], v11 offset:6272
    ds_read_b64_tr_b16 v[106:107], v11 offset:7040
    v_mfma_f32_32x32x16_bf16 v[176:191], v[112:115], v[44:47], v[176:191]
    s_add_u32 s24, s23, 32768
    buffer_load_dwordx4 v[32:35], v12, s[16:19], s24 offen
    s_add_u32 s24, s23, 69632
    buffer_load_dwordx4 v[36:39], v12, s[16:19], s24 offen
    s_add_u32 s25, s26, 589824
    s_add_u32 m0, s27, 0
    s_nop 0
    buffer_load_dwordx4 v8, s[12:15], s25 offen lds
    s_add_u32 m0, s27, 1024
    s_nop 0
    buffer_load_dwordx4 v9, s[12:15], s25 offen lds
    s_add_u32 m0, s27, 2048
    s_nop 0
    buffer_load_dwordx4 v10, s[12:15], s25 offen lds
    v_mfma_f32_32x32x16_bf16 v[192:207], v[116:119], v[40:43], v[192:207]
    v_mfma_f32_32x32x16_bf16 v[208:223], v[116:119], v[44:47], v[208:223]
    s_waitcnt lgkmcnt(0)
    s_waitcnt vmcnt(25)
    v_mfma_f32_32x32x16_bf16 v[128:143], v[96:99], v[48:51], v[128:143]
    ds_read_b64_tr_b16 v[108:109], v11 offset:9216
    ds_read_b64_tr_b16 v[110:111], v11 offset:9984
    v_mfma_f32_32x32x16_bf16 v[144:159], v[96:99], v[52:55], v[144:159]
    ds_read_b64_tr_b16 v[112:113], v11 offset:9280
    ds_read_b64_tr_b16 v[114:115], v11 offset:10048
    v_mfma_f32_32x32x16_bf16 v[160:175], v[100:103], v[48:51], v[160:175]
    ds_read_b64_tr_b16 v[116:117], v11 offset:9344
    ds_read_b64_tr_b16 v[118:119], v11 offset:10112
    v_mfma_f32_32x32x16_bf16 v[176:191], v[100:103], v[52:55], v[176:191]
    v_mfma_f32_32x32x16_bf16 v[192:207], v[104:107], v[48:51], v[192:207]
    v_mfma_f32_32x32x16_bf16 v[208:223], v[104:107], v[52:55], v[208:223]
    s_waitcnt lgkmcnt(0)
    s_waitcnt vmcnt(20)
    v_mfma_f32_32x32x16_bf16 v[128:143], v[108:111], v[56:59], v[128:143]
    ds_read_b64_tr_b16 v[96:97], v11 offset:12288
    ds_read_b64_tr_b16 v[98:99], v11 offset:13056
    v_mfma_f32_32x32x16_bf16 v[144:159], v[108:111], v[60:63], v[144:159]
    ds_read_b64_tr_b16 v[100:101], v11 offset:12352
    ds_read_b64_tr_b16 v[102:103], v11 offset:13120
    v_mfma_f32_32x32x16_bf16 v[160:175], v[112:115], v[56:59], v[160:175]
    ds_read_b64_tr_b16 v[104:105], v11 offset:12416
    ds_read_b64_tr_b16 v[106:107], v11 offset:13184
    v_mfma_f32_32x32x16_bf16 v[176:191], v[112:115], v[60:63], v[176:191]
    v_mfma_f32_32x32x16_bf16 v[192:207], v[116:119], v[56:59], v[192:207]
    v_mfma_f32_32x32x16_bf16 v[208:223], v[116:119], v[60:63], v[208:223]
    s_waitcnt lgkmcnt(0)
    s_waitcnt vmcnt(15)
    v_mfma_f32_32x32x16_bf16 v[128:143], v[96:99], v[64:67], v[128:143]
    ds_read_b64_tr_b16 v[108:109], v11 offset:15360
    ds_read_b64_tr_b16 v[110:111], v11 offset:16128
    v_mfma_f32_32x32x16_bf16 v[144:159], v[96:99], v[68:71], v[144:159]
    ds_read_b64_tr_b16 v[112:113], v11 offset:15424
    ds_read_b64_tr_b16 v[114:115], v11 offset:16192
    v_mfma_f32_32x32x16_bf16 v[160:175], v[100:103], v[64:67], v[160:175]
    ds_read_b64_tr_b16 v[116:117], v11 offset:15488
    ds_read_b64_tr_b16 v[118:119], v11 offset:16256
    v_mfma_f32_32x32x16_bf16 v[176:191], v[100:103], v[68:71], v[176:191]
    v_mfma_f32_32x32x16_bf16 v[192:207], v[104:107], v[64:67], v[192:207]
    v_mfma_f32_32x32x16_bf16 v[208:223], v[104:107], v[68:71], v[208:223]
    s_waitcnt lgkmcnt(0)
    s_waitcnt vmcnt(10)
    v_mfma_f32_32x32x16_bf16 v[128:143], v[108:111], v[72:75], v[128:143]
    ds_read_b64_tr_b16 v[96:97], v11 offset:18432
    ds_read_b64_tr_b16 v[98:99], v11 offset:19200
    v_mfma_f32_32x32x16_bf16 v[144:159], v[108:111], v[76:79], v[144:159]
    ds_read_b64_tr_b16 v[100:101], v11 offset:18496
    ds_read_b64_tr_b16 v[102:103], v11 offset:19264
    v_mfma_f32_32x32x16_bf16 v[160:175], v[112:115], v[72:75], v[160:175]
    ds_read_b64_tr_b16 v[104:105], v11 offset:18560
    ds_read_b64_tr_b16 v[106:107], v11 offset:19328
    v_mfma_f32_32x32x16_bf16 v[176:191], v[112:115], v[76:79], v[176:191]
    v_mfma_f32_32x32x16_bf16 v[192:207], v[116:119], v[72:75], v[192:207]
    v_mfma_f32_32x32x16_bf16 v[208:223], v[116:119], v[76:79], v[208:223]
    s_waitcnt lgkmcnt(0)
    s_waitcnt vmcnt(5)
    v_mfma_f32_32x32x16_bf16 v[128:143], v[96:99], v[80:83], v[128:143]
    ds_read_b64_tr_b16 v[108:109], v11 offset:21504
    ds_read_b64_tr_b16 v[110:111], v11 offset:22272
    v_mfma_f32_32x32x16_bf16 v[144:159], v[96:99], v[84:87], v[144:159]
    ds_read_b64_tr_b16 v[112:113], v11 offset:21568
    ds_read_b64_tr_b16 v[114:115], v11 offset:22336
    v_mfma_f32_32x32x16_bf16 v[160:175], v[100:103], v[80:83], v[160:175]
    ds_read_b64_tr_b16 v[116:117], v11 offset:21632
    ds_read_b64_tr_b16 v[118:119], v11 offset:22400
    v_mfma_f32_32x32x16_bf16 v[176:191], v[100:103], v[84:87], v[176:191]
    v_mfma_f32_32x32x16_bf16 v[192:207], v[104:107], v[80:83], v[192:207]
    v_mfma_f32_32x32x16_bf16 v[208:223], v[104:107], v[84:87], v[208:223]
    s_waitcnt lgkmcnt(0)
    s_waitcnt vmcnt(0)
    v_mfma_f32_32x32x16_bf16 v[128:143], v[108:111], v[88:91], v[128:143]
    ds_read_b64_tr_b16 v[96:97], v11 offset:0
    ds_read_b64_tr_b16 v[98:99], v11 offset:768
    v_mfma_f32_32x32x16_bf16 v[144:159], v[108:111], v[92:95], v[144:159]
    ds_read_b64_tr_b16 v[100:101], v11 offset:64
    ds_read_b64_tr_b16 v[102:103], v11 offset:832
    v_mfma_f32_32x32x16_bf16 v[160:175], v[112:115], v[88:91], v[160:175]
    ds_read_b64_tr_b16 v[104:105], v11 offset:128
    ds_read_b64_tr_b16 v[106:107], v11 offset:896
    v_mfma_f32_32x32x16_bf16 v[176:191], v[112:115], v[92:95], v[176:191]
    v_mfma_f32_32x32x16_bf16 v[192:207], v[116:119], v[88:91], v[192:207]
    v_mfma_f32_32x32x16_bf16 v[208:223], v[116:119], v[92:95], v[208:223]
    s_waitcnt lgkmcnt(0)
    v_mfma_f32_32x32x16_bf16 v[128:143], v[96:99], v[32:35], v[128:143]
    v_mfma_f32_32x32x16_bf16 v[144:159], v[96:99], v[36:39], v[144:159]
    v_mfma_f32_32x32x16_bf16 v[160:175], v[100:103], v[32:35], v[160:175]
    v_mfma_f32_32x32x16_bf16 v[176:191], v[100:103], v[36:39], v[176:191]
    v_mfma_f32_32x32x16_bf16 v[192:207], v[104:107], v[32:35], v[192:207]
    v_mfma_f32_32x32x16_bf16 v[208:223], v[104:107], v[36:39], v[208:223]
    v_lshrrev_b32 v1, 2, v13
    v_and_b32 v2, 3, v13
    s_lshl_b32 s30, s22, 6
    v_add_u32 v3, s30, v1
    v_mul_u32_u24 v4, 1152, v3
    v_lshlrev_b32 v5, 4, v2
    v_add_u32 v4, v4, v5
    s_mul_i32 s30, s21, 192
    buffer_load_dwordx4 v[16:19], v4, s[36:39], s30 offen offset:0
    buffer_load_dwordx4 v[20:23], v4, s[36:39], s30 offen offset:64
    buffer_load_dwordx4 v[24:27], v4, s[36:39], s30 offen offset:128
    v_lshrrev_b32 v5, 5, v3
    v_mul_u32_u24 v5, 36864, v5
    v_lshrrev_b32 v6, 1, v2
    v_lshlrev_b32 v6, 10, v6
    v_add_u32 v5, v5, v6
    v_and_b32 v6, 1, v2
    v_lshlrev_b32 v6, 5, v6
    v_and_b32 v7, 31, v3
    v_add_u32 v6, v6, v7
    v_lshlrev_b32 v6, 4, v6
    v_add_u32 v5, v5, v6
    s_mul_i32 s31, s21, 6144
    s_add_u32 s31, s31, 0
    s_barrier
    v_and_b32 v7, 31, v0
    v_mul_u32_u24 v7, 400, v7
    v_lshrrev_b32 v28, 5, v0
    v_lshlrev_b32 v28, 4, v28
    s_mul_i32 s32, s20, 25600
    v_add3_u32 v7, v7, v28, s32
    s_nop 4
    ds_write_b128 v7, v[128:131] offset:0
    ds_write_b128 v7, v[132:135] offset:32
    ds_write_b128 v7, v[136:139] offset:64
    ds_write_b128 v7, v[140:143] offset:96
    ds_write_b128 v7, v[144:147] offset:12800
    ds_write_b128 v7, v[148:151] offset:12832
    ds_write_b128 v7, v[152:155] offset:12864
    ds_write_b128 v7, v[156:159] offset:12896
    ds_write_b128 v7, v[160:163] offset:128
    ds_write_b128 v7, v[164:167] offset:160
    ds_write_b128 v7, v[168:171] offset:192
    ds_write_b128 v7, v[172:175] offset:224
    ds_write_b128 v7, v[176:179] offset:12928
    ds_write_b128 v7, v[180:183] offset:12960
    ds_write_b128 v7, v[184:187] offset:12992
    ds_write_b128 v7, v[188:191] offset:13024
    ds_write_b128 v7, v[192:195] offset:256
    ds_write_b128 v7, v[196:199] offset:288
    ds_write_b128 v7, v[200:203] offset:320
    ds_write_b128 v7, v[204:207] offset:352
    ds_write_b128 v7, v[208:211] offset:13056
    ds_write_b128 v7, v[212:215] offset:13088
    ds_write_b128 v7, v[216:219] offset:13120
    ds_write_b128 v7, v[220:223] offset:13152
    s_waitcnt lgkmcnt(0)
    s_barrier
    v_mul_u32_u24 v7, 400, v1
    v_lshlrev_b32 v28, 5, v2
    v_add_u32 v7, v7, v28
    v_add_u32 v28, 51200, v7
    ds_read_b128 v[32:35], v7 offset:0
    ds_read_b128 v[36:39], v7 offset:16
    ds_read_b128 v[40:43], v7 offset:128
    ds_read_b128 v[44:47], v7 offset:144
    ds_read_b128 v[48:51], v7 offset:256
    ds_read_b128 v[52:55], v7 offset:272
    ds_read_b128 v[56:59], v7 offset:25600
    ds_read_b128 v[60:63], v7 offset:25616
    ds_read_b128 v[64:67], v7 offset:25728
    ds_read_b128 v[68:71], v7 offset:25744
    ds_read_b128 v[72:75], v7 offset:25856
    ds_read_b128 v[76:79], v7 offset:25872
    ds_read_b128 v[80:83], v28 offset:0
    ds_read_b128 v[84:87], v28 offset:16
    ds_read_b128 v[88:91], v28 offset:128
    ds_read_b128 v[92:95], v28 offset:144
    ds_read_b128 v[96:99], v28 offset:256
    ds_read_b128 v[100:103], v28 offset:272
    ds_read_b128 v[104:107], v28 offset:25600
    ds_read_b128 v[108:111], v28 offset:25616
    ds_read_b128 v[112:115], v28 offset:25728
    ds_read_b128 v[116:119], v28 offset:25744
    ds_read_b128 v[120:123], v28 offset:25856
    ds_read_b128 v[124:127], v28 offset:25872
    s_mov_b32 s32, 0xffff0000
    s_waitcnt lgkmcnt(12)
    v_add_f32 v32, v32, v56
    v_add_f32 v33, v33, v57
    v_add_f32 v34, v34, v58
    v_add_f32 v35, v35, v59
    v_add_f32 v36, v36, v60
    v_add_f32 v37, v37, v61
    v_add_f32 v38, v38, v62
    v_add_f32 v39, v39, v63
    v_add_f32 v40, v40, v64
    v_add_f32 v41, v41, v65
    v_add_f32 v42, v42, v66
    v_add_f32 v43, v43, v67
    v_add_f32 v44, v44, v68
    v_add_f32 v45, v45, v69
    v_add_f32 v46, v46, v70
    v_add_f32 v47, v47, v71
    v_add_f32 v48, v48, v72
    v_add_f32 v49, v49, v73
    v_add_f32 v50, v50, v74
    v_add_f32 v51, v51, v75
    v_add_f32 v52, v52, v76
    v_add_f32 v53, v53, v77
    v_add_f32 v54, v54, v78
    v_add_f32 v55, v55, v79
    s_waitcnt lgkmcnt(0)
    v_add_f32 v80, v80, v104
    v_add_f32 v81, v81, v105
    v_add_f32 v82, v82, v106
    v_add_f32 v83, v83, v107
    v_add_f32 v84, v84, v108
    v_add_f32 v85, v85, v109
    v_add_f32 v86, v86, v110
    v_add_f32 v87, v87, v111
    v_add_f32 v88, v88, v112
    v_add_f32 v89, v89, v113
    v_add_f32 v90, v90, v114
    v_add_f32 v91, v91, v115
    v_add_f32 v92, v92, v116
    v_add_f32 v93, v93, v117
    v_add_f32 v94, v94, v118
    v_add_f32 v95, v95, v119
    v_add_f32 v96, v96, v120
    v_add_f32 v97, v97, v121
    v_add_f32 v98, v98, v122
    v_add_f32 v99, v99, v123
    v_add_f32 v100, v100, v124
    v_add_f32 v101, v101, v125
    v_add_f32 v102, v102, v126
    v_add_f32 v103, v103, v127
    v_add_f32 v32, v32, v80
    v_add_f32 v33, v33, v81
    v_add_f32 v34, v34, v82
    v_add_f32 v35, v35, v83
    v_add_f32 v36, v36, v84
    v_add_f32 v37, v37, v85
    v_add_f32 v38, v38, v86
    v_add_f32 v39, v39, v87
    v_add_f32 v40, v40, v88
    v_add_f32 v41, v41, v89
    v_add_f32 v42, v42, v90
    v_add_f32 v43, v43, v91
    v_add_f32 v44, v44, v92
    v_add_f32 v45, v45, v93
    v_add_f32 v46, v46, v94
    v_add_f32 v47, v47, v95
    v_add_f32 v48, v48, v96
    v_add_f32 v49, v49, v97
    v_add_f32 v50, v50, v98
    v_add_f32 v51, v51, v99
    v_add_f32 v52, v52, v100
    v_add_f32 v53, v53, v101
    v_add_f32 v54, v54, v102
    v_add_f32 v55, v55, v103
    s_waitcnt vmcnt(0)
    v_cvt_pk_bf16_f32 v80, v32, v33
    v_lshlrev_b32 v81, 16, v80
    v_and_b32 v82, s32, v80
    v_lshlrev_b32 v83, 16, v16
    v_and_b32 v84, s32, v16
    v_add_f32 v81, v81, v83
    v_add_f32 v82, v82, v84
    v_cvt_pk_bf16_f32 v128, v81, v82
    v_cvt_pk_bf16_f32 v80, v34, v35
    v_lshlrev_b32 v81, 16, v80
    v_and_b32 v82, s32, v80
    v_lshlrev_b32 v83, 16, v17
    v_and_b32 v84, s32, v17
    v_add_f32 v81, v81, v83
    v_add_f32 v82, v82, v84
    v_cvt_pk_bf16_f32 v129, v81, v82
    v_cvt_pk_bf16_f32 v80, v36, v37
    v_lshlrev_b32 v81, 16, v80
    v_and_b32 v82, s32, v80
    v_lshlrev_b32 v83, 16, v18
    v_and_b32 v84, s32, v18
    v_add_f32 v81, v81, v83
    v_add_f32 v82, v82, v84
    v_cvt_pk_bf16_f32 v130, v81, v82
    v_cvt_pk_bf16_f32 v80, v38, v39
    v_lshlrev_b32 v81, 16, v80
    v_and_b32 v82, s32, v80
    v_lshlrev_b32 v83, 16, v19
    v_and_b32 v84, s32, v19
    v_add_f32 v81, v81, v83
    v_add_f32 v82, v82, v84
    v_cvt_pk_bf16_f32 v131, v81, v82
    v_cvt_pk_bf16_f32 v80, v40, v41
    v_lshlrev_b32 v81, 16, v80
    v_and_b32 v82, s32, v80
    v_lshlrev_b32 v83, 16, v20
    v_and_b32 v84, s32, v20
    v_add_f32 v81, v81, v83
    v_add_f32 v82, v82, v84
    v_cvt_pk_bf16_f32 v132, v81, v82
    v_cvt_pk_bf16_f32 v80, v42, v43
    v_lshlrev_b32 v81, 16, v80
    v_and_b32 v82, s32, v80
    v_lshlrev_b32 v83, 16, v21
    v_and_b32 v84, s32, v21
    v_add_f32 v81, v81, v83
    v_add_f32 v82, v82, v84
    v_cvt_pk_bf16_f32 v133, v81, v82
    v_cvt_pk_bf16_f32 v80, v44, v45
    v_lshlrev_b32 v81, 16, v80
    v_and_b32 v82, s32, v80
    v_lshlrev_b32 v83, 16, v22
    v_and_b32 v84, s32, v22
    v_add_f32 v81, v81, v83
    v_add_f32 v82, v82, v84
    v_cvt_pk_bf16_f32 v134, v81, v82
    v_cvt_pk_bf16_f32 v80, v46, v47
    v_lshlrev_b32 v81, 16, v80
    v_and_b32 v82, s32, v80
    v_lshlrev_b32 v83, 16, v23
    v_and_b32 v84, s32, v23
    v_add_f32 v81, v81, v83
    v_add_f32 v82, v82, v84
    v_cvt_pk_bf16_f32 v135, v81, v82
    v_cvt_pk_bf16_f32 v80, v48, v49
    v_lshlrev_b32 v81, 16, v80
    v_and_b32 v82, s32, v80
    v_lshlrev_b32 v83, 16, v24
    v_and_b32 v84, s32, v24
    v_add_f32 v81, v81, v83
    v_add_f32 v82, v82, v84
    v_cvt_pk_bf16_f32 v136, v81, v82
    v_cvt_pk_bf16_f32 v80, v50, v51
    v_lshlrev_b32 v81, 16, v80
    v_and_b32 v82, s32, v80
    v_lshlrev_b32 v83, 16, v25
    v_and_b32 v84, s32, v25
    v_add_f32 v81, v81, v83
    v_add_f32 v82, v82, v84
    v_cvt_pk_bf16_f32 v137, v81, v82
    v_cvt_pk_bf16_f32 v80, v52, v53
    v_lshlrev_b32 v81, 16, v80
    v_and_b32 v82, s32, v80
    v_lshlrev_b32 v83, 16, v26
    v_and_b32 v84, s32, v26
    v_add_f32 v81, v81, v83
    v_add_f32 v82, v82, v84
    v_cvt_pk_bf16_f32 v138, v81, v82
    v_cvt_pk_bf16_f32 v80, v54, v55
    v_lshlrev_b32 v81, 16, v80
    v_and_b32 v82, s32, v80
    v_lshlrev_b32 v83, 16, v27
    v_and_b32 v84, s32, v27
    v_add_f32 v81, v81, v83
    v_add_f32 v82, v82, v84
    v_cvt_pk_bf16_f32 v139, v81, v82
    buffer_store_dwordx4 v[128:131], v5, s[16:19], s31 offen
    buffer_store_dwordx4 v[132:135], v5, s[16:19], s31 offen offset:2048
    v_add_u32 v6, 4096, v5
    buffer_store_dwordx4 v[136:139], v6, s[16:19], s31 offen
    v_lshlrev_b32 v140, 16, v128
    v_and_b32 v141, s32, v128
    v_lshlrev_b32 v142, 16, v129
    v_and_b32 v143, s32, v129
    v_lshlrev_b32 v144, 16, v130
    v_and_b32 v145, s32, v130
    v_lshlrev_b32 v146, 16, v131
    v_and_b32 v147, s32, v131
    v_lshlrev_b32 v148, 16, v132
    v_and_b32 v149, s32, v132
    v_lshlrev_b32 v150, 16, v133
    v_and_b32 v151, s32, v133
    v_lshlrev_b32 v152, 16, v134
    v_and_b32 v153, s32, v134
    v_lshlrev_b32 v154, 16, v135
    v_and_b32 v155, s32, v135
    v_lshlrev_b32 v156, 16, v136
    v_and_b32 v157, s32, v136
    v_lshlrev_b32 v158, 16, v137
    v_and_b32 v159, s32, v137
    v_lshlrev_b32 v160, 16, v138
    v_and_b32 v161, s32, v138
    v_lshlrev_b32 v162, 16, v139
    v_and_b32 v163, s32, v139
    v_add_f32 v28, v140, v141
    v_add_f32 v28, v28, v142
    v_add_f32 v28, v28, v143
    v_add_f32 v28, v28, v144
    v_add_f32 v28, v28, v145
    v_add_f32 v28, v28, v146
    v_add_f32 v28, v28, v147
    v_add_f32 v28, v28, v148
    v_add_f32 v28, v28, v149
    v_add_f32 v28, v28, v150
    v_add_f32 v28, v28, v151
    v_add_f32 v28, v28, v152
    v_add_f32 v28, v28, v153
    v_add_f32 v28, v28, v154
    v_add_f32 v28, v28, v155
    v_add_f32 v28, v28, v156
    v_add_f32 v28, v28, v157
    v_add_f32 v28, v28, v158
    v_add_f32 v28, v28, v159
    v_add_f32 v28, v28, v160
    v_add_f32 v28, v28, v161
    v_add_f32 v28, v28, v162
    v_add_f32 v28, v28, v163
    s_nop 1
    v_add_f32_dpp v28, v28, v28 quad_perm:[1,0,3,2] row_mask:0xf bank_mask:0xf
    s_nop 1
    v_add_f32_dpp v28, v28, v28 quad_perm:[2,3,0,1] row_mask:0xf bank_mask:0xf
    s_mov_b32 s33, 0x3c2aaaab
    v_mul_f32 v30, s33, v28
    v_mov_b32 v29, 0
    v_sub_f32 v31, v140, v30
    v_fma_f32 v29, v31, v31, v29
    v_sub_f32 v31, v141, v30
    v_fma_f32 v29, v31, v31, v29
    v_sub_f32 v31, v142, v30
    v_fma_f32 v29, v31, v31, v29
    v_sub_f32 v31, v143, v30
    v_fma_f32 v29, v31, v31, v29
    v_sub_f32 v31, v144, v30
    v_fma_f32 v29, v31, v31, v29
    v_sub_f32 v31, v145, v30
    v_fma_f32 v29, v31, v31, v29
    v_sub_f32 v31, v146, v30
    v_fma_f32 v29, v31, v31, v29
    v_sub_f32 v31, v147, v30
    v_fma_f32 v29, v31, v31, v29
    v_sub_f32 v31, v148, v30
    v_fma_f32 v29, v31, v31, v29
    v_sub_f32 v31, v149, v30
    v_fma_f32 v29, v31, v31, v29
    v_sub_f32 v31, v150, v30
    v_fma_f32 v29, v31, v31, v29
    v_sub_f32 v31, v151, v30
    v_fma_f32 v29, v31, v31, v29
    v_sub_f32 v31, v152, v30
    v_fma_f32 v29, v31, v31, v29
    v_sub_f32 v31, v153, v30
    v_fma_f32 v29, v31, v31, v29
    v_sub_f32 v31, v154, v30
    v_fma_f32 v29, v31, v31, v29
    v_sub_f32 v31, v155, v30
    v_fma_f32 v29, v31, v31, v29
    v_sub_f32 v31, v156, v30
    v_fma_f32 v29, v31, v31, v29
    v_sub_f32 v31, v157, v30
    v_fma_f32 v29, v31, v31, v29
    v_sub_f32 v31, v158, v30
    v_fma_f32 v29, v31, v31, v29
    v_sub_f32 v31, v159, v30
    v_fma_f32 v29, v31, v31, v29
    v_sub_f32 v31, v160, v30
    v_fma_f32 v29, v31, v31, v29
    v_sub_f32 v31, v161, v30
    v_fma_f32 v29, v31, v31, v29
    v_sub_f32 v31, v162, v30
    v_fma_f32 v29, v31, v31, v29
    v_sub_f32 v31, v163, v30
    v_fma_f32 v29, v31, v31, v29
    s_nop 1
    v_add_f32_dpp v29, v29, v29 quad_perm:[1,0,3,2] row_mask:0xf bank_mask:0xf
    s_nop 1
    v_add_f32_dpp v29, v29, v29 quad_perm:[2,3,0,1] row_mask:0xf bank_mask:0xf
    v_mul_u32_u24 v4, 48, v3
    s_lshl_b32 s30, s21, 3
    s_add_u32 s30, s30, 2359296
    v_cmp_eq_u32 vcc, 0, v2
    s_and_saveexec_b64 s[40:41], vcc
    buffer_store_dwordx2 v[28:29], v4, s[16:19], s30 offen
    s_mov_b64 exec, s[40:41]
    s_endpgm
k2a_kernel_relayout:
    s_load_dwordx2 s[4:5], s[0:1], 48
    s_load_dwordx2 s[8:9], s[0:1], 72
    v_lshrrev_b32 v1, 6, v0
    v_and_b32 v0, 63, v0
    s_nop 0
    v_readfirstlane_b32 s20, v1
    s_sub_u32 s21, s2, 192
    s_lshl_b32 s21, s21, 2
    s_add_u32 s21, s21, s20
    s_mul_i32 s27, s20, 18688
    v_lshlrev_b32 v2, 4, v0
    v_lshrrev_b32 v3, 5, v0
    v_lshlrev_b32 v3, 3, v3
    v_bfe_u32 v4, v0, 2, 2
    v_add_u32 v3, v3, v4
    v_mul_u32_u24 v3, 1152, v3
    v_bfe_u32 v4, v0, 4, 1
    v_lshlrev_b32 v4, 5, v4
    v_add_u32 v3, v3, v4
    v_and_b32 v4, 3, v0
    v_lshlrev_b32 v4, 3, v4
    v_add3_u32 v3, v3, v4, s27
    v_lshrrev_b32 v5, 5, v0
    v_lshlrev_b32 v5, 3, v5
    v_and_b32 v4, 7, v0
    v_add_u32 v5, v5, v4
    v_lshlrev_b32 v5, 4, v5
    s_waitcnt lgkmcnt(0)
    s_mov_b32 s12, s4
    s_and_b32 s13, s5, 0xffff
    s_mov_b32 s14, 5308416
    s_mov_b32 s15, 0x00020000
    s_mov_b32 s16, s8
    s_and_b32 s17, s9, 0xffff
    s_mov_b32 s18, 268435456
    s_mov_b32 s19, 0x00020000
    s_sub_u32 s28, s2, 192
    s_add_u32 s28, s28, 256
    s_min_u32 s28, s28, 287
    s_mul_i32 s25, s21, 18432
    s_add_u32 m0, s27, 0
    s_add_u32 s24, s25, 0
    buffer_load_dwordx4 v2, s[12:15], s24 offen lds
    s_add_u32 m0, s27, 1024
    s_add_u32 s24, s25, 1024
    buffer_load_dwordx4 v2, s[12:15], s24 offen lds
    s_add_u32 m0, s27, 2048
    s_add_u32 s24, s25, 2048
    buffer_load_dwordx4 v2, s[12:15], s24 offen lds
    s_add_u32 m0, s27, 3072
    s_add_u32 s24, s25, 3072
    buffer_load_dwordx4 v2, s[12:15], s24 offen lds
    s_add_u32 m0, s27, 4096
    s_add_u32 s24, s25, 4096
    buffer_load_dwordx4 v2, s[12:15], s24 offen lds
    s_add_u32 m0, s27, 5120
    s_add_u32 s24, s25, 5120
    buffer_load_dwordx4 v2, s[12:15], s24 offen lds
    s_add_u32 m0, s27, 6144
    s_add_u32 s24, s25, 6144
    buffer_load_dwordx4 v2, s[12:15], s24 offen lds
    s_add_u32 m0, s27, 7168
    s_add_u32 s24, s25, 7168
    buffer_load_dwordx4 v2, s[12:15], s24 offen lds
    s_add_u32 m0, s27, 8192
    s_add_u32 s24, s25, 8192
    buffer_load_dwordx4 v2, s[12:15], s24 offen lds
    s_add_u32 m0, s27, 9216
    s_add_u32 s24, s25, 9216
    buffer_load_dwordx4 v2, s[12:15], s24 offen lds
    s_add_u32 m0, s27, 10240
    s_add_u32 s24, s25, 10240
    buffer_load_dwordx4 v2, s[12:15], s24 offen lds
    s_add_u32 m0, s27, 11264
    s_add_u32 s24, s25, 11264
    buffer_load_dwordx4 v2, s[12:15], s24 offen lds
    s_add_u32 m0, s27, 12288
    s_add_u32 s24, s25, 12288
    buffer_load_dwordx4 v2, s[12:15], s24 offen lds
    s_add_u32 m0, s27, 13312
    s_add_u32 s24, s25, 13312
    buffer_load_dwordx4 v2, s[12:15], s24 offen lds
    s_add_u32 m0, s27, 14336
    s_add_u32 s24, s25, 14336
    buffer_load_dwordx4 v2, s[12:15], s24 offen lds
    s_add_u32 m0, s27, 15360
    s_add_u32 s24, s25, 15360
    buffer_load_dwordx4 v2, s[12:15], s24 offen lds
    s_add_u32 m0, s27, 16384
    s_add_u32 s24, s25, 16384
    buffer_load_dwordx4 v2, s[12:15], s24 offen lds
    s_add_u32 m0, s27, 17408
    s_add_u32 s24, s25, 17408
    buffer_load_dwordx4 v2, s[12:15], s24 offen lds
    s_mul_i32 s29, s28, 18432
    s_lshl_b32 s30, s20, 2
    s_add_u32 s30, s30, s20
    s_add_u32 s30, s30, 0
    s_min_u32 s30, s30, 17
    s_lshl_b32 s30, s30, 10
    s_add_u32 m0, s30, 74752
    s_add_u32 s24, s29, s30
    buffer_load_dwordx4 v2, s[12:15], s24 offen lds
    s_lshl_b32 s30, s20, 2
    s_add_u32 s30, s30, s20
    s_add_u32 s30, s30, 1
    s_min_u32 s30, s30, 17
    s_lshl_b32 s30, s30, 10
    s_add_u32 m0, s30, 74752
    s_add_u32 s24, s29, s30
    buffer_load_dwordx4 v2, s[12:15], s24 offen lds
    s_lshl_b32 s30, s20, 2
    s_add_u32 s30, s30, s20
    s_add_u32 s30, s30, 2
    s_min_u32 s30, s30, 17
    s_lshl_b32 s30, s30, 10
    s_add_u32 m0, s30, 74752
    s_add_u32 s24, s29, s30
    buffer_load_dwordx4 v2, s[12:15], s24 offen lds
    s_lshl_b32 s30, s20, 2
    s_add_u32 s30, s30, s20
    s_add_u32 s30, s30, 3
    s_min_u32 s30, s30, 17
    s_lshl_b32 s30, s30, 10
    s_add_u32 m0, s30, 74752
    s_add_u32 s24, s29, s30
    buffer_load_dwordx4 v2, s[12:15], s24 offen lds
    s_lshl_b32 s30, s20, 2
    s_add_u32 s30, s30, s20
    s_add_u32 s30, s30, 4
    s_min_u32 s30, s30, 17
    s_lshl_b32 s30, s30, 10
    s_add_u32 m0, s30, 74752
    s_add_u32 s24, s29, s30
    buffer_load_dwordx4 v2, s[12:15], s24 offen lds
    s_waitcnt vmcnt(5)
    ds_read_b64_tr_b16 v[8:9], v3 offset:0
    ds_read_b64_tr_b16 v[10:11], v3 offset:4608
    ds_read_b64_tr_b16 v[12:13], v3 offset:64
    ds_read_b64_tr_b16 v[14:15], v3 offset:4672
    ds_read_b64_tr_b16 v[16:17], v3 offset:128
    ds_read_b64_tr_b16 v[18:19], v3 offset:4736
    ds_read_b64_tr_b16 v[20:21], v3 offset:144
    ds_read_b64_tr_b16 v[22:23], v3 offset:4752
    ds_read_b64_tr_b16 v[24:25], v3 offset:208
    ds_read_b64_tr_b16 v[26:27], v3 offset:4816
    ds_read_b64_tr_b16 v[28:29], v3 offset:272
    ds_read_b64_tr_b16 v[30:31], v3 offset:4880
    ds_read_b64_tr_b16 v[32:33], v3 offset:288
    ds_read_b64_tr_b16 v[34:35], v3 offset:4896
    ds_read_b64_tr_b16 v[36:37], v3 offset:352
    ds_read_b64_tr_b16 v[38:39], v3 offset:4960
    ds_read_b64_tr_b16 v[40:41], v3 offset:416
    ds_read_b64_tr_b16 v[42:43], v3 offset:5024
    ds_read_b64_tr_b16 v[44:45], v3 offset:432
    ds_read_b64_tr_b16 v[46:47], v3 offset:5040
    ds_read_b64_tr_b16 v[48:49], v3 offset:496
    ds_read_b64_tr_b16 v[50:51], v3 offset:5104
    ds_read_b64_tr_b16 v[52:53], v3 offset:560
    ds_read_b64_tr_b16 v[54:55], v3 offset:5168
    ds_read_b64_tr_b16 v[56:57], v3 offset:576
    ds_read_b64_tr_b16 v[58:59], v3 offset:5184
    ds_read_b64_tr_b16 v[60:61], v3 offset:640
    ds_read_b64_tr_b16 v[62:63], v3 offset:5248
    ds_read_b64_tr_b16 v[64:65], v3 offset:704
    ds_read_b64_tr_b16 v[66:67], v3 offset:5312
    ds_read_b64_tr_b16 v[68:69], v3 offset:720
    ds_read_b64_tr_b16 v[70:71], v3 offset:5328
    ds_read_b64_tr_b16 v[72:73], v3 offset:784
    ds_read_b64_tr_b16 v[74:75], v3 offset:5392
    ds_read_b64_tr_b16 v[76:77], v3 offset:848
    ds_read_b64_tr_b16 v[78:79], v3 offset:5456
    ds_read_b64_tr_b16 v[80:81], v3 offset:864
    ds_read_b64_tr_b16 v[82:83], v3 offset:5472
    ds_read_b64_tr_b16 v[84:85], v3 offset:928
    ds_read_b64_tr_b16 v[86:87], v3 offset:5536
    ds_read_b64_tr_b16 v[88:89], v3 offset:992
    ds_read_b64_tr_b16 v[90:91], v3 offset:5600
    ds_read_b64_tr_b16 v[92:93], v3 offset:1008
    ds_read_b64_tr_b16 v[94:95], v3 offset:5616
    ds_read_b64_tr_b16 v[96:97], v3 offset:1072
    ds_read_b64_tr_b16 v[98:99], v3 offset:5680
    ds_read_b64_tr_b16 v[100:101], v3 offset:1136
    ds_read_b64_tr_b16 v[102:103], v3 offset:5744
    s_mul_i32 s25, s21, 2304
    s_add_u32 s25, s25, 75497472
    s_waitcnt lgkmcnt(15)
    s_add_u32 s24, s25, 0
    buffer_store_dwordx4 v[8:11], v2, s[16:19], s24 offen offset:0
    buffer_store_dwordx4 v[12:15], v2, s[16:19], s24 offen offset:1024
    s_mov_b32 exec_lo, 0xff
    s_mov_b32 exec_hi, 0xff
    buffer_store_dwordx4 v[16:19], v5, s[16:19], s24 offen offset:2048
    s_mov_b64 exec, -1
    s_add_u32 s24, s25, 663552
    buffer_store_dwordx4 v[20:23], v2, s[16:19], s24 offen offset:0
    buffer_store_dwordx4 v[24:27], v2, s[16:19], s24 offen offset:1024
    s_mov_b32 exec_lo, 0xff
    s_mov_b32 exec_hi, 0xff
    buffer_store_dwordx4 v[28:31], v5, s[16:19], s24 offen offset:2048
    s_mov_b64 exec, -1
    s_add_u32 s24, s25, 1327104
    buffer_store_dwordx4 v[32:35], v2, s[16:19], s24 offen offset:0
    buffer_store_dwordx4 v[36:39], v2, s[16:19], s24 offen offset:1024
    s_mov_b32 exec_lo, 0xff
    s_mov_b32 exec_hi, 0xff
    buffer_store_dwordx4 v[40:43], v5, s[16:19], s24 offen offset:2048
    s_mov_b64 exec, -1
    s_add_u32 s24, s25, 1990656
    buffer_store_dwordx4 v[44:47], v2, s[16:19], s24 offen offset:0
    buffer_store_dwordx4 v[48:51], v2, s[16:19], s24 offen offset:1024
    s_mov_b32 exec_lo, 0xff
    s_mov_b32 exec_hi, 0xff
    buffer_store_dwordx4 v[52:55], v5, s[16:19], s24 offen offset:2048
    s_mov_b64 exec, -1
    s_add_u32 s24, s25, 2654208
    buffer_store_dwordx4 v[56:59], v2, s[16:19], s24 offen offset:0
    buffer_store_dwordx4 v[60:63], v2, s[16:19], s24 offen offset:1024
    s_mov_b32 exec_lo, 0xff
    s_mov_b32 exec_hi, 0xff
    buffer_store_dwordx4 v[64:67], v5, s[16:19], s24 offen offset:2048
    s_mov_b64 exec, -1
    s_waitcnt lgkmcnt(12)
    s_add_u32 s24, s25, 3317760
    buffer_store_dwordx4 v[68:71], v2, s[16:19], s24 offen offset:0
    buffer_store_dwordx4 v[72:75], v2, s[16:19], s24 offen offset:1024
    s_mov_b32 exec_lo, 0xff
    s_mov_b32 exec_hi, 0xff
    buffer_store_dwordx4 v[76:79], v5, s[16:19], s24 offen offset:2048
    s_mov_b64 exec, -1
    s_waitcnt lgkmcnt(6)
    s_add_u32 s24, s25, 3981312
    buffer_store_dwordx4 v[80:83], v2, s[16:19], s24 offen offset:0
    buffer_store_dwordx4 v[84:87], v2, s[16:19], s24 offen offset:1024
    s_mov_b32 exec_lo, 0xff
    s_mov_b32 exec_hi, 0xff
    buffer_store_dwordx4 v[88:91], v5, s[16:19], s24 offen offset:2048
    s_mov_b64 exec, -1
    s_waitcnt lgkmcnt(0)
    s_add_u32 s24, s25, 4644864
    buffer_store_dwordx4 v[92:95], v2, s[16:19], s24 offen offset:0
    buffer_store_dwordx4 v[96:99], v2, s[16:19], s24 offen offset:1024
    s_mov_b32 exec_lo, 0xff
    s_mov_b32 exec_hi, 0xff
    buffer_store_dwordx4 v[100:103], v5, s[16:19], s24 offen offset:2048
    s_mov_b64 exec, -1
    s_waitcnt vmcnt(24)
    s_barrier
    v_subrev_u32 v6, s27, v3
    s_mul_i32 s30, s20, 288
    s_add_u32 s30, s30, 74752
    v_add_u32 v6, s30, v6
    s_nop 1
    ds_read_b64_tr_b16 v[8:9], v6 offset:0
    ds_read_b64_tr_b16 v[10:11], v6 offset:4608
    ds_read_b64_tr_b16 v[12:13], v6 offset:64
    ds_read_b64_tr_b16 v[14:15], v6 offset:4672
    ds_read_b64_tr_b16 v[16:17], v6 offset:128
    ds_read_b64_tr_b16 v[18:19], v6 offset:4736
    ds_read_b64_tr_b16 v[20:21], v6 offset:144
    ds_read_b64_tr_b16 v[22:23], v6 offset:4752
    ds_read_b64_tr_b16 v[24:25], v6 offset:208
    ds_read_b64_tr_b16 v[26:27], v6 offset:4816
    ds_read_b64_tr_b16 v[28:29], v6 offset:272
    ds_read_b64_tr_b16 v[30:31], v6 offset:4880
    s_mul_i32 s25, s28, 2304
    s_add_u32 s25, s25, 75497472
    s_mul_i32 s30, s20, 1327104
    s_add_u32 s25, s25, s30
    s_waitcnt lgkmcnt(6)
    s_add_u32 s24, s25, 0
    buffer_store_dwordx4 v[8:11], v2, s[16:19], s24 offen offset:0
    buffer_store_dwordx4 v[12:15], v2, s[16:19], s24 offen offset:1024
    s_mov_b32 exec_lo, 0xff
    s_mov_b32 exec_hi, 0xff
    buffer_store_dwordx4 v[16:19], v5, s[16:19], s24 offen offset:2048
    s_mov_b64 exec, -1
    s_waitcnt lgkmcnt(0)
    s_add_u32 s24, s25, 663552
    buffer_store_dwordx4 v[20:23], v2, s[16:19], s24 offen offset:0
    buffer_store_dwordx4 v[24:27], v2, s[16:19], s24 offen offset:1024
    s_mov_b32 exec_lo, 0xff
    s_mov_b32 exec_hi, 0xff
    buffer_store_dwordx4 v[28:31], v5, s[16:19], s24 offen offset:2048
    s_mov_b64 exec, -1
k2a_kernel_end:
    s_endpgm
.globl k3_kernel
.p2align 8
.type k3_kernel,@function
k3_kernel:
    s_cmp_ge_u32 s2, 256
    s_cbranch_scc1 k3_kernel_end
    s_load_dwordx4 s[4:7], s[0:1], 32
    s_load_dwordx2 s[8:9], s[0:1], 72
    v_lshrrev_b32 v1, 6, v0
    v_and_b32 v0, 63, v0
    s_nop 0
    v_readfirstlane_b32 s20, v1
    s_and_b32 s21, s2, 7
    s_lshl_b32 s21, s21, 2
    s_lshr_b32 s22, s2, 3
    s_and_b32 s22, s22, 3
    s_add_u32 s21, s21, s22
    s_lshr_b32 s22, s2, 5
    s_lshl_b32 s29, s22, 3
    s_lshl_b32 s30, s20, 1
    s_add_u32 s29, s29, s30
    s_mul_i32 s23, s29, 36864
    s_add_u32 s23, s23, 0
    s_mul_i32 s28, s29, 288
    s_mul_i32 s30, s21, 9
    s_add_u32 s28, s28, s30
    s_lshl_b32 s28, s28, 10
    s_add_u32 s28, s28, 8388608
    v_and_b32 v1, 31, v0
    s_lshl_b32 s30, s29, 5
    v_add_u32 v1, s30, v1
    v_mul_u32_u24 v1, 48, v1
    s_mul_i32 s30, s21, 288
    s_mov_b32 s31, 0xe38f
    s_mov_b32 s32, 9216
    v_add_u32 v2, 0, v0
    v_mul_lo_u32 v3, v2, s31
    v_lshrrev_b32 v3, 20, v3
    v_mul_u32_u24 v4, 18, v3
    v_sub_u32 v4, v2, v4
    v_mul_lo_u32 v3, v3, s32
    v_lshlrev_b32 v4, 4, v4
    v_add3_u32 v68, v3, v4, s30
    v_add_u32 v2, 64, v0
    v_mul_lo_u32 v3, v2, s31
    v_lshrrev_b32 v3, 20, v3
    v_mul_u32_u24 v4, 18, v3
    v_sub_u32 v4, v2, v4
    v_mul_lo_u32 v3, v3, s32
    v_lshlrev_b32 v4, 4, v4
    v_add3_u32 v69, v3, v4, s30
    v_add_u32 v2, 128, v0
    v_mul_lo_u32 v3, v2, s31
    v_lshrrev_b32 v3, 20, v3
    v_mul_u32_u24 v4, 18, v3
    v_sub_u32 v4, v2, v4
    v_mul_lo_u32 v3, v3, s32
    v_lshlrev_b32 v4, 4, v4
    v_add3_u32 v70, v3, v4, s30
    v_add_u32 v2, 192, v0
    v_mul_lo_u32 v3, v2, s31
    v_lshrrev_b32 v3, 20, v3
    v_mul_u32_u24 v4, 18, v3
    v_sub_u32 v4, v2, v4
    v_mul_lo_u32 v3, v3, s32
    v_lshlrev_b32 v4, 4, v4
    v_add3_u32 v71, v3, v4, s30
    v_add_u32 v2, 256, v0
    v_mul_lo_u32 v3, v2, s31
    v_lshrrev_b32 v3, 20, v3
    v_mul_u32_u24 v4, 18, v3
    v_sub_u32 v4, v2, v4
    v_mul_lo_u32 v3, v3, s32
    v_lshlrev_b32 v4, 4, v4
    v_add3_u32 v72, v3, v4, s30
    v_add_u32 v2, 320, v0
    v_mul_lo_u32 v3, v2, s31
    v_lshrrev_b32 v3, 20, v3
    v_mul_u32_u24 v4, 18, v3
    v_sub_u32 v4, v2, v4
    v_mul_lo_u32 v3, v3, s32
    v_lshlrev_b32 v4, 4, v4
    v_add3_u32 v73, v3, v4, s30
    v_add_u32 v2, 384, v0
    v_mul_lo_u32 v3, v2, s31
    v_lshrrev_b32 v3, 20, v3
    v_mul_u32_u24 v4, 18, v3
    v_sub_u32 v4, v2, v4
    v_mul_lo_u32 v3, v3, s32
    v_lshlrev_b32 v4, 4, v4
    v_add3_u32 v74, v3, v4, s30
    v_add_u32 v2, 448, v0
    v_mul_lo_u32 v3, v2, s31
    v_lshrrev_b32 v3, 20, v3
    v_mul_u32_u24 v4, 18, v3
    v_sub_u32 v4, v2, v4
    v_mul_lo_u32 v3, v3, s32
    v_lshlrev_b32 v4, 4, v4
    v_add3_u32 v75, v3, v4, s30
    v_add_u32 v2, 512, v0
    v_mul_lo_u32 v3, v2, s31
    v_lshrrev_b32 v3, 20, v3
    v_mul_u32_u24 v4, 18, v3
    v_sub_u32 v4, v2, v4
    v_mul_lo_u32 v3, v3, s32
    v_lshlrev_b32 v4, 4, v4
    v_add3_u32 v76, v3, v4, s30
    s_lshr_b32 s30, s20, 1
    s_mul_i32 s27, s30, 18560
    s_and_b32 s30, s20, 1
    s_mul_i32 s31, s30, 9216
    s_add_u32 s27, s27, s31
    s_mul_i32 s26, s30, 294912
    v_lshlrev_b32 v81, 4, v0
    s_waitcnt lgkmcnt(0)
    s_cmp_ge_u32 s20, 2
    s_cselect_b32 s12, s6, s4
    s_cselect_b32 s13, s7, s5
    s_and_b32 s13, s13, 0xffff
    s_mov_b32 s14, 5308416
    s_mov_b32 s15, 0x00020000
    s_mov_b32 s16, s8
    s_and_b32 s17, s9, 0xffff
    s_mov_b32 s18, 268435456
    s_mov_b32 s19, 0x00020000
    s_mov_b32 s30, 2359296
    buffer_load_dwordx4 v[96:99], v1, s[16:19], s30 offen offset:0
    buffer_load_dwordx4 v[100:103], v1, s[16:19], s30 offen offset:16
    buffer_load_dwordx4 v[104:107], v1, s[16:19], s30 offen offset:32
    buffer_load_dwordx4 v[108:111], v1, s[16:19], s30 offen offset:1536
    buffer_load_dwordx4 v[112:115], v1, s[16:19], s30 offen offset:1552
    buffer_load_dwordx4 v[116:119], v1, s[16:19], s30 offen offset:1568
    s_add_u32 s24, s23, 0
    buffer_load_dwordx4 v[8:11], v81, s[16:19], s24 offen
    s_add_u32 s24, s23, 36864
    buffer_load_dwordx4 v[12:15], v81, s[16:19], s24 offen
    s_add_u32 m0, s27, 0
    s_add_u32 s33, s26, 0
    buffer_load_dwordx4 v68, s[12:15], s33 offen lds
    s_add_u32 m0, s27, 1024
    s_nop 0
    buffer_load_dwordx4 v69, s[12:15], s33 offen lds
    s_add_u32 m0, s27, 2048
    s_nop 0
    buffer_load_dwordx4 v70, s[12:15], s33 offen lds
    s_add_u32 m0, s27, 3072
    s_nop 0
    buffer_load_dwordx4 v71, s[12:15], s33 offen lds
    s_add_u32 m0, s27, 4096
    s_nop 0
    buffer_load_dwordx4 v72, s[12:15], s33 offen lds
    s_add_u32 m0, s27, 5120
    s_nop 0
    buffer_load_dwordx4 v73, s[12:15], s33 offen lds
    s_add_u32 m0, s27, 6144
    s_nop 0
    buffer_load_dwordx4 v74, s[12:15], s33 offen lds
    s_add_u32 m0, s27, 7168
    s_nop 0
    buffer_load_dwordx4 v75, s[12:15], s33 offen lds
    s_add_u32 m0, s27, 8192
    s_nop 0
    buffer_load_dwordx4 v76, s[12:15], s33 offen lds
    s_add_u32 s24, s23, 1024
    buffer_load_dwordx4 v[16:19], v81, s[16:19], s24 offen
    s_add_u32 s24, s23, 37888
    buffer_load_dwordx4 v[20:23], v81, s[16:19], s24 offen
    v_bfe_u32 v2, v0, 4, 1
    s_mov_b32 s30, 18560
    v_mul_lo_u32 v2, v2, s30
    v_lshrrev_b32 v3, 5, v0
    v_lshlrev_b32 v3, 3, v3
    v_bfe_u32 v4, v0, 2, 2
    v_add_u32 v3, v3, v4
    v_mul_u32_u24 v3, 288, v3
    v_add_u32 v2, v2, v3
    v_and_b32 v3, 1, v0
    v_lshlrev_b32 v3, 4, v3
    v_add_u32 v2, v2, v3
    v_bfe_u32 v3, v0, 1, 1
    v_lshlrev_b32 v3, 3, v3
    v_add_u32 v77, v2, v3
    v_add_u32 v78, 37120, v77
    v_add_u32 v79, 74240, v77
    v_add_u32 v80, 111360, v77
    s_waitcnt vmcnt(13)
    v_add_f32 v1, v96, v98
    v_add_f32 v2, v100, v102
    v_add_f32 v3, v104, v106
    v_add_f32 v1, v1, v2
    v_add_f32 v1, v1, v3
    s_mov_b32 s30, 0x3ae38e39
    v_mul_f32 v1, s30, v1
    v_add_f32 v2, v97, v99
    v_add_f32 v3, v101, v103
    v_add_f32 v4, v105, v107
    v_add_f32 v2, v2, v3
    v_add_f32 v2, v2, v4
    s_mov_b32 s31, 0x3c2aaaab
    v_mov_b32 v4, 0
    v_fma_f32 v3, v96, s31, -v1
    v_fma_f32 v4, v3, v3, v4
    v_fma_f32 v3, v98, s31, -v1
    v_fma_f32 v4, v3, v3, v4
    v_fma_f32 v3, v100, s31, -v1
    v_fma_f32 v4, v3, v3, v4
    v_fma_f32 v3, v102, s31, -v1
    v_fma_f32 v4, v3, v3, v4
    v_fma_f32 v3, v104, s31, -v1
    v_fma_f32 v4, v3, v3, v4
    v_fma_f32 v3, v106, s31, -v1
    v_fma_f32 v4, v3, v3, v4
    s_mov_b32 s31, 0x42c00000
    v_fma_f32 v2, v4, s31, v2
    v_mul_f32 v2, s30, v2
    v_cvt_pk_bf16_f32 v1, v1, v1
    v_lshlrev_b32 v1, 16, v1
    v_cvt_pk_bf16_f32 v2, v2, v2
    v_lshlrev_b32 v2, 16, v2
    v_add_f32 v2, 0x3727c5ac, v2
    v_cvt_pk_bf16_f32 v2, v2, v2
    v_lshlrev_b32 v2, 16, v2
    v_sqrt_f32 v2, v2
    s_nop 0
    v_cvt_pk_bf16_f32 v2, v2, v2
    v_lshlrev_b32 v2, 16, v2
    v_rcp_f32 v64, v2
    s_nop 0
    v_mul_f32 v65, v1, v64
    v_sub_f32 v65, 0, v65
    v_add_f32 v1, v108, v110
    v_add_f32 v2, v112, v114
    v_add_f32 v3, v116, v118
    v_add_f32 v1, v1, v2
    v_add_f32 v1, v1, v3
    s_mov_b32 s30, 0x3ae38e39
    v_mul_f32 v1, s30, v1
    v_add_f32 v2, v109, v111
    v_add_f32 v3, v113, v115
    v_add_f32 v4, v117, v119
    v_add_f32 v2, v2, v3
    v_add_f32 v2, v2, v4
    s_mov_b32 s31, 0x3c2aaaab
    v_mov_b32 v4, 0
    v_fma_f32 v3, v108, s31, -v1
    v_fma_f32 v4, v3, v3, v4
    v_fma_f32 v3, v110, s31, -v1
    v_fma_f32 v4, v3, v3, v4
    v_fma_f32 v3, v112, s31, -v1
    v_fma_f32 v4, v3, v3, v4
    v_fma_f32 v3, v114, s31, -v1
    v_fma_f32 v4, v3, v3, v4
    v_fma_f32 v3, v116, s31, -v1
    v_fma_f32 v4, v3, v3, v4
    v_fma_f32 v3, v118, s31, -v1
    v_fma_f32 v4, v3, v3, v4
    s_mov_b32 s31, 0x42c00000
    v_fma_f32 v2, v4, s31, v2
    v_mul_f32 v2, s30, v2
    v_cvt_pk_bf16_f32 v1, v1, v1
    v_lshlrev_b32 v1, 16, v1
    v_cvt_pk_bf16_f32 v2, v2, v2
    v_lshlrev_b32 v2, 16, v2
    v_add_f32 v2, 0x3727c5ac, v2
    v_cvt_pk_bf16_f32 v2, v2, v2
    v_lshlrev_b32 v2, 16, v2
    v_sqrt_f32 v2, v2
    s_nop 0
    v_cvt_pk_bf16_f32 v2, v2, v2
    v_lshlrev_b32 v2, 16, v2
    v_rcp_f32 v66, v2
    s_nop 0
    v_mul_f32 v67, v1, v66
    v_sub_f32 v67, 0, v67
    s_waitcnt vmcnt(11)
    v_lshlrev_b32 v56, 16, v8
    v_and_b32 v57, 0xffff0000, v8
    v_fma_f32 v56, v56, v64, v65
    v_fma_f32 v57, v57, v64, v65
    v_cvt_pk_bf16_f32 v40, v56, v57
    v_lshlrev_b32 v58, 16, v9
    v_and_b32 v59, 0xffff0000, v9
    v_fma_f32 v58, v58, v64, v65
    v_fma_f32 v59, v59, v64, v65
    v_cvt_pk_bf16_f32 v41, v58, v59
    v_lshlrev_b32 v60, 16, v10
    v_and_b32 v61, 0xffff0000, v10
    v_fma_f32 v60, v60, v64, v65
    v_fma_f32 v61, v61, v64, v65
    v_cvt_pk_bf16_f32 v42, v60, v61
    v_lshlrev_b32 v62, 16, v11
    v_and_b32 v63, 0xffff0000, v11
    v_fma_f32 v62, v62, v64, v65
    v_fma_f32 v63, v63, v64, v65
    v_cvt_pk_bf16_f32 v43, v62, v63
    v_lshlrev_b32 v56, 16, v12
    v_and_b32 v57, 0xffff0000, v12
    v_fma_f32 v56, v56, v66, v67
    v_fma_f32 v57, v57, v66, v67
    v_cvt_pk_bf16_f32 v44, v56, v57
    v_lshlrev_b32 v58, 16, v13
    v_and_b32 v59, 0xffff0000, v13
    v_fma_f32 v58, v58, v66, v67
    v_fma_f32 v59, v59, v66, v67
    v_cvt_pk_bf16_f32 v45, v58, v59
    v_lshlrev_b32 v60, 16, v14
    v_and_b32 v61, 0xffff0000, v14
    v_fma_f32 v60, v60, v66, v67
    v_fma_f32 v61, v61, v66, v67
    v_cvt_pk_bf16_f32 v46, v60, v61
    v_lshlrev_b32 v62, 16, v15
    v_and_b32 v63, 0xffff0000, v15
    v_fma_f32 v62, v62, v66, v67
    v_fma_f32 v63, v63, v66, v67
    v_cvt_pk_bf16_f32 v47, v62, v63
    s_add_u32 m0, s27, 37120
    s_add_u32 s33, s26, 589824
    buffer_load_dwordx4 v68, s[12:15], s33 offen lds
    s_add_u32 m0, s27, 38144
    s_nop 0
    buffer_load_dwordx4 v69, s[12:15], s33 offen lds
    s_add_u32 m0, s27, 39168
    s_nop 0
    buffer_load_dwordx4 v70, s[12:15], s33 offen lds
    s_add_u32 m0, s27, 40192
    s_nop 0
    buffer_load_dwordx4 v71, s[12:15], s33 offen lds
    s_add_u32 m0, s27, 41216
    s_nop 0
    buffer_load_dwordx4 v72, s[12:15], s33 offen lds
    s_add_u32 m0, s27, 42240
    s_nop 0
    buffer_load_dwordx4 v73, s[12:15], s33 offen lds
    s_add_u32 m0, s27, 43264
    s_nop 0
    buffer_load_dwordx4 v74, s[12:15], s33 offen lds
    s_add_u32 m0, s27, 44288
    s_nop 0
    buffer_load_dwordx4 v75, s[12:15], s33 offen lds
    s_add_u32 m0, s27, 45312
    s_nop 0
    buffer_load_dwordx4 v76, s[12:15], s33 offen lds
    s_add_u32 s24, s23, 2048
    buffer_load_dwordx4 v[24:27], v81, s[16:19], s24 offen
    s_add_u32 s24, s23, 38912
    buffer_load_dwordx4 v[28:31], v81, s[16:19], s24 offen
    s_add_u32 s24, s23, 3072
    buffer_load_dwordx4 v[32:35], v81, s[16:19], s24 offen
    s_add_u32 s24, s23, 39936
    buffer_load_dwordx4 v[36:39], v81, s[16:19], s24 offen
    s_waitcnt vmcnt(15)
    s_barrier
    ds_read_b64_tr_b16 a[128:129], v77 offset:0
    ds_read_b64_tr_b16 a[130:131], v77 offset:1152
    ds_read_b64_tr_b16 a[132:133], v77 offset:32
    ds_read_b64_tr_b16 a[134:135], v77 offset:1184
    ds_read_b64_tr_b16 a[136:137], v77 offset:64
    ds_read_b64_tr_b16 a[138:139], v77 offset:1216
    ds_read_b64_tr_b16 a[140:141], v77 offset:96
    ds_read_b64_tr_b16 a[142:143], v77 offset:1248
    ds_read_b64_tr_b16 a[144:145], v77 offset:128
    ds_read_b64_tr_b16 a[146:147], v77 offset:1280
    ds_read_b64_tr_b16 a[148:149], v77 offset:160
    ds_read_b64_tr_b16 a[150:151], v77 offset:1312
    ds_read_b64_tr_b16 a[152:153], v77 offset:192
    ds_read_b64_tr_b16 a[154:155], v77 offset:1344
    ds_read_b64_tr_b16 a[156:157], v77 offset:224
    ds_read_b64_tr_b16 a[158:159], v77 offset:1376
    ds_read_b64_tr_b16 a[160:161], v77 offset:256
    ds_read_b64_tr_b16 a[162:163], v77 offset:1408
    s_waitcnt lgkmcnt(0)
    s_waitcnt vmcnt(13)
    v_mfma_f32_32x32x16_bf16 v[96:111], a[128:131], v[40:43], 0
    ds_read_b64_tr_b16 a[164:165], v77 offset:4608
    ds_read_b64_tr_b16 a[166:167], v77 offset:5760
    v_lshlrev_b32 v56, 16, v16
    v_and_b32 v57, 0xffff0000, v16
    v_fma_f32 v56, v56, v64, v65
    v_mfma_f32_32x32x16_bf16 v[112:127], a[128:131], v[44:47], 0
    ds_read_b64_tr_b16 a[168:169], v77 offset:4640
    ds_read_b64_tr_b16 a[170:171], v77 offset:5792
    v_fma_f32 v57, v57, v64, v65
    v_cvt_pk_bf16_f32 v48, v56, v57
    v_mfma_f32_32x32x16_bf16 v[128:143], a[132:135], v[40:43], 0
    ds_read_b64_tr_b16 a[172:173], v77 offset:4672
    ds_read_b64_tr_b16 a[174:175], v77 offset:5824
    v_lshlrev_b32 v58, 16, v17
    v_and_b32 v59, 0xffff0000, v17
    v_mfma_f32_32x32x16_bf16 v[144:159], a[132:135], v[44:47], 0
    ds_read_b64_tr_b16 a[176:177], v77 offset:4704
    ds_read_b64_tr_b16 a[178:179], v77 offset:5856
    v_fma_f32 v58, v58, v64, v65
    v_fma_f32 v59, v59, v64, v65
    v_mfma_f32_32x32x16_bf16 v[160:175], a[136:139], v[40:43], 0
    ds_read_b64_tr_b16 a[180:181], v77 offset:4736
    ds_read_b64_tr_b16 a[182:183], v77 offset:5888
    v_cvt_pk_bf16_f32 v49, v58, v59
    v_lshlrev_b32 v60, 16, v18
    v_and_b32 v61, 0xffff0000, v18
    v_mfma_f32_32x32x16_bf16 v[176:191], a[136:139], v[44:47], 0
    ds_read_b64_tr_b16 a[184:185], v77 offset:4768
    ds_read_b64_tr_b16 a[186:187], v77 offset:5920
    v_fma_f32 v60, v60, v64, v65
    v_fma_f32 v61, v61, v64, v65
    v_mfma_f32_32x32x16_bf16 v[192:207], a[140:143], v[40:43], 0
    ds_read_b64_tr_b16 a[188:189], v77 offset:4800
    ds_read_b64_tr_b16 a[190:191], v77 offset:5952
    v_cvt_pk_bf16_f32 v50, v60, v61
    v_lshlrev_b32 v62, 16, v19
    v_mfma_f32_32x32x16_bf16 v[208:223], a[140:143], v[44:47], 0
    ds_read_b64_tr_b16 a[192:193], v77 offset:4832
    ds_read_b64_tr_b16 a[194:195], v77 offset:5984
    v_and_b32 v63, 0xffff0000, v19
    v_fma_f32 v62, v62, v64, v65
    v_mfma_f32_32x32x16_bf16 v[224:239], a[144:147], v[40:43], 0
    ds_read_b64_tr_b16 a[196:197], v77 offset:4864
    ds_read_b64_tr_b16 a[198:199], v77 offset:6016
    v_fma_f32 v63, v63, v64, v65
    v_cvt_pk_bf16_f32 v51, v62, v63
    v_mfma_f32_32x32x16_bf16 v[240:255], a[144:147], v[44:47], 0
    v_lshlrev_b32 v56, 16, v20
    v_and_b32 v57, 0xffff0000, v20
    v_fma_f32 v56, v56, v66, v67
    s_add_u32 s24, s23, 4096
    buffer_load_dwordx4 v[8:11], v81, s[16:19], s24 offen
    v_mfma_f32_32x32x16_bf16 a[0:15], a[148:151], v[40:43], 0
    v_fma_f32 v57, v57, v66, v67
    v_cvt_pk_bf16_f32 v52, v56, v57
    s_add_u32 s24, s23, 40960
    buffer_load_dwordx4 v[12:15], v81, s[16:19], s24 offen
    v_mfma_f32_32x32x16_bf16 a[16:31], a[148:151], v[44:47], 0
    v_lshlrev_b32 v58, 16, v21
    v_and_b32 v59, 0xffff0000, v21
    v_mfma_f32_32x32x16_bf16 a[32:47], a[152:155], v[40:43], 0
    v_fma_f32 v58, v58, v66, v67
    v_fma_f32 v59, v59, v66, v67
    s_add_u32 m0, s27, 74240
    s_add_u32 s33, s26, 1179648
    buffer_load_dwordx4 v68, s[12:15], s33 offen lds
    v_mfma_f32_32x32x16_bf16 a[48:63], a[152:155], v[44:47], 0
    v_cvt_pk_bf16_f32 v53, v58, v59
    v_lshlrev_b32 v60, 16, v22
    v_and_b32 v61, 0xffff0000, v22
    v_mfma_f32_32x32x16_bf16 a[64:79], a[156:159], v[40:43], 0
    v_fma_f32 v60, v60, v66, v67
    v_fma_f32 v61, v61, v66, v67
    s_add_u32 m0, s27, 75264
    s_nop 0
    buffer_load_dwordx4 v69, s[12:15], s33 offen lds
    v_mfma_f32_32x32x16_bf16 a[80:95], a[156:159], v[44:47], 0
    v_cvt_pk_bf16_f32 v54, v60, v61
    v_lshlrev_b32 v62, 16, v23
    v_mfma_f32_32x32x16_bf16 a[96:111], a[160:163], v[40:43], 0
    v_and_b32 v63, 0xffff0000, v23
    v_fma_f32 v62, v62, v66, v67
    s_add_u32 m0, s27, 76288
    s_nop 0
    buffer_load_dwordx4 v70, s[12:15], s33 offen lds
    v_mfma_f32_32x32x16_bf16 a[112:127], a[160:163], v[44:47], 0
    v_fma_f32 v63, v63, v66, v67
    v_cvt_pk_bf16_f32 v55, v62, v63
    s_waitcnt lgkmcnt(0)
    s_waitcnt vmcnt(7)
    v_mfma_f32_32x32x16_bf16 v[96:111], a[164:167], v[48:51], v[96:111]
    ds_read_b64_tr_b16 a[128:129], v77 offset:9216
    ds_read_b64_tr_b16 a[130:131], v77 offset:10368
    v_lshlrev_b32 v56, 16, v24
    v_and_b32 v57, 0xffff0000, v24
    v_fma_f32 v56, v56, v64, v65
    v_mfma_f32_32x32x16_bf16 v[112:127], a[164:167], v[52:55], v[112:127]
    ds_read_b64_tr_b16 a[132:133], v77 offset:9248
    ds_read_b64_tr_b16 a[134:135], v77 offset:10400
    v_fma_f32 v57, v57, v64, v65
    v_cvt_pk_bf16_f32 v40, v56, v57
    v_mfma_f32_32x32x16_bf16 v[128:143], a[168:171], v[48:51], v[128:143]
    ds_read_b64_tr_b16 a[136:137], v77 offset:9280
    ds_read_b64_tr_b16 a[138:139], v77 offset:10432
    v_lshlrev_b32 v58, 16, v25
    v_and_b32 v59, 0xffff0000, v25
    v_mfma_f32_32x32x16_bf16 v[144:159], a[168:171], v[52:55], v[144:159]
    ds_read_b64_tr_b16 a[140:141], v77 offset:9312
    ds_read_b64_tr_b16 a[142:143], v77 offset:10464
    v_fma_f32 v58, v58, v64, v65
    v_fma_f32 v59, v59, v64, v65
    v_mfma_f32_32x32x16_bf16 v[160:175], a[172:175], v[48:51], v[160:175]
    ds_read_b64_tr_b16 a[144:145], v77 offset:9344
    ds_read_b64_tr_b16 a[146:147], v77 offset:10496
    v_cvt_pk_bf16_f32 v41, v58, v59
    v_lshlrev_b32 v60, 16, v26
    v_and_b32 v61, 0xffff0000, v26
    v_mfma_f32_32x32x16_bf16 v[176:191], a[172:175], v[52:55], v[176:191]
    ds_read_b64_tr_b16 a[148:149], v77 offset:9376
    ds_read_b64_tr_b16 a[150:151], v77 offset:10528
    v_fma_f32 v60, v60, v64, v65
    v_fma_f32 v61, v61, v64, v65
    v_mfma_f32_32x32x16_bf16 v[192:207], a[176:179], v[48:51], v[192:207]
    ds_read_b64_tr_b16 a[152:153], v77 offset:9408
    ds_read_b64_tr_b16 a[154:155], v77 offset:10560
    v_cvt_pk_bf16_f32 v42, v60, v61
    v_lshlrev_b32 v62, 16, v27
    v_mfma_f32_32x32x16_bf16 v[208:223], a[176:179], v[52:55], v[208:223]
    ds_read_b64_tr_b16 a[156:157], v77 offset:9440
    ds_read_b64_tr_b16 a[158:159], v77 offset:10592
    v_and_b32 v63, 0xffff0000, v27
    v_fma_f32 v62, v62, v64, v65
    v_mfma_f32_32x32x16_bf16 v[224:239], a[180:183], v[48:51], v[224:239]
    ds_read_b64_tr_b16 a[160:161], v77 offset:9472
    ds_read_b64_tr_b16 a[162:163], v77 offset:10624
    v_fma_f32 v63, v63, v64, v65
    v_cvt_pk_bf16_f32 v43, v62, v63
    v_mfma_f32_32x32x16_bf16 v[240:255], a[180:183], v[52:55], v[240:255]
    v_lshlrev_b32 v56, 16, v28
    v_and_b32 v57, 0xffff0000, v28
    v_fma_f32 v56, v56, v66, v67
    s_add_u32 s24, s23, 5120
    buffer_load_dwordx4 v[16:19], v81, s[16:19], s24 offen
    v_mfma_f32_32x32x16_bf16 a[0:15], a[184:187], v[48:51], a[0:15]
    v_fma_f32 v57, v57, v66, v67
    v_cvt_pk_bf16_f32 v44, v56, v57
    s_add_u32 s24, s23, 41984
    buffer_load_dwordx4 v[20:23], v81, s[16:19], s24 offen
    v_mfma_f32_32x32x16_bf16 a[16:31], a[184:187], v[52:55], a[16:31]
    v_lshlrev_b32 v58, 16, v29
    v_and_b32 v59, 0xffff0000, v29
    v_mfma_f32_32x32x16_bf16 a[32:47], a[188:191], v[48:51], a[32:47]
    v_fma_f32 v58, v58, v66, v67
    v_fma_f32 v59, v59, v66, v67
    s_add_u32 m0, s27, 77312
    s_nop 0
    buffer_load_dwordx4 v71, s[12:15], s33 offen lds
    v_mfma_f32_32x32x16_bf16 a[48:63], a[188:191], v[52:55], a[48:63]
    v_cvt_pk_bf16_f32 v45, v58, v59
    v_lshlrev_b32 v60, 16, v30
    v_and_b32 v61, 0xffff0000, v30
    v_mfma_f32_32x32x16_bf16 a[64:79], a[192:195], v[48:51], a[64:79]
    v_fma_f32 v60, v60, v66, v67
    v_fma_f32 v61, v61, v66, v67
    s_add_u32 m0, s27, 78336
    s_nop 0
    buffer_load_dwordx4 v72, s[12:15], s33 offen lds
    v_mfma_f32_32x32x16_bf16 a[80:95], a[192:195], v[52:55], a[80:95]
    v_cvt_pk_bf16_f32 v46, v60, v61
    v_lshlrev_b32 v62, 16, v31
    v_mfma_f32_32x32x16_bf16 a[96:111], a[196:199], v[48:51], a[96:111]
    v_and_b32 v63, 0xffff0000, v31
    v_fma_f32 v62, v62, v66, v67
    s_add_u32 m0, s27, 79360
    s_nop 0
    buffer_load_dwordx4 v73, s[12:15], s33 offen lds
    v_mfma_f32_32x32x16_bf16 a[112:127], a[196:199], v[52:55], a[112:127]
    v_fma_f32 v63, v63, v66, v67
    v_cvt_pk_bf16_f32 v47, v62, v63
    s_waitcnt lgkmcnt(0)
    s_waitcnt vmcnt(10)
    v_mfma_f32_32x32x16_bf16 v[96:111], a[128:131], v[40:43], v[96:111]
    ds_read_b64_tr_b16 a[164:165], v77 offset:13824
    ds_read_b64_tr_b16 a[166:167], v77 offset:14976
    v_lshlrev_b32 v56, 16, v32
    v_and_b32 v57, 0xffff0000, v32
    v_fma_f32 v56, v56, v64, v65
    v_mfma_f32_32x32x16_bf16 v[112:127], a[128:131], v[44:47], v[112:127]
    ds_read_b64_tr_b16 a[168:169], v77 offset:13856
    ds_read_b64_tr_b16 a[170:171], v77 offset:15008
    v_fma_f32 v57, v57, v64, v65
    v_cvt_pk_bf16_f32 v48, v56, v57
    v_mfma_f32_32x32x16_bf16 v[128:143], a[132:135], v[40:43], v[128:143]
    ds_read_b64_tr_b16 a[172:173], v77 offset:13888
    ds_read_b64_tr_b16 a[174:175], v77 offset:15040
    v_lshlrev_b32 v58, 16, v33
    v_and_b32 v59, 0xffff0000, v33
    v_mfma_f32_32x32x16_bf16 v[144:159], a[132:135], v[44:47], v[144:159]
    ds_read_b64_tr_b16 a[176:177], v77 offset:13920
    ds_read_b64_tr_b16 a[178:179], v77 offset:15072
    v_fma_f32 v58, v58, v64, v65
    v_fma_f32 v59, v59, v64, v65
    v_mfma_f32_32x32x16_bf16 v[160:175], a[136:139], v[40:43], v[160:175]
    ds_read_b64_tr_b16 a[180:181], v77 offset:13952
    ds_read_b64_tr_b16 a[182:183], v77 offset:15104
    v_cvt_pk_bf16_f32 v49, v58, v59
    v_lshlrev_b32 v60, 16, v34
    v_and_b32 v61, 0xffff0000, v34
    v_mfma_f32_32x32x16_bf16 v[176:191], a[136:139], v[44:47], v[176:191]
    ds_read_b64_tr_b16 a[184:185], v77 offset:13984
    ds_read_b64_tr_b16 a[186:187], v77 offset:15136
    v_fma_f32 v60, v60, v64, v65
    v_fma_f32 v61, v61, v64, v65
    v_mfma_f32_32x32x16_bf16 v[192:207], a[140:143], v[40:43], v[192:207]
    ds_read_b64_tr_b16 a[188:189], v77 offset:14016
    ds_read_b64_tr_b16 a[190:191], v77 offset:15168
    v_cvt_pk_bf16_f32 v50, v60, v61
    v_lshlrev_b32 v62, 16, v35
    v_mfma_f32_32x32x16_bf16 v[208:223], a[140:143], v[44:47], v[208:223]
    ds_read_b64_tr_b16 a[192:193], v77 offset:14048
    ds_read_b64_tr_b16 a[194:195], v77 offset:15200
    v_and_b32 v63, 0xffff0000, v35
    v_fma_f32 v62, v62, v64, v65
    v_mfma_f32_32x32x16_bf16 v[224:239], a[144:147], v[40:43], v[224:239]
    ds_read_b64_tr_b16 a[196:197], v77 offset:14080
    ds_read_b64_tr_b16 a[198:199], v77 offset:15232
    v_fma_f32 v63, v63, v64, v65
    v_cvt_pk_bf16_f32 v51, v62, v63
    v_mfma_f32_32x32x16_bf16 v[240:255], a[144:147], v[44:47], v[240:255]
    v_lshlrev_b32 v56, 16, v36
    v_and_b32 v57, 0xffff0000, v36
    v_fma_f32 v56, v56, v66, v67
    s_add_u32 s24, s23, 6144
    buffer_load_dwordx4 v[24:27], v81, s[16:19], s24 offen
    v_mfma_f32_32x32x16_bf16 a[0:15], a[148:151], v[40:43], a[0:15]
    v_fma_f32 v57, v57, v66, v67
    v_cvt_pk_bf16_f32 v52, v56, v57
    s_add_u32 s24, s23, 43008
    buffer_load_dwordx4 v[28:31], v81, s[16:19], s24 offen
    v_mfma_f32_32x32x16_bf16 a[16:31], a[148:151], v[44:47], a[16:31]
    v_lshlrev_b32 v58, 16, v37
    v_and_b32 v59, 0xffff0000, v37
    v_mfma_f32_32x32x16_bf16 a[32:47], a[152:155], v[40:43], a[32:47]
    v_fma_f32 v58, v58, v66, v67
    v_fma_f32 v59, v59, v66, v67
    s_add_u32 m0, s27, 80384
    s_nop 0
    buffer_load_dwordx4 v74, s[12:15], s33 offen lds
    v_mfma_f32_32x32x16_bf16 a[48:63], a[152:155], v[44:47], a[48:63]
    v_cvt_pk_bf16_f32 v53, v58, v59
    v_lshlrev_b32 v60, 16, v38
    v_and_b32 v61, 0xffff0000, v38
    v_mfma_f32_32x32x16_bf16 a[64:79], a[156:159], v[40:43], a[64:79]
    v_fma_f32 v60, v60, v66, v67
    v_fma_f32 v61, v61, v66, v67
    s_add_u32 m0, s27, 81408
    s_nop 0
    buffer_load_dwordx4 v75, s[12:15], s33 offen lds
    v_mfma_f32_32x32x16_bf16 a[80:95], a[156:159], v[44:47], a[80:95]
    v_cvt_pk_bf16_f32 v54, v60, v61
    v_lshlrev_b32 v62, 16, v39
    v_mfma_f32_32x32x16_bf16 a[96:111], a[160:163], v[40:43], a[96:111]
    v_and_b32 v63, 0xffff0000, v39
    v_fma_f32 v62, v62, v66, v67
    s_add_u32 m0, s27, 82432
    s_nop 0
    buffer_load_dwordx4 v76, s[12:15], s33 offen lds
    v_mfma_f32_32x32x16_bf16 a[112:127], a[160:163], v[44:47], a[112:127]
    v_fma_f32 v63, v63, v66, v67
    v_cvt_pk_bf16_f32 v55, v62, v63
    s_waitcnt lgkmcnt(0)
    s_barrier
    s_waitcnt vmcnt(13)
    v_mfma_f32_32x32x16_bf16 v[96:111], a[164:167], v[48:51], v[96:111]
    ds_read_b64_tr_b16 a[128:129], v78 offset:0
    ds_read_b64_tr_b16 a[130:131], v78 offset:1152
    v_lshlrev_b32 v56, 16, v8
    v_and_b32 v57, 0xffff0000, v8
    v_fma_f32 v56, v56, v64, v65
    v_mfma_f32_32x32x16_bf16 v[112:127], a[164:167], v[52:55], v[112:127]
    ds_read_b64_tr_b16 a[132:133], v78 offset:32
    ds_read_b64_tr_b16 a[134:135], v78 offset:1184
    v_fma_f32 v57, v57, v64, v65
    v_cvt_pk_bf16_f32 v40, v56, v57
    v_mfma_f32_32x32x16_bf16 v[128:143], a[168:171], v[48:51], v[128:143]
    ds_read_b64_tr_b16 a[136:137], v78 offset:64
    ds_read_b64_tr_b16 a[138:139], v78 offset:1216
    v_lshlrev_b32 v58, 16, v9
    v_and_b32 v59, 0xffff0000, v9
    v_mfma_f32_32x32x16_bf16 v[144:159], a[168:171], v[52:55], v[144:159]
    ds_read_b64_tr_b16 a[140:141], v78 offset:96
    ds_read_b64_tr_b16 a[142:143], v78 offset:1248
    v_fma_f32 v58, v58, v64, v65
    v_fma_f32 v59, v59, v64, v65
    v_mfma_f32_32x32x16_bf16 v[160:175], a[172:175], v[48:51], v[160:175]
    ds_read_b64_tr_b16 a[144:145], v78 offset:128
    ds_read_b64_tr_b16 a[146:147], v78 offset:1280
    v_cvt_pk_bf16_f32 v41, v58, v59
    v_lshlrev_b32 v60, 16, v10
    v_and_b32 v61, 0xffff0000, v10
    v_mfma_f32_32x32x16_bf16 v[176:191], a[172:175], v[52:55], v[176:191]
    ds_read_b64_tr_b16 a[148:149], v78 offset:160
    ds_read_b64_tr_b16 a[150:151], v78 offset:1312
    v_fma_f32 v60, v60, v64, v65
    v_fma_f32 v61, v61, v64, v65
    v_mfma_f32_32x32x16_bf16 v[192:207], a[176:179], v[48:51], v[192:207]
    ds_read_b64_tr_b16 a[152:153], v78 offset:192
    ds_read_b64_tr_b16 a[154:155], v78 offset:1344
    v_cvt_pk_bf16_f32 v42, v60, v61
    v_lshlrev_b32 v62, 16, v11
    v_mfma_f32_32x32x16_bf16 v[208:223], a[176:179], v[52:55], v[208:223]
    ds_read_b64_tr_b16 a[156:157], v78 offset:224
    ds_read_b64_tr_b16 a[158:159], v78 offset:1376
    v_and_b32 v63, 0xffff0000, v11
    v_fma_f32 v62, v62, v64, v65
    v_mfma_f32_32x32x16_bf16 v[224:239], a[180:183], v[48:51], v[224:239]
    ds_read_b64_tr_b16 a[160:161], v78 offset:256
    ds_read_b64_tr_b16 a[162:163], v78 offset:1408
    v_fma_f32 v63, v63, v64, v65
    v_cvt_pk_bf16_f32 v43, v62, v63
    v_mfma_f32_32x32x16_bf16 v[240:255], a[180:183], v[52:55], v[240:255]
    v_lshlrev_b32 v56, 16, v12
    v_and_b32 v57, 0xffff0000, v12
    v_fma_f32 v56, v56, v66, v67
    s_add_u32 s24, s23, 7168
    buffer_load_dwordx4 v[32:35], v81, s[16:19], s24 offen
    v_mfma_f32_32x32x16_bf16 a[0:15], a[184:187], v[48:51], a[0:15]
    v_fma_f32 v57, v57, v66, v67
    v_cvt_pk_bf16_f32 v44, v56, v57
    s_add_u32 s24, s23, 44032
    buffer_load_dwordx4 v[36:39], v81, s[16:19], s24 offen
    v_mfma_f32_32x32x16_bf16 a[16:31], a[184:187], v[52:55], a[16:31]
    v_lshlrev_b32 v58, 16, v13
    v_and_b32 v59, 0xffff0000, v13
    v_mfma_f32_32x32x16_bf16 a[32:47], a[188:191], v[48:51], a[32:47]
    v_fma_f32 v58, v58, v66, v67
    v_fma_f32 v59, v59, v66, v67
    s_add_u32 m0, s27, 111360
    s_add_u32 s33, s26, 1769472
    buffer_load_dwordx4 v68, s[12:15], s33 offen lds
    v_mfma_f32_32x32x16_bf16 a[48:63], a[188:191], v[52:55], a[48:63]
    v_cvt_pk_bf16_f32 v45, v58, v59
    v_lshlrev_b32 v60, 16, v14
    v_and_b32 v61, 0xffff0000, v14
    v_mfma_f32_32x32x16_bf16 a[64:79], a[192:195], v[48:51], a[64:79]
    v_fma_f32 v60, v60, v66, v67
    v_fma_f32 v61, v61, v66, v67
    s_add_u32 m0, s27, 112384
    s_nop 0
    buffer_load_dwordx4 v69, s[12:15], s33 offen lds
    v_mfma_f32_32x32x16_bf16 a[80:95], a[192:195], v[52:55], a[80:95]
    v_cvt_pk_bf16_f32 v46, v60, v61
    v_lshlrev_b32 v62, 16, v15
    v_mfma_f32_32x32x16_bf16 a[96:111], a[196:199], v[48:51], a[96:111]
    v_and_b32 v63, 0xffff0000, v15
    v_fma_f32 v62, v62, v66, v67
    s_add_u32 m0, s27, 113408
    s_nop 0
    buffer_load_dwordx4 v70, s[12:15], s33 offen lds
    v_mfma_f32_32x32x16_bf16 a[112:127], a[196:199], v[52:55], a[112:127]
    v_fma_f32 v63, v63, v66, v67
    v_cvt_pk_bf16_f32 v47, v62, v63
    s_waitcnt lgkmcnt(0)
    s_waitcnt vmcnt(13)
    v_mfma_f32_32x32x16_bf16 v[96:111], a[128:131], v[40:43], v[96:111]
    ds_read_b64_tr_b16 a[164:165], v78 offset:4608
    ds_read_b64_tr_b16 a[166:167], v78 offset:5760
    v_lshlrev_b32 v56, 16, v16
    v_and_b32 v57, 0xffff0000, v16
    v_fma_f32 v56, v56, v64, v65
    v_mfma_f32_32x32x16_bf16 v[112:127], a[128:131], v[44:47], v[112:127]
    ds_read_b64_tr_b16 a[168:169], v78 offset:4640
    ds_read_b64_tr_b16 a[170:171], v78 offset:5792
    v_fma_f32 v57, v57, v64, v65
    v_cvt_pk_bf16_f32 v48, v56, v57
    v_mfma_f32_32x32x16_bf16 v[128:143], a[132:135], v[40:43], v[128:143]
    ds_read_b64_tr_b16 a[172:173], v78 offset:4672
    ds_read_b64_tr_b16 a[174:175], v78 offset:5824
    v_lshlrev_b32 v58, 16, v17
    v_and_b32 v59, 0xffff0000, v17
    v_mfma_f32_32x32x16_bf16 v[144:159], a[132:135], v[44:47], v[144:159]
    ds_read_b64_tr_b16 a[176:177], v78 offset:4704
    ds_read_b64_tr_b16 a[178:179], v78 offset:5856
    v_fma_f32 v58, v58, v64, v65
    v_fma_f32 v59, v59, v64, v65
    v_mfma_f32_32x32x16_bf16 v[160:175], a[136:139], v[40:43], v[160:175]
    ds_read_b64_tr_b16 a[180:181], v78 offset:4736
    ds_read_b64_tr_b16 a[182:183], v78 offset:5888
    v_cvt_pk_bf16_f32 v49, v58, v59
    v_lshlrev_b32 v60, 16, v18
    v_and_b32 v61, 0xffff0000, v18
    v_mfma_f32_32x32x16_bf16 v[176:191], a[136:139], v[44:47], v[176:191]
    ds_read_b64_tr_b16 a[184:185], v78 offset:4768
    ds_read_b64_tr_b16 a[186:187], v78 offset:5920
    v_fma_f32 v60, v60, v64, v65
    v_fma_f32 v61, v61, v64, v65
    v_mfma_f32_32x32x16_bf16 v[192:207], a[140:143], v[40:43], v[192:207]
    ds_read_b64_tr_b16 a[188:189], v78 offset:4800
    ds_read_b64_tr_b16 a[190:191], v78 offset:5952
    v_cvt_pk_bf16_f32 v50, v60, v61
    v_lshlrev_b32 v62, 16, v19
    v_mfma_f32_32x32x16_bf16 v[208:223], a[140:143], v[44:47], v[208:223]
    ds_read_b64_tr_b16 a[192:193], v78 offset:4832
    ds_read_b64_tr_b16 a[194:195], v78 offset:5984
    v_and_b32 v63, 0xffff0000, v19
    v_fma_f32 v62, v62, v64, v65
    v_mfma_f32_32x32x16_bf16 v[224:239], a[144:147], v[40:43], v[224:239]
    ds_read_b64_tr_b16 a[196:197], v78 offset:4864
    ds_read_b64_tr_b16 a[198:199], v78 offset:6016
    v_fma_f32 v63, v63, v64, v65
    v_cvt_pk_bf16_f32 v51, v62, v63
    v_mfma_f32_32x32x16_bf16 v[240:255], a[144:147], v[44:47], v[240:255]
    v_lshlrev_b32 v56, 16, v20
    v_and_b32 v57, 0xffff0000, v20
    v_fma_f32 v56, v56, v66, v67
    s_add_u32 s24, s23, 8192
    buffer_load_dwordx4 v[8:11], v81, s[16:19], s24 offen
    v_mfma_f32_32x32x16_bf16 a[0:15], a[148:151], v[40:43], a[0:15]
    v_fma_f32 v57, v57, v66, v67
    v_cvt_pk_bf16_f32 v52, v56, v57
    s_add_u32 s24, s23, 45056
    buffer_load_dwordx4 v[12:15], v81, s[16:19], s24 offen
    v_mfma_f32_32x32x16_bf16 a[16:31], a[148:151], v[44:47], a[16:31]
    v_lshlrev_b32 v58, 16, v21
    v_and_b32 v59, 0xffff0000, v21
    v_mfma_f32_32x32x16_bf16 a[32:47], a[152:155], v[40:43], a[32:47]
    v_fma_f32 v58, v58, v66, v67
    v_fma_f32 v59, v59, v66, v67
    s_add_u32 m0, s27, 114432
    s_nop 0
    buffer_load_dwordx4 v71, s[12:15], s33 offen lds
    v_mfma_f32_32x32x16_bf16 a[48:63], a[152:155], v[44:47], a[48:63]
    v_cvt_pk_bf16_f32 v53, v58, v59
    v_lshlrev_b32 v60, 16, v22
    v_and_b32 v61, 0xffff0000, v22
    v_mfma_f32_32x32x16_bf16 a[64:79], a[156:159], v[40:43], a[64:79]
    v_fma_f32 v60, v60, v66, v67
    v_fma_f32 v61, v61, v66, v67
    s_add_u32 m0, s27, 115456
    s_nop 0
    buffer_load_dwordx4 v72, s[12:15], s33 offen lds
    v_mfma_f32_32x32x16_bf16 a[80:95], a[156:159], v[44:47], a[80:95]
    v_cvt_pk_bf16_f32 v54, v60, v61
    v_lshlrev_b32 v62, 16, v23
    v_mfma_f32_32x32x16_bf16 a[96:111], a[160:163], v[40:43], a[96:111]
    v_and_b32 v63, 0xffff0000, v23
    v_fma_f32 v62, v62, v66, v67
    s_add_u32 m0, s27, 116480
    s_nop 0
    buffer_load_dwordx4 v73, s[12:15], s33 offen lds
    v_mfma_f32_32x32x16_bf16 a[112:127], a[160:163], v[44:47], a[112:127]
    v_fma_f32 v63, v63, v66, v67
    v_cvt_pk_bf16_f32 v55, v62, v63
    s_waitcnt lgkmcnt(0)
    s_waitcnt vmcnt(13)
    v_mfma_f32_32x32x16_bf16 v[96:111], a[164:167], v[48:51], v[96:111]
    ds_read_b64_tr_b16 a[128:129], v78 offset:9216
    ds_read_b64_tr_b16 a[130:131], v78 offset:10368
    v_lshlrev_b32 v56, 16, v24
    v_and_b32 v57, 0xffff0000, v24
    v_fma_f32 v56, v56, v64, v65
    v_mfma_f32_32x32x16_bf16 v[112:127], a[164:167], v[52:55], v[112:127]
    ds_read_b64_tr_b16 a[132:133], v78 offset:9248
    ds_read_b64_tr_b16 a[134:135], v78 offset:10400
    v_fma_f32 v57, v57, v64, v65
    v_cvt_pk_bf16_f32 v40, v56, v57
    v_mfma_f32_32x32x16_bf16 v[128:143], a[168:171], v[48:51], v[128:143]
    ds_read_b64_tr_b16 a[136:137], v78 offset:9280
    ds_read_b64_tr_b16 a[138:139], v78 offset:10432
    v_lshlrev_b32 v58, 16, v25
    v_and_b32 v59, 0xffff0000, v25
    v_mfma_f32_32x32x16_bf16 v[144:159], a[168:171], v[52:55], v[144:159]
    ds_read_b64_tr_b16 a[140:141], v78 offset:9312
    ds_read_b64_tr_b16 a[142:143], v78 offset:10464
    v_fma_f32 v58, v58, v64, v65
    v_fma_f32 v59, v59, v64, v65
    v_mfma_f32_32x32x16_bf16 v[160:175], a[172:175], v[48:51], v[160:175]
    ds_read_b64_tr_b16 a[144:145], v78 offset:9344
    ds_read_b64_tr_b16 a[146:147], v78 offset:10496
    v_cvt_pk_bf16_f32 v41, v58, v59
    v_lshlrev_b32 v60, 16, v26
    v_and_b32 v61, 0xffff0000, v26
    v_mfma_f32_32x32x16_bf16 v[176:191], a[172:175], v[52:55], v[176:191]
    ds_read_b64_tr_b16 a[148:149], v78 offset:9376
    ds_read_b64_tr_b16 a[150:151], v78 offset:10528
    v_fma_f32 v60, v60, v64, v65
    v_fma_f32 v61, v61, v64, v65
    v_mfma_f32_32x32x16_bf16 v[192:207], a[176:179], v[48:51], v[192:207]
    ds_read_b64_tr_b16 a[152:153], v78 offset:9408
    ds_read_b64_tr_b16 a[154:155], v78 offset:10560
    v_cvt_pk_bf16_f32 v42, v60, v61
    v_lshlrev_b32 v62, 16, v27
    v_mfma_f32_32x32x16_bf16 v[208:223], a[176:179], v[52:55], v[208:223]
    ds_read_b64_tr_b16 a[156:157], v78 offset:9440
    ds_read_b64_tr_b16 a[158:159], v78 offset:10592
    v_and_b32 v63, 0xffff0000, v27
    v_fma_f32 v62, v62, v64, v65
    v_mfma_f32_32x32x16_bf16 v[224:239], a[180:183], v[48:51], v[224:239]
    ds_read_b64_tr_b16 a[160:161], v78 offset:9472
    ds_read_b64_tr_b16 a[162:163], v78 offset:10624
    v_fma_f32 v63, v63, v64, v65
    v_cvt_pk_bf16_f32 v43, v62, v63
    v_mfma_f32_32x32x16_bf16 v[240:255], a[180:183], v[52:55], v[240:255]
    v_lshlrev_b32 v56, 16, v28
    v_and_b32 v57, 0xffff0000, v28
    v_fma_f32 v56, v56, v66, v67
    s_add_u32 s24, s23, 9216
    buffer_load_dwordx4 v[16:19], v81, s[16:19], s24 offen
    v_mfma_f32_32x32x16_bf16 a[0:15], a[184:187], v[48:51], a[0:15]
    v_fma_f32 v57, v57, v66, v67
    v_cvt_pk_bf16_f32 v44, v56, v57
    s_add_u32 s24, s23, 46080
    buffer_load_dwordx4 v[20:23], v81, s[16:19], s24 offen
    v_mfma_f32_32x32x16_bf16 a[16:31], a[184:187], v[52:55], a[16:31]
    v_lshlrev_b32 v58, 16, v29
    v_and_b32 v59, 0xffff0000, v29
    v_mfma_f32_32x32x16_bf16 a[32:47], a[188:191], v[48:51], a[32:47]
    v_fma_f32 v58, v58, v66, v67
    v_fma_f32 v59, v59, v66, v67
    s_add_u32 m0, s27, 117504
    s_nop 0
    buffer_load_dwordx4 v74, s[12:15], s33 offen lds
    v_mfma_f32_32x32x16_bf16 a[48:63], a[188:191], v[52:55], a[48:63]
    v_cvt_pk_bf16_f32 v45, v58, v59
    v_lshlrev_b32 v60, 16, v30
    v_and_b32 v61, 0xffff0000, v30
    v_mfma_f32_32x32x16_bf16 a[64:79], a[192:195], v[48:51], a[64:79]
    v_fma_f32 v60, v60, v66, v67
    v_fma_f32 v61, v61, v66, v67
    s_add_u32 m0, s27, 118528
    s_nop 0
    buffer_load_dwordx4 v75, s[12:15], s33 offen lds
    v_mfma_f32_32x32x16_bf16 a[80:95], a[192:195], v[52:55], a[80:95]
    v_cvt_pk_bf16_f32 v46, v60, v61
    v_lshlrev_b32 v62, 16, v31
    v_mfma_f32_32x32x16_bf16 a[96:111], a[196:199], v[48:51], a[96:111]
    v_and_b32 v63, 0xffff0000, v31
    v_fma_f32 v62, v62, v66, v67
    s_add_u32 m0, s27, 119552
    s_nop 0
    buffer_load_dwordx4 v76, s[12:15], s33 offen lds
    v_mfma_f32_32x32x16_bf16 a[112:127], a[196:199], v[52:55], a[112:127]
    v_fma_f32 v63, v63, v66, v67
    v_cvt_pk_bf16_f32 v47, v62, v63
    s_waitcnt lgkmcnt(0)
    s_waitcnt vmcnt(13)
    v_mfma_f32_32x32x16_bf16 v[96:111], a[128:131], v[40:43], v[96:111]
    ds_read_b64_tr_b16 a[164:165], v78 offset:13824
    ds_read_b64_tr_b16 a[166:167], v78 offset:14976
    v_lshlrev_b32 v56, 16, v32
    v_and_b32 v57, 0xffff0000, v32
    v_fma_f32 v56, v56, v64, v65
    v_mfma_f32_32x32x16_bf16 v[112:127], a[128:131], v[44:47], v[112:127]
    ds_read_b64_tr_b16 a[168:169], v78 offset:13856
    ds_read_b64_tr_b16 a[170:171], v78 offset:15008
    v_fma_f32 v57, v57, v64, v65
    v_cvt_pk_bf16_f32 v48, v56, v57
    v_mfma_f32_32x32x16_bf16 v[128:143], a[132:135], v[40:43], v[128:143]
    ds_read_b64_tr_b16 a[172:173], v78 offset:13888
    ds_read_b64_tr_b16 a[174:175], v78 offset:15040
    v_lshlrev_b32 v58, 16, v33
    v_and_b32 v59, 0xffff0000, v33
    v_mfma_f32_32x32x16_bf16 v[144:159], a[132:135], v[44:47], v[144:159]
    ds_read_b64_tr_b16 a[176:177], v78 offset:13920
    ds_read_b64_tr_b16 a[178:179], v78 offset:15072
    v_fma_f32 v58, v58, v64, v65
    v_fma_f32 v59, v59, v64, v65
    v_mfma_f32_32x32x16_bf16 v[160:175], a[136:139], v[40:43], v[160:175]
    ds_read_b64_tr_b16 a[180:181], v78 offset:13952
    ds_read_b64_tr_b16 a[182:183], v78 offset:15104
    v_cvt_pk_bf16_f32 v49, v58, v59
    v_lshlrev_b32 v60, 16, v34
    v_and_b32 v61, 0xffff0000, v34
    v_mfma_f32_32x32x16_bf16 v[176:191], a[136:139], v[44:47], v[176:191]
    ds_read_b64_tr_b16 a[184:185], v78 offset:13984
    ds_read_b64_tr_b16 a[186:187], v78 offset:15136
    v_fma_f32 v60, v60, v64, v65
    v_fma_f32 v61, v61, v64, v65
    v_mfma_f32_32x32x16_bf16 v[192:207], a[140:143], v[40:43], v[192:207]
    ds_read_b64_tr_b16 a[188:189], v78 offset:14016
    ds_read_b64_tr_b16 a[190:191], v78 offset:15168
    v_cvt_pk_bf16_f32 v50, v60, v61
    v_lshlrev_b32 v62, 16, v35
    v_mfma_f32_32x32x16_bf16 v[208:223], a[140:143], v[44:47], v[208:223]
    ds_read_b64_tr_b16 a[192:193], v78 offset:14048
    ds_read_b64_tr_b16 a[194:195], v78 offset:15200
    v_and_b32 v63, 0xffff0000, v35
    v_fma_f32 v62, v62, v64, v65
    v_mfma_f32_32x32x16_bf16 v[224:239], a[144:147], v[40:43], v[224:239]
    ds_read_b64_tr_b16 a[196:197], v78 offset:14080
    ds_read_b64_tr_b16 a[198:199], v78 offset:15232
    v_fma_f32 v63, v63, v64, v65
    v_cvt_pk_bf16_f32 v51, v62, v63
    v_mfma_f32_32x32x16_bf16 v[240:255], a[144:147], v[44:47], v[240:255]
    v_lshlrev_b32 v56, 16, v36
    v_and_b32 v57, 0xffff0000, v36
    v_fma_f32 v56, v56, v66, v67
    s_add_u32 s24, s23, 10240
    buffer_load_dwordx4 v[24:27], v81, s[16:19], s24 offen
    v_mfma_f32_32x32x16_bf16 a[0:15], a[148:151], v[40:43], a[0:15]
    v_fma_f32 v57, v57, v66, v67
    v_cvt_pk_bf16_f32 v52, v56, v57
    s_add_u32 s24, s23, 47104
    buffer_load_dwordx4 v[28:31], v81, s[16:19], s24 offen
    v_mfma_f32_32x32x16_bf16 a[16:31], a[148:151], v[44:47], a[16:31]
    v_lshlrev_b32 v58, 16, v37
    v_and_b32 v59, 0xffff0000, v37
    v_mfma_f32_32x32x16_bf16 a[32:47], a[152:155], v[40:43], a[32:47]
    v_fma_f32 v58, v58, v66, v67
    v_fma_f32 v59, v59, v66, v67
    v_mfma_f32_32x32x16_bf16 a[48:63], a[152:155], v[44:47], a[48:63]
    v_cvt_pk_bf16_f32 v53, v58, v59
    v_lshlrev_b32 v60, 16, v38
    v_and_b32 v61, 0xffff0000, v38
    v_mfma_f32_32x32x16_bf16 a[64:79], a[156:159], v[40:43], a[64:79]
    v_fma_f32 v60, v60, v66, v67
    v_fma_f32 v61, v61, v66, v67
    v_mfma_f32_32x32x16_bf16 a[80:95], a[156:159], v[44:47], a[80:95]
    v_cvt_pk_bf16_f32 v54, v60, v61
    v_lshlrev_b32 v62, 16, v39
    v_mfma_f32_32x32x16_bf16 a[96:111], a[160:163], v[40:43], a[96:111]
    v_and_b32 v63, 0xffff0000, v39
    v_fma_f32 v62, v62, v66, v67
    v_mfma_f32_32x32x16_bf16 a[112:127], a[160:163], v[44:47], a[112:127]
    v_fma_f32 v63, v63, v66, v67
    v_cvt_pk_bf16_f32 v55, v62, v63
    s_waitcnt lgkmcnt(0)
    s_barrier
    s_waitcnt vmcnt(10)
    v_mfma_f32_32x32x16_bf16 v[96:111], a[164:167], v[48:51], v[96:111]
    ds_read_b64_tr_b16 a[128:129], v79 offset:0
    ds_read_b64_tr_b16 a[130:131], v79 offset:1152
    v_lshlrev_b32 v56, 16, v8
    v_and_b32 v57, 0xffff0000, v8
    v_fma_f32 v56, v56, v64, v65
    v_mfma_f32_32x32x16_bf16 v[112:127], a[164:167], v[52:55], v[112:127]
    ds_read_b64_tr_b16 a[132:133], v79 offset:32
    ds_read_b64_tr_b16 a[134:135], v79 offset:1184
    v_fma_f32 v57, v57, v64, v65
    v_cvt_pk_bf16_f32 v40, v56, v57
    v_mfma_f32_32x32x16_bf16 v[128:143], a[168:171], v[48:51], v[128:143]
    ds_read_b64_tr_b16 a[136:137], v79 offset:64
    ds_read_b64_tr_b16 a[138:139], v79 offset:1216
    v_lshlrev_b32 v58, 16, v9
    v_and_b32 v59, 0xffff0000, v9
    v_mfma_f32_32x32x16_bf16 v[144:159], a[168:171], v[52:55], v[144:159]
    ds_read_b64_tr_b16 a[140:141], v79 offset:96
    ds_read_b64_tr_b16 a[142:143], v79 offset:1248
    v_fma_f32 v58, v58, v64, v65
    v_fma_f32 v59, v59, v64, v65
    v_mfma_f32_32x32x16_bf16 v[160:175], a[172:175], v[48:51], v[160:175]
    ds_read_b64_tr_b16 a[144:145], v79 offset:128
    ds_read_b64_tr_b16 a[146:147], v79 offset:1280
    v_cvt_pk_bf16_f32 v41, v58, v59
    v_lshlrev_b32 v60, 16, v10
    v_and_b32 v61, 0xffff0000, v10
    v_mfma_f32_32x32x16_bf16 v[176:191], a[172:175], v[52:55], v[176:191]
    ds_read_b64_tr_b16 a[148:149], v79 offset:160
    ds_read_b64_tr_b16 a[150:151], v79 offset:1312
    v_fma_f32 v60, v60, v64, v65
    v_fma_f32 v61, v61, v64, v65
    v_mfma_f32_32x32x16_bf16 v[192:207], a[176:179], v[48:51], v[192:207]
    ds_read_b64_tr_b16 a[152:153], v79 offset:192
    ds_read_b64_tr_b16 a[154:155], v79 offset:1344
    v_cvt_pk_bf16_f32 v42, v60, v61
    v_lshlrev_b32 v62, 16, v11
    v_mfma_f32_32x32x16_bf16 v[208:223], a[176:179], v[52:55], v[208:223]
    ds_read_b64_tr_b16 a[156:157], v79 offset:224
    ds_read_b64_tr_b16 a[158:159], v79 offset:1376
    v_and_b32 v63, 0xffff0000, v11
    v_fma_f32 v62, v62, v64, v65
    v_mfma_f32_32x32x16_bf16 v[224:239], a[180:183], v[48:51], v[224:239]
    ds_read_b64_tr_b16 a[160:161], v79 offset:256
    ds_read_b64_tr_b16 a[162:163], v79 offset:1408
    v_fma_f32 v63, v63, v64, v65
    v_cvt_pk_bf16_f32 v43, v62, v63
    v_mfma_f32_32x32x16_bf16 v[240:255], a[180:183], v[52:55], v[240:255]
    v_lshlrev_b32 v56, 16, v12
    v_and_b32 v57, 0xffff0000, v12
    v_fma_f32 v56, v56, v66, v67
    s_add_u32 s24, s23, 11264
    buffer_load_dwordx4 v[32:35], v81, s[16:19], s24 offen
    v_mfma_f32_32x32x16_bf16 a[0:15], a[184:187], v[48:51], a[0:15]
    v_fma_f32 v57, v57, v66, v67
    v_cvt_pk_bf16_f32 v44, v56, v57
    s_add_u32 s24, s23, 48128
    buffer_load_dwordx4 v[36:39], v81, s[16:19], s24 offen
    v_mfma_f32_32x32x16_bf16 a[16:31], a[184:187], v[52:55], a[16:31]
    v_lshlrev_b32 v58, 16, v13
    v_and_b32 v59, 0xffff0000, v13
    v_mfma_f32_32x32x16_bf16 a[32:47], a[188:191], v[48:51], a[32:47]
    v_fma_f32 v58, v58, v66, v67
    v_fma_f32 v59, v59, v66, v67
    s_add_u32 m0, s27, 0
    s_add_u32 s33, s26, 2359296
    buffer_load_dwordx4 v68, s[12:15], s33 offen lds
    v_mfma_f32_32x32x16_bf16 a[48:63], a[188:191], v[52:55], a[48:63]
    v_cvt_pk_bf16_f32 v45, v58, v59
    v_lshlrev_b32 v60, 16, v14
    v_and_b32 v61, 0xffff0000, v14
    v_mfma_f32_32x32x16_bf16 a[64:79], a[192:195], v[48:51], a[64:79]
    v_fma_f32 v60, v60, v66, v67
    v_fma_f32 v61, v61, v66, v67
    s_add_u32 m0, s27, 1024
    s_nop 0
    buffer_load_dwordx4 v69, s[12:15], s33 offen lds
    v_mfma_f32_32x32x16_bf16 a[80:95], a[192:195], v[52:55], a[80:95]
    v_cvt_pk_bf16_f32 v46, v60, v61
    v_lshlrev_b32 v62, 16, v15
    v_mfma_f32_32x32x16_bf16 a[96:111], a[196:199], v[48:51], a[96:111]
    v_and_b32 v63, 0xffff0000, v15
    v_fma_f32 v62, v62, v66, v67
    s_add_u32 m0, s27, 2048
    s_nop 0
    buffer_load_dwordx4 v70, s[12:15], s33 offen lds
    v_mfma_f32_32x32x16_bf16 a[112:127], a[196:199], v[52:55], a[112:127]
    v_fma_f32 v63, v63, v66, v67
    v_cvt_pk_bf16_f32 v47, v62, v63
    s_waitcnt lgkmcnt(0)
    s_waitcnt vmcnt(10)
    v_mfma_f32_32x32x16_bf16 v[96:111], a[128:131], v[40:43], v[96:111]
    ds_read_b64_tr_b16 a[164:165], v79 offset:4608
    ds_read_b64_tr_b16 a[166:167], v79 offset:5760
    v_lshlrev_b32 v56, 16, v16
    v_and_b32 v57, 0xffff0000, v16
    v_fma_f32 v56, v56, v64, v65
    v_mfma_f32_32x32x16_bf16 v[112:127], a[128:131], v[44:47], v[112:127]
    ds_read_b64_tr_b16 a[168:169], v79 offset:4640
    ds_read_b64_tr_b16 a[170:171], v79 offset:5792
    v_fma_f32 v57, v57, v64, v65
    v_cvt_pk_bf16_f32 v48, v56, v57
    v_mfma_f32_32x32x16_bf16 v[128:143], a[132:135], v[40:43], v[128:143]
    ds_read_b64_tr_b16 a[172:173], v79 offset:4672
    ds_read_b64_tr_b16 a[174:175], v79 offset:5824
    v_lshlrev_b32 v58, 16, v17
    v_and_b32 v59, 0xffff0000, v17
    v_mfma_f32_32x32x16_bf16 v[144:159], a[132:135], v[44:47], v[144:159]
    ds_read_b64_tr_b16 a[176:177], v79 offset:4704
    ds_read_b64_tr_b16 a[178:179], v79 offset:5856
    v_fma_f32 v58, v58, v64, v65
    v_fma_f32 v59, v59, v64, v65
    v_mfma_f32_32x32x16_bf16 v[160:175], a[136:139], v[40:43], v[160:175]
    ds_read_b64_tr_b16 a[180:181], v79 offset:4736
    ds_read_b64_tr_b16 a[182:183], v79 offset:5888
    v_cvt_pk_bf16_f32 v49, v58, v59
    v_lshlrev_b32 v60, 16, v18
    v_and_b32 v61, 0xffff0000, v18
    v_mfma_f32_32x32x16_bf16 v[176:191], a[136:139], v[44:47], v[176:191]
    ds_read_b64_tr_b16 a[184:185], v79 offset:4768
    ds_read_b64_tr_b16 a[186:187], v79 offset:5920
    v_fma_f32 v60, v60, v64, v65
    v_fma_f32 v61, v61, v64, v65
    v_mfma_f32_32x32x16_bf16 v[192:207], a[140:143], v[40:43], v[192:207]
    ds_read_b64_tr_b16 a[188:189], v79 offset:4800
    ds_read_b64_tr_b16 a[190:191], v79 offset:5952
    v_cvt_pk_bf16_f32 v50, v60, v61
    v_lshlrev_b32 v62, 16, v19
    v_mfma_f32_32x32x16_bf16 v[208:223], a[140:143], v[44:47], v[208:223]
    ds_read_b64_tr_b16 a[192:193], v79 offset:4832
    ds_read_b64_tr_b16 a[194:195], v79 offset:5984
    v_and_b32 v63, 0xffff0000, v19
    v_fma_f32 v62, v62, v64, v65
    v_mfma_f32_32x32x16_bf16 v[224:239], a[144:147], v[40:43], v[224:239]
    ds_read_b64_tr_b16 a[196:197], v79 offset:4864
    ds_read_b64_tr_b16 a[198:199], v79 offset:6016
    v_fma_f32 v63, v63, v64, v65
    v_cvt_pk_bf16_f32 v51, v62, v63
    v_mfma_f32_32x32x16_bf16 v[240:255], a[144:147], v[44:47], v[240:255]
    v_lshlrev_b32 v56, 16, v20
    v_and_b32 v57, 0xffff0000, v20
    v_fma_f32 v56, v56, v66, v67
    s_add_u32 s24, s23, 12288
    buffer_load_dwordx4 v[8:11], v81, s[16:19], s24 offen
    v_mfma_f32_32x32x16_bf16 a[0:15], a[148:151], v[40:43], a[0:15]
    v_fma_f32 v57, v57, v66, v67
    v_cvt_pk_bf16_f32 v52, v56, v57
    s_add_u32 s24, s23, 49152
    buffer_load_dwordx4 v[12:15], v81, s[16:19], s24 offen
    v_mfma_f32_32x32x16_bf16 a[16:31], a[148:151], v[44:47], a[16:31]
    v_lshlrev_b32 v58, 16, v21
    v_and_b32 v59, 0xffff0000, v21
    v_mfma_f32_32x32x16_bf16 a[32:47], a[152:155], v[40:43], a[32:47]
    v_fma_f32 v58, v58, v66, v67
    v_fma_f32 v59, v59, v66, v67
    s_add_u32 m0, s27, 3072
    s_nop 0
    buffer_load_dwordx4 v71, s[12:15], s33 offen lds
    v_mfma_f32_32x32x16_bf16 a[48:63], a[152:155], v[44:47], a[48:63]
    v_cvt_pk_bf16_f32 v53, v58, v59
    v_lshlrev_b32 v60, 16, v22
    v_and_b32 v61, 0xffff0000, v22
    v_mfma_f32_32x32x16_bf16 a[64:79], a[156:159], v[40:43], a[64:79]
    v_fma_f32 v60, v60, v66, v67
    v_fma_f32 v61, v61, v66, v67
    s_add_u32 m0, s27, 4096
    s_nop 0
    buffer_load_dwordx4 v72, s[12:15], s33 offen lds
    v_mfma_f32_32x32x16_bf16 a[80:95], a[156:159], v[44:47], a[80:95]
    v_cvt_pk_bf16_f32 v54, v60, v61
    v_lshlrev_b32 v62, 16, v23
    v_mfma_f32_32x32x16_bf16 a[96:111], a[160:163], v[40:43], a[96:111]
    v_and_b32 v63, 0xffff0000, v23
    v_fma_f32 v62, v62, v66, v67
    s_add_u32 m0, s27, 5120
    s_nop 0
    buffer_load_dwordx4 v73, s[12:15], s33 offen lds
    v_mfma_f32_32x32x16_bf16 a[112:127], a[160:163], v[44:47], a[112:127]
    v_fma_f32 v63, v63, v66, v67
    v_cvt_pk_bf16_f32 v55, v62, v63
    s_waitcnt lgkmcnt(0)
    s_waitcnt vmcnt(10)
    v_mfma_f32_32x32x16_bf16 v[96:111], a[164:167], v[48:51], v[96:111]
    ds_read_b64_tr_b16 a[128:129], v79 offset:9216
    ds_read_b64_tr_b16 a[130:131], v79 offset:10368
    v_lshlrev_b32 v56, 16, v24
    v_and_b32 v57, 0xffff0000, v24
    v_fma_f32 v56, v56, v64, v65
    v_mfma_f32_32x32x16_bf16 v[112:127], a[164:167], v[52:55], v[112:127]
    ds_read_b64_tr_b16 a[132:133], v79 offset:9248
    ds_read_b64_tr_b16 a[134:135], v79 offset:10400
    v_fma_f32 v57, v57, v64, v65
    v_cvt_pk_bf16_f32 v40, v56, v57
    v_mfma_f32_32x32x16_bf16 v[128:143], a[168:171], v[48:51], v[128:143]
    ds_read_b64_tr_b16 a[136:137], v79 offset:9280
    ds_read_b64_tr_b16 a[138:139], v79 offset:10432
    v_lshlrev_b32 v58, 16, v25
    v_and_b32 v59, 0xffff0000, v25
    v_mfma_f32_32x32x16_bf16 v[144:159], a[168:171], v[52:55], v[144:159]
    ds_read_b64_tr_b16 a[140:141], v79 offset:9312
    ds_read_b64_tr_b16 a[142:143], v79 offset:10464
    v_fma_f32 v58, v58, v64, v65
    v_fma_f32 v59, v59, v64, v65
    v_mfma_f32_32x32x16_bf16 v[160:175], a[172:175], v[48:51], v[160:175]
    ds_read_b64_tr_b16 a[144:145], v79 offset:9344
    ds_read_b64_tr_b16 a[146:147], v79 offset:10496
    v_cvt_pk_bf16_f32 v41, v58, v59
    v_lshlrev_b32 v60, 16, v26
    v_and_b32 v61, 0xffff0000, v26
    v_mfma_f32_32x32x16_bf16 v[176:191], a[172:175], v[52:55], v[176:191]
    ds_read_b64_tr_b16 a[148:149], v79 offset:9376
    ds_read_b64_tr_b16 a[150:151], v79 offset:10528
    v_fma_f32 v60, v60, v64, v65
    v_fma_f32 v61, v61, v64, v65
    v_mfma_f32_32x32x16_bf16 v[192:207], a[176:179], v[48:51], v[192:207]
    ds_read_b64_tr_b16 a[152:153], v79 offset:9408
    ds_read_b64_tr_b16 a[154:155], v79 offset:10560
    v_cvt_pk_bf16_f32 v42, v60, v61
    v_lshlrev_b32 v62, 16, v27
    v_mfma_f32_32x32x16_bf16 v[208:223], a[176:179], v[52:55], v[208:223]
    ds_read_b64_tr_b16 a[156:157], v79 offset:9440
    ds_read_b64_tr_b16 a[158:159], v79 offset:10592
    v_and_b32 v63, 0xffff0000, v27
    v_fma_f32 v62, v62, v64, v65
    v_mfma_f32_32x32x16_bf16 v[224:239], a[180:183], v[48:51], v[224:239]
    ds_read_b64_tr_b16 a[160:161], v79 offset:9472
    ds_read_b64_tr_b16 a[162:163], v79 offset:10624
    v_fma_f32 v63, v63, v64, v65
    v_cvt_pk_bf16_f32 v43, v62, v63
    v_mfma_f32_32x32x16_bf16 v[240:255], a[180:183], v[52:55], v[240:255]
    v_lshlrev_b32 v56, 16, v28
    v_and_b32 v57, 0xffff0000, v28
    v_fma_f32 v56, v56, v66, v67
    s_add_u32 s24, s23, 13312
    buffer_load_dwordx4 v[16:19], v81, s[16:19], s24 offen
    v_mfma_f32_32x32x16_bf16 a[0:15], a[184:187], v[48:51], a[0:15]
    v_fma_f32 v57, v57, v66, v67
    v_cvt_pk_bf16_f32 v44, v56, v57
    s_add_u32 s24, s23, 50176
    buffer_load_dwordx4 v[20:23], v81, s[16:19], s24 offen
    v_mfma_f32_32x32x16_bf16 a[16:31], a[184:187], v[52:55], a[16:31]
    v_lshlrev_b32 v58, 16, v29
    v_and_b32 v59, 0xffff0000, v29
    v_mfma_f32_32x32x16_bf16 a[32:47], a[188:191], v[48:51], a[32:47]
    v_fma_f32 v58, v58, v66, v67
    v_fma_f32 v59, v59, v66, v67
    s_add_u32 m0, s27, 6144
    s_nop 0
    buffer_load_dwordx4 v74, s[12:15], s33 offen lds
    v_mfma_f32_32x32x16_bf16 a[48:63], a[188:191], v[52:55], a[48:63]
    v_cvt_pk_bf16_f32 v45, v58, v59
    v_lshlrev_b32 v60, 16, v30
    v_and_b32 v61, 0xffff0000, v30
    v_mfma_f32_32x32x16_bf16 a[64:79], a[192:195], v[48:51], a[64:79]
    v_fma_f32 v60, v60, v66, v67
    v_fma_f32 v61, v61, v66, v67
    s_add_u32 m0, s27, 7168
    s_nop 0
    buffer_load_dwordx4 v75, s[12:15], s33 offen lds
    v_mfma_f32_32x32x16_bf16 a[80:95], a[192:195], v[52:55], a[80:95]
    v_cvt_pk_bf16_f32 v46, v60, v61
    v_lshlrev_b32 v62, 16, v31
    v_mfma_f32_32x32x16_bf16 a[96:111], a[196:199], v[48:51], a[96:111]
    v_and_b32 v63, 0xffff0000, v31
    v_fma_f32 v62, v62, v66, v67
    s_add_u32 m0, s27, 8192
    s_nop 0
    buffer_load_dwordx4 v76, s[12:15], s33 offen lds
    v_mfma_f32_32x32x16_bf16 a[112:127], a[196:199], v[52:55], a[112:127]
    v_fma_f32 v63, v63, v66, v67
    v_cvt_pk_bf16_f32 v47, v62, v63
    s_waitcnt lgkmcnt(0)
    s_waitcnt vmcnt(13)
    v_mfma_f32_32x32x16_bf16 v[96:111], a[128:131], v[40:43], v[96:111]
    ds_read_b64_tr_b16 a[164:165], v79 offset:13824
    ds_read_b64_tr_b16 a[166:167], v79 offset:14976
    v_lshlrev_b32 v56, 16, v32
    v_and_b32 v57, 0xffff0000, v32
    v_fma_f32 v56, v56, v64, v65
    v_mfma_f32_32x32x16_bf16 v[112:127], a[128:131], v[44:47], v[112:127]
    ds_read_b64_tr_b16 a[168:169], v79 offset:13856
    ds_read_b64_tr_b16 a[170:171], v79 offset:15008
    v_fma_f32 v57, v57, v64, v65
    v_cvt_pk_bf16_f32 v48, v56, v57
    v_mfma_f32_32x32x16_bf16 v[128:143], a[132:135], v[40:43], v[128:143]
    ds_read_b64_tr_b16 a[172:173], v79 offset:13888
    ds_read_b64_tr_b16 a[174:175], v79 offset:15040
    v_lshlrev_b32 v58, 16, v33
    v_and_b32 v59, 0xffff0000, v33
    v_mfma_f32_32x32x16_bf16 v[144:159], a[132:135], v[44:47], v[144:159]
    ds_read_b64_tr_b16 a[176:177], v79 offset:13920
    ds_read_b64_tr_b16 a[178:179], v79 offset:15072
    v_fma_f32 v58, v58, v64, v65
    v_fma_f32 v59, v59, v64, v65
    v_mfma_f32_32x32x16_bf16 v[160:175], a[136:139], v[40:43], v[160:175]
    ds_read_b64_tr_b16 a[180:181], v79 offset:13952
    ds_read_b64_tr_b16 a[182:183], v79 offset:15104
    v_cvt_pk_bf16_f32 v49, v58, v59
    v_lshlrev_b32 v60, 16, v34
    v_and_b32 v61, 0xffff0000, v34
    v_mfma_f32_32x32x16_bf16 v[176:191], a[136:139], v[44:47], v[176:191]
    ds_read_b64_tr_b16 a[184:185], v79 offset:13984
    ds_read_b64_tr_b16 a[186:187], v79 offset:15136
    v_fma_f32 v60, v60, v64, v65
    v_fma_f32 v61, v61, v64, v65
    v_mfma_f32_32x32x16_bf16 v[192:207], a[140:143], v[40:43], v[192:207]
    ds_read_b64_tr_b16 a[188:189], v79 offset:14016
    ds_read_b64_tr_b16 a[190:191], v79 offset:15168
    v_cvt_pk_bf16_f32 v50, v60, v61
    v_lshlrev_b32 v62, 16, v35
    v_mfma_f32_32x32x16_bf16 v[208:223], a[140:143], v[44:47], v[208:223]
    ds_read_b64_tr_b16 a[192:193], v79 offset:14048
    ds_read_b64_tr_b16 a[194:195], v79 offset:15200
    v_and_b32 v63, 0xffff0000, v35
    v_fma_f32 v62, v62, v64, v65
    v_mfma_f32_32x32x16_bf16 v[224:239], a[144:147], v[40:43], v[224:239]
    ds_read_b64_tr_b16 a[196:197], v79 offset:14080
    ds_read_b64_tr_b16 a[198:199], v79 offset:15232
    v_fma_f32 v63, v63, v64, v65
    v_cvt_pk_bf16_f32 v51, v62, v63
    v_mfma_f32_32x32x16_bf16 v[240:255], a[144:147], v[44:47], v[240:255]
    v_lshlrev_b32 v56, 16, v36
    v_and_b32 v57, 0xffff0000, v36
    v_fma_f32 v56, v56, v66, v67
    s_add_u32 s24, s23, 14336
    buffer_load_dwordx4 v[24:27], v81, s[16:19], s24 offen
    v_mfma_f32_32x32x16_bf16 a[0:15], a[148:151], v[40:43], a[0:15]
    v_fma_f32 v57, v57, v66, v67
    v_cvt_pk_bf16_f32 v52, v56, v57
    s_add_u32 s24, s23, 51200
    buffer_load_dwordx4 v[28:31], v81, s[16:19], s24 offen
    v_mfma_f32_32x32x16_bf16 a[16:31], a[148:151], v[44:47], a[16:31]
    v_lshlrev_b32 v58, 16, v37
    v_and_b32 v59, 0xffff0000, v37
    v_mfma_f32_32x32x16_bf16 a[32:47], a[152:155], v[40:43], a[32:47]
    v_fma_f32 v58, v58, v66, v67
    v_fma_f32 v59, v59, v66, v67
    v_mfma_f32_32x32x16_bf16 a[48:63], a[152:155], v[44:47], a[48:63]
    v_cvt_pk_bf16_f32 v53, v58, v59
    v_lshlrev_b32 v60, 16, v38
    v_and_b32 v61, 0xffff0000, v38
    v_mfma_f32_32x32x16_bf16 a[64:79], a[156:159], v[40:43], a[64:79]
    v_fma_f32 v60, v60, v66, v67
    v_fma_f32 v61, v61, v66, v67
    v_mfma_f32_32x32x16_bf16 a[80:95], a[156:159], v[44:47], a[80:95]
    v_cvt_pk_bf16_f32 v54, v60, v61
    v_lshlrev_b32 v62, 16, v39
    v_mfma_f32_32x32x16_bf16 a[96:111], a[160:163], v[40:43], a[96:111]
    v_and_b32 v63, 0xffff0000, v39
    v_fma_f32 v62, v62, v66, v67
    v_mfma_f32_32x32x16_bf16 a[112:127], a[160:163], v[44:47], a[112:127]
    v_fma_f32 v63, v63, v66, v67
    v_cvt_pk_bf16_f32 v55, v62, v63
    s_waitcnt lgkmcnt(0)
    s_barrier
    s_waitcnt vmcnt(10)
    v_mfma_f32_32x32x16_bf16 v[96:111], a[164:167], v[48:51], v[96:111]
    ds_read_b64_tr_b16 a[128:129], v80 offset:0
    ds_read_b64_tr_b16 a[130:131], v80 offset:1152
    v_lshlrev_b32 v56, 16, v8
    v_and_b32 v57, 0xffff0000, v8
    v_fma_f32 v56, v56, v64, v65
    v_mfma_f32_32x32x16_bf16 v[112:127], a[164:167], v[52:55], v[112:127]
    ds_read_b64_tr_b16 a[132:133], v80 offset:32
    ds_read_b64_tr_b16 a[134:135], v80 offset:1184
    v_fma_f32 v57, v57, v64, v65
    v_cvt_pk_bf16_f32 v40, v56, v57
    v_mfma_f32_32x32x16_bf16 v[128:143], a[168:171], v[48:51], v[128:143]
    ds_read_b64_tr_b16 a[136:137], v80 offset:64
    ds_read_b64_tr_b16 a[138:139], v80 offset:1216
    v_lshlrev_b32 v58, 16, v9
    v_and_b32 v59, 0xffff0000, v9
    v_mfma_f32_32x32x16_bf16 v[144:159], a[168:171], v[52:55], v[144:159]
    ds_read_b64_tr_b16 a[140:141], v80 offset:96
    ds_read_b64_tr_b16 a[142:143], v80 offset:1248
    v_fma_f32 v58, v58, v64, v65
    v_fma_f32 v59, v59, v64, v65
    v_mfma_f32_32x32x16_bf16 v[160:175], a[172:175], v[48:51], v[160:175]
    ds_read_b64_tr_b16 a[144:145], v80 offset:128
    ds_read_b64_tr_b16 a[146:147], v80 offset:1280
    v_cvt_pk_bf16_f32 v41, v58, v59
    v_lshlrev_b32 v60, 16, v10
    v_and_b32 v61, 0xffff0000, v10
    v_mfma_f32_32x32x16_bf16 v[176:191], a[172:175], v[52:55], v[176:191]
    ds_read_b64_tr_b16 a[148:149], v80 offset:160
    ds_read_b64_tr_b16 a[150:151], v80 offset:1312
    v_fma_f32 v60, v60, v64, v65
    v_fma_f32 v61, v61, v64, v65
    v_mfma_f32_32x32x16_bf16 v[192:207], a[176:179], v[48:51], v[192:207]
    ds_read_b64_tr_b16 a[152:153], v80 offset:192
    ds_read_b64_tr_b16 a[154:155], v80 offset:1344
    v_cvt_pk_bf16_f32 v42, v60, v61
    v_lshlrev_b32 v62, 16, v11
    v_mfma_f32_32x32x16_bf16 v[208:223], a[176:179], v[52:55], v[208:223]
    ds_read_b64_tr_b16 a[156:157], v80 offset:224
    ds_read_b64_tr_b16 a[158:159], v80 offset:1376
    v_and_b32 v63, 0xffff0000, v11
    v_fma_f32 v62, v62, v64, v65
    v_mfma_f32_32x32x16_bf16 v[224:239], a[180:183], v[48:51], v[224:239]
    ds_read_b64_tr_b16 a[160:161], v80 offset:256
    ds_read_b64_tr_b16 a[162:163], v80 offset:1408
    v_fma_f32 v63, v63, v64, v65
    v_cvt_pk_bf16_f32 v43, v62, v63
    v_mfma_f32_32x32x16_bf16 v[240:255], a[180:183], v[52:55], v[240:255]
    v_lshlrev_b32 v56, 16, v12
    v_and_b32 v57, 0xffff0000, v12
    v_fma_f32 v56, v56, v66, v67
    s_add_u32 s24, s23, 15360
    buffer_load_dwordx4 v[32:35], v81, s[16:19], s24 offen
    v_mfma_f32_32x32x16_bf16 a[0:15], a[184:187], v[48:51], a[0:15]
    v_fma_f32 v57, v57, v66, v67
    v_cvt_pk_bf16_f32 v44, v56, v57
    s_add_u32 s24, s23, 52224
    buffer_load_dwordx4 v[36:39], v81, s[16:19], s24 offen
    v_mfma_f32_32x32x16_bf16 a[16:31], a[184:187], v[52:55], a[16:31]
    v_lshlrev_b32 v58, 16, v13
    v_and_b32 v59, 0xffff0000, v13
    v_mfma_f32_32x32x16_bf16 a[32:47], a[188:191], v[48:51], a[32:47]
    v_fma_f32 v58, v58, v66, v67
    v_fma_f32 v59, v59, v66, v67
    s_add_u32 m0, s27, 37120
    s_add_u32 s33, s26, 2949120
    buffer_load_dwordx4 v68, s[12:15], s33 offen lds
    v_mfma_f32_32x32x16_bf16 a[48:63], a[188:191], v[52:55], a[48:63]
    v_cvt_pk_bf16_f32 v45, v58, v59
    v_lshlrev_b32 v60, 16, v14
    v_and_b32 v61, 0xffff0000, v14
    v_mfma_f32_32x32x16_bf16 a[64:79], a[192:195], v[48:51], a[64:79]
    v_fma_f32 v60, v60, v66, v67
    v_fma_f32 v61, v61, v66, v67
    s_add_u32 m0, s27, 38144
    s_nop 0
    buffer_load_dwordx4 v69, s[12:15], s33 offen lds
    v_mfma_f32_32x32x16_bf16 a[80:95], a[192:195], v[52:55], a[80:95]
    v_cvt_pk_bf16_f32 v46, v60, v61
    v_lshlrev_b32 v62, 16, v15
    v_mfma_f32_32x32x16_bf16 a[96:111], a[196:199], v[48:51], a[96:111]
    v_and_b32 v63, 0xffff0000, v15
    v_fma_f32 v62, v62, v66, v67
    s_add_u32 m0, s27, 39168
    s_nop 0
    buffer_load_dwordx4 v70, s[12:15], s33 offen lds
    v_mfma_f32_32x32x16_bf16 a[112:127], a[196:199], v[52:55], a[112:127]
    v_fma_f32 v63, v63, v66, v67
    v_cvt_pk_bf16_f32 v47, v62, v63
    s_waitcnt lgkmcnt(0)
    s_waitcnt vmcnt(10)
    v_mfma_f32_32x32x16_bf16 v[96:111], a[128:131], v[40:43], v[96:111]
    ds_read_b64_tr_b16 a[164:165], v80 offset:4608
    ds_read_b64_tr_b16 a[166:167], v80 offset:5760
    v_lshlrev_b32 v56, 16, v16
    v_and_b32 v57, 0xffff0000, v16
    v_fma_f32 v56, v56, v64, v65
    v_mfma_f32_32x32x16_bf16 v[112:127], a[128:131], v[44:47], v[112:127]
    ds_read_b64_tr_b16 a[168:169], v80 offset:4640
    ds_read_b64_tr_b16 a[170:171], v80 offset:5792
    v_fma_f32 v57, v57, v64, v65
    v_cvt_pk_bf16_f32 v48, v56, v57
    v_mfma_f32_32x32x16_bf16 v[128:143], a[132:135], v[40:43], v[128:143]
    ds_read_b64_tr_b16 a[172:173], v80 offset:4672
    ds_read_b64_tr_b16 a[174:175], v80 offset:5824
    v_lshlrev_b32 v58, 16, v17
    v_and_b32 v59, 0xffff0000, v17
    v_mfma_f32_32x32x16_bf16 v[144:159], a[132:135], v[44:47], v[144:159]
    ds_read_b64_tr_b16 a[176:177], v80 offset:4704
    ds_read_b64_tr_b16 a[178:179], v80 offset:5856
    v_fma_f32 v58, v58, v64, v65
    v_fma_f32 v59, v59, v64, v65
    v_mfma_f32_32x32x16_bf16 v[160:175], a[136:139], v[40:43], v[160:175]
    ds_read_b64_tr_b16 a[180:181], v80 offset:4736
    ds_read_b64_tr_b16 a[182:183], v80 offset:5888
    v_cvt_pk_bf16_f32 v49, v58, v59
    v_lshlrev_b32 v60, 16, v18
    v_and_b32 v61, 0xffff0000, v18
    v_mfma_f32_32x32x16_bf16 v[176:191], a[136:139], v[44:47], v[176:191]
    ds_read_b64_tr_b16 a[184:185], v80 offset:4768
    ds_read_b64_tr_b16 a[186:187], v80 offset:5920
    v_fma_f32 v60, v60, v64, v65
    v_fma_f32 v61, v61, v64, v65
    v_mfma_f32_32x32x16_bf16 v[192:207], a[140:143], v[40:43], v[192:207]
    ds_read_b64_tr_b16 a[188:189], v80 offset:4800
    ds_read_b64_tr_b16 a[190:191], v80 offset:5952
    v_cvt_pk_bf16_f32 v50, v60, v61
    v_lshlrev_b32 v62, 16, v19
    v_mfma_f32_32x32x16_bf16 v[208:223], a[140:143], v[44:47], v[208:223]
    ds_read_b64_tr_b16 a[192:193], v80 offset:4832
    ds_read_b64_tr_b16 a[194:195], v80 offset:5984
    v_and_b32 v63, 0xffff0000, v19
    v_fma_f32 v62, v62, v64, v65
    v_mfma_f32_32x32x16_bf16 v[224:239], a[144:147], v[40:43], v[224:239]
    ds_read_b64_tr_b16 a[196:197], v80 offset:4864
    ds_read_b64_tr_b16 a[198:199], v80 offset:6016
    v_fma_f32 v63, v63, v64, v65
    v_cvt_pk_bf16_f32 v51, v62, v63
    v_mfma_f32_32x32x16_bf16 v[240:255], a[144:147], v[44:47], v[240:255]
    v_lshlrev_b32 v56, 16, v20
    v_and_b32 v57, 0xffff0000, v20
    v_fma_f32 v56, v56, v66, v67
    s_add_u32 s24, s23, 16384
    buffer_load_dwordx4 v[8:11], v81, s[16:19], s24 offen
    v_mfma_f32_32x32x16_bf16 a[0:15], a[148:151], v[40:43], a[0:15]
    v_fma_f32 v57, v57, v66, v67
    v_cvt_pk_bf16_f32 v52, v56, v57
    s_add_u32 s24, s23, 53248
    buffer_load_dwordx4 v[12:15], v81, s[16:19], s24 offen
    v_mfma_f32_32x32x16_bf16 a[16:31], a[148:151], v[44:47], a[16:31]
    v_lshlrev_b32 v58, 16, v21
    v_and_b32 v59, 0xffff0000, v21
    v_mfma_f32_32x32x16_bf16 a[32:47], a[152:155], v[40:43], a[32:47]
    v_fma_f32 v58, v58, v66, v67
    v_fma_f32 v59, v59, v66, v67
    s_add_u32 m0, s27, 40192
    s_nop 0
    buffer_load_dwordx4 v71, s[12:15], s33 offen lds
    v_mfma_f32_32x32x16_bf16 a[48:63], a[152:155], v[44:47], a[48:63]
    v_cvt_pk_bf16_f32 v53, v58, v59
    v_lshlrev_b32 v60, 16, v22
    v_and_b32 v61, 0xffff0000, v22
    v_mfma_f32_32x32x16_bf16 a[64:79], a[156:159], v[40:43], a[64:79]
    v_fma_f32 v60, v60, v66, v67
    v_fma_f32 v61, v61, v66, v67
    s_add_u32 m0, s27, 41216
    s_nop 0
    buffer_load_dwordx4 v72, s[12:15], s33 offen lds
    v_mfma_f32_32x32x16_bf16 a[80:95], a[156:159], v[44:47], a[80:95]
    v_cvt_pk_bf16_f32 v54, v60, v61
    v_lshlrev_b32 v62, 16, v23
    v_mfma_f32_32x32x16_bf16 a[96:111], a[160:163], v[40:43], a[96:111]
    v_and_b32 v63, 0xffff0000, v23
    v_fma_f32 v62, v62, v66, v67
    s_add_u32 m0, s27, 42240
    s_nop 0
    buffer_load_dwordx4 v73, s[12:15], s33 offen lds
    v_mfma_f32_32x32x16_bf16 a[112:127], a[160:163], v[44:47], a[112:127]
    v_fma_f32 v63, v63, v66, v67
    v_cvt_pk_bf16_f32 v55, v62, v63
    s_waitcnt lgkmcnt(0)
    s_waitcnt vmcnt(10)
    v_mfma_f32_32x32x16_bf16 v[96:111], a[164:167], v[48:51], v[96:111]
    ds_read_b64_tr_b16 a[128:129], v80 offset:9216
    ds_read_b64_tr_b16 a[130:131], v80 offset:10368
    v_lshlrev_b32 v56, 16, v24
    v_and_b32 v57, 0xffff0000, v24
    v_fma_f32 v56, v56, v64, v65
    v_mfma_f32_32x32x16_bf16 v[112:127], a[164:167], v[52:55], v[112:127]
    ds_read_b64_tr_b16 a[132:133], v80 offset:9248
    ds_read_b64_tr_b16 a[134:135], v80 offset:10400
    v_fma_f32 v57, v57, v64, v65
    v_cvt_pk_bf16_f32 v40, v56, v57
    v_mfma_f32_32x32x16_bf16 v[128:143], a[168:171], v[48:51], v[128:143]
    ds_read_b64_tr_b16 a[136:137], v80 offset:9280
    ds_read_b64_tr_b16 a[138:139], v80 offset:10432
    v_lshlrev_b32 v58, 16, v25
    v_and_b32 v59, 0xffff0000, v25
    v_mfma_f32_32x32x16_bf16 v[144:159], a[168:171], v[52:55], v[144:159]
    ds_read_b64_tr_b16 a[140:141], v80 offset:9312
    ds_read_b64_tr_b16 a[142:143], v80 offset:10464
    v_fma_f32 v58, v58, v64, v65
    v_fma_f32 v59, v59, v64, v65
    v_mfma_f32_32x32x16_bf16 v[160:175], a[172:175], v[48:51], v[160:175]
    ds_read_b64_tr_b16 a[144:145], v80 offset:9344
    ds_read_b64_tr_b16 a[146:147], v80 offset:10496
    v_cvt_pk_bf16_f32 v41, v58, v59
    v_lshlrev_b32 v60, 16, v26
    v_and_b32 v61, 0xffff0000, v26
    v_mfma_f32_32x32x16_bf16 v[176:191], a[172:175], v[52:55], v[176:191]
    ds_read_b64_tr_b16 a[148:149], v80 offset:9376
    ds_read_b64_tr_b16 a[150:151], v80 offset:10528
    v_fma_f32 v60, v60, v64, v65
    v_fma_f32 v61, v61, v64, v65
    v_mfma_f32_32x32x16_bf16 v[192:207], a[176:179], v[48:51], v[192:207]
    ds_read_b64_tr_b16 a[152:153], v80 offset:9408
    ds_read_b64_tr_b16 a[154:155], v80 offset:10560
    v_cvt_pk_bf16_f32 v42, v60, v61
    v_lshlrev_b32 v62, 16, v27
    v_mfma_f32_32x32x16_bf16 v[208:223], a[176:179], v[52:55], v[208:223]
    ds_read_b64_tr_b16 a[156:157], v80 offset:9440
    ds_read_b64_tr_b16 a[158:159], v80 offset:10592
    v_and_b32 v63, 0xffff0000, v27
    v_fma_f32 v62, v62, v64, v65
    v_mfma_f32_32x32x16_bf16 v[224:239], a[180:183], v[48:51], v[224:239]
    ds_read_b64_tr_b16 a[160:161], v80 offset:9472
    ds_read_b64_tr_b16 a[162:163], v80 offset:10624
    v_fma_f32 v63, v63, v64, v65
    v_cvt_pk_bf16_f32 v43, v62, v63
    v_mfma_f32_32x32x16_bf16 v[240:255], a[180:183], v[52:55], v[240:255]
    v_lshlrev_b32 v56, 16, v28
    v_and_b32 v57, 0xffff0000, v28
    v_fma_f32 v56, v56, v66, v67
    s_add_u32 s24, s23, 17408
    buffer_load_dwordx4 v[16:19], v81, s[16:19], s24 offen
    v_mfma_f32_32x32x16_bf16 a[0:15], a[184:187], v[48:51], a[0:15]
    v_fma_f32 v57, v57, v66, v67
    v_cvt_pk_bf16_f32 v44, v56, v57
    s_add_u32 s24, s23, 54272
    buffer_load_dwordx4 v[20:23], v81, s[16:19], s24 offen
    v_mfma_f32_32x32x16_bf16 a[16:31], a[184:187], v[52:55], a[16:31]
    v_lshlrev_b32 v58, 16, v29
    v_and_b32 v59, 0xffff0000, v29
    v_mfma_f32_32x32x16_bf16 a[32:47], a[188:191], v[48:51], a[32:47]
    v_fma_f32 v58, v58, v66, v67
    v_fma_f32 v59, v59, v66, v67
    s_add_u32 m0, s27, 43264
    s_nop 0
    buffer_load_dwordx4 v74, s[12:15], s33 offen lds
    v_mfma_f32_32x32x16_bf16 a[48:63], a[188:191], v[52:55], a[48:63]
    v_cvt_pk_bf16_f32 v45, v58, v59
    v_lshlrev_b32 v60, 16, v30
    v_and_b32 v61, 0xffff0000, v30
    v_mfma_f32_32x32x16_bf16 a[64:79], a[192:195], v[48:51], a[64:79]
    v_fma_f32 v60, v60, v66, v67
    v_fma_f32 v61, v61, v66, v67
    s_add_u32 m0, s27, 44288
    s_nop 0
    buffer_load_dwordx4 v75, s[12:15], s33 offen lds
    v_mfma_f32_32x32x16_bf16 a[80:95], a[192:195], v[52:55], a[80:95]
    v_cvt_pk_bf16_f32 v46, v60, v61
    v_lshlrev_b32 v62, 16, v31
    v_mfma_f32_32x32x16_bf16 a[96:111], a[196:199], v[48:51], a[96:111]
    v_and_b32 v63, 0xffff0000, v31
    v_fma_f32 v62, v62, v66, v67
    s_add_u32 m0, s27, 45312
    s_nop 0
    buffer_load_dwordx4 v76, s[12:15], s33 offen lds
    v_mfma_f32_32x32x16_bf16 a[112:127], a[196:199], v[52:55], a[112:127]
    v_fma_f32 v63, v63, v66, v67
    v_cvt_pk_bf16_f32 v47, v62, v63
    s_waitcnt lgkmcnt(0)
    s_waitcnt vmcnt(13)
    v_mfma_f32_32x32x16_bf16 v[96:111], a[128:131], v[40:43], v[96:111]
    ds_read_b64_tr_b16 a[164:165], v80 offset:13824
    ds_read_b64_tr_b16 a[166:167], v80 offset:14976
    v_lshlrev_b32 v56, 16, v32
    v_and_b32 v57, 0xffff0000, v32
    v_fma_f32 v56, v56, v64, v65
    v_mfma_f32_32x32x16_bf16 v[112:127], a[128:131], v[44:47], v[112:127]
    ds_read_b64_tr_b16 a[168:169], v80 offset:13856
    ds_read_b64_tr_b16 a[170:171], v80 offset:15008
    v_fma_f32 v57, v57, v64, v65
    v_cvt_pk_bf16_f32 v48, v56, v57
    v_mfma_f32_32x32x16_bf16 v[128:143], a[132:135], v[40:43], v[128:143]
    ds_read_b64_tr_b16 a[172:173], v80 offset:13888
    ds_read_b64_tr_b16 a[174:175], v80 offset:15040
    v_lshlrev_b32 v58, 16, v33
    v_and_b32 v59, 0xffff0000, v33
    v_mfma_f32_32x32x16_bf16 v[144:159], a[132:135], v[44:47], v[144:159]
    ds_read_b64_tr_b16 a[176:177], v80 offset:13920
    ds_read_b64_tr_b16 a[178:179], v80 offset:15072
    v_fma_f32 v58, v58, v64, v65
    v_fma_f32 v59, v59, v64, v65
    v_mfma_f32_32x32x16_bf16 v[160:175], a[136:139], v[40:43], v[160:175]
    ds_read_b64_tr_b16 a[180:181], v80 offset:13952
    ds_read_b64_tr_b16 a[182:183], v80 offset:15104
    v_cvt_pk_bf16_f32 v49, v58, v59
    v_lshlrev_b32 v60, 16, v34
    v_and_b32 v61, 0xffff0000, v34
    v_mfma_f32_32x32x16_bf16 v[176:191], a[136:139], v[44:47], v[176:191]
    ds_read_b64_tr_b16 a[184:185], v80 offset:13984
    ds_read_b64_tr_b16 a[186:187], v80 offset:15136
    v_fma_f32 v60, v60, v64, v65
    v_fma_f32 v61, v61, v64, v65
    v_mfma_f32_32x32x16_bf16 v[192:207], a[140:143], v[40:43], v[192:207]
    ds_read_b64_tr_b16 a[188:189], v80 offset:14016
    ds_read_b64_tr_b16 a[190:191], v80 offset:15168
    v_cvt_pk_bf16_f32 v50, v60, v61
    v_lshlrev_b32 v62, 16, v35
    v_mfma_f32_32x32x16_bf16 v[208:223], a[140:143], v[44:47], v[208:223]
    ds_read_b64_tr_b16 a[192:193], v80 offset:14048
    ds_read_b64_tr_b16 a[194:195], v80 offset:15200
    v_and_b32 v63, 0xffff0000, v35
    v_fma_f32 v62, v62, v64, v65
    v_mfma_f32_32x32x16_bf16 v[224:239], a[144:147], v[40:43], v[224:239]
    ds_read_b64_tr_b16 a[196:197], v80 offset:14080
    ds_read_b64_tr_b16 a[198:199], v80 offset:15232
    v_fma_f32 v63, v63, v64, v65
    v_cvt_pk_bf16_f32 v51, v62, v63
    v_mfma_f32_32x32x16_bf16 v[240:255], a[144:147], v[44:47], v[240:255]
    v_lshlrev_b32 v56, 16, v36
    v_and_b32 v57, 0xffff0000, v36
    v_fma_f32 v56, v56, v66, v67
    s_add_u32 s24, s23, 18432
    buffer_load_dwordx4 v[24:27], v81, s[16:19], s24 offen
    v_mfma_f32_32x32x16_bf16 a[0:15], a[148:151], v[40:43], a[0:15]
    v_fma_f32 v57, v57, v66, v67
    v_cvt_pk_bf16_f32 v52, v56, v57
    s_add_u32 s24, s23, 55296
    buffer_load_dwordx4 v[28:31], v81, s[16:19], s24 offen
    v_mfma_f32_32x32x16_bf16 a[16:31], a[148:151], v[44:47], a[16:31]
    v_lshlrev_b32 v58, 16, v37
    v_and_b32 v59, 0xffff0000, v37
    v_mfma_f32_32x32x16_bf16 a[32:47], a[152:155], v[40:43], a[32:47]
    v_fma_f32 v58, v58, v66, v67
    v_fma_f32 v59, v59, v66, v67
    v_mfma_f32_32x32x16_bf16 a[48:63], a[152:155], v[44:47], a[48:63]
    v_cvt_pk_bf16_f32 v53, v58, v59
    v_lshlrev_b32 v60, 16, v38
    v_and_b32 v61, 0xffff0000, v38
    v_mfma_f32_32x32x16_bf16 a[64:79], a[156:159], v[40:43], a[64:79]
    v_fma_f32 v60, v60, v66, v67
    v_fma_f32 v61, v61, v66, v67
    v_mfma_f32_32x32x16_bf16 a[80:95], a[156:159], v[44:47], a[80:95]
    v_cvt_pk_bf16_f32 v54, v60, v61
    v_lshlrev_b32 v62, 16, v39
    v_mfma_f32_32x32x16_bf16 a[96:111], a[160:163], v[40:43], a[96:111]
    v_and_b32 v63, 0xffff0000, v39
    v_fma_f32 v62, v62, v66, v67
    v_mfma_f32_32x32x16_bf16 a[112:127], a[160:163], v[44:47], a[112:127]
    v_fma_f32 v63, v63, v66, v67
    v_cvt_pk_bf16_f32 v55, v62, v63
    s_waitcnt lgkmcnt(0)
    s_barrier
    s_waitcnt vmcnt(10)
    v_mfma_f32_32x32x16_bf16 v[96:111], a[164:167], v[48:51], v[96:111]
    ds_read_b64_tr_b16 a[128:129], v77 offset:0
    ds_read_b64_tr_b16 a[130:131], v77 offset:1152
    v_lshlrev_b32 v56, 16, v8
    v_and_b32 v57, 0xffff0000, v8
    v_fma_f32 v56, v56, v64, v65
    v_mfma_f32_32x32x16_bf16 v[112:127], a[164:167], v[52:55], v[112:127]
    ds_read_b64_tr_b16 a[132:133], v77 offset:32
    ds_read_b64_tr_b16 a[134:135], v77 offset:1184
    v_fma_f32 v57, v57, v64, v65
    v_cvt_pk_bf16_f32 v40, v56, v57
    v_mfma_f32_32x32x16_bf16 v[128:143], a[168:171], v[48:51], v[128:143]
    ds_read_b64_tr_b16 a[136:137], v77 offset:64
    ds_read_b64_tr_b16 a[138:139], v77 offset:1216
    v_lshlrev_b32 v58, 16, v9
    v_and_b32 v59, 0xffff0000, v9
    v_mfma_f32_32x32x16_bf16 v[144:159], a[168:171], v[52:55], v[144:159]
    ds_read_b64_tr_b16 a[140:141], v77 offset:96
    ds_read_b64_tr_b16 a[142:143], v77 offset:1248
    v_fma_f32 v58, v58, v64, v65
    v_fma_f32 v59, v59, v64, v65
    v_mfma_f32_32x32x16_bf16 v[160:175], a[172:175], v[48:51], v[160:175]
    ds_read_b64_tr_b16 a[144:145], v77 offset:128
    ds_read_b64_tr_b16 a[146:147], v77 offset:1280
    v_cvt_pk_bf16_f32 v41, v58, v59
    v_lshlrev_b32 v60, 16, v10
    v_and_b32 v61, 0xffff0000, v10
    v_mfma_f32_32x32x16_bf16 v[176:191], a[172:175], v[52:55], v[176:191]
    ds_read_b64_tr_b16 a[148:149], v77 offset:160
    ds_read_b64_tr_b16 a[150:151], v77 offset:1312
    v_fma_f32 v60, v60, v64, v65
    v_fma_f32 v61, v61, v64, v65
    v_mfma_f32_32x32x16_bf16 v[192:207], a[176:179], v[48:51], v[192:207]
    ds_read_b64_tr_b16 a[152:153], v77 offset:192
    ds_read_b64_tr_b16 a[154:155], v77 offset:1344
    v_cvt_pk_bf16_f32 v42, v60, v61
    v_lshlrev_b32 v62, 16, v11
    v_mfma_f32_32x32x16_bf16 v[208:223], a[176:179], v[52:55], v[208:223]
    ds_read_b64_tr_b16 a[156:157], v77 offset:224
    ds_read_b64_tr_b16 a[158:159], v77 offset:1376
    v_and_b32 v63, 0xffff0000, v11
    v_fma_f32 v62, v62, v64, v65
    v_mfma_f32_32x32x16_bf16 v[224:239], a[180:183], v[48:51], v[224:239]
    ds_read_b64_tr_b16 a[160:161], v77 offset:256
    ds_read_b64_tr_b16 a[162:163], v77 offset:1408
    v_fma_f32 v63, v63, v64, v65
    v_cvt_pk_bf16_f32 v43, v62, v63
    v_mfma_f32_32x32x16_bf16 v[240:255], a[180:183], v[52:55], v[240:255]
    v_lshlrev_b32 v56, 16, v12
    v_and_b32 v57, 0xffff0000, v12
    v_fma_f32 v56, v56, v66, v67
    s_add_u32 s24, s23, 19456
    buffer_load_dwordx4 v[32:35], v81, s[16:19], s24 offen
    v_mfma_f32_32x32x16_bf16 a[0:15], a[184:187], v[48:51], a[0:15]
    v_fma_f32 v57, v57, v66, v67
    v_cvt_pk_bf16_f32 v44, v56, v57
    s_add_u32 s24, s23, 56320
    buffer_load_dwordx4 v[36:39], v81, s[16:19], s24 offen
    v_mfma_f32_32x32x16_bf16 a[16:31], a[184:187], v[52:55], a[16:31]
    v_lshlrev_b32 v58, 16, v13
    v_and_b32 v59, 0xffff0000, v13
    v_mfma_f32_32x32x16_bf16 a[32:47], a[188:191], v[48:51], a[32:47]
    v_fma_f32 v58, v58, v66, v67
    v_fma_f32 v59, v59, v66, v67
    s_add_u32 m0, s27, 74240
    s_add_u32 s33, s26, 3538944
    buffer_load_dwordx4 v68, s[12:15], s33 offen lds
    v_mfma_f32_32x32x16_bf16 a[48:63], a[188:191], v[52:55], a[48:63]
    v_cvt_pk_bf16_f32 v45, v58, v59
    v_lshlrev_b32 v60, 16, v14
    v_and_b32 v61, 0xffff0000, v14
    v_mfma_f32_32x32x16_bf16 a[64:79], a[192:195], v[48:51], a[64:79]
    v_fma_f32 v60, v60, v66, v67
    v_fma_f32 v61, v61, v66, v67
    s_add_u32 m0, s27, 75264
    s_nop 0
    buffer_load_dwordx4 v69, s[12:15], s33 offen lds
    v_mfma_f32_32x32x16_bf16 a[80:95], a[192:195], v[52:55], a[80:95]
    v_cvt_pk_bf16_f32 v46, v60, v61
    v_lshlrev_b32 v62, 16, v15
    v_mfma_f32_32x32x16_bf16 a[96:111], a[196:199], v[48:51], a[96:111]
    v_and_b32 v63, 0xffff0000, v15
    v_fma_f32 v62, v62, v66, v67
    s_add_u32 m0, s27, 76288
    s_nop 0
    buffer_load_dwordx4 v70, s[12:15], s33 offen lds
    v_mfma_f32_32x32x16_bf16 a[112:127], a[196:199], v[52:55], a[112:127]
    v_fma_f32 v63, v63, v66, v67
    v_cvt_pk_bf16_f32 v47, v62, v63
    s_waitcnt lgkmcnt(0)
    s_waitcnt vmcnt(10)
    v_mfma_f32_32x32x16_bf16 v[96:111], a[128:131], v[40:43], v[96:111]
    ds_read_b64_tr_b16 a[164:165], v77 offset:4608
    ds_read_b64_tr_b16 a[166:167], v77 offset:5760
    v_lshlrev_b32 v56, 16, v16
    v_and_b32 v57, 0xffff0000, v16
    v_fma_f32 v56, v56, v64, v65
    v_mfma_f32_32x32x16_bf16 v[112:127], a[128:131], v[44:47], v[112:127]
    ds_read_b64_tr_b16 a[168:169], v77 offset:4640
    ds_read_b64_tr_b16 a[170:171], v77 offset:5792
    v_fma_f32 v57, v57, v64, v65
    v_cvt_pk_bf16_f32 v48, v56, v57
    v_mfma_f32_32x32x16_bf16 v[128:143], a[132:135], v[40:43], v[128:143]
    ds_read_b64_tr_b16 a[172:173], v77 offset:4672
    ds_read_b64_tr_b16 a[174:175], v77 offset:5824
    v_lshlrev_b32 v58, 16, v17
    v_and_b32 v59, 0xffff0000, v17
    v_mfma_f32_32x32x16_bf16 v[144:159], a[132:135], v[44:47], v[144:159]
    ds_read_b64_tr_b16 a[176:177], v77 offset:4704
    ds_read_b64_tr_b16 a[178:179], v77 offset:5856
    v_fma_f32 v58, v58, v64, v65
    v_fma_f32 v59, v59, v64, v65
    v_mfma_f32_32x32x16_bf16 v[160:175], a[136:139], v[40:43], v[160:175]
    ds_read_b64_tr_b16 a[180:181], v77 offset:4736
    ds_read_b64_tr_b16 a[182:183], v77 offset:5888
    v_cvt_pk_bf16_f32 v49, v58, v59
    v_lshlrev_b32 v60, 16, v18
    v_and_b32 v61, 0xffff0000, v18
    v_mfma_f32_32x32x16_bf16 v[176:191], a[136:139], v[44:47], v[176:191]
    ds_read_b64_tr_b16 a[184:185], v77 offset:4768
    ds_read_b64_tr_b16 a[186:187], v77 offset:5920
    v_fma_f32 v60, v60, v64, v65
    v_fma_f32 v61, v61, v64, v65
    v_mfma_f32_32x32x16_bf16 v[192:207], a[140:143], v[40:43], v[192:207]
    ds_read_b64_tr_b16 a[188:189], v77 offset:4800
    ds_read_b64_tr_b16 a[190:191], v77 offset:5952
    v_cvt_pk_bf16_f32 v50, v60, v61
    v_lshlrev_b32 v62, 16, v19
    v_mfma_f32_32x32x16_bf16 v[208:223], a[140:143], v[44:47], v[208:223]
    ds_read_b64_tr_b16 a[192:193], v77 offset:4832
    ds_read_b64_tr_b16 a[194:195], v77 offset:5984
    v_and_b32 v63, 0xffff0000, v19
    v_fma_f32 v62, v62, v64, v65
    v_mfma_f32_32x32x16_bf16 v[224:239], a[144:147], v[40:43], v[224:239]
    ds_read_b64_tr_b16 a[196:197], v77 offset:4864
    ds_read_b64_tr_b16 a[198:199], v77 offset:6016
    v_fma_f32 v63, v63, v64, v65
    v_cvt_pk_bf16_f32 v51, v62, v63
    v_mfma_f32_32x32x16_bf16 v[240:255], a[144:147], v[44:47], v[240:255]
    v_lshlrev_b32 v56, 16, v20
    v_and_b32 v57, 0xffff0000, v20
    v_fma_f32 v56, v56, v66, v67
    s_add_u32 s24, s23, 20480
    buffer_load_dwordx4 v[8:11], v81, s[16:19], s24 offen
    v_mfma_f32_32x32x16_bf16 a[0:15], a[148:151], v[40:43], a[0:15]
    v_fma_f32 v57, v57, v66, v67
    v_cvt_pk_bf16_f32 v52, v56, v57
    s_add_u32 s24, s23, 57344
    buffer_load_dwordx4 v[12:15], v81, s[16:19], s24 offen
    v_mfma_f32_32x32x16_bf16 a[16:31], a[148:151], v[44:47], a[16:31]
    v_lshlrev_b32 v58, 16, v21
    v_and_b32 v59, 0xffff0000, v21
    v_mfma_f32_32x32x16_bf16 a[32:47], a[152:155], v[40:43], a[32:47]
    v_fma_f32 v58, v58, v66, v67
    v_fma_f32 v59, v59, v66, v67
    s_add_u32 m0, s27, 77312
    s_nop 0
    buffer_load_dwordx4 v71, s[12:15], s33 offen lds
    v_mfma_f32_32x32x16_bf16 a[48:63], a[152:155], v[44:47], a[48:63]
    v_cvt_pk_bf16_f32 v53, v58, v59
    v_lshlrev_b32 v60, 16, v22
    v_and_b32 v61, 0xffff0000, v22
    v_mfma_f32_32x32x16_bf16 a[64:79], a[156:159], v[40:43], a[64:79]
    v_fma_f32 v60, v60, v66, v67
    v_fma_f32 v61, v61, v66, v67
    s_add_u32 m0, s27, 78336
    s_nop 0
    buffer_load_dwordx4 v72, s[12:15], s33 offen lds
    v_mfma_f32_32x32x16_bf16 a[80:95], a[156:159], v[44:47], a[80:95]
    v_cvt_pk_bf16_f32 v54, v60, v61
    v_lshlrev_b32 v62, 16, v23
    v_mfma_f32_32x32x16_bf16 a[96:111], a[160:163], v[40:43], a[96:111]
    v_and_b32 v63, 0xffff0000, v23
    v_fma_f32 v62, v62, v66, v67
    s_add_u32 m0, s27, 79360
    s_nop 0
    buffer_load_dwordx4 v73, s[12:15], s33 offen lds
    v_mfma_f32_32x32x16_bf16 a[112:127], a[160:163], v[44:47], a[112:127]
    v_fma_f32 v63, v63, v66, v67
    v_cvt_pk_bf16_f32 v55, v62, v63
    s_waitcnt lgkmcnt(0)
    s_waitcnt vmcnt(10)
    v_mfma_f32_32x32x16_bf16 v[96:111], a[164:167], v[48:51], v[96:111]
    ds_read_b64_tr_b16 a[128:129], v77 offset:9216
    ds_read_b64_tr_b16 a[130:131], v77 offset:10368
    v_lshlrev_b32 v56, 16, v24
    v_and_b32 v57, 0xffff0000, v24
    v_fma_f32 v56, v56, v64, v65
    v_mfma_f32_32x32x16_bf16 v[112:127], a[164:167], v[52:55], v[112:127]
    ds_read_b64_tr_b16 a[132:133], v77 offset:9248
    ds_read_b64_tr_b16 a[134:135], v77 offset:10400
    v_fma_f32 v57, v57, v64, v65
    v_cvt_pk_bf16_f32 v40, v56, v57
    v_mfma_f32_32x32x16_bf16 v[128:143], a[168:171], v[48:51], v[128:143]
    ds_read_b64_tr_b16 a[136:137], v77 offset:9280
    ds_read_b64_tr_b16 a[138:139], v77 offset:10432
    v_lshlrev_b32 v58, 16, v25
    v_and_b32 v59, 0xffff0000, v25
    v_mfma_f32_32x32x16_bf16 v[144:159], a[168:171], v[52:55], v[144:159]
    ds_read_b64_tr_b16 a[140:141], v77 offset:9312
    ds_read_b64_tr_b16 a[142:143], v77 offset:10464
    v_fma_f32 v58, v58, v64, v65
    v_fma_f32 v59, v59, v64, v65
    v_mfma_f32_32x32x16_bf16 v[160:175], a[172:175], v[48:51], v[160:175]
    ds_read_b64_tr_b16 a[144:145], v77 offset:9344
    ds_read_b64_tr_b16 a[146:147], v77 offset:10496
    v_cvt_pk_bf16_f32 v41, v58, v59
    v_lshlrev_b32 v60, 16, v26
    v_and_b32 v61, 0xffff0000, v26
    v_mfma_f32_32x32x16_bf16 v[176:191], a[172:175], v[52:55], v[176:191]
    ds_read_b64_tr_b16 a[148:149], v77 offset:9376
    ds_read_b64_tr_b16 a[150:151], v77 offset:10528
    v_fma_f32 v60, v60, v64, v65
    v_fma_f32 v61, v61, v64, v65
    v_mfma_f32_32x32x16_bf16 v[192:207], a[176:179], v[48:51], v[192:207]
    ds_read_b64_tr_b16 a[152:153], v77 offset:9408
    ds_read_b64_tr_b16 a[154:155], v77 offset:10560
    v_cvt_pk_bf16_f32 v42, v60, v61
    v_lshlrev_b32 v62, 16, v27
    v_mfma_f32_32x32x16_bf16 v[208:223], a[176:179], v[52:55], v[208:223]
    ds_read_b64_tr_b16 a[156:157], v77 offset:9440
    ds_read_b64_tr_b16 a[158:159], v77 offset:10592
    v_and_b32 v63, 0xffff0000, v27
    v_fma_f32 v62, v62, v64, v65
    v_mfma_f32_32x32x16_bf16 v[224:239], a[180:183], v[48:51], v[224:239]
    ds_read_b64_tr_b16 a[160:161], v77 offset:9472
    ds_read_b64_tr_b16 a[162:163], v77 offset:10624
    v_fma_f32 v63, v63, v64, v65
    v_cvt_pk_bf16_f32 v43, v62, v63
    v_mfma_f32_32x32x16_bf16 v[240:255], a[180:183], v[52:55], v[240:255]
    v_lshlrev_b32 v56, 16, v28
    v_and_b32 v57, 0xffff0000, v28
    v_fma_f32 v56, v56, v66, v67
    s_add_u32 s24, s23, 21504
    buffer_load_dwordx4 v[16:19], v81, s[16:19], s24 offen
    v_mfma_f32_32x32x16_bf16 a[0:15], a[184:187], v[48:51], a[0:15]
    v_fma_f32 v57, v57, v66, v67
    v_cvt_pk_bf16_f32 v44, v56, v57
    s_add_u32 s24, s23, 58368
    buffer_load_dwordx4 v[20:23], v81, s[16:19], s24 offen
    v_mfma_f32_32x32x16_bf16 a[16:31], a[184:187], v[52:55], a[16:31]
    v_lshlrev_b32 v58, 16, v29
    v_and_b32 v59, 0xffff0000, v29
    v_mfma_f32_32x32x16_bf16 a[32:47], a[188:191], v[48:51], a[32:47]
    v_fma_f32 v58, v58, v66, v67
    v_fma_f32 v59, v59, v66, v67
    s_add_u32 m0, s27, 80384
    s_nop 0
    buffer_load_dwordx4 v74, s[12:15], s33 offen lds
    v_mfma_f32_32x32x16_bf16 a[48:63], a[188:191], v[52:55], a[48:63]
    v_cvt_pk_bf16_f32 v45, v58, v59
    v_lshlrev_b32 v60, 16, v30
    v_and_b32 v61, 0xffff0000, v30
    v_mfma_f32_32x32x16_bf16 a[64:79], a[192:195], v[48:51], a[64:79]
    v_fma_f32 v60, v60, v66, v67
    v_fma_f32 v61, v61, v66, v67
    s_add_u32 m0, s27, 81408
    s_nop 0
    buffer_load_dwordx4 v75, s[12:15], s33 offen lds
    v_mfma_f32_32x32x16_bf16 a[80:95], a[192:195], v[52:55], a[80:95]
    v_cvt_pk_bf16_f32 v46, v60, v61
    v_lshlrev_b32 v62, 16, v31
    v_mfma_f32_32x32x16_bf16 a[96:111], a[196:199], v[48:51], a[96:111]
    v_and_b32 v63, 0xffff0000, v31
    v_fma_f32 v62, v62, v66, v67
    s_add_u32 m0, s27, 82432
    s_nop 0
    buffer_load_dwordx4 v76, s[12:15], s33 offen lds
    v_mfma_f32_32x32x16_bf16 a[112:127], a[196:199], v[52:55], a[112:127]
    v_fma_f32 v63, v63, v66, v67
    v_cvt_pk_bf16_f32 v47, v62, v63
    s_waitcnt lgkmcnt(0)
    s_waitcnt vmcnt(13)
    v_mfma_f32_32x32x16_bf16 v[96:111], a[128:131], v[40:43], v[96:111]
    ds_read_b64_tr_b16 a[164:165], v77 offset:13824
    ds_read_b64_tr_b16 a[166:167], v77 offset:14976
    v_lshlrev_b32 v56, 16, v32
    v_and_b32 v57, 0xffff0000, v32
    v_fma_f32 v56, v56, v64, v65
    v_mfma_f32_32x32x16_bf16 v[112:127], a[128:131], v[44:47], v[112:127]
    ds_read_b64_tr_b16 a[168:169], v77 offset:13856
    ds_read_b64_tr_b16 a[170:171], v77 offset:15008
    v_fma_f32 v57, v57, v64, v65
    v_cvt_pk_bf16_f32 v48, v56, v57
    v_mfma_f32_32x32x16_bf16 v[128:143], a[132:135], v[40:43], v[128:143]
    ds_read_b64_tr_b16 a[172:173], v77 offset:13888
    ds_read_b64_tr_b16 a[174:175], v77 offset:15040
    v_lshlrev_b32 v58, 16, v33
    v_and_b32 v59, 0xffff0000, v33
    v_mfma_f32_32x32x16_bf16 v[144:159], a[132:135], v[44:47], v[144:159]
    ds_read_b64_tr_b16 a[176:177], v77 offset:13920
    ds_read_b64_tr_b16 a[178:179], v77 offset:15072
    v_fma_f32 v58, v58, v64, v65
    v_fma_f32 v59, v59, v64, v65
    v_mfma_f32_32x32x16_bf16 v[160:175], a[136:139], v[40:43], v[160:175]
    ds_read_b64_tr_b16 a[180:181], v77 offset:13952
    ds_read_b64_tr_b16 a[182:183], v77 offset:15104
    v_cvt_pk_bf16_f32 v49, v58, v59
    v_lshlrev_b32 v60, 16, v34
    v_and_b32 v61, 0xffff0000, v34
    v_mfma_f32_32x32x16_bf16 v[176:191], a[136:139], v[44:47], v[176:191]
    ds_read_b64_tr_b16 a[184:185], v77 offset:13984
    ds_read_b64_tr_b16 a[186:187], v77 offset:15136
    v_fma_f32 v60, v60, v64, v65
    v_fma_f32 v61, v61, v64, v65
    v_mfma_f32_32x32x16_bf16 v[192:207], a[140:143], v[40:43], v[192:207]
    ds_read_b64_tr_b16 a[188:189], v77 offset:14016
    ds_read_b64_tr_b16 a[190:191], v77 offset:15168
    v_cvt_pk_bf16_f32 v50, v60, v61
    v_lshlrev_b32 v62, 16, v35
    v_mfma_f32_32x32x16_bf16 v[208:223], a[140:143], v[44:47], v[208:223]
    ds_read_b64_tr_b16 a[192:193], v77 offset:14048
    ds_read_b64_tr_b16 a[194:195], v77 offset:15200
    v_and_b32 v63, 0xffff0000, v35
    v_fma_f32 v62, v62, v64, v65
    v_mfma_f32_32x32x16_bf16 v[224:239], a[144:147], v[40:43], v[224:239]
    ds_read_b64_tr_b16 a[196:197], v77 offset:14080
    ds_read_b64_tr_b16 a[198:199], v77 offset:15232
    v_fma_f32 v63, v63, v64, v65
    v_cvt_pk_bf16_f32 v51, v62, v63
    v_mfma_f32_32x32x16_bf16 v[240:255], a[144:147], v[44:47], v[240:255]
    v_lshlrev_b32 v56, 16, v36
    v_and_b32 v57, 0xffff0000, v36
    v_fma_f32 v56, v56, v66, v67
    s_add_u32 s24, s23, 22528
    buffer_load_dwordx4 v[24:27], v81, s[16:19], s24 offen
    v_mfma_f32_32x32x16_bf16 a[0:15], a[148:151], v[40:43], a[0:15]
    v_fma_f32 v57, v57, v66, v67
    v_cvt_pk_bf16_f32 v52, v56, v57
    s_add_u32 s24, s23, 59392
    buffer_load_dwordx4 v[28:31], v81, s[16:19], s24 offen
    v_mfma_f32_32x32x16_bf16 a[16:31], a[148:151], v[44:47], a[16:31]
    v_lshlrev_b32 v58, 16, v37
    v_and_b32 v59, 0xffff0000, v37
    v_mfma_f32_32x32x16_bf16 a[32:47], a[152:155], v[40:43], a[32:47]
    v_fma_f32 v58, v58, v66, v67
    v_fma_f32 v59, v59, v66, v67
    v_mfma_f32_32x32x16_bf16 a[48:63], a[152:155], v[44:47], a[48:63]
    v_cvt_pk_bf16_f32 v53, v58, v59
    v_lshlrev_b32 v60, 16, v38
    v_and_b32 v61, 0xffff0000, v38
    v_mfma_f32_32x32x16_bf16 a[64:79], a[156:159], v[40:43], a[64:79]
    v_fma_f32 v60, v60, v66, v67
    v_fma_f32 v61, v61, v66, v67
    v_mfma_f32_32x32x16_bf16 a[80:95], a[156:159], v[44:47], a[80:95]
    v_cvt_pk_bf16_f32 v54, v60, v61
    v_lshlrev_b32 v62, 16, v39
    v_mfma_f32_32x32x16_bf16 a[96:111], a[160:163], v[40:43], a[96:111]
    v_and_b32 v63, 0xffff0000, v39
    v_fma_f32 v62, v62, v66, v67
    v_mfma_f32_32x32x16_bf16 a[112:127], a[160:163], v[44:47], a[112:127]
    v_fma_f32 v63, v63, v66, v67
    v_cvt_pk_bf16_f32 v55, v62, v63
    s_waitcnt lgkmcnt(0)
    s_barrier
    s_waitcnt vmcnt(10)
    v_mfma_f32_32x32x16_bf16 v[96:111], a[164:167], v[48:51], v[96:111]
    ds_read_b64_tr_b16 a[128:129], v78 offset:0
    ds_read_b64_tr_b16 a[130:131], v78 offset:1152
    v_lshlrev_b32 v56, 16, v8
    v_and_b32 v57, 0xffff0000, v8
    v_fma_f32 v56, v56, v64, v65
    v_mfma_f32_32x32x16_bf16 v[112:127], a[164:167], v[52:55], v[112:127]
    ds_read_b64_tr_b16 a[132:133], v78 offset:32
    ds_read_b64_tr_b16 a[134:135], v78 offset:1184
    v_fma_f32 v57, v57, v64, v65
    v_cvt_pk_bf16_f32 v40, v56, v57
    v_mfma_f32_32x32x16_bf16 v[128:143], a[168:171], v[48:51], v[128:143]
    ds_read_b64_tr_b16 a[136:137], v78 offset:64
    ds_read_b64_tr_b16 a[138:139], v78 offset:1216
    v_lshlrev_b32 v58, 16, v9
    v_and_b32 v59, 0xffff0000, v9
    v_mfma_f32_32x32x16_bf16 v[144:159], a[168:171], v[52:55], v[144:159]
    ds_read_b64_tr_b16 a[140:141], v78 offset:96
    ds_read_b64_tr_b16 a[142:143], v78 offset:1248
    v_fma_f32 v58, v58, v64, v65
    v_fma_f32 v59, v59, v64, v65
    v_mfma_f32_32x32x16_bf16 v[160:175], a[172:175], v[48:51], v[160:175]
    ds_read_b64_tr_b16 a[144:145], v78 offset:128
    ds_read_b64_tr_b16 a[146:147], v78 offset:1280
    v_cvt_pk_bf16_f32 v41, v58, v59
    v_lshlrev_b32 v60, 16, v10
    v_and_b32 v61, 0xffff0000, v10
    v_mfma_f32_32x32x16_bf16 v[176:191], a[172:175], v[52:55], v[176:191]
    ds_read_b64_tr_b16 a[148:149], v78 offset:160
    ds_read_b64_tr_b16 a[150:151], v78 offset:1312
    v_fma_f32 v60, v60, v64, v65
    v_fma_f32 v61, v61, v64, v65
    v_mfma_f32_32x32x16_bf16 v[192:207], a[176:179], v[48:51], v[192:207]
    ds_read_b64_tr_b16 a[152:153], v78 offset:192
    ds_read_b64_tr_b16 a[154:155], v78 offset:1344
    v_cvt_pk_bf16_f32 v42, v60, v61
    v_lshlrev_b32 v62, 16, v11
    v_mfma_f32_32x32x16_bf16 v[208:223], a[176:179], v[52:55], v[208:223]
    ds_read_b64_tr_b16 a[156:157], v78 offset:224
    ds_read_b64_tr_b16 a[158:159], v78 offset:1376
    v_and_b32 v63, 0xffff0000, v11
    v_fma_f32 v62, v62, v64, v65
    v_mfma_f32_32x32x16_bf16 v[224:239], a[180:183], v[48:51], v[224:239]
    ds_read_b64_tr_b16 a[160:161], v78 offset:256
    ds_read_b64_tr_b16 a[162:163], v78 offset:1408
    v_fma_f32 v63, v63, v64, v65
    v_cvt_pk_bf16_f32 v43, v62, v63
    v_mfma_f32_32x32x16_bf16 v[240:255], a[180:183], v[52:55], v[240:255]
    v_lshlrev_b32 v56, 16, v12
    v_and_b32 v57, 0xffff0000, v12
    v_fma_f32 v56, v56, v66, v67
    s_add_u32 s24, s23, 23552
    buffer_load_dwordx4 v[32:35], v81, s[16:19], s24 offen
    v_mfma_f32_32x32x16_bf16 a[0:15], a[184:187], v[48:51], a[0:15]
    v_fma_f32 v57, v57, v66, v67
    v_cvt_pk_bf16_f32 v44, v56, v57
    s_add_u32 s24, s23, 60416
    buffer_load_dwordx4 v[36:39], v81, s[16:19], s24 offen
    v_mfma_f32_32x32x16_bf16 a[16:31], a[184:187], v[52:55], a[16:31]
    v_lshlrev_b32 v58, 16, v13
    v_and_b32 v59, 0xffff0000, v13
    v_mfma_f32_32x32x16_bf16 a[32:47], a[188:191], v[48:51], a[32:47]
    v_fma_f32 v58, v58, v66, v67
    v_fma_f32 v59, v59, v66, v67
    s_add_u32 m0, s27, 111360
    s_add_u32 s33, s26, 4128768
    buffer_load_dwordx4 v68, s[12:15], s33 offen lds
    v_mfma_f32_32x32x16_bf16 a[48:63], a[188:191], v[52:55], a[48:63]
    v_cvt_pk_bf16_f32 v45, v58, v59
    v_lshlrev_b32 v60, 16, v14
    v_and_b32 v61, 0xffff0000, v14
    v_mfma_f32_32x32x16_bf16 a[64:79], a[192:195], v[48:51], a[64:79]
    v_fma_f32 v60, v60, v66, v67
    v_fma_f32 v61, v61, v66, v67
    s_add_u32 m0, s27, 112384
    s_nop 0
    buffer_load_dwordx4 v69, s[12:15], s33 offen lds
    v_mfma_f32_32x32x16_bf16 a[80:95], a[192:195], v[52:55], a[80:95]
    v_cvt_pk_bf16_f32 v46, v60, v61
    v_lshlrev_b32 v62, 16, v15
    v_mfma_f32_32x32x16_bf16 a[96:111], a[196:199], v[48:51], a[96:111]
    v_and_b32 v63, 0xffff0000, v15
    v_fma_f32 v62, v62, v66, v67
    s_add_u32 m0, s27, 113408
    s_nop 0
    buffer_load_dwordx4 v70, s[12:15], s33 offen lds
    v_mfma_f32_32x32x16_bf16 a[112:127], a[196:199], v[52:55], a[112:127]
    v_fma_f32 v63, v63, v66, v67
    v_cvt_pk_bf16_f32 v47, v62, v63
    s_waitcnt lgkmcnt(0)
    s_waitcnt vmcnt(10)
    v_mfma_f32_32x32x16_bf16 v[96:111], a[128:131], v[40:43], v[96:111]
    ds_read_b64_tr_b16 a[164:165], v78 offset:4608
    ds_read_b64_tr_b16 a[166:167], v78 offset:5760
    v_lshlrev_b32 v56, 16, v16
    v_and_b32 v57, 0xffff0000, v16
    v_fma_f32 v56, v56, v64, v65
    v_mfma_f32_32x32x16_bf16 v[112:127], a[128:131], v[44:47], v[112:127]
    ds_read_b64_tr_b16 a[168:169], v78 offset:4640
    ds_read_b64_tr_b16 a[170:171], v78 offset:5792
    v_fma_f32 v57, v57, v64, v65
    v_cvt_pk_bf16_f32 v48, v56, v57
    v_mfma_f32_32x32x16_bf16 v[128:143], a[132:135], v[40:43], v[128:143]
    ds_read_b64_tr_b16 a[172:173], v78 offset:4672
    ds_read_b64_tr_b16 a[174:175], v78 offset:5824
    v_lshlrev_b32 v58, 16, v17
    v_and_b32 v59, 0xffff0000, v17
    v_mfma_f32_32x32x16_bf16 v[144:159], a[132:135], v[44:47], v[144:159]
    ds_read_b64_tr_b16 a[176:177], v78 offset:4704
    ds_read_b64_tr_b16 a[178:179], v78 offset:5856
    v_fma_f32 v58, v58, v64, v65
    v_fma_f32 v59, v59, v64, v65
    v_mfma_f32_32x32x16_bf16 v[160:175], a[136:139], v[40:43], v[160:175]
    ds_read_b64_tr_b16 a[180:181], v78 offset:4736
    ds_read_b64_tr_b16 a[182:183], v78 offset:5888
    v_cvt_pk_bf16_f32 v49, v58, v59
    v_lshlrev_b32 v60, 16, v18
    v_and_b32 v61, 0xffff0000, v18
    v_mfma_f32_32x32x16_bf16 v[176:191], a[136:139], v[44:47], v[176:191]
    ds_read_b64_tr_b16 a[184:185], v78 offset:4768
    ds_read_b64_tr_b16 a[186:187], v78 offset:5920
    v_fma_f32 v60, v60, v64, v65
    v_fma_f32 v61, v61, v64, v65
    v_mfma_f32_32x32x16_bf16 v[192:207], a[140:143], v[40:43], v[192:207]
    ds_read_b64_tr_b16 a[188:189], v78 offset:4800
    ds_read_b64_tr_b16 a[190:191], v78 offset:5952
    v_cvt_pk_bf16_f32 v50, v60, v61
    v_lshlrev_b32 v62, 16, v19
    v_mfma_f32_32x32x16_bf16 v[208:223], a[140:143], v[44:47], v[208:223]
    ds_read_b64_tr_b16 a[192:193], v78 offset:4832
    ds_read_b64_tr_b16 a[194:195], v78 offset:5984
    v_and_b32 v63, 0xffff0000, v19
    v_fma_f32 v62, v62, v64, v65
    v_mfma_f32_32x32x16_bf16 v[224:239], a[144:147], v[40:43], v[224:239]
    ds_read_b64_tr_b16 a[196:197], v78 offset:4864
    ds_read_b64_tr_b16 a[198:199], v78 offset:6016
    v_fma_f32 v63, v63, v64, v65
    v_cvt_pk_bf16_f32 v51, v62, v63
    v_mfma_f32_32x32x16_bf16 v[240:255], a[144:147], v[44:47], v[240:255]
    v_lshlrev_b32 v56, 16, v20
    v_and_b32 v57, 0xffff0000, v20
    v_fma_f32 v56, v56, v66, v67
    s_add_u32 s24, s23, 24576
    buffer_load_dwordx4 v[8:11], v81, s[16:19], s24 offen
    v_mfma_f32_32x32x16_bf16 a[0:15], a[148:151], v[40:43], a[0:15]
    v_fma_f32 v57, v57, v66, v67
    v_cvt_pk_bf16_f32 v52, v56, v57
    s_add_u32 s24, s23, 61440
    buffer_load_dwordx4 v[12:15], v81, s[16:19], s24 offen
    v_mfma_f32_32x32x16_bf16 a[16:31], a[148:151], v[44:47], a[16:31]
    v_lshlrev_b32 v58, 16, v21
    v_and_b32 v59, 0xffff0000, v21
    v_mfma_f32_32x32x16_bf16 a[32:47], a[152:155], v[40:43], a[32:47]
    v_fma_f32 v58, v58, v66, v67
    v_fma_f32 v59, v59, v66, v67
    s_add_u32 m0, s27, 114432
    s_nop 0
    buffer_load_dwordx4 v71, s[12:15], s33 offen lds
    v_mfma_f32_32x32x16_bf16 a[48:63], a[152:155], v[44:47], a[48:63]
    v_cvt_pk_bf16_f32 v53, v58, v59
    v_lshlrev_b32 v60, 16, v22
    v_and_b32 v61, 0xffff0000, v22
    v_mfma_f32_32x32x16_bf16 a[64:79], a[156:159], v[40:43], a[64:79]
    v_fma_f32 v60, v60, v66, v67
    v_fma_f32 v61, v61, v66, v67
    s_add_u32 m0, s27, 115456
    s_nop 0
    buffer_load_dwordx4 v72, s[12:15], s33 offen lds
    v_mfma_f32_32x32x16_bf16 a[80:95], a[156:159], v[44:47], a[80:95]
    v_cvt_pk_bf16_f32 v54, v60, v61
    v_lshlrev_b32 v62, 16, v23
    v_mfma_f32_32x32x16_bf16 a[96:111], a[160:163], v[40:43], a[96:111]
    v_and_b32 v63, 0xffff0000, v23
    v_fma_f32 v62, v62, v66, v67
    s_add_u32 m0, s27, 116480
    s_nop 0
    buffer_load_dwordx4 v73, s[12:15], s33 offen lds
    v_mfma_f32_32x32x16_bf16 a[112:127], a[160:163], v[44:47], a[112:127]
    v_fma_f32 v63, v63, v66, v67
    v_cvt_pk_bf16_f32 v55, v62, v63
    s_waitcnt lgkmcnt(0)
    s_waitcnt vmcnt(10)
    v_mfma_f32_32x32x16_bf16 v[96:111], a[164:167], v[48:51], v[96:111]
    ds_read_b64_tr_b16 a[128:129], v78 offset:9216
    ds_read_b64_tr_b16 a[130:131], v78 offset:10368
    v_lshlrev_b32 v56, 16, v24
    v_and_b32 v57, 0xffff0000, v24
    v_fma_f32 v56, v56, v64, v65
    v_mfma_f32_32x32x16_bf16 v[112:127], a[164:167], v[52:55], v[112:127]
    ds_read_b64_tr_b16 a[132:133], v78 offset:9248
    ds_read_b64_tr_b16 a[134:135], v78 offset:10400
    v_fma_f32 v57, v57, v64, v65
    v_cvt_pk_bf16_f32 v40, v56, v57
    v_mfma_f32_32x32x16_bf16 v[128:143], a[168:171], v[48:51], v[128:143]
    ds_read_b64_tr_b16 a[136:137], v78 offset:9280
    ds_read_b64_tr_b16 a[138:139], v78 offset:10432
    v_lshlrev_b32 v58, 16, v25
    v_and_b32 v59, 0xffff0000, v25
    v_mfma_f32_32x32x16_bf16 v[144:159], a[168:171], v[52:55], v[144:159]
    ds_read_b64_tr_b16 a[140:141], v78 offset:9312
    ds_read_b64_tr_b16 a[142:143], v78 offset:10464
    v_fma_f32 v58, v58, v64, v65
    v_fma_f32 v59, v59, v64, v65
    v_mfma_f32_32x32x16_bf16 v[160:175], a[172:175], v[48:51], v[160:175]
    ds_read_b64_tr_b16 a[144:145], v78 offset:9344
    ds_read_b64_tr_b16 a[146:147], v78 offset:10496
    v_cvt_pk_bf16_f32 v41, v58, v59
    v_lshlrev_b32 v60, 16, v26
    v_and_b32 v61, 0xffff0000, v26
    v_mfma_f32_32x32x16_bf16 v[176:191], a[172:175], v[52:55], v[176:191]
    ds_read_b64_tr_b16 a[148:149], v78 offset:9376
    ds_read_b64_tr_b16 a[150:151], v78 offset:10528
    v_fma_f32 v60, v60, v64, v65
    v_fma_f32 v61, v61, v64, v65
    v_mfma_f32_32x32x16_bf16 v[192:207], a[176:179], v[48:51], v[192:207]
    ds_read_b64_tr_b16 a[152:153], v78 offset:9408
    ds_read_b64_tr_b16 a[154:155], v78 offset:10560
    v_cvt_pk_bf16_f32 v42, v60, v61
    v_lshlrev_b32 v62, 16, v27
    v_mfma_f32_32x32x16_bf16 v[208:223], a[176:179], v[52:55], v[208:223]
    ds_read_b64_tr_b16 a[156:157], v78 offset:9440
    ds_read_b64_tr_b16 a[158:159], v78 offset:10592
    v_and_b32 v63, 0xffff0000, v27
    v_fma_f32 v62, v62, v64, v65
    v_mfma_f32_32x32x16_bf16 v[224:239], a[180:183], v[48:51], v[224:239]
    ds_read_b64_tr_b16 a[160:161], v78 offset:9472
    ds_read_b64_tr_b16 a[162:163], v78 offset:10624
    v_fma_f32 v63, v63, v64, v65
    v_cvt_pk_bf16_f32 v43, v62, v63
    v_mfma_f32_32x32x16_bf16 v[240:255], a[180:183], v[52:55], v[240:255]
    v_lshlrev_b32 v56, 16, v28
    v_and_b32 v57, 0xffff0000, v28
    v_fma_f32 v56, v56, v66, v67
    s_add_u32 s24, s23, 25600
    buffer_load_dwordx4 v[16:19], v81, s[16:19], s24 offen
    v_mfma_f32_32x32x16_bf16 a[0:15], a[184:187], v[48:51], a[0:15]
    v_fma_f32 v57, v57, v66, v67
    v_cvt_pk_bf16_f32 v44, v56, v57
    s_add_u32 s24, s23, 62464
    buffer_load_dwordx4 v[20:23], v81, s[16:19], s24 offen
    v_mfma_f32_32x32x16_bf16 a[16:31], a[184:187], v[52:55], a[16:31]
    v_lshlrev_b32 v58, 16, v29
    v_and_b32 v59, 0xffff0000, v29
    v_mfma_f32_32x32x16_bf16 a[32:47], a[188:191], v[48:51], a[32:47]
    v_fma_f32 v58, v58, v66, v67
    v_fma_f32 v59, v59, v66, v67
    s_add_u32 m0, s27, 117504
    s_nop 0
    buffer_load_dwordx4 v74, s[12:15], s33 offen lds
    v_mfma_f32_32x32x16_bf16 a[48:63], a[188:191], v[52:55], a[48:63]
    v_cvt_pk_bf16_f32 v45, v58, v59
    v_lshlrev_b32 v60, 16, v30
    v_and_b32 v61, 0xffff0000, v30
    v_mfma_f32_32x32x16_bf16 a[64:79], a[192:195], v[48:51], a[64:79]
    v_fma_f32 v60, v60, v66, v67
    v_fma_f32 v61, v61, v66, v67
    s_add_u32 m0, s27, 118528
    s_nop 0
    buffer_load_dwordx4 v75, s[12:15], s33 offen lds
    v_mfma_f32_32x32x16_bf16 a[80:95], a[192:195], v[52:55], a[80:95]
    v_cvt_pk_bf16_f32 v46, v60, v61
    v_lshlrev_b32 v62, 16, v31
    v_mfma_f32_32x32x16_bf16 a[96:111], a[196:199], v[48:51], a[96:111]
    v_and_b32 v63, 0xffff0000, v31
    v_fma_f32 v62, v62, v66, v67
    s_add_u32 m0, s27, 119552
    s_nop 0
    buffer_load_dwordx4 v76, s[12:15], s33 offen lds
    v_mfma_f32_32x32x16_bf16 a[112:127], a[196:199], v[52:55], a[112:127]
    v_fma_f32 v63, v63, v66, v67
    v_cvt_pk_bf16_f32 v47, v62, v63
    s_waitcnt lgkmcnt(0)
    s_waitcnt vmcnt(13)
    v_mfma_f32_32x32x16_bf16 v[96:111], a[128:131], v[40:43], v[96:111]
    ds_read_b64_tr_b16 a[164:165], v78 offset:13824
    ds_read_b64_tr_b16 a[166:167], v78 offset:14976
    v_lshlrev_b32 v56, 16, v32
    v_and_b32 v57, 0xffff0000, v32
    v_fma_f32 v56, v56, v64, v65
    v_mfma_f32_32x32x16_bf16 v[112:127], a[128:131], v[44:47], v[112:127]
    ds_read_b64_tr_b16 a[168:169], v78 offset:13856
    ds_read_b64_tr_b16 a[170:171], v78 offset:15008
    v_fma_f32 v57, v57, v64, v65
    v_cvt_pk_bf16_f32 v48, v56, v57
    v_mfma_f32_32x32x16_bf16 v[128:143], a[132:135], v[40:43], v[128:143]
    ds_read_b64_tr_b16 a[172:173], v78 offset:13888
    ds_read_b64_tr_b16 a[174:175], v78 offset:15040
    v_lshlrev_b32 v58, 16, v33
    v_and_b32 v59, 0xffff0000, v33
    v_mfma_f32_32x32x16_bf16 v[144:159], a[132:135], v[44:47], v[144:159]
    ds_read_b64_tr_b16 a[176:177], v78 offset:13920
    ds_read_b64_tr_b16 a[178:179], v78 offset:15072
    v_fma_f32 v58, v58, v64, v65
    v_fma_f32 v59, v59, v64, v65
    v_mfma_f32_32x32x16_bf16 v[160:175], a[136:139], v[40:43], v[160:175]
    ds_read_b64_tr_b16 a[180:181], v78 offset:13952
    ds_read_b64_tr_b16 a[182:183], v78 offset:15104
    v_cvt_pk_bf16_f32 v49, v58, v59
    v_lshlrev_b32 v60, 16, v34
    v_and_b32 v61, 0xffff0000, v34
    v_mfma_f32_32x32x16_bf16 v[176:191], a[136:139], v[44:47], v[176:191]
    ds_read_b64_tr_b16 a[184:185], v78 offset:13984
    ds_read_b64_tr_b16 a[186:187], v78 offset:15136
    v_fma_f32 v60, v60, v64, v65
    v_fma_f32 v61, v61, v64, v65
    v_mfma_f32_32x32x16_bf16 v[192:207], a[140:143], v[40:43], v[192:207]
    ds_read_b64_tr_b16 a[188:189], v78 offset:14016
    ds_read_b64_tr_b16 a[190:191], v78 offset:15168
    v_cvt_pk_bf16_f32 v50, v60, v61
    v_lshlrev_b32 v62, 16, v35
    v_mfma_f32_32x32x16_bf16 v[208:223], a[140:143], v[44:47], v[208:223]
    ds_read_b64_tr_b16 a[192:193], v78 offset:14048
    ds_read_b64_tr_b16 a[194:195], v78 offset:15200
    v_and_b32 v63, 0xffff0000, v35
    v_fma_f32 v62, v62, v64, v65
    v_mfma_f32_32x32x16_bf16 v[224:239], a[144:147], v[40:43], v[224:239]
    ds_read_b64_tr_b16 a[196:197], v78 offset:14080
    ds_read_b64_tr_b16 a[198:199], v78 offset:15232
    v_fma_f32 v63, v63, v64, v65
    v_cvt_pk_bf16_f32 v51, v62, v63
    v_mfma_f32_32x32x16_bf16 v[240:255], a[144:147], v[44:47], v[240:255]
    v_lshlrev_b32 v56, 16, v36
    v_and_b32 v57, 0xffff0000, v36
    v_fma_f32 v56, v56, v66, v67
    s_add_u32 s24, s23, 26624
    buffer_load_dwordx4 v[24:27], v81, s[16:19], s24 offen
    v_mfma_f32_32x32x16_bf16 a[0:15], a[148:151], v[40:43], a[0:15]
    v_fma_f32 v57, v57, v66, v67
    v_cvt_pk_bf16_f32 v52, v56, v57
    s_add_u32 s24, s23, 63488
    buffer_load_dwordx4 v[28:31], v81, s[16:19], s24 offen
    v_mfma_f32_32x32x16_bf16 a[16:31], a[148:151], v[44:47], a[16:31]
    v_lshlrev_b32 v58, 16, v37
    v_and_b32 v59, 0xffff0000, v37
    v_mfma_f32_32x32x16_bf16 a[32:47], a[152:155], v[40:43], a[32:47]
    v_fma_f32 v58, v58, v66, v67
    v_fma_f32 v59, v59, v66, v67
    v_mfma_f32_32x32x16_bf16 a[48:63], a[152:155], v[44:47], a[48:63]
    v_cvt_pk_bf16_f32 v53, v58, v59
    v_lshlrev_b32 v60, 16, v38
    v_and_b32 v61, 0xffff0000, v38
    v_mfma_f32_32x32x16_bf16 a[64:79], a[156:159], v[40:43], a[64:79]
    v_fma_f32 v60, v60, v66, v67
    v_fma_f32 v61, v61, v66, v67
    v_mfma_f32_32x32x16_bf16 a[80:95], a[156:159], v[44:47], a[80:95]
    v_cvt_pk_bf16_f32 v54, v60, v61
    v_lshlrev_b32 v62, 16, v39
    v_mfma_f32_32x32x16_bf16 a[96:111], a[160:163], v[40:43], a[96:111]
    v_and_b32 v63, 0xffff0000, v39
    v_fma_f32 v62, v62, v66, v67
    v_mfma_f32_32x32x16_bf16 a[112:127], a[160:163], v[44:47], a[112:127]
    v_fma_f32 v63, v63, v66, v67
    v_cvt_pk_bf16_f32 v55, v62, v63
    s_waitcnt lgkmcnt(0)
    s_barrier
    s_waitcnt vmcnt(10)
    v_mfma_f32_32x32x16_bf16 v[96:111], a[164:167], v[48:51], v[96:111]
    ds_read_b64_tr_b16 a[128:129], v79 offset:0
    ds_read_b64_tr_b16 a[130:131], v79 offset:1152
    v_lshlrev_b32 v56, 16, v8
    v_and_b32 v57, 0xffff0000, v8
    v_fma_f32 v56, v56, v64, v65
    v_mfma_f32_32x32x16_bf16 v[112:127], a[164:167], v[52:55], v[112:127]
    ds_read_b64_tr_b16 a[132:133], v79 offset:32
    ds_read_b64_tr_b16 a[134:135], v79 offset:1184
    v_fma_f32 v57, v57, v64, v65
    v_cvt_pk_bf16_f32 v40, v56, v57
    v_mfma_f32_32x32x16_bf16 v[128:143], a[168:171], v[48:51], v[128:143]
    ds_read_b64_tr_b16 a[136:137], v79 offset:64
    ds_read_b64_tr_b16 a[138:139], v79 offset:1216
    v_lshlrev_b32 v58, 16, v9
    v_and_b32 v59, 0xffff0000, v9
    v_mfma_f32_32x32x16_bf16 v[144:159], a[168:171], v[52:55], v[144:159]
    ds_read_b64_tr_b16 a[140:141], v79 offset:96
    ds_read_b64_tr_b16 a[142:143], v79 offset:1248
    v_fma_f32 v58, v58, v64, v65
    v_fma_f32 v59, v59, v64, v65
    v_mfma_f32_32x32x16_bf16 v[160:175], a[172:175], v[48:51], v[160:175]
    ds_read_b64_tr_b16 a[144:145], v79 offset:128
    ds_read_b64_tr_b16 a[146:147], v79 offset:1280
    v_cvt_pk_bf16_f32 v41, v58, v59
    v_lshlrev_b32 v60, 16, v10
    v_and_b32 v61, 0xffff0000, v10
    v_mfma_f32_32x32x16_bf16 v[176:191], a[172:175], v[52:55], v[176:191]
    ds_read_b64_tr_b16 a[148:149], v79 offset:160
    ds_read_b64_tr_b16 a[150:151], v79 offset:1312
    v_fma_f32 v60, v60, v64, v65
    v_fma_f32 v61, v61, v64, v65
    v_mfma_f32_32x32x16_bf16 v[192:207], a[176:179], v[48:51], v[192:207]
    ds_read_b64_tr_b16 a[152:153], v79 offset:192
    ds_read_b64_tr_b16 a[154:155], v79 offset:1344
    v_cvt_pk_bf16_f32 v42, v60, v61
    v_lshlrev_b32 v62, 16, v11
    v_mfma_f32_32x32x16_bf16 v[208:223], a[176:179], v[52:55], v[208:223]
    ds_read_b64_tr_b16 a[156:157], v79 offset:224
    ds_read_b64_tr_b16 a[158:159], v79 offset:1376
    v_and_b32 v63, 0xffff0000, v11
    v_fma_f32 v62, v62, v64, v65
    v_mfma_f32_32x32x16_bf16 v[224:239], a[180:183], v[48:51], v[224:239]
    ds_read_b64_tr_b16 a[160:161], v79 offset:256
    ds_read_b64_tr_b16 a[162:163], v79 offset:1408
    v_fma_f32 v63, v63, v64, v65
    v_cvt_pk_bf16_f32 v43, v62, v63
    v_mfma_f32_32x32x16_bf16 v[240:255], a[180:183], v[52:55], v[240:255]
    v_lshlrev_b32 v56, 16, v12
    v_and_b32 v57, 0xffff0000, v12
    v_fma_f32 v56, v56, v66, v67
    s_add_u32 s24, s23, 27648
    buffer_load_dwordx4 v[32:35], v81, s[16:19], s24 offen
    v_mfma_f32_32x32x16_bf16 a[0:15], a[184:187], v[48:51], a[0:15]
    v_fma_f32 v57, v57, v66, v67
    v_cvt_pk_bf16_f32 v44, v56, v57
    s_add_u32 s24, s23, 64512
    buffer_load_dwordx4 v[36:39], v81, s[16:19], s24 offen
    v_mfma_f32_32x32x16_bf16 a[16:31], a[184:187], v[52:55], a[16:31]
    v_lshlrev_b32 v58, 16, v13
    v_and_b32 v59, 0xffff0000, v13
    v_mfma_f32_32x32x16_bf16 a[32:47], a[188:191], v[48:51], a[32:47]
    v_fma_f32 v58, v58, v66, v67
    v_fma_f32 v59, v59, v66, v67
    s_add_u32 m0, s27, 0
    s_add_u32 s33, s26, 4718592
    buffer_load_dwordx4 v68, s[12:15], s33 offen lds
    v_mfma_f32_32x32x16_bf16 a[48:63], a[188:191], v[52:55], a[48:63]
    v_cvt_pk_bf16_f32 v45, v58, v59
    v_lshlrev_b32 v60, 16, v14
    v_and_b32 v61, 0xffff0000, v14
    v_mfma_f32_32x32x16_bf16 a[64:79], a[192:195], v[48:51], a[64:79]
    v_fma_f32 v60, v60, v66, v67
    v_fma_f32 v61, v61, v66, v67
    s_add_u32 m0, s27, 1024
    s_nop 0
    buffer_load_dwordx4 v69, s[12:15], s33 offen lds
    v_mfma_f32_32x32x16_bf16 a[80:95], a[192:195], v[52:55], a[80:95]
    v_cvt_pk_bf16_f32 v46, v60, v61
    v_lshlrev_b32 v62, 16, v15
    v_mfma_f32_32x32x16_bf16 a[96:111], a[196:199], v[48:51], a[96:111]
    v_and_b32 v63, 0xffff0000, v15
    v_fma_f32 v62, v62, v66, v67
    s_add_u32 m0, s27, 2048
    s_nop 0
    buffer_load_dwordx4 v70, s[12:15], s33 offen lds
    v_mfma_f32_32x32x16_bf16 a[112:127], a[196:199], v[52:55], a[112:127]
    v_fma_f32 v63, v63, v66, v67
    v_cvt_pk_bf16_f32 v47, v62, v63
    s_waitcnt lgkmcnt(0)
    s_waitcnt vmcnt(10)
    v_mfma_f32_32x32x16_bf16 v[96:111], a[128:131], v[40:43], v[96:111]
    ds_read_b64_tr_b16 a[164:165], v79 offset:4608
    ds_read_b64_tr_b16 a[166:167], v79 offset:5760
    v_lshlrev_b32 v56, 16, v16
    v_and_b32 v57, 0xffff0000, v16
    v_fma_f32 v56, v56, v64, v65
    v_mfma_f32_32x32x16_bf16 v[112:127], a[128:131], v[44:47], v[112:127]
    ds_read_b64_tr_b16 a[168:169], v79 offset:4640
    ds_read_b64_tr_b16 a[170:171], v79 offset:5792
    v_fma_f32 v57, v57, v64, v65
    v_cvt_pk_bf16_f32 v48, v56, v57
    v_mfma_f32_32x32x16_bf16 v[128:143], a[132:135], v[40:43], v[128:143]
    ds_read_b64_tr_b16 a[172:173], v79 offset:4672
    ds_read_b64_tr_b16 a[174:175], v79 offset:5824
    v_lshlrev_b32 v58, 16, v17
    v_and_b32 v59, 0xffff0000, v17
    v_mfma_f32_32x32x16_bf16 v[144:159], a[132:135], v[44:47], v[144:159]
    ds_read_b64_tr_b16 a[176:177], v79 offset:4704
    ds_read_b64_tr_b16 a[178:179], v79 offset:5856
    v_fma_f32 v58, v58, v64, v65
    v_fma_f32 v59, v59, v64, v65
    v_mfma_f32_32x32x16_bf16 v[160:175], a[136:139], v[40:43], v[160:175]
    ds_read_b64_tr_b16 a[180:181], v79 offset:4736
    ds_read_b64_tr_b16 a[182:183], v79 offset:5888
    v_cvt_pk_bf16_f32 v49, v58, v59
    v_lshlrev_b32 v60, 16, v18
    v_and_b32 v61, 0xffff0000, v18
    v_mfma_f32_32x32x16_bf16 v[176:191], a[136:139], v[44:47], v[176:191]
    ds_read_b64_tr_b16 a[184:185], v79 offset:4768
    ds_read_b64_tr_b16 a[186:187], v79 offset:5920
    v_fma_f32 v60, v60, v64, v65
    v_fma_f32 v61, v61, v64, v65
    v_mfma_f32_32x32x16_bf16 v[192:207], a[140:143], v[40:43], v[192:207]
    ds_read_b64_tr_b16 a[188:189], v79 offset:4800
    ds_read_b64_tr_b16 a[190:191], v79 offset:5952
    v_cvt_pk_bf16_f32 v50, v60, v61
    v_lshlrev_b32 v62, 16, v19
    v_mfma_f32_32x32x16_bf16 v[208:223], a[140:143], v[44:47], v[208:223]
    ds_read_b64_tr_b16 a[192:193], v79 offset:4832
    ds_read_b64_tr_b16 a[194:195], v79 offset:5984
    v_and_b32 v63, 0xffff0000, v19
    v_fma_f32 v62, v62, v64, v65
    v_mfma_f32_32x32x16_bf16 v[224:239], a[144:147], v[40:43], v[224:239]
    ds_read_b64_tr_b16 a[196:197], v79 offset:4864
    ds_read_b64_tr_b16 a[198:199], v79 offset:6016
    v_fma_f32 v63, v63, v64, v65
    v_cvt_pk_bf16_f32 v51, v62, v63
    v_mfma_f32_32x32x16_bf16 v[240:255], a[144:147], v[44:47], v[240:255]
    v_lshlrev_b32 v56, 16, v20
    v_and_b32 v57, 0xffff0000, v20
    v_fma_f32 v56, v56, v66, v67
    s_add_u32 s24, s23, 28672
    buffer_load_dwordx4 v[8:11], v81, s[16:19], s24 offen
    v_mfma_f32_32x32x16_bf16 a[0:15], a[148:151], v[40:43], a[0:15]
    v_fma_f32 v57, v57, v66, v67
    v_cvt_pk_bf16_f32 v52, v56, v57
    s_add_u32 s24, s23, 65536
    buffer_load_dwordx4 v[12:15], v81, s[16:19], s24 offen
    v_mfma_f32_32x32x16_bf16 a[16:31], a[148:151], v[44:47], a[16:31]
    v_lshlrev_b32 v58, 16, v21
    v_and_b32 v59, 0xffff0000, v21
    v_mfma_f32_32x32x16_bf16 a[32:47], a[152:155], v[40:43], a[32:47]
    v_fma_f32 v58, v58, v66, v67
    v_fma_f32 v59, v59, v66, v67
    s_add_u32 m0, s27, 3072
    s_nop 0
    buffer_load_dwordx4 v71, s[12:15], s33 offen lds
    v_mfma_f32_32x32x16_bf16 a[48:63], a[152:155], v[44:47], a[48:63]
    v_cvt_pk_bf16_f32 v53, v58, v59
    v_lshlrev_b32 v60, 16, v22
    v_and_b32 v61, 0xffff0000, v22
    v_mfma_f32_32x32x16_bf16 a[64:79], a[156:159], v[40:43], a[64:79]
    v_fma_f32 v60, v60, v66, v67
    v_fma_f32 v61, v61, v66, v67
    s_add_u32 m0, s27, 4096
    s_nop 0
    buffer_load_dwordx4 v72, s[12:15], s33 offen lds
    v_mfma_f32_32x32x16_bf16 a[80:95], a[156:159], v[44:47], a[80:95]
    v_cvt_pk_bf16_f32 v54, v60, v61
    v_lshlrev_b32 v62, 16, v23
    v_mfma_f32_32x32x16_bf16 a[96:111], a[160:163], v[40:43], a[96:111]
    v_and_b32 v63, 0xffff0000, v23
    v_fma_f32 v62, v62, v66, v67
    s_add_u32 m0, s27, 5120
    s_nop 0
    buffer_load_dwordx4 v73, s[12:15], s33 offen lds
    v_mfma_f32_32x32x16_bf16 a[112:127], a[160:163], v[44:47], a[112:127]
    v_fma_f32 v63, v63, v66, v67
    v_cvt_pk_bf16_f32 v55, v62, v63
    s_waitcnt lgkmcnt(0)
    s_waitcnt vmcnt(10)
    v_mfma_f32_32x32x16_bf16 v[96:111], a[164:167], v[48:51], v[96:111]
    ds_read_b64_tr_b16 a[128:129], v79 offset:9216
    ds_read_b64_tr_b16 a[130:131], v79 offset:10368
    v_lshlrev_b32 v56, 16, v24
    v_and_b32 v57, 0xffff0000, v24
    v_fma_f32 v56, v56, v64, v65
    v_mfma_f32_32x32x16_bf16 v[112:127], a[164:167], v[52:55], v[112:127]
    ds_read_b64_tr_b16 a[132:133], v79 offset:9248
    ds_read_b64_tr_b16 a[134:135], v79 offset:10400
    v_fma_f32 v57, v57, v64, v65
    v_cvt_pk_bf16_f32 v40, v56, v57
    v_mfma_f32_32x32x16_bf16 v[128:143], a[168:171], v[48:51], v[128:143]
    ds_read_b64_tr_b16 a[136:137], v79 offset:9280
    ds_read_b64_tr_b16 a[138:139], v79 offset:10432
    v_lshlrev_b32 v58, 16, v25
    v_and_b32 v59, 0xffff0000, v25
    v_mfma_f32_32x32x16_bf16 v[144:159], a[168:171], v[52:55], v[144:159]
    ds_read_b64_tr_b16 a[140:141], v79 offset:9312
    ds_read_b64_tr_b16 a[142:143], v79 offset:10464
    v_fma_f32 v58, v58, v64, v65
    v_fma_f32 v59, v59, v64, v65
    v_mfma_f32_32x32x16_bf16 v[160:175], a[172:175], v[48:51], v[160:175]
    ds_read_b64_tr_b16 a[144:145], v79 offset:9344
    ds_read_b64_tr_b16 a[146:147], v79 offset:10496
    v_cvt_pk_bf16_f32 v41, v58, v59
    v_lshlrev_b32 v60, 16, v26
    v_and_b32 v61, 0xffff0000, v26
    v_mfma_f32_32x32x16_bf16 v[176:191], a[172:175], v[52:55], v[176:191]
    ds_read_b64_tr_b16 a[148:149], v79 offset:9376
    ds_read_b64_tr_b16 a[150:151], v79 offset:10528
    v_fma_f32 v60, v60, v64, v65
    v_fma_f32 v61, v61, v64, v65
    v_mfma_f32_32x32x16_bf16 v[192:207], a[176:179], v[48:51], v[192:207]
    ds_read_b64_tr_b16 a[152:153], v79 offset:9408
    ds_read_b64_tr_b16 a[154:155], v79 offset:10560
    v_cvt_pk_bf16_f32 v42, v60, v61
    v_lshlrev_b32 v62, 16, v27
    v_mfma_f32_32x32x16_bf16 v[208:223], a[176:179], v[52:55], v[208:223]
    ds_read_b64_tr_b16 a[156:157], v79 offset:9440
    ds_read_b64_tr_b16 a[158:159], v79 offset:10592
    v_and_b32 v63, 0xffff0000, v27
    v_fma_f32 v62, v62, v64, v65
    v_mfma_f32_32x32x16_bf16 v[224:239], a[180:183], v[48:51], v[224:239]
    ds_read_b64_tr_b16 a[160:161], v79 offset:9472
    ds_read_b64_tr_b16 a[162:163], v79 offset:10624
    v_fma_f32 v63, v63, v64, v65
    v_cvt_pk_bf16_f32 v43, v62, v63
    v_mfma_f32_32x32x16_bf16 v[240:255], a[180:183], v[52:55], v[240:255]
    v_lshlrev_b32 v56, 16, v28
    v_and_b32 v57, 0xffff0000, v28
    v_fma_f32 v56, v56, v66, v67
    s_add_u32 s24, s23, 29696
    buffer_load_dwordx4 v[16:19], v81, s[16:19], s24 offen
    v_mfma_f32_32x32x16_bf16 a[0:15], a[184:187], v[48:51], a[0:15]
    v_fma_f32 v57, v57, v66, v67
    v_cvt_pk_bf16_f32 v44, v56, v57
    s_add_u32 s24, s23, 66560
    buffer_load_dwordx4 v[20:23], v81, s[16:19], s24 offen
    v_mfma_f32_32x32x16_bf16 a[16:31], a[184:187], v[52:55], a[16:31]
    v_lshlrev_b32 v58, 16, v29
    v_and_b32 v59, 0xffff0000, v29
    v_mfma_f32_32x32x16_bf16 a[32:47], a[188:191], v[48:51], a[32:47]
    v_fma_f32 v58, v58, v66, v67
    v_fma_f32 v59, v59, v66, v67
    s_add_u32 m0, s27, 6144
    s_nop 0
    buffer_load_dwordx4 v74, s[12:15], s33 offen lds
    v_mfma_f32_32x32x16_bf16 a[48:63], a[188:191], v[52:55], a[48:63]
    v_cvt_pk_bf16_f32 v45, v58, v59
    v_lshlrev_b32 v60, 16, v30
    v_and_b32 v61, 0xffff0000, v30
    v_mfma_f32_32x32x16_bf16 a[64:79], a[192:195], v[48:51], a[64:79]
    v_fma_f32 v60, v60, v66, v67
    v_fma_f32 v61, v61, v66, v67
    s_add_u32 m0, s27, 7168
    s_nop 0
    buffer_load_dwordx4 v75, s[12:15], s33 offen lds
    v_mfma_f32_32x32x16_bf16 a[80:95], a[192:195], v[52:55], a[80:95]
    v_cvt_pk_bf16_f32 v46, v60, v61
    v_lshlrev_b32 v62, 16, v31
    v_mfma_f32_32x32x16_bf16 a[96:111], a[196:199], v[48:51], a[96:111]
    v_and_b32 v63, 0xffff0000, v31
    v_fma_f32 v62, v62, v66, v67
    s_add_u32 m0, s27, 8192
    s_nop 0
    buffer_load_dwordx4 v76, s[12:15], s33 offen lds
    v_mfma_f32_32x32x16_bf16 a[112:127], a[196:199], v[52:55], a[112:127]
    v_fma_f32 v63, v63, v66, v67
    v_cvt_pk_bf16_f32 v47, v62, v63
    s_waitcnt lgkmcnt(0)
    s_waitcnt vmcnt(13)
    v_mfma_f32_32x32x16_bf16 v[96:111], a[128:131], v[40:43], v[96:111]
    ds_read_b64_tr_b16 a[164:165], v79 offset:13824
    ds_read_b64_tr_b16 a[166:167], v79 offset:14976
    v_lshlrev_b32 v56, 16, v32
    v_and_b32 v57, 0xffff0000, v32
    v_fma_f32 v56, v56, v64, v65
    v_mfma_f32_32x32x16_bf16 v[112:127], a[128:131], v[44:47], v[112:127]
    ds_read_b64_tr_b16 a[168:169], v79 offset:13856
    ds_read_b64_tr_b16 a[170:171], v79 offset:15008
    v_fma_f32 v57, v57, v64, v65
    v_cvt_pk_bf16_f32 v48, v56, v57
    v_mfma_f32_32x32x16_bf16 v[128:143], a[132:135], v[40:43], v[128:143]
    ds_read_b64_tr_b16 a[172:173], v79 offset:13888
    ds_read_b64_tr_b16 a[174:175], v79 offset:15040
    v_lshlrev_b32 v58, 16, v33
    v_and_b32 v59, 0xffff0000, v33
    v_mfma_f32_32x32x16_bf16 v[144:159], a[132:135], v[44:47], v[144:159]
    ds_read_b64_tr_b16 a[176:177], v79 offset:13920
    ds_read_b64_tr_b16 a[178:179], v79 offset:15072
    v_fma_f32 v58, v58, v64, v65
    v_fma_f32 v59, v59, v64, v65
    v_mfma_f32_32x32x16_bf16 v[160:175], a[136:139], v[40:43], v[160:175]
    ds_read_b64_tr_b16 a[180:181], v79 offset:13952
    ds_read_b64_tr_b16 a[182:183], v79 offset:15104
    v_cvt_pk_bf16_f32 v49, v58, v59
    v_lshlrev_b32 v60, 16, v34
    v_and_b32 v61, 0xffff0000, v34
    v_mfma_f32_32x32x16_bf16 v[176:191], a[136:139], v[44:47], v[176:191]
    ds_read_b64_tr_b16 a[184:185], v79 offset:13984
    ds_read_b64_tr_b16 a[186:187], v79 offset:15136
    v_fma_f32 v60, v60, v64, v65
    v_fma_f32 v61, v61, v64, v65
    v_mfma_f32_32x32x16_bf16 v[192:207], a[140:143], v[40:43], v[192:207]
    ds_read_b64_tr_b16 a[188:189], v79 offset:14016
    ds_read_b64_tr_b16 a[190:191], v79 offset:15168
    v_cvt_pk_bf16_f32 v50, v60, v61
    v_lshlrev_b32 v62, 16, v35
    v_mfma_f32_32x32x16_bf16 v[208:223], a[140:143], v[44:47], v[208:223]
    ds_read_b64_tr_b16 a[192:193], v79 offset:14048
    ds_read_b64_tr_b16 a[194:195], v79 offset:15200
    v_and_b32 v63, 0xffff0000, v35
    v_fma_f32 v62, v62, v64, v65
    v_mfma_f32_32x32x16_bf16 v[224:239], a[144:147], v[40:43], v[224:239]
    ds_read_b64_tr_b16 a[196:197], v79 offset:14080
    ds_read_b64_tr_b16 a[198:199], v79 offset:15232
    v_fma_f32 v63, v63, v64, v65
    v_cvt_pk_bf16_f32 v51, v62, v63
    v_mfma_f32_32x32x16_bf16 v[240:255], a[144:147], v[44:47], v[240:255]
    v_lshlrev_b32 v56, 16, v36
    v_and_b32 v57, 0xffff0000, v36
    v_fma_f32 v56, v56, v66, v67
    s_add_u32 s24, s23, 30720
    buffer_load_dwordx4 v[24:27], v81, s[16:19], s24 offen
    v_mfma_f32_32x32x16_bf16 a[0:15], a[148:151], v[40:43], a[0:15]
    v_fma_f32 v57, v57, v66, v67
    v_cvt_pk_bf16_f32 v52, v56, v57
    s_add_u32 s24, s23, 67584
    buffer_load_dwordx4 v[28:31], v81, s[16:19], s24 offen
    v_mfma_f32_32x32x16_bf16 a[16:31], a[148:151], v[44:47], a[16:31]
    v_lshlrev_b32 v58, 16, v37
    v_and_b32 v59, 0xffff0000, v37
    v_mfma_f32_32x32x16_bf16 a[32:47], a[152:155], v[40:43], a[32:47]
    v_fma_f32 v58, v58, v66, v67
    v_fma_f32 v59, v59, v66, v67
    v_mfma_f32_32x32x16_bf16 a[48:63], a[152:155], v[44:47], a[48:63]
    v_cvt_pk_bf16_f32 v53, v58, v59
    v_lshlrev_b32 v60, 16, v38
    v_and_b32 v61, 0xffff0000, v38
    v_mfma_f32_32x32x16_bf16 a[64:79], a[156:159], v[40:43], a[64:79]
    v_fma_f32 v60, v60, v66, v67
    v_fma_f32 v61, v61, v66, v67
    v_mfma_f32_32x32x16_bf16 a[80:95], a[156:159], v[44:47], a[80:95]
    v_cvt_pk_bf16_f32 v54, v60, v61
    v_lshlrev_b32 v62, 16, v39
    v_mfma_f32_32x32x16_bf16 a[96:111], a[160:163], v[40:43], a[96:111]
    v_and_b32 v63, 0xffff0000, v39
    v_fma_f32 v62, v62, v66, v67
    v_mfma_f32_32x32x16_bf16 a[112:127], a[160:163], v[44:47], a[112:127]
    v_fma_f32 v63, v63, v66, v67
    v_cvt_pk_bf16_f32 v55, v62, v63
    s_waitcnt lgkmcnt(0)
    s_barrier
    s_waitcnt vmcnt(10)
    v_mfma_f32_32x32x16_bf16 v[96:111], a[164:167], v[48:51], v[96:111]
    ds_read_b64_tr_b16 a[128:129], v80 offset:0
    ds_read_b64_tr_b16 a[130:131], v80 offset:1152
    v_lshlrev_b32 v56, 16, v8
    v_and_b32 v57, 0xffff0000, v8
    v_fma_f32 v56, v56, v64, v65
    v_mfma_f32_32x32x16_bf16 v[112:127], a[164:167], v[52:55], v[112:127]
    ds_read_b64_tr_b16 a[132:133], v80 offset:32
    ds_read_b64_tr_b16 a[134:135], v80 offset:1184
    v_fma_f32 v57, v57, v64, v65
    v_cvt_pk_bf16_f32 v40, v56, v57
    v_mfma_f32_32x32x16_bf16 v[128:143], a[168:171], v[48:51], v[128:143]
    ds_read_b64_tr_b16 a[136:137], v80 offset:64
    ds_read_b64_tr_b16 a[138:139], v80 offset:1216
    v_lshlrev_b32 v58, 16, v9
    v_and_b32 v59, 0xffff0000, v9
    v_mfma_f32_32x32x16_bf16 v[144:159], a[168:171], v[52:55], v[144:159]
    ds_read_b64_tr_b16 a[140:141], v80 offset:96
    ds_read_b64_tr_b16 a[142:143], v80 offset:1248
    v_fma_f32 v58, v58, v64, v65
    v_fma_f32 v59, v59, v64, v65
    v_mfma_f32_32x32x16_bf16 v[160:175], a[172:175], v[48:51], v[160:175]
    ds_read_b64_tr_b16 a[144:145], v80 offset:128
    ds_read_b64_tr_b16 a[146:147], v80 offset:1280
    v_cvt_pk_bf16_f32 v41, v58, v59
    v_lshlrev_b32 v60, 16, v10
    v_and_b32 v61, 0xffff0000, v10
    v_mfma_f32_32x32x16_bf16 v[176:191], a[172:175], v[52:55], v[176:191]
    ds_read_b64_tr_b16 a[148:149], v80 offset:160
    ds_read_b64_tr_b16 a[150:151], v80 offset:1312
    v_fma_f32 v60, v60, v64, v65
    v_fma_f32 v61, v61, v64, v65
    v_mfma_f32_32x32x16_bf16 v[192:207], a[176:179], v[48:51], v[192:207]
    ds_read_b64_tr_b16 a[152:153], v80 offset:192
    ds_read_b64_tr_b16 a[154:155], v80 offset:1344
    v_cvt_pk_bf16_f32 v42, v60, v61
    v_lshlrev_b32 v62, 16, v11
    v_mfma_f32_32x32x16_bf16 v[208:223], a[176:179], v[52:55], v[208:223]
    ds_read_b64_tr_b16 a[156:157], v80 offset:224
    ds_read_b64_tr_b16 a[158:159], v80 offset:1376
    v_and_b32 v63, 0xffff0000, v11
    v_fma_f32 v62, v62, v64, v65
    v_mfma_f32_32x32x16_bf16 v[224:239], a[180:183], v[48:51], v[224:239]
    ds_read_b64_tr_b16 a[160:161], v80 offset:256
    ds_read_b64_tr_b16 a[162:163], v80 offset:1408
    v_fma_f32 v63, v63, v64, v65
    v_cvt_pk_bf16_f32 v43, v62, v63
    v_mfma_f32_32x32x16_bf16 v[240:255], a[180:183], v[52:55], v[240:255]
    v_lshlrev_b32 v56, 16, v12
    v_and_b32 v57, 0xffff0000, v12
    v_fma_f32 v56, v56, v66, v67
    s_add_u32 s24, s23, 31744
    buffer_load_dwordx4 v[32:35], v81, s[16:19], s24 offen
    v_mfma_f32_32x32x16_bf16 a[0:15], a[184:187], v[48:51], a[0:15]
    v_fma_f32 v57, v57, v66, v67
    v_cvt_pk_bf16_f32 v44, v56, v57
    s_add_u32 s24, s23, 68608
    buffer_load_dwordx4 v[36:39], v81, s[16:19], s24 offen
    v_mfma_f32_32x32x16_bf16 a[16:31], a[184:187], v[52:55], a[16:31]
    v_lshlrev_b32 v58, 16, v13
    v_and_b32 v59, 0xffff0000, v13
    v_mfma_f32_32x32x16_bf16 a[32:47], a[188:191], v[48:51], a[32:47]
    v_fma_f32 v58, v58, v66, v67
    v_fma_f32 v59, v59, v66, v67
    v_mfma_f32_32x32x16_bf16 a[48:63], a[188:191], v[52:55], a[48:63]
    v_cvt_pk_bf16_f32 v45, v58, v59
    v_lshlrev_b32 v60, 16, v14
    v_and_b32 v61, 0xffff0000, v14
    v_mfma_f32_32x32x16_bf16 a[64:79], a[192:195], v[48:51], a[64:79]
    v_fma_f32 v60, v60, v66, v67
    v_fma_f32 v61, v61, v66, v67
    v_mfma_f32_32x32x16_bf16 a[80:95], a[192:195], v[52:55], a[80:95]
    v_cvt_pk_bf16_f32 v46, v60, v61
    v_lshlrev_b32 v62, 16, v15
    v_mfma_f32_32x32x16_bf16 a[96:111], a[196:199], v[48:51], a[96:111]
    v_and_b32 v63, 0xffff0000, v15
    v_fma_f32 v62, v62, v66, v67
    v_mfma_f32_32x32x16_bf16 a[112:127], a[196:199], v[52:55], a[112:127]
    v_fma_f32 v63, v63, v66, v67
    v_cvt_pk_bf16_f32 v47, v62, v63
    s_waitcnt lgkmcnt(0)
    s_waitcnt vmcnt(7)
    v_mfma_f32_32x32x16_bf16 v[96:111], a[128:131], v[40:43], v[96:111]
    ds_read_b64_tr_b16 a[164:165], v80 offset:4608
    ds_read_b64_tr_b16 a[166:167], v80 offset:5760
    v_lshlrev_b32 v56, 16, v16
    v_and_b32 v57, 0xffff0000, v16
    v_fma_f32 v56, v56, v64, v65
    v_mfma_f32_32x32x16_bf16 v[112:127], a[128:131], v[44:47], v[112:127]
    ds_read_b64_tr_b16 a[168:169], v80 offset:4640
    ds_read_b64_tr_b16 a[170:171], v80 offset:5792
    v_fma_f32 v57, v57, v64, v65
    v_cvt_pk_bf16_f32 v48, v56, v57
    v_mfma_f32_32x32x16_bf16 v[128:143], a[132:135], v[40:43], v[128:143]
    ds_read_b64_tr_b16 a[172:173], v80 offset:4672
    ds_read_b64_tr_b16 a[174:175], v80 offset:5824
    v_lshlrev_b32 v58, 16, v17
    v_and_b32 v59, 0xffff0000, v17
    v_mfma_f32_32x32x16_bf16 v[144:159], a[132:135], v[44:47], v[144:159]
    ds_read_b64_tr_b16 a[176:177], v80 offset:4704
    ds_read_b64_tr_b16 a[178:179], v80 offset:5856
    v_fma_f32 v58, v58, v64, v65
    v_fma_f32 v59, v59, v64, v65
    v_mfma_f32_32x32x16_bf16 v[160:175], a[136:139], v[40:43], v[160:175]
    ds_read_b64_tr_b16 a[180:181], v80 offset:4736
    ds_read_b64_tr_b16 a[182:183], v80 offset:5888
    v_cvt_pk_bf16_f32 v49, v58, v59
    v_lshlrev_b32 v60, 16, v18
    v_and_b32 v61, 0xffff0000, v18
    v_mfma_f32_32x32x16_bf16 v[176:191], a[136:139], v[44:47], v[176:191]
    ds_read_b64_tr_b16 a[184:185], v80 offset:4768
    ds_read_b64_tr_b16 a[186:187], v80 offset:5920
    v_fma_f32 v60, v60, v64, v65
    v_fma_f32 v61, v61, v64, v65
    v_mfma_f32_32x32x16_bf16 v[192:207], a[140:143], v[40:43], v[192:207]
    ds_read_b64_tr_b16 a[188:189], v80 offset:4800
    ds_read_b64_tr_b16 a[190:191], v80 offset:5952
    v_cvt_pk_bf16_f32 v50, v60, v61
    v_lshlrev_b32 v62, 16, v19
    v_mfma_f32_32x32x16_bf16 v[208:223], a[140:143], v[44:47], v[208:223]
    ds_read_b64_tr_b16 a[192:193], v80 offset:4832
    ds_read_b64_tr_b16 a[194:195], v80 offset:5984
    v_and_b32 v63, 0xffff0000, v19
    v_fma_f32 v62, v62, v64, v65
    v_mfma_f32_32x32x16_bf16 v[224:239], a[144:147], v[40:43], v[224:239]
    ds_read_b64_tr_b16 a[196:197], v80 offset:4864
    ds_read_b64_tr_b16 a[198:199], v80 offset:6016
    v_fma_f32 v63, v63, v64, v65
    v_cvt_pk_bf16_f32 v51, v62, v63
    v_mfma_f32_32x32x16_bf16 v[240:255], a[144:147], v[44:47], v[240:255]
    v_lshlrev_b32 v56, 16, v20
    v_and_b32 v57, 0xffff0000, v20
    v_fma_f32 v56, v56, v66, v67
    s_add_u32 s24, s23, 32768
    buffer_load_dwordx4 v[8:11], v81, s[16:19], s24 offen
    v_mfma_f32_32x32x16_bf16 a[0:15], a[148:151], v[40:43], a[0:15]
    v_fma_f32 v57, v57, v66, v67
    v_cvt_pk_bf16_f32 v52, v56, v57
    s_add_u32 s24, s23, 69632
    buffer_load_dwordx4 v[12:15], v81, s[16:19], s24 offen
    v_mfma_f32_32x32x16_bf16 a[16:31], a[148:151], v[44:47], a[16:31]
    v_lshlrev_b32 v58, 16, v21
    v_and_b32 v59, 0xffff0000, v21
    v_mfma_f32_32x32x16_bf16 a[32:47], a[152:155], v[40:43], a[32:47]
    v_fma_f32 v58, v58, v66, v67
    v_fma_f32 v59, v59, v66, v67
    v_mfma_f32_32x32x16_bf16 a[48:63], a[152:155], v[44:47], a[48:63]
    v_cvt_pk_bf16_f32 v53, v58, v59
    v_lshlrev_b32 v60, 16, v22
    v_and_b32 v61, 0xffff0000, v22
    v_mfma_f32_32x32x16_bf16 a[64:79], a[156:159], v[40:43], a[64:79]
    v_fma_f32 v60, v60, v66, v67
    v_fma_f32 v61, v61, v66, v67
    v_mfma_f32_32x32x16_bf16 a[80:95], a[156:159], v[44:47], a[80:95]
    v_cvt_pk_bf16_f32 v54, v60, v61
    v_lshlrev_b32 v62, 16, v23
    v_mfma_f32_32x32x16_bf16 a[96:111], a[160:163], v[40:43], a[96:111]
    v_and_b32 v63, 0xffff0000, v23
    v_fma_f32 v62, v62, v66, v67
    v_mfma_f32_32x32x16_bf16 a[112:127], a[160:163], v[44:47], a[112:127]
    v_fma_f32 v63, v63, v66, v67
    v_cvt_pk_bf16_f32 v55, v62, v63
    s_waitcnt lgkmcnt(0)
    s_waitcnt vmcnt(4)
    v_mfma_f32_32x32x16_bf16 v[96:111], a[164:167], v[48:51], v[96:111]
    ds_read_b64_tr_b16 a[128:129], v80 offset:9216
    ds_read_b64_tr_b16 a[130:131], v80 offset:10368
    v_lshlrev_b32 v56, 16, v24
    v_and_b32 v57, 0xffff0000, v24
    v_fma_f32 v56, v56, v64, v65
    v_mfma_f32_32x32x16_bf16 v[112:127], a[164:167], v[52:55], v[112:127]
    ds_read_b64_tr_b16 a[132:133], v80 offset:9248
    ds_read_b64_tr_b16 a[134:135], v80 offset:10400
    v_fma_f32 v57, v57, v64, v65
    v_cvt_pk_bf16_f32 v40, v56, v57
    v_mfma_f32_32x32x16_bf16 v[128:143], a[168:171], v[48:51], v[128:143]
    ds_read_b64_tr_b16 a[136:137], v80 offset:9280
    ds_read_b64_tr_b16 a[138:139], v80 offset:10432
    v_lshlrev_b32 v58, 16, v25
    v_and_b32 v59, 0xffff0000, v25
    v_mfma_f32_32x32x16_bf16 v[144:159], a[168:171], v[52:55], v[144:159]
    ds_read_b64_tr_b16 a[140:141], v80 offset:9312
    ds_read_b64_tr_b16 a[142:143], v80 offset:10464
    v_fma_f32 v58, v58, v64, v65
    v_fma_f32 v59, v59, v64, v65
    v_mfma_f32_32x32x16_bf16 v[160:175], a[172:175], v[48:51], v[160:175]
    ds_read_b64_tr_b16 a[144:145], v80 offset:9344
    ds_read_b64_tr_b16 a[146:147], v80 offset:10496
    v_cvt_pk_bf16_f32 v41, v58, v59
    v_lshlrev_b32 v60, 16, v26
    v_and_b32 v61, 0xffff0000, v26
    v_mfma_f32_32x32x16_bf16 v[176:191], a[172:175], v[52:55], v[176:191]
    ds_read_b64_tr_b16 a[148:149], v80 offset:9376
    ds_read_b64_tr_b16 a[150:151], v80 offset:10528
    v_fma_f32 v60, v60, v64, v65
    v_fma_f32 v61, v61, v64, v65
    v_mfma_f32_32x32x16_bf16 v[192:207], a[176:179], v[48:51], v[192:207]
    ds_read_b64_tr_b16 a[152:153], v80 offset:9408
    ds_read_b64_tr_b16 a[154:155], v80 offset:10560
    v_cvt_pk_bf16_f32 v42, v60, v61
    v_lshlrev_b32 v62, 16, v27
    v_mfma_f32_32x32x16_bf16 v[208:223], a[176:179], v[52:55], v[208:223]
    ds_read_b64_tr_b16 a[156:157], v80 offset:9440
    ds_read_b64_tr_b16 a[158:159], v80 offset:10592
    v_and_b32 v63, 0xffff0000, v27
    v_fma_f32 v62, v62, v64, v65
    v_mfma_f32_32x32x16_bf16 v[224:239], a[180:183], v[48:51], v[224:239]
    ds_read_b64_tr_b16 a[160:161], v80 offset:9472
    ds_read_b64_tr_b16 a[162:163], v80 offset:10624
    v_fma_f32 v63, v63, v64, v65
    v_cvt_pk_bf16_f32 v43, v62, v63
    v_mfma_f32_32x32x16_bf16 v[240:255], a[180:183], v[52:55], v[240:255]
    v_lshlrev_b32 v56, 16, v28
    v_and_b32 v57, 0xffff0000, v28
    v_fma_f32 v56, v56, v66, v67
    s_add_u32 s24, s23, 33792
    buffer_load_dwordx4 v[16:19], v81, s[16:19], s24 offen
    v_mfma_f32_32x32x16_bf16 a[0:15], a[184:187], v[48:51], a[0:15]
    v_fma_f32 v57, v57, v66, v67
    v_cvt_pk_bf16_f32 v44, v56, v57
    s_add_u32 s24, s23, 70656
    buffer_load_dwordx4 v[20:23], v81, s[16:19], s24 offen
    v_mfma_f32_32x32x16_bf16 a[16:31], a[184:187], v[52:55], a[16:31]
    v_lshlrev_b32 v58, 16, v29
    v_and_b32 v59, 0xffff0000, v29
    v_mfma_f32_32x32x16_bf16 a[32:47], a[188:191], v[48:51], a[32:47]
    v_fma_f32 v58, v58, v66, v67
    v_fma_f32 v59, v59, v66, v67
    v_mfma_f32_32x32x16_bf16 a[48:63], a[188:191], v[52:55], a[48:63]
    v_cvt_pk_bf16_f32 v45, v58, v59
    v_lshlrev_b32 v60, 16, v30
    v_and_b32 v61, 0xffff0000, v30
    v_mfma_f32_32x32x16_bf16 a[64:79], a[192:195], v[48:51], a[64:79]
    v_fma_f32 v60, v60, v66, v67
    v_fma_f32 v61, v61, v66, v67
    v_mfma_f32_32x32x16_bf16 a[80:95], a[192:195], v[52:55], a[80:95]
    v_cvt_pk_bf16_f32 v46, v60, v61
    v_lshlrev_b32 v62, 16, v31
    v_mfma_f32_32x32x16_bf16 a[96:111], a[196:199], v[48:51], a[96:111]
    v_and_b32 v63, 0xffff0000, v31
    v_fma_f32 v62, v62, v66, v67
    v_mfma_f32_32x32x16_bf16 a[112:127], a[196:199], v[52:55], a[112:127]
    v_fma_f32 v63, v63, v66, v67
    v_cvt_pk_bf16_f32 v47, v62, v63
    s_waitcnt lgkmcnt(0)
    s_waitcnt vmcnt(4)
    v_mfma_f32_32x32x16_bf16 v[96:111], a[128:131], v[40:43], v[96:111]
    ds_read_b64_tr_b16 a[164:165], v80 offset:13824
    ds_read_b64_tr_b16 a[166:167], v80 offset:14976
    v_lshlrev_b32 v56, 16, v32
    v_and_b32 v57, 0xffff0000, v32
    v_fma_f32 v56, v56, v64, v65
    v_mfma_f32_32x32x16_bf16 v[112:127], a[128:131], v[44:47], v[112:127]
    ds_read_b64_tr_b16 a[168:169], v80 offset:13856
    ds_read_b64_tr_b16 a[170:171], v80 offset:15008
    v_fma_f32 v57, v57, v64, v65
    v_cvt_pk_bf16_f32 v48, v56, v57
    v_mfma_f32_32x32x16_bf16 v[128:143], a[132:135], v[40:43], v[128:143]
    ds_read_b64_tr_b16 a[172:173], v80 offset:13888
    ds_read_b64_tr_b16 a[174:175], v80 offset:15040
    v_lshlrev_b32 v58, 16, v33
    v_and_b32 v59, 0xffff0000, v33
    v_mfma_f32_32x32x16_bf16 v[144:159], a[132:135], v[44:47], v[144:159]
    ds_read_b64_tr_b16 a[176:177], v80 offset:13920
    ds_read_b64_tr_b16 a[178:179], v80 offset:15072
    v_fma_f32 v58, v58, v64, v65
    v_fma_f32 v59, v59, v64, v65
    v_mfma_f32_32x32x16_bf16 v[160:175], a[136:139], v[40:43], v[160:175]
    ds_read_b64_tr_b16 a[180:181], v80 offset:13952
    ds_read_b64_tr_b16 a[182:183], v80 offset:15104
    v_cvt_pk_bf16_f32 v49, v58, v59
    v_lshlrev_b32 v60, 16, v34
    v_and_b32 v61, 0xffff0000, v34
    v_mfma_f32_32x32x16_bf16 v[176:191], a[136:139], v[44:47], v[176:191]
    ds_read_b64_tr_b16 a[184:185], v80 offset:13984
    ds_read_b64_tr_b16 a[186:187], v80 offset:15136
    v_fma_f32 v60, v60, v64, v65
    v_fma_f32 v61, v61, v64, v65
    v_mfma_f32_32x32x16_bf16 v[192:207], a[140:143], v[40:43], v[192:207]
    ds_read_b64_tr_b16 a[188:189], v80 offset:14016
    ds_read_b64_tr_b16 a[190:191], v80 offset:15168
    v_cvt_pk_bf16_f32 v50, v60, v61
    v_lshlrev_b32 v62, 16, v35
    v_mfma_f32_32x32x16_bf16 v[208:223], a[140:143], v[44:47], v[208:223]
    ds_read_b64_tr_b16 a[192:193], v80 offset:14048
    ds_read_b64_tr_b16 a[194:195], v80 offset:15200
    v_and_b32 v63, 0xffff0000, v35
    v_fma_f32 v62, v62, v64, v65
    v_mfma_f32_32x32x16_bf16 v[224:239], a[144:147], v[40:43], v[224:239]
    ds_read_b64_tr_b16 a[196:197], v80 offset:14080
    ds_read_b64_tr_b16 a[198:199], v80 offset:15232
    v_fma_f32 v63, v63, v64, v65
    v_cvt_pk_bf16_f32 v51, v62, v63
    v_mfma_f32_32x32x16_bf16 v[240:255], a[144:147], v[44:47], v[240:255]
    v_lshlrev_b32 v56, 16, v36
    v_and_b32 v57, 0xffff0000, v36
    v_fma_f32 v56, v56, v66, v67
    s_add_u32 s24, s23, 34816
    buffer_load_dwordx4 v[24:27], v81, s[16:19], s24 offen
    v_mfma_f32_32x32x16_bf16 a[0:15], a[148:151], v[40:43], a[0:15]
    v_fma_f32 v57, v57, v66, v67
    v_cvt_pk_bf16_f32 v52, v56, v57
    s_add_u32 s24, s23, 71680
    buffer_load_dwordx4 v[28:31], v81, s[16:19], s24 offen
    v_mfma_f32_32x32x16_bf16 a[16:31], a[148:151], v[44:47], a[16:31]
    v_lshlrev_b32 v58, 16, v37
    v_and_b32 v59, 0xffff0000, v37
    v_mfma_f32_32x32x16_bf16 a[32:47], a[152:155], v[40:43], a[32:47]
    v_fma_f32 v58, v58, v66, v67
    v_fma_f32 v59, v59, v66, v67
    v_mfma_f32_32x32x16_bf16 a[48:63], a[152:155], v[44:47], a[48:63]
    v_cvt_pk_bf16_f32 v53, v58, v59
    v_lshlrev_b32 v60, 16, v38
    v_and_b32 v61, 0xffff0000, v38
    v_mfma_f32_32x32x16_bf16 a[64:79], a[156:159], v[40:43], a[64:79]
    v_fma_f32 v60, v60, v66, v67
    v_fma_f32 v61, v61, v66, v67
    v_mfma_f32_32x32x16_bf16 a[80:95], a[156:159], v[44:47], a[80:95]
    v_cvt_pk_bf16_f32 v54, v60, v61
    v_lshlrev_b32 v62, 16, v39
    v_mfma_f32_32x32x16_bf16 a[96:111], a[160:163], v[40:43], a[96:111]
    v_and_b32 v63, 0xffff0000, v39
    v_fma_f32 v62, v62, v66, v67
    v_mfma_f32_32x32x16_bf16 a[112:127], a[160:163], v[44:47], a[112:127]
    v_fma_f32 v63, v63, v66, v67
    v_cvt_pk_bf16_f32 v55, v62, v63
    s_waitcnt lgkmcnt(0)
    s_barrier
    s_waitcnt vmcnt(4)
    v_mfma_f32_32x32x16_bf16 v[96:111], a[164:167], v[48:51], v[96:111]
    ds_read_b64_tr_b16 a[128:129], v77 offset:0
    ds_read_b64_tr_b16 a[130:131], v77 offset:1152
    v_lshlrev_b32 v56, 16, v8
    v_and_b32 v57, 0xffff0000, v8
    v_fma_f32 v56, v56, v64, v65
    v_mfma_f32_32x32x16_bf16 v[112:127], a[164:167], v[52:55], v[112:127]
    ds_read_b64_tr_b16 a[132:133], v77 offset:32
    ds_read_b64_tr_b16 a[134:135], v77 offset:1184
    v_fma_f32 v57, v57, v64, v65
    v_cvt_pk_bf16_f32 v40, v56, v57
    v_mfma_f32_32x32x16_bf16 v[128:143], a[168:171], v[48:51], v[128:143]
    ds_read_b64_tr_b16 a[136:137], v77 offset:64
    ds_read_b64_tr_b16 a[138:139], v77 offset:1216
    v_lshlrev_b32 v58, 16, v9
    v_and_b32 v59, 0xffff0000, v9
    v_mfma_f32_32x32x16_bf16 v[144:159], a[168:171], v[52:55], v[144:159]
    ds_read_b64_tr_b16 a[140:141], v77 offset:96
    ds_read_b64_tr_b16 a[142:143], v77 offset:1248
    v_fma_f32 v58, v58, v64, v65
    v_fma_f32 v59, v59, v64, v65
    v_mfma_f32_32x32x16_bf16 v[160:175], a[172:175], v[48:51], v[160:175]
    ds_read_b64_tr_b16 a[144:145], v77 offset:128
    ds_read_b64_tr_b16 a[146:147], v77 offset:1280
    v_cvt_pk_bf16_f32 v41, v58, v59
    v_lshlrev_b32 v60, 16, v10
    v_and_b32 v61, 0xffff0000, v10
    v_mfma_f32_32x32x16_bf16 v[176:191], a[172:175], v[52:55], v[176:191]
    ds_read_b64_tr_b16 a[148:149], v77 offset:160
    ds_read_b64_tr_b16 a[150:151], v77 offset:1312
    v_fma_f32 v60, v60, v64, v65
    v_fma_f32 v61, v61, v64, v65
    v_mfma_f32_32x32x16_bf16 v[192:207], a[176:179], v[48:51], v[192:207]
    ds_read_b64_tr_b16 a[152:153], v77 offset:192
    ds_read_b64_tr_b16 a[154:155], v77 offset:1344
    v_cvt_pk_bf16_f32 v42, v60, v61
    v_lshlrev_b32 v62, 16, v11
    v_mfma_f32_32x32x16_bf16 v[208:223], a[176:179], v[52:55], v[208:223]
    ds_read_b64_tr_b16 a[156:157], v77 offset:224
    ds_read_b64_tr_b16 a[158:159], v77 offset:1376
    v_and_b32 v63, 0xffff0000, v11
    v_fma_f32 v62, v62, v64, v65
    v_mfma_f32_32x32x16_bf16 v[224:239], a[180:183], v[48:51], v[224:239]
    ds_read_b64_tr_b16 a[160:161], v77 offset:256
    ds_read_b64_tr_b16 a[162:163], v77 offset:1408
    v_fma_f32 v63, v63, v64, v65
    v_cvt_pk_bf16_f32 v43, v62, v63
    v_mfma_f32_32x32x16_bf16 v[240:255], a[180:183], v[52:55], v[240:255]
    v_lshlrev_b32 v56, 16, v12
    v_and_b32 v57, 0xffff0000, v12
    v_fma_f32 v56, v56, v66, v67
    s_add_u32 s24, s23, 35840
    buffer_load_dwordx4 v[32:35], v81, s[16:19], s24 offen
    v_mfma_f32_32x32x16_bf16 a[0:15], a[184:187], v[48:51], a[0:15]
    v_fma_f32 v57, v57, v66, v67
    v_cvt_pk_bf16_f32 v44, v56, v57
    s_add_u32 s24, s23, 72704
    buffer_load_dwordx4 v[36:39], v81, s[16:19], s24 offen
    v_mfma_f32_32x32x16_bf16 a[16:31], a[184:187], v[52:55], a[16:31]
    v_lshlrev_b32 v58, 16, v13
    v_and_b32 v59, 0xffff0000, v13
    v_mfma_f32_32x32x16_bf16 a[32:47], a[188:191], v[48:51], a[32:47]
    v_fma_f32 v58, v58, v66, v67
    v_fma_f32 v59, v59, v66, v67
    v_mfma_f32_32x32x16_bf16 a[48:63], a[188:191], v[52:55], a[48:63]
    v_cvt_pk_bf16_f32 v45, v58, v59
    v_lshlrev_b32 v60, 16, v14
    v_and_b32 v61, 0xffff0000, v14
    v_mfma_f32_32x32x16_bf16 a[64:79], a[192:195], v[48:51], a[64:79]
    v_fma_f32 v60, v60, v66, v67
    v_fma_f32 v61, v61, v66, v67
    v_mfma_f32_32x32x16_bf16 a[80:95], a[192:195], v[52:55], a[80:95]
    v_cvt_pk_bf16_f32 v46, v60, v61
    v_lshlrev_b32 v62, 16, v15
    v_mfma_f32_32x32x16_bf16 a[96:111], a[196:199], v[48:51], a[96:111]
    v_and_b32 v63, 0xffff0000, v15
    v_fma_f32 v62, v62, v66, v67
    v_mfma_f32_32x32x16_bf16 a[112:127], a[196:199], v[52:55], a[112:127]
    v_fma_f32 v63, v63, v66, v67
    v_cvt_pk_bf16_f32 v47, v62, v63
    s_waitcnt lgkmcnt(0)
    s_waitcnt vmcnt(4)
    v_mfma_f32_32x32x16_bf16 v[96:111], a[128:131], v[40:43], v[96:111]
    ds_read_b64_tr_b16 a[164:165], v77 offset:4608
    ds_read_b64_tr_b16 a[166:167], v77 offset:5760
    v_lshlrev_b32 v56, 16, v16
    v_and_b32 v57, 0xffff0000, v16
    v_fma_f32 v56, v56, v64, v65
    v_mfma_f32_32x32x16_bf16 v[112:127], a[128:131], v[44:47], v[112:127]
    ds_read_b64_tr_b16 a[168:169], v77 offset:4640
    ds_read_b64_tr_b16 a[170:171], v77 offset:5792
    v_fma_f32 v57, v57, v64, v65
    v_cvt_pk_bf16_f32 v48, v56, v57
    v_mfma_f32_32x32x16_bf16 v[128:143], a[132:135], v[40:43], v[128:143]
    ds_read_b64_tr_b16 a[172:173], v77 offset:4672
    ds_read_b64_tr_b16 a[174:175], v77 offset:5824
    v_lshlrev_b32 v58, 16, v17
    v_and_b32 v59, 0xffff0000, v17
    v_mfma_f32_32x32x16_bf16 v[144:159], a[132:135], v[44:47], v[144:159]
    ds_read_b64_tr_b16 a[176:177], v77 offset:4704
    ds_read_b64_tr_b16 a[178:179], v77 offset:5856
    v_fma_f32 v58, v58, v64, v65
    v_fma_f32 v59, v59, v64, v65
    v_mfma_f32_32x32x16_bf16 v[160:175], a[136:139], v[40:43], v[160:175]
    ds_read_b64_tr_b16 a[180:181], v77 offset:4736
    ds_read_b64_tr_b16 a[182:183], v77 offset:5888
    v_cvt_pk_bf16_f32 v49, v58, v59
    v_lshlrev_b32 v60, 16, v18
    v_and_b32 v61, 0xffff0000, v18
    v_mfma_f32_32x32x16_bf16 v[176:191], a[136:139], v[44:47], v[176:191]
    ds_read_b64_tr_b16 a[184:185], v77 offset:4768
    ds_read_b64_tr_b16 a[186:187], v77 offset:5920
    v_fma_f32 v60, v60, v64, v65
    v_fma_f32 v61, v61, v64, v65
    v_mfma_f32_32x32x16_bf16 v[192:207], a[140:143], v[40:43], v[192:207]
    ds_read_b64_tr_b16 a[188:189], v77 offset:4800
    ds_read_b64_tr_b16 a[190:191], v77 offset:5952
    v_cvt_pk_bf16_f32 v50, v60, v61
    v_lshlrev_b32 v62, 16, v19
    v_mfma_f32_32x32x16_bf16 v[208:223], a[140:143], v[44:47], v[208:223]
    ds_read_b64_tr_b16 a[192:193], v77 offset:4832
    ds_read_b64_tr_b16 a[194:195], v77 offset:5984
    v_and_b32 v63, 0xffff0000, v19
    v_fma_f32 v62, v62, v64, v65
    v_mfma_f32_32x32x16_bf16 v[224:239], a[144:147], v[40:43], v[224:239]
    ds_read_b64_tr_b16 a[196:197], v77 offset:4864
    ds_read_b64_tr_b16 a[198:199], v77 offset:6016
    v_fma_f32 v63, v63, v64, v65
    v_cvt_pk_bf16_f32 v51, v62, v63
    v_mfma_f32_32x32x16_bf16 v[240:255], a[144:147], v[44:47], v[240:255]
    v_lshlrev_b32 v56, 16, v20
    v_and_b32 v57, 0xffff0000, v20
    v_fma_f32 v56, v56, v66, v67
    v_mfma_f32_32x32x16_bf16 a[0:15], a[148:151], v[40:43], a[0:15]
    v_fma_f32 v57, v57, v66, v67
    v_cvt_pk_bf16_f32 v52, v56, v57
    v_mfma_f32_32x32x16_bf16 a[16:31], a[148:151], v[44:47], a[16:31]
    v_lshlrev_b32 v58, 16, v21
    v_and_b32 v59, 0xffff0000, v21
    v_mfma_f32_32x32x16_bf16 a[32:47], a[152:155], v[40:43], a[32:47]
    v_fma_f32 v58, v58, v66, v67
    v_fma_f32 v59, v59, v66, v67
    v_mfma_f32_32x32x16_bf16 a[48:63], a[152:155], v[44:47], a[48:63]
    v_cvt_pk_bf16_f32 v53, v58, v59
    v_lshlrev_b32 v60, 16, v22
    v_and_b32 v61, 0xffff0000, v22
    v_mfma_f32_32x32x16_bf16 a[64:79], a[156:159], v[40:43], a[64:79]
    v_fma_f32 v60, v60, v66, v67
    v_fma_f32 v61, v61, v66, v67
    v_mfma_f32_32x32x16_bf16 a[80:95], a[156:159], v[44:47], a[80:95]
    v_cvt_pk_bf16_f32 v54, v60, v61
    v_lshlrev_b32 v62, 16, v23
    v_mfma_f32_32x32x16_bf16 a[96:111], a[160:163], v[40:43], a[96:111]
    v_and_b32 v63, 0xffff0000, v23
    v_fma_f32 v62, v62, v66, v67
    v_mfma_f32_32x32x16_bf16 a[112:127], a[160:163], v[44:47], a[112:127]
    v_fma_f32 v63, v63, v66, v67
    v_cvt_pk_bf16_f32 v55, v62, v63
    s_waitcnt lgkmcnt(0)
    s_waitcnt vmcnt(2)
    v_mfma_f32_32x32x16_bf16 v[96:111], a[164:167], v[48:51], v[96:111]
    ds_read_b64_tr_b16 a[128:129], v77 offset:9216
    ds_read_b64_tr_b16 a[130:131], v77 offset:10368
    v_lshlrev_b32 v56, 16, v24
    v_and_b32 v57, 0xffff0000, v24
    v_fma_f32 v56, v56, v64, v65
    v_mfma_f32_32x32x16_bf16 v[112:127], a[164:167], v[52:55], v[112:127]
    ds_read_b64_tr_b16 a[132:133], v77 offset:9248
    ds_read_b64_tr_b16 a[134:135], v77 offset:10400
    v_fma_f32 v57, v57, v64, v65
    v_cvt_pk_bf16_f32 v40, v56, v57
    v_mfma_f32_32x32x16_bf16 v[128:143], a[168:171], v[48:51], v[128:143]
    ds_read_b64_tr_b16 a[136:137], v77 offset:9280
    ds_read_b64_tr_b16 a[138:139], v77 offset:10432
    v_lshlrev_b32 v58, 16, v25
    v_and_b32 v59, 0xffff0000, v25
    v_mfma_f32_32x32x16_bf16 v[144:159], a[168:171], v[52:55], v[144:159]
    ds_read_b64_tr_b16 a[140:141], v77 offset:9312
    ds_read_b64_tr_b16 a[142:143], v77 offset:10464
    v_fma_f32 v58, v58, v64, v65
    v_fma_f32 v59, v59, v64, v65
    v_mfma_f32_32x32x16_bf16 v[160:175], a[172:175], v[48:51], v[160:175]
    ds_read_b64_tr_b16 a[144:145], v77 offset:9344
    ds_read_b64_tr_b16 a[146:147], v77 offset:10496
    v_cvt_pk_bf16_f32 v41, v58, v59
    v_lshlrev_b32 v60, 16, v26
    v_and_b32 v61, 0xffff0000, v26
    v_mfma_f32_32x32x16_bf16 v[176:191], a[172:175], v[52:55], v[176:191]
    ds_read_b64_tr_b16 a[148:149], v77 offset:9376
    ds_read_b64_tr_b16 a[150:151], v77 offset:10528
    v_fma_f32 v60, v60, v64, v65
    v_fma_f32 v61, v61, v64, v65
    v_mfma_f32_32x32x16_bf16 v[192:207], a[176:179], v[48:51], v[192:207]
    ds_read_b64_tr_b16 a[152:153], v77 offset:9408
    ds_read_b64_tr_b16 a[154:155], v77 offset:10560
    v_cvt_pk_bf16_f32 v42, v60, v61
    v_lshlrev_b32 v62, 16, v27
    v_mfma_f32_32x32x16_bf16 v[208:223], a[176:179], v[52:55], v[208:223]
    ds_read_b64_tr_b16 a[156:157], v77 offset:9440
    ds_read_b64_tr_b16 a[158:159], v77 offset:10592
    v_and_b32 v63, 0xffff0000, v27
    v_fma_f32 v62, v62, v64, v65
    v_mfma_f32_32x32x16_bf16 v[224:239], a[180:183], v[48:51], v[224:239]
    ds_read_b64_tr_b16 a[160:161], v77 offset:9472
    ds_read_b64_tr_b16 a[162:163], v77 offset:10624
    v_fma_f32 v63, v63, v64, v65
    v_cvt_pk_bf16_f32 v43, v62, v63
    v_mfma_f32_32x32x16_bf16 v[240:255], a[180:183], v[52:55], v[240:255]
    v_lshlrev_b32 v56, 16, v28
    v_and_b32 v57, 0xffff0000, v28
    v_fma_f32 v56, v56, v66, v67
    v_mfma_f32_32x32x16_bf16 a[0:15], a[184:187], v[48:51], a[0:15]
    v_fma_f32 v57, v57, v66, v67
    v_cvt_pk_bf16_f32 v44, v56, v57
    v_mfma_f32_32x32x16_bf16 a[16:31], a[184:187], v[52:55], a[16:31]
    v_lshlrev_b32 v58, 16, v29
    v_and_b32 v59, 0xffff0000, v29
    v_mfma_f32_32x32x16_bf16 a[32:47], a[188:191], v[48:51], a[32:47]
    v_fma_f32 v58, v58, v66, v67
    v_fma_f32 v59, v59, v66, v67
    v_mfma_f32_32x32x16_bf16 a[48:63], a[188:191], v[52:55], a[48:63]
    v_cvt_pk_bf16_f32 v45, v58, v59
    v_lshlrev_b32 v60, 16, v30
    v_and_b32 v61, 0xffff0000, v30
    v_mfma_f32_32x32x16_bf16 a[64:79], a[192:195], v[48:51], a[64:79]
    v_fma_f32 v60, v60, v66, v67
    v_fma_f32 v61, v61, v66, v67
    v_mfma_f32_32x32x16_bf16 a[80:95], a[192:195], v[52:55], a[80:95]
    v_cvt_pk_bf16_f32 v46, v60, v61
    v_lshlrev_b32 v62, 16, v31
    v_mfma_f32_32x32x16_bf16 a[96:111], a[196:199], v[48:51], a[96:111]
    v_and_b32 v63, 0xffff0000, v31
    v_fma_f32 v62, v62, v66, v67
    v_mfma_f32_32x32x16_bf16 a[112:127], a[196:199], v[52:55], a[112:127]
    v_fma_f32 v63, v63, v66, v67
    v_cvt_pk_bf16_f32 v47, v62, v63
    s_waitcnt lgkmcnt(0)
    s_waitcnt vmcnt(0)
    v_mfma_f32_32x32x16_bf16 v[96:111], a[128:131], v[40:43], v[96:111]
    ds_read_b64_tr_b16 a[164:165], v77 offset:13824
    ds_read_b64_tr_b16 a[166:167], v77 offset:14976
    v_lshlrev_b32 v56, 16, v32
    v_and_b32 v57, 0xffff0000, v32
    v_fma_f32 v56, v56, v64, v65
    v_mfma_f32_32x32x16_bf16 v[112:127], a[128:131], v[44:47], v[112:127]
    ds_read_b64_tr_b16 a[168:169], v77 offset:13856
    ds_read_b64_tr_b16 a[170:171], v77 offset:15008
    v_fma_f32 v57, v57, v64, v65
    v_cvt_pk_bf16_f32 v48, v56, v57
    v_mfma_f32_32x32x16_bf16 v[128:143], a[132:135], v[40:43], v[128:143]
    ds_read_b64_tr_b16 a[172:173], v77 offset:13888
    ds_read_b64_tr_b16 a[174:175], v77 offset:15040
    v_lshlrev_b32 v58, 16, v33
    v_and_b32 v59, 0xffff0000, v33
    v_mfma_f32_32x32x16_bf16 v[144:159], a[132:135], v[44:47], v[144:159]
    ds_read_b64_tr_b16 a[176:177], v77 offset:13920
    ds_read_b64_tr_b16 a[178:179], v77 offset:15072
    v_fma_f32 v58, v58, v64, v65
    v_fma_f32 v59, v59, v64, v65
    v_mfma_f32_32x32x16_bf16 v[160:175], a[136:139], v[40:43], v[160:175]
    ds_read_b64_tr_b16 a[180:181], v77 offset:13952
    ds_read_b64_tr_b16 a[182:183], v77 offset:15104
    v_cvt_pk_bf16_f32 v49, v58, v59
    v_lshlrev_b32 v60, 16, v34
    v_and_b32 v61, 0xffff0000, v34
    v_mfma_f32_32x32x16_bf16 v[176:191], a[136:139], v[44:47], v[176:191]
    ds_read_b64_tr_b16 a[184:185], v77 offset:13984
    ds_read_b64_tr_b16 a[186:187], v77 offset:15136
    v_fma_f32 v60, v60, v64, v65
    v_fma_f32 v61, v61, v64, v65
    v_mfma_f32_32x32x16_bf16 v[192:207], a[140:143], v[40:43], v[192:207]
    ds_read_b64_tr_b16 a[188:189], v77 offset:14016
    ds_read_b64_tr_b16 a[190:191], v77 offset:15168
    v_cvt_pk_bf16_f32 v50, v60, v61
    v_lshlrev_b32 v62, 16, v35
    v_mfma_f32_32x32x16_bf16 v[208:223], a[140:143], v[44:47], v[208:223]
    ds_read_b64_tr_b16 a[192:193], v77 offset:14048
    ds_read_b64_tr_b16 a[194:195], v77 offset:15200
    v_and_b32 v63, 0xffff0000, v35
    v_fma_f32 v62, v62, v64, v65
    v_mfma_f32_32x32x16_bf16 v[224:239], a[144:147], v[40:43], v[224:239]
    ds_read_b64_tr_b16 a[196:197], v77 offset:14080
    ds_read_b64_tr_b16 a[198:199], v77 offset:15232
    v_fma_f32 v63, v63, v64, v65
    v_cvt_pk_bf16_f32 v51, v62, v63
    v_mfma_f32_32x32x16_bf16 v[240:255], a[144:147], v[44:47], v[240:255]
    v_lshlrev_b32 v56, 16, v36
    v_and_b32 v57, 0xffff0000, v36
    v_fma_f32 v56, v56, v66, v67
    v_mfma_f32_32x32x16_bf16 a[0:15], a[148:151], v[40:43], a[0:15]
    v_fma_f32 v57, v57, v66, v67
    v_cvt_pk_bf16_f32 v52, v56, v57
    v_mfma_f32_32x32x16_bf16 a[16:31], a[148:151], v[44:47], a[16:31]
    v_lshlrev_b32 v58, 16, v37
    v_and_b32 v59, 0xffff0000, v37
    v_mfma_f32_32x32x16_bf16 a[32:47], a[152:155], v[40:43], a[32:47]
    v_fma_f32 v58, v58, v66, v67
    v_fma_f32 v59, v59, v66, v67
    v_mfma_f32_32x32x16_bf16 a[48:63], a[152:155], v[44:47], a[48:63]
    v_cvt_pk_bf16_f32 v53, v58, v59
    v_lshlrev_b32 v60, 16, v38
    v_and_b32 v61, 0xffff0000, v38
    v_mfma_f32_32x32x16_bf16 a[64:79], a[156:159], v[40:43], a[64:79]
    v_fma_f32 v60, v60, v66, v67
    v_fma_f32 v61, v61, v66, v67
    v_mfma_f32_32x32x16_bf16 a[80:95], a[156:159], v[44:47], a[80:95]
    v_cvt_pk_bf16_f32 v54, v60, v61
    v_lshlrev_b32 v62, 16, v39
    v_mfma_f32_32x32x16_bf16 a[96:111], a[160:163], v[40:43], a[96:111]
    v_and_b32 v63, 0xffff0000, v39
    v_fma_f32 v62, v62, v66, v67
    v_mfma_f32_32x32x16_bf16 a[112:127], a[160:163], v[44:47], a[112:127]
    v_fma_f32 v63, v63, v66, v67
    v_cvt_pk_bf16_f32 v55, v62, v63
    s_waitcnt lgkmcnt(0)
    v_mfma_f32_32x32x16_bf16 v[96:111], a[164:167], v[48:51], v[96:111]
    v_mfma_f32_32x32x16_bf16 v[112:127], a[164:167], v[52:55], v[112:127]
    v_mfma_f32_32x32x16_bf16 v[128:143], a[168:171], v[48:51], v[128:143]
    v_mfma_f32_32x32x16_bf16 v[144:159], a[168:171], v[52:55], v[144:159]
    v_mfma_f32_32x32x16_bf16 v[160:175], a[172:175], v[48:51], v[160:175]
    v_mfma_f32_32x32x16_bf16 v[176:191], a[172:175], v[52:55], v[176:191]
    v_mfma_f32_32x32x16_bf16 v[192:207], a[176:179], v[48:51], v[192:207]
    v_mfma_f32_32x32x16_bf16 v[208:223], a[176:179], v[52:55], v[208:223]
    v_mfma_f32_32x32x16_bf16 v[224:239], a[180:183], v[48:51], v[224:239]
    v_mfma_f32_32x32x16_bf16 v[240:255], a[180:183], v[52:55], v[240:255]
    v_mfma_f32_32x32x16_bf16 a[0:15], a[184:187], v[48:51], a[0:15]
    v_mfma_f32_32x32x16_bf16 a[16:31], a[184:187], v[52:55], a[16:31]
    v_mfma_f32_32x32x16_bf16 a[32:47], a[188:191], v[48:51], a[32:47]
    v_mfma_f32_32x32x16_bf16 a[48:63], a[188:191], v[52:55], a[48:63]
    v_mfma_f32_32x32x16_bf16 a[64:79], a[192:195], v[48:51], a[64:79]
    v_mfma_f32_32x32x16_bf16 a[80:95], a[192:195], v[52:55], a[80:95]
    v_mfma_f32_32x32x16_bf16 a[96:111], a[196:199], v[48:51], a[96:111]
    v_mfma_f32_32x32x16_bf16 a[112:127], a[196:199], v[52:55], a[112:127]
    s_mov_b32 s30, 0xbfb8aa3b
    s_mov_b32 s31, 0xbfb8aa3b
    s_mov_b32 s32, 0xffff0000
    s_mov_b32 s34, 1.0
    s_mov_b32 s35, 1.0
    s_nop 8
    v_pk_mul_f32 v[40:41], v[96:97], s[30:31]
    v_pk_mul_f32 v[42:43], v[98:99], s[30:31]
    v_pk_mul_f32 v[44:45], v[100:101], s[30:31]
    v_pk_mul_f32 v[46:47], v[102:103], s[30:31]
    v_exp_f32 v40, v40
    v_exp_f32 v41, v41
    v_exp_f32 v42, v42
    v_exp_f32 v43, v43
    v_exp_f32 v44, v44
    v_exp_f32 v45, v45
    v_exp_f32 v46, v46
    v_exp_f32 v47, v47
    v_pk_add_f32 v[40:41], v[40:41], s[34:35]
    v_pk_add_f32 v[42:43], v[42:43], s[34:35]
    v_pk_add_f32 v[44:45], v[44:45], s[34:35]
    v_pk_add_f32 v[46:47], v[46:47], s[34:35]
    v_rcp_f32 v40, v40
    v_rcp_f32 v41, v41
    v_rcp_f32 v42, v42
    v_rcp_f32 v43, v43
    v_rcp_f32 v44, v44
    v_rcp_f32 v45, v45
    v_rcp_f32 v46, v46
    v_rcp_f32 v47, v47
    v_pk_mul_f32 v[40:41], v[96:97], v[40:41]
    v_pk_mul_f32 v[42:43], v[98:99], v[42:43]
    v_pk_mul_f32 v[44:45], v[100:101], v[44:45]
    v_pk_mul_f32 v[46:47], v[102:103], v[46:47]
    v_pk_mul_f32 v[40:41], v[40:41], v[104:105]
    v_pk_mul_f32 v[42:43], v[42:43], v[106:107]
    v_pk_mul_f32 v[44:45], v[44:45], v[108:109]
    v_pk_mul_f32 v[46:47], v[46:47], v[110:111]
    v_cvt_pk_bf16_f32 v52, v40, v41
    v_cvt_pk_bf16_f32 v53, v42, v43
    v_cvt_pk_bf16_f32 v54, v44, v45
    v_cvt_pk_bf16_f32 v55, v46, v47
    s_add_u32 s24, s28, 0
    buffer_store_dwordx4 v[52:55], v81, s[16:19], s24 offen
    v_pk_mul_f32 v[40:41], v[112:113], s[30:31]
    v_pk_mul_f32 v[42:43], v[114:115], s[30:31]
    v_pk_mul_f32 v[44:45], v[116:117], s[30:31]
    v_pk_mul_f32 v[46:47], v[118:119], s[30:31]
    v_exp_f32 v40, v40
    v_exp_f32 v41, v41
    v_exp_f32 v42, v42
    v_exp_f32 v43, v43
    v_exp_f32 v44, v44
    v_exp_f32 v45, v45
    v_exp_f32 v46, v46
    v_exp_f32 v47, v47
    v_pk_add_f32 v[40:41], v[40:41], s[34:35]
    v_pk_add_f32 v[42:43], v[42:43], s[34:35]
    v_pk_add_f32 v[44:45], v[44:45], s[34:35]
    v_pk_add_f32 v[46:47], v[46:47], s[34:35]
    v_rcp_f32 v40, v40
    v_rcp_f32 v41, v41
    v_rcp_f32 v42, v42
    v_rcp_f32 v43, v43
    v_rcp_f32 v44, v44
    v_rcp_f32 v45, v45
    v_rcp_f32 v46, v46
    v_rcp_f32 v47, v47
    v_pk_mul_f32 v[40:41], v[112:113], v[40:41]
    v_pk_mul_f32 v[42:43], v[114:115], v[42:43]
    v_pk_mul_f32 v[44:45], v[116:117], v[44:45]
    v_pk_mul_f32 v[46:47], v[118:119], v[46:47]
    v_pk_mul_f32 v[40:41], v[40:41], v[120:121]
    v_pk_mul_f32 v[42:43], v[42:43], v[122:123]
    v_pk_mul_f32 v[44:45], v[44:45], v[124:125]
    v_pk_mul_f32 v[46:47], v[46:47], v[126:127]
    v_cvt_pk_bf16_f32 v52, v40, v41
    v_cvt_pk_bf16_f32 v53, v42, v43
    v_cvt_pk_bf16_f32 v54, v44, v45
    v_cvt_pk_bf16_f32 v55, v46, v47
    s_add_u32 s24, s28, 294912
    buffer_store_dwordx4 v[52:55], v81, s[16:19], s24 offen
    v_pk_mul_f32 v[40:41], v[128:129], s[30:31]
    v_pk_mul_f32 v[42:43], v[130:131], s[30:31]
    v_pk_mul_f32 v[44:45], v[132:133], s[30:31]
    v_pk_mul_f32 v[46:47], v[134:135], s[30:31]
    v_exp_f32 v40, v40
    v_exp_f32 v41, v41
    v_exp_f32 v42, v42
    v_exp_f32 v43, v43
    v_exp_f32 v44, v44
    v_exp_f32 v45, v45
    v_exp_f32 v46, v46
    v_exp_f32 v47, v47
    v_pk_add_f32 v[40:41], v[40:41], s[34:35]
    v_pk_add_f32 v[42:43], v[42:43], s[34:35]
    v_pk_add_f32 v[44:45], v[44:45], s[34:35]
    v_pk_add_f32 v[46:47], v[46:47], s[34:35]
    v_rcp_f32 v40, v40
    v_rcp_f32 v41, v41
    v_rcp_f32 v42, v42
    v_rcp_f32 v43, v43
    v_rcp_f32 v44, v44
    v_rcp_f32 v45, v45
    v_rcp_f32 v46, v46
    v_rcp_f32 v47, v47
    v_pk_mul_f32 v[40:41], v[128:129], v[40:41]
    v_pk_mul_f32 v[42:43], v[130:131], v[42:43]
    v_pk_mul_f32 v[44:45], v[132:133], v[44:45]
    v_pk_mul_f32 v[46:47], v[134:135], v[46:47]
    v_pk_mul_f32 v[40:41], v[40:41], v[136:137]
    v_pk_mul_f32 v[42:43], v[42:43], v[138:139]
    v_pk_mul_f32 v[44:45], v[44:45], v[140:141]
    v_pk_mul_f32 v[46:47], v[46:47], v[142:143]
    v_cvt_pk_bf16_f32 v52, v40, v41
    v_cvt_pk_bf16_f32 v53, v42, v43
    v_cvt_pk_bf16_f32 v54, v44, v45
    v_cvt_pk_bf16_f32 v55, v46, v47
    s_add_u32 s24, s28, 1024
    buffer_store_dwordx4 v[52:55], v81, s[16:19], s24 offen
    v_pk_mul_f32 v[40:41], v[144:145], s[30:31]
    v_pk_mul_f32 v[42:43], v[146:147], s[30:31]
    v_pk_mul_f32 v[44:45], v[148:149], s[30:31]
    v_pk_mul_f32 v[46:47], v[150:151], s[30:31]
    v_exp_f32 v40, v40
    v_exp_f32 v41, v41
    v_exp_f32 v42, v42
    v_exp_f32 v43, v43
    v_exp_f32 v44, v44
    v_exp_f32 v45, v45
    v_exp_f32 v46, v46
    v_exp_f32 v47, v47
    v_pk_add_f32 v[40:41], v[40:41], s[34:35]
    v_pk_add_f32 v[42:43], v[42:43], s[34:35]
    v_pk_add_f32 v[44:45], v[44:45], s[34:35]
    v_pk_add_f32 v[46:47], v[46:47], s[34:35]
    v_rcp_f32 v40, v40
    v_rcp_f32 v41, v41
    v_rcp_f32 v42, v42
    v_rcp_f32 v43, v43
    v_rcp_f32 v44, v44
    v_rcp_f32 v45, v45
    v_rcp_f32 v46, v46
    v_rcp_f32 v47, v47
    v_pk_mul_f32 v[40:41], v[144:145], v[40:41]
    v_pk_mul_f32 v[42:43], v[146:147], v[42:43]
    v_pk_mul_f32 v[44:45], v[148:149], v[44:45]
    v_pk_mul_f32 v[46:47], v[150:151], v[46:47]
    v_pk_mul_f32 v[40:41], v[40:41], v[152:153]
    v_pk_mul_f32 v[42:43], v[42:43], v[154:155]
    v_pk_mul_f32 v[44:45], v[44:45], v[156:157]
    v_pk_mul_f32 v[46:47], v[46:47], v[158:159]
    v_cvt_pk_bf16_f32 v52, v40, v41
    v_cvt_pk_bf16_f32 v53, v42, v43
    v_cvt_pk_bf16_f32 v54, v44, v45
    v_cvt_pk_bf16_f32 v55, v46, v47
    s_add_u32 s24, s28, 295936
    buffer_store_dwordx4 v[52:55], v81, s[16:19], s24 offen
    v_pk_mul_f32 v[40:41], v[160:161], s[30:31]
    v_pk_mul_f32 v[42:43], v[162:163], s[30:31]
    v_pk_mul_f32 v[44:45], v[164:165], s[30:31]
    v_pk_mul_f32 v[46:47], v[166:167], s[30:31]
    v_exp_f32 v40, v40
    v_exp_f32 v41, v41
    v_exp_f32 v42, v42
    v_exp_f32 v43, v43
    v_exp_f32 v44, v44
    v_exp_f32 v45, v45
    v_exp_f32 v46, v46
    v_exp_f32 v47, v47
    v_pk_add_f32 v[40:41], v[40:41], s[34:35]
    v_pk_add_f32 v[42:43], v[42:43], s[34:35]
    v_pk_add_f32 v[44:45], v[44:45], s[34:35]
    v_pk_add_f32 v[46:47], v[46:47], s[34:35]
    v_rcp_f32 v40, v40
    v_rcp_f32 v41, v41
    v_rcp_f32 v42, v42
    v_rcp_f32 v43, v43
    v_rcp_f32 v44, v44
    v_rcp_f32 v45, v45
    v_rcp_f32 v46, v46
    v_rcp_f32 v47, v47
    v_pk_mul_f32 v[40:41], v[160:161], v[40:41]
    v_pk_mul_f32 v[42:43], v[162:163], v[42:43]
    v_pk_mul_f32 v[44:45], v[164:165], v[44:45]
    v_pk_mul_f32 v[46:47], v[166:167], v[46:47]
    v_pk_mul_f32 v[40:41], v[40:41], v[168:169]
    v_pk_mul_f32 v[42:43], v[42:43], v[170:171]
    v_pk_mul_f32 v[44:45], v[44:45], v[172:173]
    v_pk_mul_f32 v[46:47], v[46:47], v[174:175]
    v_cvt_pk_bf16_f32 v52, v40, v41
    v_cvt_pk_bf16_f32 v53, v42, v43
    v_cvt_pk_bf16_f32 v54, v44, v45
    v_cvt_pk_bf16_f32 v55, v46, v47
    s_add_u32 s24, s28, 2048
    buffer_store_dwordx4 v[52:55], v81, s[16:19], s24 offen
    v_pk_mul_f32 v[40:41], v[176:177], s[30:31]
    v_pk_mul_f32 v[42:43], v[178:179], s[30:31]
    v_pk_mul_f32 v[44:45], v[180:181], s[30:31]
    v_pk_mul_f32 v[46:47], v[182:183], s[30:31]
    v_exp_f32 v40, v40
    v_exp_f32 v41, v41
    v_exp_f32 v42, v42
    v_exp_f32 v43, v43
    v_exp_f32 v44, v44
    v_exp_f32 v45, v45
    v_exp_f32 v46, v46
    v_exp_f32 v47, v47
    v_pk_add_f32 v[40:41], v[40:41], s[34:35]
    v_pk_add_f32 v[42:43], v[42:43], s[34:35]
    v_pk_add_f32 v[44:45], v[44:45], s[34:35]
    v_pk_add_f32 v[46:47], v[46:47], s[34:35]
    v_rcp_f32 v40, v40
    v_rcp_f32 v41, v41
    v_rcp_f32 v42, v42
    v_rcp_f32 v43, v43
    v_rcp_f32 v44, v44
    v_rcp_f32 v45, v45
    v_rcp_f32 v46, v46
    v_rcp_f32 v47, v47
    v_pk_mul_f32 v[40:41], v[176:177], v[40:41]
    v_pk_mul_f32 v[42:43], v[178:179], v[42:43]
    v_pk_mul_f32 v[44:45], v[180:181], v[44:45]
    v_pk_mul_f32 v[46:47], v[182:183], v[46:47]
    v_pk_mul_f32 v[40:41], v[40:41], v[184:185]
    v_pk_mul_f32 v[42:43], v[42:43], v[186:187]
    v_pk_mul_f32 v[44:45], v[44:45], v[188:189]
    v_pk_mul_f32 v[46:47], v[46:47], v[190:191]
    v_cvt_pk_bf16_f32 v52, v40, v41
    v_cvt_pk_bf16_f32 v53, v42, v43
    v_cvt_pk_bf16_f32 v54, v44, v45
    v_cvt_pk_bf16_f32 v55, v46, v47
    s_add_u32 s24, s28, 296960
    buffer_store_dwordx4 v[52:55], v81, s[16:19], s24 offen
    v_pk_mul_f32 v[40:41], v[192:193], s[30:31]
    v_pk_mul_f32 v[42:43], v[194:195], s[30:31]
    v_pk_mul_f32 v[44:45], v[196:197], s[30:31]
    v_pk_mul_f32 v[46:47], v[198:199], s[30:31]
    v_exp_f32 v40, v40
    v_exp_f32 v41, v41
    v_exp_f32 v42, v42
    v_exp_f32 v43, v43
    v_exp_f32 v44, v44
    v_exp_f32 v45, v45
    v_exp_f32 v46, v46
    v_exp_f32 v47, v47
    v_pk_add_f32 v[40:41], v[40:41], s[34:35]
    v_pk_add_f32 v[42:43], v[42:43], s[34:35]
    v_pk_add_f32 v[44:45], v[44:45], s[34:35]
    v_pk_add_f32 v[46:47], v[46:47], s[34:35]
    v_rcp_f32 v40, v40
    v_rcp_f32 v41, v41
    v_rcp_f32 v42, v42
    v_rcp_f32 v43, v43
    v_rcp_f32 v44, v44
    v_rcp_f32 v45, v45
    v_rcp_f32 v46, v46
    v_rcp_f32 v47, v47
    v_pk_mul_f32 v[40:41], v[192:193], v[40:41]
    v_pk_mul_f32 v[42:43], v[194:195], v[42:43]
    v_pk_mul_f32 v[44:45], v[196:197], v[44:45]
    v_pk_mul_f32 v[46:47], v[198:199], v[46:47]
    v_pk_mul_f32 v[40:41], v[40:41], v[200:201]
    v_pk_mul_f32 v[42:43], v[42:43], v[202:203]
    v_pk_mul_f32 v[44:45], v[44:45], v[204:205]
    v_pk_mul_f32 v[46:47], v[46:47], v[206:207]
    v_cvt_pk_bf16_f32 v52, v40, v41
    v_cvt_pk_bf16_f32 v53, v42, v43
    v_cvt_pk_bf16_f32 v54, v44, v45
    v_cvt_pk_bf16_f32 v55, v46, v47
    s_add_u32 s24, s28, 3072
    buffer_store_dwordx4 v[52:55], v81, s[16:19], s24 offen
    v_pk_mul_f32 v[40:41], v[208:209], s[30:31]
    v_pk_mul_f32 v[42:43], v[210:211], s[30:31]
    v_pk_mul_f32 v[44:45], v[212:213], s[30:31]
    v_pk_mul_f32 v[46:47], v[214:215], s[30:31]
    v_exp_f32 v40, v40
    v_exp_f32 v41, v41
    v_exp_f32 v42, v42
    v_exp_f32 v43, v43
    v_exp_f32 v44, v44
    v_exp_f32 v45, v45
    v_exp_f32 v46, v46
    v_exp_f32 v47, v47
    v_pk_add_f32 v[40:41], v[40:41], s[34:35]
    v_pk_add_f32 v[42:43], v[42:43], s[34:35]
    v_pk_add_f32 v[44:45], v[44:45], s[34:35]
    v_pk_add_f32 v[46:47], v[46:47], s[34:35]
    v_rcp_f32 v40, v40
    v_rcp_f32 v41, v41
    v_rcp_f32 v42, v42
    v_rcp_f32 v43, v43
    v_rcp_f32 v44, v44
    v_rcp_f32 v45, v45
    v_rcp_f32 v46, v46
    v_rcp_f32 v47, v47
    v_pk_mul_f32 v[40:41], v[208:209], v[40:41]
    v_pk_mul_f32 v[42:43], v[210:211], v[42:43]
    v_pk_mul_f32 v[44:45], v[212:213], v[44:45]
    v_pk_mul_f32 v[46:47], v[214:215], v[46:47]
    v_pk_mul_f32 v[40:41], v[40:41], v[216:217]
    v_pk_mul_f32 v[42:43], v[42:43], v[218:219]
    v_pk_mul_f32 v[44:45], v[44:45], v[220:221]
    v_pk_mul_f32 v[46:47], v[46:47], v[222:223]
    v_cvt_pk_bf16_f32 v52, v40, v41
    v_cvt_pk_bf16_f32 v53, v42, v43
    v_cvt_pk_bf16_f32 v54, v44, v45
    v_cvt_pk_bf16_f32 v55, v46, v47
    s_add_u32 s24, s28, 297984
    buffer_store_dwordx4 v[52:55], v81, s[16:19], s24 offen
    v_pk_mul_f32 v[40:41], v[224:225], s[30:31]
    v_pk_mul_f32 v[42:43], v[226:227], s[30:31]
    v_pk_mul_f32 v[44:45], v[228:229], s[30:31]
    v_pk_mul_f32 v[46:47], v[230:231], s[30:31]
    v_exp_f32 v40, v40
    v_exp_f32 v41, v41
    v_exp_f32 v42, v42
    v_exp_f32 v43, v43
    v_exp_f32 v44, v44
    v_exp_f32 v45, v45
    v_exp_f32 v46, v46
    v_exp_f32 v47, v47
    v_pk_add_f32 v[40:41], v[40:41], s[34:35]
    v_pk_add_f32 v[42:43], v[42:43], s[34:35]
    v_pk_add_f32 v[44:45], v[44:45], s[34:35]
    v_pk_add_f32 v[46:47], v[46:47], s[34:35]
    v_rcp_f32 v40, v40
    v_rcp_f32 v41, v41
    v_rcp_f32 v42, v42
    v_rcp_f32 v43, v43
    v_rcp_f32 v44, v44
    v_rcp_f32 v45, v45
    v_rcp_f32 v46, v46
    v_rcp_f32 v47, v47
    v_pk_mul_f32 v[40:41], v[224:225], v[40:41]
    v_pk_mul_f32 v[42:43], v[226:227], v[42:43]
    v_pk_mul_f32 v[44:45], v[228:229], v[44:45]
    v_pk_mul_f32 v[46:47], v[230:231], v[46:47]
    v_pk_mul_f32 v[40:41], v[40:41], v[232:233]
    v_pk_mul_f32 v[42:43], v[42:43], v[234:235]
    v_pk_mul_f32 v[44:45], v[44:45], v[236:237]
    v_pk_mul_f32 v[46:47], v[46:47], v[238:239]
    v_cvt_pk_bf16_f32 v52, v40, v41
    v_cvt_pk_bf16_f32 v53, v42, v43
    v_cvt_pk_bf16_f32 v54, v44, v45
    v_cvt_pk_bf16_f32 v55, v46, v47
    s_add_u32 s24, s28, 4096
    buffer_store_dwordx4 v[52:55], v81, s[16:19], s24 offen
    v_pk_mul_f32 v[40:41], v[240:241], s[30:31]
    v_pk_mul_f32 v[42:43], v[242:243], s[30:31]
    v_pk_mul_f32 v[44:45], v[244:245], s[30:31]
    v_pk_mul_f32 v[46:47], v[246:247], s[30:31]
    v_exp_f32 v40, v40
    v_exp_f32 v41, v41
    v_exp_f32 v42, v42
    v_exp_f32 v43, v43
    v_exp_f32 v44, v44
    v_exp_f32 v45, v45
    v_exp_f32 v46, v46
    v_exp_f32 v47, v47
    v_pk_add_f32 v[40:41], v[40:41], s[34:35]
    v_pk_add_f32 v[42:43], v[42:43], s[34:35]
    v_pk_add_f32 v[44:45], v[44:45], s[34:35]
    v_pk_add_f32 v[46:47], v[46:47], s[34:35]
    v_rcp_f32 v40, v40
    v_rcp_f32 v41, v41
    v_rcp_f32 v42, v42
    v_rcp_f32 v43, v43
    v_rcp_f32 v44, v44
    v_rcp_f32 v45, v45
    v_rcp_f32 v46, v46
    v_rcp_f32 v47, v47
    v_pk_mul_f32 v[40:41], v[240:241], v[40:41]
    v_pk_mul_f32 v[42:43], v[242:243], v[42:43]
    v_pk_mul_f32 v[44:45], v[244:245], v[44:45]
    v_pk_mul_f32 v[46:47], v[246:247], v[46:47]
    v_pk_mul_f32 v[40:41], v[40:41], v[248:249]
    v_pk_mul_f32 v[42:43], v[42:43], v[250:251]
    v_pk_mul_f32 v[44:45], v[44:45], v[252:253]
    v_pk_mul_f32 v[46:47], v[46:47], v[254:255]
    v_cvt_pk_bf16_f32 v52, v40, v41
    v_cvt_pk_bf16_f32 v53, v42, v43
    v_cvt_pk_bf16_f32 v54, v44, v45
    v_cvt_pk_bf16_f32 v55, v46, v47
    s_add_u32 s24, s28, 299008
    buffer_store_dwordx4 v[52:55], v81, s[16:19], s24 offen
    v_accvgpr_read_b32 v8, a0
    v_accvgpr_read_b32 v9, a1
    v_accvgpr_read_b32 v10, a2
    v_accvgpr_read_b32 v11, a3
    v_accvgpr_read_b32 v12, a4
    v_accvgpr_read_b32 v13, a5
    v_accvgpr_read_b32 v14, a6
    v_accvgpr_read_b32 v15, a7
    v_accvgpr_read_b32 v16, a8
    v_accvgpr_read_b32 v17, a9
    v_accvgpr_read_b32 v18, a10
    v_accvgpr_read_b32 v19, a11
    v_accvgpr_read_b32 v20, a12
    v_accvgpr_read_b32 v21, a13
    v_accvgpr_read_b32 v22, a14
    v_accvgpr_read_b32 v23, a15
    v_pk_mul_f32 v[40:41], v[8:9], s[30:31]
    v_pk_mul_f32 v[42:43], v[10:11], s[30:31]
    v_pk_mul_f32 v[44:45], v[12:13], s[30:31]
    v_pk_mul_f32 v[46:47], v[14:15], s[30:31]
    v_exp_f32 v40, v40
    v_exp_f32 v41, v41
    v_exp_f32 v42, v42
    v_exp_f32 v43, v43
    v_exp_f32 v44, v44
    v_exp_f32 v45, v45
    v_exp_f32 v46, v46
    v_exp_f32 v47, v47
    v_pk_add_f32 v[40:41], v[40:41], s[34:35]
    v_pk_add_f32 v[42:43], v[42:43], s[34:35]
    v_pk_add_f32 v[44:45], v[44:45], s[34:35]
    v_pk_add_f32 v[46:47], v[46:47], s[34:35]
    v_rcp_f32 v40, v40
    v_rcp_f32 v41, v41
    v_rcp_f32 v42, v42
    v_rcp_f32 v43, v43
    v_rcp_f32 v44, v44
    v_rcp_f32 v45, v45
    v_rcp_f32 v46, v46
    v_rcp_f32 v47, v47
    v_pk_mul_f32 v[40:41], v[8:9], v[40:41]
    v_pk_mul_f32 v[42:43], v[10:11], v[42:43]
    v_pk_mul_f32 v[44:45], v[12:13], v[44:45]
    v_pk_mul_f32 v[46:47], v[14:15], v[46:47]
    v_pk_mul_f32 v[40:41], v[40:41], v[16:17]
    v_pk_mul_f32 v[42:43], v[42:43], v[18:19]
    v_pk_mul_f32 v[44:45], v[44:45], v[20:21]
    v_pk_mul_f32 v[46:47], v[46:47], v[22:23]
    v_cvt_pk_bf16_f32 v52, v40, v41
    v_cvt_pk_bf16_f32 v53, v42, v43
    v_cvt_pk_bf16_f32 v54, v44, v45
    v_cvt_pk_bf16_f32 v55, v46, v47
    s_add_u32 s24, s28, 5120
    buffer_store_dwordx4 v[52:55], v81, s[16:19], s24 offen
    v_accvgpr_read_b32 v8, a16
    v_accvgpr_read_b32 v9, a17
    v_accvgpr_read_b32 v10, a18
    v_accvgpr_read_b32 v11, a19
    v_accvgpr_read_b32 v12, a20
    v_accvgpr_read_b32 v13, a21
    v_accvgpr_read_b32 v14, a22
    v_accvgpr_read_b32 v15, a23
    v_accvgpr_read_b32 v16, a24
    v_accvgpr_read_b32 v17, a25
    v_accvgpr_read_b32 v18, a26
    v_accvgpr_read_b32 v19, a27
    v_accvgpr_read_b32 v20, a28
    v_accvgpr_read_b32 v21, a29
    v_accvgpr_read_b32 v22, a30
    v_accvgpr_read_b32 v23, a31
    v_pk_mul_f32 v[40:41], v[8:9], s[30:31]
    v_pk_mul_f32 v[42:43], v[10:11], s[30:31]
    v_pk_mul_f32 v[44:45], v[12:13], s[30:31]
    v_pk_mul_f32 v[46:47], v[14:15], s[30:31]
    v_exp_f32 v40, v40
    v_exp_f32 v41, v41
    v_exp_f32 v42, v42
    v_exp_f32 v43, v43
    v_exp_f32 v44, v44
    v_exp_f32 v45, v45
    v_exp_f32 v46, v46
    v_exp_f32 v47, v47
    v_pk_add_f32 v[40:41], v[40:41], s[34:35]
    v_pk_add_f32 v[42:43], v[42:43], s[34:35]
    v_pk_add_f32 v[44:45], v[44:45], s[34:35]
    v_pk_add_f32 v[46:47], v[46:47], s[34:35]
    v_rcp_f32 v40, v40
    v_rcp_f32 v41, v41
    v_rcp_f32 v42, v42
    v_rcp_f32 v43, v43
    v_rcp_f32 v44, v44
    v_rcp_f32 v45, v45
    v_rcp_f32 v46, v46
    v_rcp_f32 v47, v47
    v_pk_mul_f32 v[40:41], v[8:9], v[40:41]
    v_pk_mul_f32 v[42:43], v[10:11], v[42:43]
    v_pk_mul_f32 v[44:45], v[12:13], v[44:45]
    v_pk_mul_f32 v[46:47], v[14:15], v[46:47]
    v_pk_mul_f32 v[40:41], v[40:41], v[16:17]
    v_pk_mul_f32 v[42:43], v[42:43], v[18:19]
    v_pk_mul_f32 v[44:45], v[44:45], v[20:21]
    v_pk_mul_f32 v[46:47], v[46:47], v[22:23]
    v_cvt_pk_bf16_f32 v52, v40, v41
    v_cvt_pk_bf16_f32 v53, v42, v43
    v_cvt_pk_bf16_f32 v54, v44, v45
    v_cvt_pk_bf16_f32 v55, v46, v47
    s_add_u32 s24, s28, 300032
    buffer_store_dwordx4 v[52:55], v81, s[16:19], s24 offen
    v_accvgpr_read_b32 v8, a32
    v_accvgpr_read_b32 v9, a33
    v_accvgpr_read_b32 v10, a34
    v_accvgpr_read_b32 v11, a35
    v_accvgpr_read_b32 v12, a36
    v_accvgpr_read_b32 v13, a37
    v_accvgpr_read_b32 v14, a38
    v_accvgpr_read_b32 v15, a39
    v_accvgpr_read_b32 v16, a40
    v_accvgpr_read_b32 v17, a41
    v_accvgpr_read_b32 v18, a42
    v_accvgpr_read_b32 v19, a43
    v_accvgpr_read_b32 v20, a44
    v_accvgpr_read_b32 v21, a45
    v_accvgpr_read_b32 v22, a46
    v_accvgpr_read_b32 v23, a47
    v_pk_mul_f32 v[40:41], v[8:9], s[30:31]
    v_pk_mul_f32 v[42:43], v[10:11], s[30:31]
    v_pk_mul_f32 v[44:45], v[12:13], s[30:31]
    v_pk_mul_f32 v[46:47], v[14:15], s[30:31]
    v_exp_f32 v40, v40
    v_exp_f32 v41, v41
    v_exp_f32 v42, v42
    v_exp_f32 v43, v43
    v_exp_f32 v44, v44
    v_exp_f32 v45, v45
    v_exp_f32 v46, v46
    v_exp_f32 v47, v47
    v_pk_add_f32 v[40:41], v[40:41], s[34:35]
    v_pk_add_f32 v[42:43], v[42:43], s[34:35]
    v_pk_add_f32 v[44:45], v[44:45], s[34:35]
    v_pk_add_f32 v[46:47], v[46:47], s[34:35]
    v_rcp_f32 v40, v40
    v_rcp_f32 v41, v41
    v_rcp_f32 v42, v42
    v_rcp_f32 v43, v43
    v_rcp_f32 v44, v44
    v_rcp_f32 v45, v45
    v_rcp_f32 v46, v46
    v_rcp_f32 v47, v47
    v_pk_mul_f32 v[40:41], v[8:9], v[40:41]
    v_pk_mul_f32 v[42:43], v[10:11], v[42:43]
    v_pk_mul_f32 v[44:45], v[12:13], v[44:45]
    v_pk_mul_f32 v[46:47], v[14:15], v[46:47]
    v_pk_mul_f32 v[40:41], v[40:41], v[16:17]
    v_pk_mul_f32 v[42:43], v[42:43], v[18:19]
    v_pk_mul_f32 v[44:45], v[44:45], v[20:21]
    v_pk_mul_f32 v[46:47], v[46:47], v[22:23]
    v_cvt_pk_bf16_f32 v52, v40, v41
    v_cvt_pk_bf16_f32 v53, v42, v43
    v_cvt_pk_bf16_f32 v54, v44, v45
    v_cvt_pk_bf16_f32 v55, v46, v47
    s_add_u32 s24, s28, 6144
    buffer_store_dwordx4 v[52:55], v81, s[16:19], s24 offen
    v_accvgpr_read_b32 v8, a48
    v_accvgpr_read_b32 v9, a49
    v_accvgpr_read_b32 v10, a50
    v_accvgpr_read_b32 v11, a51
    v_accvgpr_read_b32 v12, a52
    v_accvgpr_read_b32 v13, a53
    v_accvgpr_read_b32 v14, a54
    v_accvgpr_read_b32 v15, a55
    v_accvgpr_read_b32 v16, a56
    v_accvgpr_read_b32 v17, a57
    v_accvgpr_read_b32 v18, a58
    v_accvgpr_read_b32 v19, a59
    v_accvgpr_read_b32 v20, a60
    v_accvgpr_read_b32 v21, a61
    v_accvgpr_read_b32 v22, a62
    v_accvgpr_read_b32 v23, a63
    v_pk_mul_f32 v[40:41], v[8:9], s[30:31]
    v_pk_mul_f32 v[42:43], v[10:11], s[30:31]
    v_pk_mul_f32 v[44:45], v[12:13], s[30:31]
    v_pk_mul_f32 v[46:47], v[14:15], s[30:31]
    v_exp_f32 v40, v40
    v_exp_f32 v41, v41
    v_exp_f32 v42, v42
    v_exp_f32 v43, v43
    v_exp_f32 v44, v44
    v_exp_f32 v45, v45
    v_exp_f32 v46, v46
    v_exp_f32 v47, v47
    v_pk_add_f32 v[40:41], v[40:41], s[34:35]
    v_pk_add_f32 v[42:43], v[42:43], s[34:35]
    v_pk_add_f32 v[44:45], v[44:45], s[34:35]
    v_pk_add_f32 v[46:47], v[46:47], s[34:35]
    v_rcp_f32 v40, v40
    v_rcp_f32 v41, v41
    v_rcp_f32 v42, v42
    v_rcp_f32 v43, v43
    v_rcp_f32 v44, v44
    v_rcp_f32 v45, v45
    v_rcp_f32 v46, v46
    v_rcp_f32 v47, v47
    v_pk_mul_f32 v[40:41], v[8:9], v[40:41]
    v_pk_mul_f32 v[42:43], v[10:11], v[42:43]
    v_pk_mul_f32 v[44:45], v[12:13], v[44:45]
    v_pk_mul_f32 v[46:47], v[14:15], v[46:47]
    v_pk_mul_f32 v[40:41], v[40:41], v[16:17]
    v_pk_mul_f32 v[42:43], v[42:43], v[18:19]
    v_pk_mul_f32 v[44:45], v[44:45], v[20:21]
    v_pk_mul_f32 v[46:47], v[46:47], v[22:23]
    v_cvt_pk_bf16_f32 v52, v40, v41
    v_cvt_pk_bf16_f32 v53, v42, v43
    v_cvt_pk_bf16_f32 v54, v44, v45
    v_cvt_pk_bf16_f32 v55, v46, v47
    s_add_u32 s24, s28, 301056
    buffer_store_dwordx4 v[52:55], v81, s[16:19], s24 offen
    v_accvgpr_read_b32 v8, a64
    v_accvgpr_read_b32 v9, a65
    v_accvgpr_read_b32 v10, a66
    v_accvgpr_read_b32 v11, a67
    v_accvgpr_read_b32 v12, a68
    v_accvgpr_read_b32 v13, a69
    v_accvgpr_read_b32 v14, a70
    v_accvgpr_read_b32 v15, a71
    v_accvgpr_read_b32 v16, a72
    v_accvgpr_read_b32 v17, a73
    v_accvgpr_read_b32 v18, a74
    v_accvgpr_read_b32 v19, a75
    v_accvgpr_read_b32 v20, a76
    v_accvgpr_read_b32 v21, a77
    v_accvgpr_read_b32 v22, a78
    v_accvgpr_read_b32 v23, a79
    v_pk_mul_f32 v[40:41], v[8:9], s[30:31]
    v_pk_mul_f32 v[42:43], v[10:11], s[30:31]
    v_pk_mul_f32 v[44:45], v[12:13], s[30:31]
    v_pk_mul_f32 v[46:47], v[14:15], s[30:31]
    v_exp_f32 v40, v40
    v_exp_f32 v41, v41
    v_exp_f32 v42, v42
    v_exp_f32 v43, v43
    v_exp_f32 v44, v44
    v_exp_f32 v45, v45
    v_exp_f32 v46, v46
    v_exp_f32 v47, v47
    v_pk_add_f32 v[40:41], v[40:41], s[34:35]
    v_pk_add_f32 v[42:43], v[42:43], s[34:35]
    v_pk_add_f32 v[44:45], v[44:45], s[34:35]
    v_pk_add_f32 v[46:47], v[46:47], s[34:35]
    v_rcp_f32 v40, v40
    v_rcp_f32 v41, v41
    v_rcp_f32 v42, v42
    v_rcp_f32 v43, v43
    v_rcp_f32 v44, v44
    v_rcp_f32 v45, v45
    v_rcp_f32 v46, v46
    v_rcp_f32 v47, v47
    v_pk_mul_f32 v[40:41], v[8:9], v[40:41]
    v_pk_mul_f32 v[42:43], v[10:11], v[42:43]
    v_pk_mul_f32 v[44:45], v[12:13], v[44:45]
    v_pk_mul_f32 v[46:47], v[14:15], v[46:47]
    v_pk_mul_f32 v[40:41], v[40:41], v[16:17]
    v_pk_mul_f32 v[42:43], v[42:43], v[18:19]
    v_pk_mul_f32 v[44:45], v[44:45], v[20:21]
    v_pk_mul_f32 v[46:47], v[46:47], v[22:23]
    v_cvt_pk_bf16_f32 v52, v40, v41
    v_cvt_pk_bf16_f32 v53, v42, v43
    v_cvt_pk_bf16_f32 v54, v44, v45
    v_cvt_pk_bf16_f32 v55, v46, v47
    s_add_u32 s24, s28, 7168
    buffer_store_dwordx4 v[52:55], v81, s[16:19], s24 offen
    v_accvgpr_read_b32 v8, a80
    v_accvgpr_read_b32 v9, a81
    v_accvgpr_read_b32 v10, a82
    v_accvgpr_read_b32 v11, a83
    v_accvgpr_read_b32 v12, a84
    v_accvgpr_read_b32 v13, a85
    v_accvgpr_read_b32 v14, a86
    v_accvgpr_read_b32 v15, a87
    v_accvgpr_read_b32 v16, a88
    v_accvgpr_read_b32 v17, a89
    v_accvgpr_read_b32 v18, a90
    v_accvgpr_read_b32 v19, a91
    v_accvgpr_read_b32 v20, a92
    v_accvgpr_read_b32 v21, a93
    v_accvgpr_read_b32 v22, a94
    v_accvgpr_read_b32 v23, a95
    v_pk_mul_f32 v[40:41], v[8:9], s[30:31]
    v_pk_mul_f32 v[42:43], v[10:11], s[30:31]
    v_pk_mul_f32 v[44:45], v[12:13], s[30:31]
    v_pk_mul_f32 v[46:47], v[14:15], s[30:31]
    v_exp_f32 v40, v40
    v_exp_f32 v41, v41
    v_exp_f32 v42, v42
    v_exp_f32 v43, v43
    v_exp_f32 v44, v44
    v_exp_f32 v45, v45
    v_exp_f32 v46, v46
    v_exp_f32 v47, v47
    v_pk_add_f32 v[40:41], v[40:41], s[34:35]
    v_pk_add_f32 v[42:43], v[42:43], s[34:35]
    v_pk_add_f32 v[44:45], v[44:45], s[34:35]
    v_pk_add_f32 v[46:47], v[46:47], s[34:35]
    v_rcp_f32 v40, v40
    v_rcp_f32 v41, v41
    v_rcp_f32 v42, v42
    v_rcp_f32 v43, v43
    v_rcp_f32 v44, v44
    v_rcp_f32 v45, v45
    v_rcp_f32 v46, v46
    v_rcp_f32 v47, v47
    v_pk_mul_f32 v[40:41], v[8:9], v[40:41]
    v_pk_mul_f32 v[42:43], v[10:11], v[42:43]
    v_pk_mul_f32 v[44:45], v[12:13], v[44:45]
    v_pk_mul_f32 v[46:47], v[14:15], v[46:47]
    v_pk_mul_f32 v[40:41], v[40:41], v[16:17]
    v_pk_mul_f32 v[42:43], v[42:43], v[18:19]
    v_pk_mul_f32 v[44:45], v[44:45], v[20:21]
    v_pk_mul_f32 v[46:47], v[46:47], v[22:23]
    v_cvt_pk_bf16_f32 v52, v40, v41
    v_cvt_pk_bf16_f32 v53, v42, v43
    v_cvt_pk_bf16_f32 v54, v44, v45
    v_cvt_pk_bf16_f32 v55, v46, v47
    s_add_u32 s24, s28, 302080
    buffer_store_dwordx4 v[52:55], v81, s[16:19], s24 offen
    v_accvgpr_read_b32 v8, a96
    v_accvgpr_read_b32 v9, a97
    v_accvgpr_read_b32 v10, a98
    v_accvgpr_read_b32 v11, a99
    v_accvgpr_read_b32 v12, a100
    v_accvgpr_read_b32 v13, a101
    v_accvgpr_read_b32 v14, a102
    v_accvgpr_read_b32 v15, a103
    v_accvgpr_read_b32 v16, a104
    v_accvgpr_read_b32 v17, a105
    v_accvgpr_read_b32 v18, a106
    v_accvgpr_read_b32 v19, a107
    v_accvgpr_read_b32 v20, a108
    v_accvgpr_read_b32 v21, a109
    v_accvgpr_read_b32 v22, a110
    v_accvgpr_read_b32 v23, a111
    v_pk_mul_f32 v[40:41], v[8:9], s[30:31]
    v_pk_mul_f32 v[42:43], v[10:11], s[30:31]
    v_pk_mul_f32 v[44:45], v[12:13], s[30:31]
    v_pk_mul_f32 v[46:47], v[14:15], s[30:31]
    v_exp_f32 v40, v40
    v_exp_f32 v41, v41
    v_exp_f32 v42, v42
    v_exp_f32 v43, v43
    v_exp_f32 v44, v44
    v_exp_f32 v45, v45
    v_exp_f32 v46, v46
    v_exp_f32 v47, v47
    v_pk_add_f32 v[40:41], v[40:41], s[34:35]
    v_pk_add_f32 v[42:43], v[42:43], s[34:35]
    v_pk_add_f32 v[44:45], v[44:45], s[34:35]
    v_pk_add_f32 v[46:47], v[46:47], s[34:35]
    v_rcp_f32 v40, v40
    v_rcp_f32 v41, v41
    v_rcp_f32 v42, v42
    v_rcp_f32 v43, v43
    v_rcp_f32 v44, v44
    v_rcp_f32 v45, v45
    v_rcp_f32 v46, v46
    v_rcp_f32 v47, v47
    v_pk_mul_f32 v[40:41], v[8:9], v[40:41]
    v_pk_mul_f32 v[42:43], v[10:11], v[42:43]
    v_pk_mul_f32 v[44:45], v[12:13], v[44:45]
    v_pk_mul_f32 v[46:47], v[14:15], v[46:47]
    v_pk_mul_f32 v[40:41], v[40:41], v[16:17]
    v_pk_mul_f32 v[42:43], v[42:43], v[18:19]
    v_pk_mul_f32 v[44:45], v[44:45], v[20:21]
    v_pk_mul_f32 v[46:47], v[46:47], v[22:23]
    v_cvt_pk_bf16_f32 v52, v40, v41
    v_cvt_pk_bf16_f32 v53, v42, v43
    v_cvt_pk_bf16_f32 v54, v44, v45
    v_cvt_pk_bf16_f32 v55, v46, v47
    s_add_u32 s24, s28, 8192
    buffer_store_dwordx4 v[52:55], v81, s[16:19], s24 offen
    v_accvgpr_read_b32 v8, a112
    v_accvgpr_read_b32 v9, a113
    v_accvgpr_read_b32 v10, a114
    v_accvgpr_read_b32 v11, a115
    v_accvgpr_read_b32 v12, a116
    v_accvgpr_read_b32 v13, a117
    v_accvgpr_read_b32 v14, a118
    v_accvgpr_read_b32 v15, a119
    v_accvgpr_read_b32 v16, a120
    v_accvgpr_read_b32 v17, a121
    v_accvgpr_read_b32 v18, a122
    v_accvgpr_read_b32 v19, a123
    v_accvgpr_read_b32 v20, a124
    v_accvgpr_read_b32 v21, a125
    v_accvgpr_read_b32 v22, a126
    v_accvgpr_read_b32 v23, a127
    v_pk_mul_f32 v[40:41], v[8:9], s[30:31]
    v_pk_mul_f32 v[42:43], v[10:11], s[30:31]
    v_pk_mul_f32 v[44:45], v[12:13], s[30:31]
    v_pk_mul_f32 v[46:47], v[14:15], s[30:31]
    v_exp_f32 v40, v40
    v_exp_f32 v41, v41
    v_exp_f32 v42, v42
    v_exp_f32 v43, v43
    v_exp_f32 v44, v44
    v_exp_f32 v45, v45
    v_exp_f32 v46, v46
    v_exp_f32 v47, v47
    v_pk_add_f32 v[40:41], v[40:41], s[34:35]
    v_pk_add_f32 v[42:43], v[42:43], s[34:35]
    v_pk_add_f32 v[44:45], v[44:45], s[34:35]
    v_pk_add_f32 v[46:47], v[46:47], s[34:35]
    v_rcp_f32 v40, v40
    v_rcp_f32 v41, v41
    v_rcp_f32 v42, v42
    v_rcp_f32 v43, v43
    v_rcp_f32 v44, v44
    v_rcp_f32 v45, v45
    v_rcp_f32 v46, v46
    v_rcp_f32 v47, v47
    v_pk_mul_f32 v[40:41], v[8:9], v[40:41]
    v_pk_mul_f32 v[42:43], v[10:11], v[42:43]
    v_pk_mul_f32 v[44:45], v[12:13], v[44:45]
    v_pk_mul_f32 v[46:47], v[14:15], v[46:47]
    v_pk_mul_f32 v[40:41], v[40:41], v[16:17]
    v_pk_mul_f32 v[42:43], v[42:43], v[18:19]
    v_pk_mul_f32 v[44:45], v[44:45], v[20:21]
    v_pk_mul_f32 v[46:47], v[46:47], v[22:23]
    v_cvt_pk_bf16_f32 v52, v40, v41
    v_cvt_pk_bf16_f32 v53, v42, v43
    v_cvt_pk_bf16_f32 v54, v44, v45
    v_cvt_pk_bf16_f32 v55, v46, v47
    s_add_u32 s24, s28, 303104
    buffer_store_dwordx4 v[52:55], v81, s[16:19], s24 offen
k3_kernel_end:
    s_endpgm
.globl k4a_kernel
.p2align 8
.type k4a_kernel,@function
k4a_kernel:
    s_cmp_ge_u32 s2, 256
    s_cbranch_scc1 k4a_kernel_end
    s_load_dwordx2 s[8:9], s[0:1], 72
    v_lshrrev_b32 v1, 6, v0
    v_and_b32 v0, 63, v0
    s_nop 0
    v_readfirstlane_b32 s20, v1
    s_bfe_u32 s21, s2, 0x30003
    s_and_b32 s22, s2, 7
    s_lshl_b32 s22, s22, 2
    s_lshr_b32 s23, s2, 6
    s_add_u32 s22, s22, s23
    s_mul_i32 s23, s22, 589824
    s_lshl_b32 s24, s20, 10
    s_add_u32 s23, s23, s24
    s_add_u32 s23, s23, 8388608
    s_mul_i32 s26, s21, 288
    s_add_u32 s26, s26, s20
    s_mul_i32 s26, s26, 2304
    s_add_u32 s26, s26, 75497472
    v_lshlrev_b32 v7, 4, v0
    v_lshrrev_b32 v6, 5, v0
    v_lshlrev_b32 v6, 3, v6
    v_and_b32 v5, 7, v0
    v_add_u32 v6, v6, v5
    v_lshlrev_b32 v6, 4, v6
    s_waitcnt lgkmcnt(0)
    s_mov_b32 s16, s8
    s_and_b32 s17, s9, 0xffff
    s_mov_b32 s18, 268435456
    s_mov_b32 s19, 0x00020000
    s_add_u32 s25, s26, 0
    buffer_load_dwordx4 v[8:11], v7, s[16:19], s25 offen offset:0
    buffer_load_dwordx4 v[12:15], v7, s[16:19], s25 offen offset:1024
    buffer_load_dwordx4 v[16:19], v6, s[16:19], s25 offen offset:2048
    s_add_u32 s24, s23, 0
    buffer_load_dwordx4 v[20:23], v7, s[16:19], s24 offen
    s_add_u32 s24, s23, 294912
    buffer_load_dwordx4 v[24:27], v7, s[16:19], s24 offen
    s_add_u32 s25, s26, 9216
    buffer_load_dwordx4 v[28:31], v7, s[16:19], s25 offen offset:0
    buffer_load_dwordx4 v[32:35], v7, s[16:19], s25 offen offset:1024
    buffer_load_dwordx4 v[36:39], v6, s[16:19], s25 offen offset:2048
    s_add_u32 s24, s23, 4096
    buffer_load_dwordx4 v[40:43], v7, s[16:19], s24 offen
    s_add_u32 s24, s23, 299008
    buffer_load_dwordx4 v[44:47], v7, s[16:19], s24 offen
    s_add_u32 s25, s26, 18432
    buffer_load_dwordx4 v[48:51], v7, s[16:19], s25 offen offset:0
    buffer_load_dwordx4 v[52:55], v7, s[16:19], s25 offen offset:1024
    buffer_load_dwordx4 v[56:59], v6, s[16:19], s25 offen offset:2048
    s_add_u32 s24, s23, 8192
    buffer_load_dwordx4 v[60:63], v7, s[16:19], s24 offen
    s_add_u32 s24, s23, 303104
    buffer_load_dwordx4 v[64:67], v7, s[16:19], s24 offen
    s_add_u32 s25, s26, 27648
    buffer_load_dwordx4 v[68:71], v7, s[16:19], s25 offen offset:0
    buffer_load_dwordx4 v[72:75], v7, s[16:19], s25 offen offset:1024
    buffer_load_dwordx4 v[76:79], v6, s[16:19], s25 offen offset:2048
    s_add_u32 s24, s23, 12288
    buffer_load_dwordx4 v[80:83], v7, s[16:19], s24 offen
    s_add_u32 s24, s23, 307200
    buffer_load_dwordx4 v[84:87], v7, s[16:19], s24 offen
    s_add_u32 s25, s26, 36864
    buffer_load_dwordx4 v[88:91], v7, s[16:19], s25 offen offset:0
    buffer_load_dwordx4 v[92:95], v7, s[16:19], s25 offen offset:1024
    buffer_load_dwordx4 v[96:99], v6, s[16:19], s25 offen offset:2048
    s_add_u32 s24, s23, 16384
    buffer_load_dwordx4 v[100:103], v7, s[16:19], s24 offen
    s_add_u32 s24, s23, 311296
    buffer_load_dwordx4 v[104:107], v7, s[16:19], s24 offen
    v_accvgpr_write_b32 a0, 0
    v_accvgpr_write_b32 a1, 0
    v_accvgpr_write_b32 a2, 0
    v_accvgpr_write_b32 a3, 0
    v_accvgpr_write_b32 a4, 0
    v_accvgpr_write_b32 a5, 0
    v_accvgpr_write_b32 a6, 0
    v_accvgpr_write_b32 a7, 0
    v_accvgpr_write_b32 a8, 0
    v_accvgpr_write_b32 a9, 0
    v_accvgpr_write_b32 a10, 0
    v_accvgpr_write_b32 a11, 0
    v_accvgpr_write_b32 a12, 0
    v_accvgpr_write_b32 a13, 0
    v_accvgpr_write_b32 a14, 0
    v_accvgpr_write_b32 a15, 0
    v_accvgpr_write_b32 a16, 0
    v_accvgpr_write_b32 a17, 0
    v_accvgpr_write_b32 a18, 0
    v_accvgpr_write_b32 a19, 0
    v_accvgpr_write_b32 a20, 0
    v_accvgpr_write_b32 a21, 0
    v_accvgpr_write_b32 a22, 0
    v_accvgpr_write_b32 a23, 0
    v_accvgpr_write_b32 a24, 0
    v_accvgpr_write_b32 a25, 0
    v_accvgpr_write_b32 a26, 0
    v_accvgpr_write_b32 a27, 0
    v_accvgpr_write_b32 a28, 0
    v_accvgpr_write_b32 a29, 0
    v_accvgpr_write_b32 a30, 0
    v_accvgpr_write_b32 a31, 0
    v_accvgpr_write_b32 a32, 0
    v_accvgpr_write_b32 a33, 0
    v_accvgpr_write_b32 a34, 0
    v_accvgpr_write_b32 a35, 0
    v_accvgpr_write_b32 a36, 0
    v_accvgpr_write_b32 a37, 0
    v_accvgpr_write_b32 a38, 0
    v_accvgpr_write_b32 a39, 0
    v_accvgpr_write_b32 a40, 0
    v_accvgpr_write_b32 a41, 0
    v_accvgpr_write_b32 a42, 0
    v_accvgpr_write_b32 a43, 0
    v_accvgpr_write_b32 a44, 0
    v_accvgpr_write_b32 a45, 0
    v_accvgpr_write_b32 a46, 0
    v_accvgpr_write_b32 a47, 0
    v_accvgpr_write_b32 a48, 0
    v_accvgpr_write_b32 a49, 0
    v_accvgpr_write_b32 a50, 0
    v_accvgpr_write_b32 a51, 0
    v_accvgpr_write_b32 a52, 0
    v_accvgpr_write_b32 a53, 0
    v_accvgpr_write_b32 a54, 0
    v_accvgpr_write_b32 a55, 0
    v_accvgpr_write_b32 a56, 0
    v_accvgpr_write_b32 a57, 0
    v_accvgpr_write_b32 a58, 0
    v_accvgpr_write_b32 a59, 0
    v_accvgpr_write_b32 a60, 0
    v_accvgpr_write_b32 a61, 0
    v_accvgpr_write_b32 a62, 0
    v_accvgpr_write_b32 a63, 0
    v_accvgpr_write_b32 a64, 0
    v_accvgpr_write_b32 a65, 0
    v_accvgpr_write_b32 a66, 0
    v_accvgpr_write_b32 a67, 0
    v_accvgpr_write_b32 a68, 0
    v_accvgpr_write_b32 a69, 0
    v_accvgpr_write_b32 a70, 0
    v_accvgpr_write_b32 a71, 0
    v_accvgpr_write_b32 a72, 0
    v_accvgpr_write_b32 a73, 0
    v_accvgpr_write_b32 a74, 0
    v_accvgpr_write_b32 a75, 0
    v_accvgpr_write_b32 a76, 0
    v_accvgpr_write_b32 a77, 0
    v_accvgpr_write_b32 a78, 0
    v_accvgpr_write_b32 a79, 0
    v_accvgpr_write_b32 a80, 0
    v_accvgpr_write_b32 a81, 0
    v_accvgpr_write_b32 a82, 0
    v_accvgpr_write_b32 a83, 0
    v_accvgpr_write_b32 a84, 0
    v_accvgpr_write_b32 a85, 0
    v_accvgpr_write_b32 a86, 0
    v_accvgpr_write_b32 a87, 0
    v_accvgpr_write_b32 a88, 0
    v_accvgpr_write_b32 a89, 0
    v_accvgpr_write_b32 a90, 0
    v_accvgpr_write_b32 a91, 0
    v_accvgpr_write_b32 a92, 0
    v_accvgpr_write_b32 a93, 0
    v_accvgpr_write_b32 a94, 0
    v_accvgpr_write_b32 a95, 0
    s_mov_b32 s34, 0
k4a_kernel_loop:
    s_waitcnt vmcnt(20)
    v_mfma_f32_32x32x16_bf16 a[0:15], v[8:11], v[20:23], a[0:15]
    s_add_u32 s25, s26, 46080
    buffer_load_dwordx4 v[108:111], v7, s[16:19], s25 offen offset:0
    buffer_load_dwordx4 v[112:115], v7, s[16:19], s25 offen offset:1024
    buffer_load_dwordx4 v[116:119], v6, s[16:19], s25 offen offset:2048
    s_add_u32 s24, s23, 20480
    buffer_load_dwordx4 v[120:123], v7, s[16:19], s24 offen
    s_add_u32 s24, s23, 315392
    buffer_load_dwordx4 v[124:127], v7, s[16:19], s24 offen
    v_mfma_f32_32x32x16_bf16 a[16:31], v[8:11], v[24:27], a[16:31]
    v_mfma_f32_32x32x16_bf16 a[32:47], v[12:15], v[20:23], a[32:47]
    v_mfma_f32_32x32x16_bf16 a[48:63], v[12:15], v[24:27], a[48:63]
    v_mfma_f32_32x32x16_bf16 a[64:79], v[16:19], v[20:23], a[64:79]
    v_mfma_f32_32x32x16_bf16 a[80:95], v[16:19], v[24:27], a[80:95]
    s_waitcnt vmcnt(20)
    v_mfma_f32_32x32x16_bf16 a[0:15], v[28:31], v[40:43], a[0:15]
    s_add_u32 s25, s26, 55296
    buffer_load_dwordx4 v[8:11], v7, s[16:19], s25 offen offset:0
    buffer_load_dwordx4 v[12:15], v7, s[16:19], s25 offen offset:1024
    buffer_load_dwordx4 v[16:19], v6, s[16:19], s25 offen offset:2048
    s_add_u32 s24, s23, 24576
    buffer_load_dwordx4 v[20:23], v7, s[16:19], s24 offen
    s_add_u32 s24, s23, 319488
    buffer_load_dwordx4 v[24:27], v7, s[16:19], s24 offen
    v_mfma_f32_32x32x16_bf16 a[16:31], v[28:31], v[44:47], a[16:31]
    v_mfma_f32_32x32x16_bf16 a[32:47], v[32:35], v[40:43], a[32:47]
    v_mfma_f32_32x32x16_bf16 a[48:63], v[32:35], v[44:47], a[48:63]
    v_mfma_f32_32x32x16_bf16 a[64:79], v[36:39], v[40:43], a[64:79]
    v_mfma_f32_32x32x16_bf16 a[80:95], v[36:39], v[44:47], a[80:95]
    s_waitcnt vmcnt(20)
    v_mfma_f32_32x32x16_bf16 a[0:15], v[48:51], v[60:63], a[0:15]
    s_add_u32 s25, s26, 64512
    buffer_load_dwordx4 v[28:31], v7, s[16:19], s25 offen offset:0
    buffer_load_dwordx4 v[32:35], v7, s[16:19], s25 offen offset:1024
    buffer_load_dwordx4 v[36:39], v6, s[16:19], s25 offen offset:2048
    s_add_u32 s24, s23, 28672
    buffer_load_dwordx4 v[40:43], v7, s[16:19], s24 offen
    s_add_u32 s24, s23, 323584
    buffer_load_dwordx4 v[44:47], v7, s[16:19], s24 offen
    v_mfma_f32_32x32x16_bf16 a[16:31], v[48:51], v[64:67], a[16:31]
    v_mfma_f32_32x32x16_bf16 a[32:47], v[52:55], v[60:63], a[32:47]
    v_mfma_f32_32x32x16_bf16 a[48:63], v[52:55], v[64:67], a[48:63]
    v_mfma_f32_32x32x16_bf16 a[64:79], v[56:59], v[60:63], a[64:79]
    v_mfma_f32_32x32x16_bf16 a[80:95], v[56:59], v[64:67], a[80:95]
    s_waitcnt vmcnt(20)
    v_mfma_f32_32x32x16_bf16 a[0:15], v[68:71], v[80:83], a[0:15]
    s_add_u32 s25, s26, 73728
    buffer_load_dwordx4 v[48:51], v7, s[16:19], s25 offen offset:0
    buffer_load_dwordx4 v[52:55], v7, s[16:19], s25 offen offset:1024
    buffer_load_dwordx4 v[56:59], v6, s[16:19], s25 offen offset:2048
    s_add_u32 s24, s23, 32768
    buffer_load_dwordx4 v[60:63], v7, s[16:19], s24 offen
    s_add_u32 s24, s23, 327680
    buffer_load_dwordx4 v[64:67], v7, s[16:19], s24 offen
    v_mfma_f32_32x32x16_bf16 a[16:31], v[68:71], v[84:87], a[16:31]
    v_mfma_f32_32x32x16_bf16 a[32:47], v[72:75], v[80:83], a[32:47]
    v_mfma_f32_32x32x16_bf16 a[48:63], v[72:75], v[84:87], a[48:63]
    v_mfma_f32_32x32x16_bf16 a[64:79], v[76:79], v[80:83], a[64:79]
    v_mfma_f32_32x32x16_bf16 a[80:95], v[76:79], v[84:87], a[80:95]
    s_waitcnt vmcnt(20)
    v_mfma_f32_32x32x16_bf16 a[0:15], v[88:91], v[100:103], a[0:15]
    s_add_u32 s25, s26, 82944
    buffer_load_dwordx4 v[68:71], v7, s[16:19], s25 offen offset:0
    buffer_load_dwordx4 v[72:75], v7, s[16:19], s25 offen offset:1024
    buffer_load_dwordx4 v[76:79], v6, s[16:19], s25 offen offset:2048
    s_add_u32 s24, s23, 36864
    buffer_load_dwordx4 v[80:83], v7, s[16:19], s24 offen
    s_add_u32 s24, s23, 331776
    buffer_load_dwordx4 v[84:87], v7, s[16:19], s24 offen
    v_mfma_f32_32x32x16_bf16 a[16:31], v[88:91], v[104:107], a[16:31]
    v_mfma_f32_32x32x16_bf16 a[32:47], v[92:95], v[100:103], a[32:47]
    v_mfma_f32_32x32x16_bf16 a[48:63], v[92:95], v[104:107], a[48:63]
    v_mfma_f32_32x32x16_bf16 a[64:79], v[96:99], v[100:103], a[64:79]
    v_mfma_f32_32x32x16_bf16 a[80:95], v[96:99], v[104:107], a[80:95]
    s_waitcnt vmcnt(20)
    v_mfma_f32_32x32x16_bf16 a[0:15], v[108:111], v[120:123], a[0:15]
    s_add_u32 s25, s26, 92160
    buffer_load_dwordx4 v[88:91], v7, s[16:19], s25 offen offset:0
    buffer_load_dwordx4 v[92:95], v7, s[16:19], s25 offen offset:1024
    buffer_load_dwordx4 v[96:99], v6, s[16:19], s25 offen offset:2048
    s_add_u32 s24, s23, 40960
    buffer_load_dwordx4 v[100:103], v7, s[16:19], s24 offen
    s_add_u32 s24, s23, 335872
    buffer_load_dwordx4 v[104:107], v7, s[16:19], s24 offen
    v_mfma_f32_32x32x16_bf16 a[16:31], v[108:111], v[124:127], a[16:31]
    v_mfma_f32_32x32x16_bf16 a[32:47], v[112:115], v[120:123], a[32:47]
    v_mfma_f32_32x32x16_bf16 a[48:63], v[112:115], v[124:127], a[48:63]
    v_mfma_f32_32x32x16_bf16 a[64:79], v[116:119], v[120:123], a[64:79]
    v_mfma_f32_32x32x16_bf16 a[80:95], v[116:119], v[124:127], a[80:95]
    s_add_u32 s26, s26, 55296
    s_add_u32 s23, s23, 24576
    s_add_u32 s34, s34, 1
    s_cmp_lt_u32 s34, 11
    s_cbranch_scc1 k4a_kernel_loop
    s_waitcnt vmcnt(20)
    v_mfma_f32_32x32x16_bf16 a[0:15], v[8:11], v[20:23], a[0:15]
    s_add_u32 s25, s26, 46080
    buffer_load_dwordx4 v[108:111], v7, s[16:19], s25 offen offset:0
    buffer_load_dwordx4 v[112:115], v7, s[16:19], s25 offen offset:1024
    buffer_load_dwordx4 v[116:119], v6, s[16:19], s25 offen offset:2048
    s_add_u32 s24, s23, 20480
    buffer_load_dwordx4 v[120:123], v7, s[16:19], s24 offen
    s_add_u32 s24, s23, 315392
    buffer_load_dwordx4 v[124:127], v7, s[16:19], s24 offen
    v_mfma_f32_32x32x16_bf16 a[16:31], v[8:11], v[24:27], a[16:31]
    v_mfma_f32_32x32x16_bf16 a[32:47], v[12:15], v[20:23], a[32:47]
    v_mfma_f32_32x32x16_bf16 a[48:63], v[12:15], v[24:27], a[48:63]
    v_mfma_f32_32x32x16_bf16 a[64:79], v[16:19], v[20:23], a[64:79]
    v_mfma_f32_32x32x16_bf16 a[80:95], v[16:19], v[24:27], a[80:95]
    s_waitcnt vmcnt(20)
    v_mfma_f32_32x32x16_bf16 a[0:15], v[28:31], v[40:43], a[0:15]
    v_mfma_f32_32x32x16_bf16 a[16:31], v[28:31], v[44:47], a[16:31]
    v_mfma_f32_32x32x16_bf16 a[32:47], v[32:35], v[40:43], a[32:47]
    v_mfma_f32_32x32x16_bf16 a[48:63], v[32:35], v[44:47], a[48:63]
    v_mfma_f32_32x32x16_bf16 a[64:79], v[36:39], v[40:43], a[64:79]
    v_mfma_f32_32x32x16_bf16 a[80:95], v[36:39], v[44:47], a[80:95]
    s_waitcnt vmcnt(15)
    v_mfma_f32_32x32x16_bf16 a[0:15], v[48:51], v[60:63], a[0:15]
    v_mfma_f32_32x32x16_bf16 a[16:31], v[48:51], v[64:67], a[16:31]
    v_mfma_f32_32x32x16_bf16 a[32:47], v[52:55], v[60:63], a[32:47]
    v_mfma_f32_32x32x16_bf16 a[48:63], v[52:55], v[64:67], a[48:63]
    v_mfma_f32_32x32x16_bf16 a[64:79], v[56:59], v[60:63], a[64:79]
    v_mfma_f32_32x32x16_bf16 a[80:95], v[56:59], v[64:67], a[80:95]
    s_waitcnt vmcnt(10)
    v_mfma_f32_32x32x16_bf16 a[0:15], v[68:71], v[80:83], a[0:15]
    v_mfma_f32_32x32x16_bf16 a[16:31], v[68:71], v[84:87], a[16:31]
    v_mfma_f32_32x32x16_bf16 a[32:47], v[72:75], v[80:83], a[32:47]
    v_mfma_f32_32x32x16_bf16 a[48:63], v[72:75], v[84:87], a[48:63]
    v_mfma_f32_32x32x16_bf16 a[64:79], v[76:79], v[80:83], a[64:79]
    v_mfma_f32_32x32x16_bf16 a[80:95], v[76:79], v[84:87], a[80:95]
    s_waitcnt vmcnt(5)
    v_mfma_f32_32x32x16_bf16 a[0:15], v[88:91], v[100:103], a[0:15]
    v_mfma_f32_32x32x16_bf16 a[16:31], v[88:91], v[104:107], a[16:31]
    v_mfma_f32_32x32x16_bf16 a[32:47], v[92:95], v[100:103], a[32:47]
    v_mfma_f32_32x32x16_bf16 a[48:63], v[92:95], v[104:107], a[48:63]
    v_mfma_f32_32x32x16_bf16 a[64:79], v[96:99], v[100:103], a[64:79]
    v_mfma_f32_32x32x16_bf16 a[80:95], v[96:99], v[104:107], a[80:95]
    s_waitcnt vmcnt(0)
    v_mfma_f32_32x32x16_bf16 a[0:15], v[108:111], v[120:123], a[0:15]
    v_mfma_f32_32x32x16_bf16 a[16:31], v[108:111], v[124:127], a[16:31]
    v_mfma_f32_32x32x16_bf16 a[32:47], v[112:115], v[120:123], a[32:47]
    v_mfma_f32_32x32x16_bf16 a[48:63], v[112:115], v[124:127], a[48:63]
    v_mfma_f32_32x32x16_bf16 a[64:79], v[116:119], v[120:123], a[64:79]
    v_mfma_f32_32x32x16_bf16 a[80:95], v[116:119], v[124:127], a[80:95]
    s_lshl_b32 s30, s20, 6
    v_add_u32 v13, s30, v0
    v_lshrrev_b32 v1, 2, v13
    v_and_b32 v2, 3, v13
    s_lshl_b32 s30, s22, 6
    v_add_u32 v3, s30, v1
    s_mul_i32 s31, s21, 9
    v_lshrrev_b32 v8, 5, v3
    v_mul_u32_u24 v8, 36864, v8
    v_and_b32 v9, 31, v3
    v_lshlrev_b32 v9, 4, v9
    v_add_u32 v8, v8, v9
    v_mul_u32_u24 v9, 1152, v3
    s_mov_b32 s33, 0
    v_add_u32 v4, 0, v2
    v_add_u32 v4, s31, v4
    v_lshrrev_b32 v5, 1, v4
    v_lshlrev_b32 v5, 10, v5
    v_and_b32 v6, 1, v4
    v_lshlrev_b32 v6, 9, v6
    v_add3_u32 v5, v5, v6, v8
    buffer_load_dwordx4 v[16:19], v5, s[16:19], s33 offen
    v_lshlrev_b32 v4, 4, v4
    v_add_u32 v10, v9, v4
    v_add_u32 v4, 4, v2
    v_add_u32 v4, s31, v4
    v_lshrrev_b32 v5, 1, v4
    v_lshlrev_b32 v5, 10, v5
    v_and_b32 v6, 1, v4
    v_lshlrev_b32 v6, 9, v6
    v_add3_u32 v5, v5, v6, v8
    buffer_load_dwordx4 v[20:23], v5, s[16:19], s33 offen
    v_lshlrev_b32 v4, 4, v4
    v_add_u32 v11, v9, v4
    v_mov_b32 v4, 8
    v_add_u32 v4, s31, v4
    v_lshrrev_b32 v5, 1, v4
    v_lshlrev_b32 v5, 10, v5
    v_and_b32 v6, 1, v4
    v_lshlrev_b32 v6, 9, v6
    v_add3_u32 v5, v5, v6, v8
    buffer_load_dwordx4 v[24:27], v5, s[16:19], s33 offen
    v_lshlrev_b32 v4, 4, v4
    v_add_u32 v12, v9, v4
    v_and_b32 v7, 31, v0
    v_mul_u32_u24 v7, 304, v7
    v_lshrrev_b32 v28, 5, v0
    v_lshlrev_b32 v28, 4, v28
    s_mul_i32 s32, s20, 19456
    v_add3_u32 v7, v7, v28, s32
    ds_write_b128 v7, a[0:3] offset:0
    ds_write_b128 v7, a[4:7] offset:32
    ds_write_b128 v7, a[8:11] offset:64
    ds_write_b128 v7, a[12:15] offset:96
    ds_write_b128 v7, a[16:19] offset:9728
    ds_write_b128 v7, a[20:23] offset:9760
    ds_write_b128 v7, a[24:27] offset:9792
    ds_write_b128 v7, a[28:31] offset:9824
    ds_write_b128 v7, a[32:35] offset:128
    ds_write_b128 v7, a[36:39] offset:160
    ds_write_b128 v7, a[40:43] offset:192
    ds_write_b128 v7, a[44:47] offset:224
    ds_write_b128 v7, a[48:51] offset:9856
    ds_write_b128 v7, a[52:55] offset:9888
    ds_write_b128 v7, a[56:59] offset:9920
    ds_write_b128 v7, a[60:63] offset:9952
    ds_write_b128 v7, a[64:67] offset:256
    ds_write_b128 v7, a[80:83] offset:9984
    s_waitcnt lgkmcnt(0)
    s_barrier
    v_mul_u32_u24 v7, 304, v1
    v_lshlrev_b32 v28, 5, v2
    v_add_u32 v28, v7, v28
    ds_read_b128 v[32:35], v28 offset:0
    ds_read_b128 v[36:39], v28 offset:16
    ds_read_b128 v[40:43], v28 offset:128
    ds_read_b128 v[44:47], v28 offset:144
    ds_read_b128 v[48:51], v7 offset:256
    ds_read_b128 v[52:55], v7 offset:272
    ds_read_b128 v[56:59], v28 offset:19456
    ds_read_b128 v[60:63], v28 offset:19472
    ds_read_b128 v[64:67], v28 offset:19584
    ds_read_b128 v[68:71], v28 offset:19600
    ds_read_b128 v[72:75], v7 offset:19712
    ds_read_b128 v[76:79], v7 offset:19728
    ds_read_b128 v[80:83], v28 offset:38912
    ds_read_b128 v[84:87], v28 offset:38928
    ds_read_b128 v[88:91], v28 offset:39040
    ds_read_b128 v[92:95], v28 offset:39056
    ds_read_b128 v[96:99], v7 offset:39168
    ds_read_b128 v[100:103], v7 offset:39184
    ds_read_b128 v[104:107], v28 offset:58368
    ds_read_b128 v[108:111], v28 offset:58384
    ds_read_b128 v[112:115], v28 offset:58496
    ds_read_b128 v[116:119], v28 offset:58512
    ds_read_b128 v[120:123], v7 offset:58624
    ds_read_b128 v[124:127], v7 offset:58640
    s_mov_b32 s32, 0xffff0000
    s_waitcnt lgkmcnt(12)
    v_add_f32 v32, v32, v56
    v_add_f32 v33, v33, v57
    v_add_f32 v34, v34, v58
    v_add_f32 v35, v35, v59
    v_add_f32 v36, v36, v60
    v_add_f32 v37, v37, v61
    v_add_f32 v38, v38, v62
    v_add_f32 v39, v39, v63
    v_add_f32 v40, v40, v64
    v_add_f32 v41, v41, v65
    v_add_f32 v42, v42, v66
    v_add_f32 v43, v43, v67
    v_add_f32 v44, v44, v68
    v_add_f32 v45, v45, v69
    v_add_f32 v46, v46, v70
    v_add_f32 v47, v47, v71
    v_add_f32 v48, v48, v72
    v_add_f32 v49, v49, v73
    v_add_f32 v50, v50, v74
    v_add_f32 v51, v51, v75
    v_add_f32 v52, v52, v76
    v_add_f32 v53, v53, v77
    v_add_f32 v54, v54, v78
    v_add_f32 v55, v55, v79
    s_waitcnt lgkmcnt(0)
    v_add_f32 v80, v80, v104
    v_add_f32 v81, v81, v105
    v_add_f32 v82, v82, v106
    v_add_f32 v83, v83, v107
    v_add_f32 v84, v84, v108
    v_add_f32 v85, v85, v109
    v_add_f32 v86, v86, v110
    v_add_f32 v87, v87, v111
    v_add_f32 v88, v88, v112
    v_add_f32 v89, v89, v113
    v_add_f32 v90, v90, v114
    v_add_f32 v91, v91, v115
    v_add_f32 v92, v92, v116
    v_add_f32 v93, v93, v117
    v_add_f32 v94, v94, v118
    v_add_f32 v95, v95, v119
    v_add_f32 v96, v96, v120
    v_add_f32 v97, v97, v121
    v_add_f32 v98, v98, v122
    v_add_f32 v99, v99, v123
    v_add_f32 v100, v100, v124
    v_add_f32 v101, v101, v125
    v_add_f32 v102, v102, v126
    v_add_f32 v103, v103, v127
    v_add_f32 v32, v32, v80
    v_add_f32 v33, v33, v81
    v_add_f32 v34, v34, v82
    v_add_f32 v35, v35, v83
    v_add_f32 v36, v36, v84
    v_add_f32 v37, v37, v85
    v_add_f32 v38, v38, v86
    v_add_f32 v39, v39, v87
    v_add_f32 v40, v40, v88
    v_add_f32 v41, v41, v89
    v_add_f32 v42, v42, v90
    v_add_f32 v43, v43, v91
    v_add_f32 v44, v44, v92
    v_add_f32 v45, v45, v93
    v_add_f32 v46, v46, v94
    v_add_f32 v47, v47, v95
    v_add_f32 v48, v48, v96
    v_add_f32 v49, v49, v97
    v_add_f32 v50, v50, v98
    v_add_f32 v51, v51, v99
    v_add_f32 v52, v52, v100
    v_add_f32 v53, v53, v101
    v_add_f32 v54, v54, v102
    v_add_f32 v55, v55, v103
    s_waitcnt vmcnt(0)
    v_cvt_pk_bf16_f32 v80, v32, v33
    v_lshlrev_b32 v81, 16, v80
    v_and_b32 v82, s32, v80
    v_lshlrev_b32 v83, 16, v16
    v_and_b32 v84, s32, v16
    v_add_f32 v81, v81, v83
    v_add_f32 v82, v82, v84
    v_cvt_pk_bf16_f32 v128, v81, v82
    v_cvt_pk_bf16_f32 v80, v34, v35
    v_lshlrev_b32 v81, 16, v80
    v_and_b32 v82, s32, v80
    v_lshlrev_b32 v83, 16, v17
    v_and_b32 v84, s32, v17
    v_add_f32 v81, v81, v83
    v_add_f32 v82, v82, v84
    v_cvt_pk_bf16_f32 v129, v81, v82
    v_cvt_pk_bf16_f32 v80, v36, v37
    v_lshlrev_b32 v81, 16, v80
    v_and_b32 v82, s32, v80
    v_lshlrev_b32 v83, 16, v18
    v_and_b32 v84, s32, v18
    v_add_f32 v81, v81, v83
    v_add_f32 v82, v82, v84
    v_cvt_pk_bf16_f32 v130, v81, v82
    v_cvt_pk_bf16_f32 v80, v38, v39
    v_lshlrev_b32 v81, 16, v80
    v_and_b32 v82, s32, v80
    v_lshlrev_b32 v83, 16, v19
    v_and_b32 v84, s32, v19
    v_add_f32 v81, v81, v83
    v_add_f32 v82, v82, v84
    v_cvt_pk_bf16_f32 v131, v81, v82
    v_cvt_pk_bf16_f32 v80, v40, v41
    v_lshlrev_b32 v81, 16, v80
    v_and_b32 v82, s32, v80
    v_lshlrev_b32 v83, 16, v20
    v_and_b32 v84, s32, v20
    v_add_f32 v81, v81, v83
    v_add_f32 v82, v82, v84
    v_cvt_pk_bf16_f32 v132, v81, v82
    v_cvt_pk_bf16_f32 v80, v42, v43
    v_lshlrev_b32 v81, 16, v80
    v_and_b32 v82, s32, v80
    v_lshlrev_b32 v83, 16, v21
    v_and_b32 v84, s32, v21
    v_add_f32 v81, v81, v83
    v_add_f32 v82, v82, v84
    v_cvt_pk_bf16_f32 v133, v81, v82
    v_cvt_pk_bf16_f32 v80, v44, v45
    v_lshlrev_b32 v81, 16, v80
    v_and_b32 v82, s32, v80
    v_lshlrev_b32 v83, 16, v22
    v_and_b32 v84, s32, v22
    v_add_f32 v81, v81, v83
    v_add_f32 v82, v82, v84
    v_cvt_pk_bf16_f32 v134, v81, v82
    v_cvt_pk_bf16_f32 v80, v46, v47
    v_lshlrev_b32 v81, 16, v80
    v_and_b32 v82, s32, v80
    v_lshlrev_b32 v83, 16, v23
    v_and_b32 v84, s32, v23
    v_add_f32 v81, v81, v83
    v_add_f32 v82, v82, v84
    v_cvt_pk_bf16_f32 v135, v81, v82
    v_cvt_pk_bf16_f32 v80, v48, v49
    v_lshlrev_b32 v81, 16, v80
    v_and_b32 v82, s32, v80
    v_lshlrev_b32 v83, 16, v24
    v_and_b32 v84, s32, v24
    v_add_f32 v81, v81, v83
    v_add_f32 v82, v82, v84
    v_cvt_pk_bf16_f32 v136, v81, v82
    v_cvt_pk_bf16_f32 v80, v50, v51
    v_lshlrev_b32 v81, 16, v80
    v_and_b32 v82, s32, v80
    v_lshlrev_b32 v83, 16, v25
    v_and_b32 v84, s32, v25
    v_add_f32 v81, v81, v83
    v_add_f32 v82, v82, v84
    v_cvt_pk_bf16_f32 v137, v81, v82
    v_cvt_pk_bf16_f32 v80, v52, v53
    v_lshlrev_b32 v81, 16, v80
    v_and_b32 v82, s32, v80
    v_lshlrev_b32 v83, 16, v26
    v_and_b32 v84, s32, v26
    v_add_f32 v81, v81, v83
    v_add_f32 v82, v82, v84
    v_cvt_pk_bf16_f32 v138, v81, v82
    v_cvt_pk_bf16_f32 v80, v54, v55
    v_lshlrev_b32 v81, 16, v80
    v_and_b32 v82, s32, v80
    v_lshlrev_b32 v83, 16, v27
    v_and_b32 v84, s32, v27
    v_add_f32 v81, v81, v83
    v_add_f32 v82, v82, v84
    v_cvt_pk_bf16_f32 v139, v81, v82
    s_mov_b32 s30, 5242880
    buffer_store_dwordx4 v[128:131], v10, s[16:19], s30 offen
    buffer_store_dwordx4 v[132:135], v11, s[16:19], s30 offen
    v_cmp_eq_u32 vcc, 0, v2
    s_and_saveexec_b64 s[40:41], vcc
    buffer_store_dwordx4 v[136:139], v12, s[16:19], s30 offen
    s_mov_b64 exec, s[40:41]
    v_lshlrev_b32 v140, 16, v128
    v_and_b32 v141, s32, v128
    v_lshlrev_b32 v142, 16, v129
    v_and_b32 v143, s32, v129
    v_lshlrev_b32 v144, 16, v130
    v_and_b32 v145, s32, v130
    v_lshlrev_b32 v146, 16, v131
    v_and_b32 v147, s32, v131
    v_lshlrev_b32 v148, 16, v132
    v_and_b32 v149, s32, v132
    v_lshlrev_b32 v150, 16, v133
    v_and_b32 v151, s32, v133
    v_lshlrev_b32 v152, 16, v134
    v_and_b32 v153, s32, v134
    v_lshlrev_b32 v154, 16, v135
    v_and_b32 v155, s32, v135
    v_lshlrev_b32 v156, 16, v136
    v_and_b32 v157, s32, v136
    v_lshlrev_b32 v158, 16, v137
    v_and_b32 v159, s32, v137
    v_lshlrev_b32 v160, 16, v138
    v_and_b32 v161, s32, v138
    v_lshlrev_b32 v162, 16, v139
    v_and_b32 v163, s32, v139
    v_add_f32 v28, v140, v141
    v_add_f32 v28, v28, v142
    v_add_f32 v28, v28, v143
    v_add_f32 v28, v28, v144
    v_add_f32 v28, v28, v145
    v_add_f32 v28, v28, v146
    v_add_f32 v28, v28, v147
    v_add_f32 v28, v28, v148
    v_add_f32 v28, v28, v149
    v_add_f32 v28, v28, v150
    v_add_f32 v28, v28, v151
    v_add_f32 v28, v28, v152
    v_add_f32 v28, v28, v153
    v_add_f32 v28, v28, v154
    v_add_f32 v28, v28, v155
    v_add_f32 v30, v156, v157
    v_add_f32 v30, v30, v158
    v_add_f32 v30, v30, v159
    v_add_f32 v30, v30, v160
    v_add_f32 v30, v30, v161
    v_add_f32 v30, v30, v162
    v_add_f32 v30, v30, v163
    v_cndmask_b32 v30, 0, v30, vcc
    v_add_f32 v28, v28, v30
    s_nop 1
    v_add_f32_dpp v28, v28, v28 quad_perm:[1,0,3,2] row_mask:0xf bank_mask:0xf
    s_nop 1
    v_add_f32_dpp v28, v28, v28 quad_perm:[2,3,0,1] row_mask:0xf bank_mask:0xf
    s_mov_b32 s33, 0x3c638e39
    v_mul_f32 v30, s33, v28
    v_mov_b32 v29, 0
    v_mov_b32 v27, 0
    v_sub_f32 v31, v140, v30
    v_fma_f32 v29, v31, v31, v29
    v_sub_f32 v31, v141, v30
    v_fma_f32 v29, v31, v31, v29
    v_sub_f32 v31, v142, v30
    v_fma_f32 v29, v31, v31, v29
    v_sub_f32 v31, v143, v30
    v_fma_f32 v29, v31, v31, v29
    v_sub_f32 v31, v144, v30
    v_fma_f32 v29, v31, v31, v29
    v_sub_f32 v31, v145, v30
    v_fma_f32 v29, v31, v31, v29
    v_sub_f32 v31, v146, v30
    v_fma_f32 v29, v31, v31, v29
    v_sub_f32 v31, v147, v30
    v_fma_f32 v29, v31, v31, v29
    v_sub_f32 v31, v148, v30
    v_fma_f32 v29, v31, v31, v29
    v_sub_f32 v31, v149, v30
    v_fma_f32 v29, v31, v31, v29
    v_sub_f32 v31, v150, v30
    v_fma_f32 v29, v31, v31, v29
    v_sub_f32 v31, v151, v30
    v_fma_f32 v29, v31, v31, v29
    v_sub_f32 v31, v152, v30
    v_fma_f32 v29, v31, v31, v29
    v_sub_f32 v31, v153, v30
    v_fma_f32 v29, v31, v31, v29
    v_sub_f32 v31, v154, v30
    v_fma_f32 v29, v31, v31, v29
    v_sub_f32 v31, v155, v30
    v_fma_f32 v29, v31, v31, v29
    v_sub_f32 v31, v156, v30
    v_fma_f32 v27, v31, v31, v27
    v_sub_f32 v31, v157, v30
    v_fma_f32 v27, v31, v31, v27
    v_sub_f32 v31, v158, v30
    v_fma_f32 v27, v31, v31, v27
    v_sub_f32 v31, v159, v30
    v_fma_f32 v27, v31, v31, v27
    v_sub_f32 v31, v160, v30
    v_fma_f32 v27, v31, v31, v27
    v_sub_f32 v31, v161, v30
    v_fma_f32 v27, v31, v31, v27
    v_sub_f32 v31, v162, v30
    v_fma_f32 v27, v31, v31, v27
    v_sub_f32 v31, v163, v30
    v_fma_f32 v27, v31, v31, v27
    v_cndmask_b32 v27, 0, v27, vcc
    v_add_f32 v29, v29, v27
    s_nop 1
    v_add_f32_dpp v29, v29, v29 quad_perm:[1,0,3,2] row_mask:0xf bank_mask:0xf
    s_nop 1
    v_add_f32_dpp v29, v29, v29 quad_perm:[2,3,0,1] row_mask:0xf bank_mask:0xf
    v_lshlrev_b32 v4, 6, v3
    s_lshl_b32 s30, s21, 3
    s_add_u32 s30, s30, 2457600
    s_and_saveexec_b64 s[40:41], vcc
    buffer_store_dwordx2 v[28:29], v4, s[16:19], s30 offen
    s_mov_b64 exec, s[40:41]
k4a_kernel_end:
    s_endpgm
.globl k1b_kernel
.p2align 8
.type k1b_kernel,@function
k1b_kernel:
    s_cmp_ge_u32 s2, 256
    s_cbranch_scc1 k1b_kernel_end
    s_load_dwordx2 s[4:5], s[0:1], 8
    s_load_dwordx2 s[8:9], s[0:1], 72
    v_lshrrev_b32 v1, 6, v0
    v_mov_b32 v2, v0
    v_and_b32 v0, 63, v0
    v_readfirstlane_b32 s20, v1
    s_and_b32 s21, s2, 1
    s_lshl_b32 s21, s21, 2
    s_bfe_u32 s30, s2, 0x20003
    s_add_u32 s21, s21, s30
    s_bfe_u32 s22, s2, 0x20001
    s_lshl_b32 s22, s22, 3
    s_lshr_b32 s30, s2, 5
    s_add_u32 s22, s22, s30
    s_mul_i32 s31, s21, 144
    s_mov_b32 s32, 0x8889
    s_add_u32 s30, s20, 0
    s_min_u32 s30, s30, 14
    s_lshl_b32 s40, s30, 10
    s_add_u32 s40, s40, 92160
    s_lshl_b32 s30, s30, 6
    v_add_u32 v3, s30, v0
    v_mul_lo_u32 v4, v3, s32
    v_lshrrev_b32 v4, 20, v4
    v_mul_u32_u24 v5, 30, v4
    v_sub_u32 v5, v3, v5
    v_min_u32 v5, 26, v5
    v_mul_u32_u24 v6, 57, v5
    v_lshrrev_b32 v6, 9, v6
    v_mul_u32_u24 v7, 9, v6
    v_sub_u32 v5, v5, v7
    v_mul_u32_u24 v4, 3456, v4
    v_mul_u32_u24 v6, 1152, v6
    v_lshlrev_b32 v5, 4, v5
    v_add3_u32 v4, v4, v6, v5
    v_add_u32 v8, s31, v4
    s_add_u32 s30, s20, 4
    s_min_u32 s30, s30, 14
    s_lshl_b32 s41, s30, 10
    s_add_u32 s41, s41, 92160
    s_lshl_b32 s30, s30, 6
    v_add_u32 v3, s30, v0
    v_mul_lo_u32 v4, v3, s32
    v_lshrrev_b32 v4, 20, v4
    v_mul_u32_u24 v5, 30, v4
    v_sub_u32 v5, v3, v5
    v_min_u32 v5, 26, v5
    v_mul_u32_u24 v6, 57, v5
    v_lshrrev_b32 v6, 9, v6
    v_mul_u32_u24 v7, 9, v6
    v_sub_u32 v5, v5, v7
    v_mul_u32_u24 v4, 3456, v4
    v_mul_u32_u24 v6, 1152, v6
    v_lshlrev_b32 v5, 4, v5
    v_add3_u32 v4, v4, v6, v5
    v_add_u32 v9, s31, v4
    s_add_u32 s30, s20, 8
    s_min_u32 s30, s30, 14
    s_lshl_b32 s42, s30, 10
    s_add_u32 s42, s42, 92160
    s_lshl_b32 s30, s30, 6
    v_add_u32 v3, s30, v0
    v_mul_lo_u32 v4, v3, s32
    v_lshrrev_b32 v4, 20, v4
    v_mul_u32_u24 v5, 30, v4
    v_sub_u32 v5, v3, v5
    v_min_u32 v5, 26, v5
    v_mul_u32_u24 v6, 57, v5
    v_lshrrev_b32 v6, 9, v6
    v_mul_u32_u24 v7, 9, v6
    v_sub_u32 v5, v5, v7
    v_mul_u32_u24 v4, 3456, v4
    v_mul_u32_u24 v6, 1152, v6
    v_lshlrev_b32 v5, 4, v5
    v_add3_u32 v4, v4, v6, v5
    v_add_u32 v10, s31, v4
    s_add_u32 s30, s20, 12
    s_min_u32 s30, s30, 14
    s_lshl_b32 s43, s30, 10
    s_add_u32 s43, s43, 92160
    s_lshl_b32 s30, s30, 6
    v_add_u32 v3, s30, v0
    v_mul_lo_u32 v4, v3, s32
    v_lshrrev_b32 v4, 20, v4
    v_mul_u32_u24 v5, 30, v4
    v_sub_u32 v5, v3, v5
    v_min_u32 v5, 26, v5
    v_mul_u32_u24 v6, 57, v5
    v_lshrrev_b32 v6, 9, v6
    v_mul_u32_u24 v7, 9, v6
    v_sub_u32 v5, v5, v7
    v_mul_u32_u24 v4, 3456, v4
    v_mul_u32_u24 v6, 1152, v6
    v_lshlrev_b32 v5, 4, v5
    v_add3_u32 v4, v4, v6, v5
    v_add_u32 v11, s31, v4
    v_lshrrev_b32 v3, 3, v0
    s_lshl_b32 s30, s20, 3
    s_lshl_b32 s31, s22, 6
    s_add_u32 s30, s30, s31
    s_sub_u32 s30, s30, 16
    v_add_u32 v3, s30, v3
    v_and_b32 v4, 7, v0
    v_lshlrev_b32 v4, 4, v4
    v_add_u32 v5, 0, v3
    v_max_i32 v5, 0, v5
    v_min_i32 v5, 2047, v5
    v_mov_b32 v15, v5
    v_mul_u32_u24 v5, 1152, v5
    v_add_u32 v12, v5, v4
    v_add_u32 v5, 32, v3
    v_max_i32 v5, 0, v5
    v_min_i32 v5, 2047, v5
    v_mov_b32 v16, v5
    v_mul_u32_u24 v5, 1152, v5
    v_add_u32 v13, v5, v4
    v_bfe_u32 v5, v0, 3, 2
    s_lshl_b32 s30, s20, 2
    s_add_u32 s30, s30, s31
    s_add_u32 s30, s30, 48
    v_add_u32 v5, s30, v5
    v_max_i32 v5, 0, v5
    v_min_i32 v5, 2047, v5
    v_mov_b32 v17, v5
    v_mul_u32_u24 v5, 1152, v5
    v_add_u32 v14, v5, v4
    s_waitcnt lgkmcnt(0)
    s_mov_b32 s12, s4
    s_and_b32 s13, s5, 0xffff
    s_mov_b32 s14, 1990656
    s_mov_b32 s15, 0x00020000
    s_mov_b32 s16, s8
    s_and_b32 s17, s9, 0xffff
    s_mov_b32 s18, 268435456
    s_mov_b32 s19, 0x00020000
    s_mov_b32 s33, 5242880
    s_mul_i32 s60, s21, 276480
    s_add_u32 s60, s60, 83793920
    v_lshlrev_b32 v1, 4, v0
    s_mov_b32 s30, 2457600
    v_lshlrev_b32 v5, 6, v15
    buffer_load_dwordx4 v[60:63], v5, s[16:19], s30 offen offset:0
    buffer_load_dwordx4 v[64:67], v5, s[16:19], s30 offen offset:16
    buffer_load_dwordx4 v[68:71], v5, s[16:19], s30 offen offset:32
    buffer_load_dwordx4 v[72:75], v5, s[16:19], s30 offen offset:48
    v_lshlrev_b32 v5, 6, v16
    buffer_load_dwordx4 v[76:79], v5, s[16:19], s30 offen offset:0
    buffer_load_dwordx4 v[80:83], v5, s[16:19], s30 offen offset:16
    buffer_load_dwordx4 v[84:87], v5, s[16:19], s30 offen offset:32
    buffer_load_dwordx4 v[88:91], v5, s[16:19], s30 offen offset:48
    v_lshlrev_b32 v5, 6, v17
    buffer_load_dwordx4 v[92:95], v5, s[16:19], s30 offen offset:0
    buffer_load_dwordx4 v[96:99], v5, s[16:19], s30 offen offset:16
    buffer_load_dwordx4 v[100:103], v5, s[16:19], s30 offen offset:32
    buffer_load_dwordx4 v[104:107], v5, s[16:19], s30 offen offset:48
    buffer_load_dwordx4 v[148:151], v12, s[16:19], s33 offen offset:0
    buffer_load_dwordx4 v[152:155], v12, s[16:19], s33 offen offset:128
    buffer_load_dwordx4 v[156:159], v12, s[16:19], s33 offen offset:256
    buffer_load_dwordx4 v[160:163], v12, s[16:19], s33 offen offset:384
    buffer_load_dwordx4 v[164:167], v12, s[16:19], s33 offen offset:512
    buffer_load_dwordx4 v[168:171], v12, s[16:19], s33 offen offset:640
    buffer_load_dwordx4 v[172:175], v12, s[16:19], s33 offen offset:768
    buffer_load_dwordx4 v[176:179], v12, s[16:19], s33 offen offset:896
    buffer_load_dwordx4 v[180:183], v12, s[16:19], s33 offen offset:1024
    buffer_load_dwordx4 v[184:187], v13, s[16:19], s33 offen offset:0
    buffer_load_dwordx4 v[188:191], v13, s[16:19], s33 offen offset:128
    buffer_load_dwordx4 v[192:195], v13, s[16:19], s33 offen offset:256
    buffer_load_dwordx4 v[196:199], v13, s[16:19], s33 offen offset:384
    buffer_load_dwordx4 v[200:203], v13, s[16:19], s33 offen offset:512
    buffer_load_dwordx4 v[204:207], v13, s[16:19], s33 offen offset:640
    buffer_load_dwordx4 v[208:211], v13, s[16:19], s33 offen offset:768
    buffer_load_dwordx4 v[212:215], v13, s[16:19], s33 offen offset:896
    buffer_load_dwordx4 v[216:219], v13, s[16:19], s33 offen offset:1024
    s_mov_b32 s46, 0x97b5
    s_mul_i32 s31, s21, 144
    s_and_b32 s47, s22, 7
    s_mul_i32 s47, s47, 248832
    s_add_u32 s47, s47, s31
    s_and_b32 s61, s22, 7
    s_mul_i32 s61, s61, 36
    s_add_u32 s61, s61, s20
    s_lshl_b32 s61, s61, 10
    s_add_u32 s61, s61, s60
    s_add_u32 s61, s61, 92160
    v_lshrrev_b32 v3, 3, v0
    s_lshl_b32 s30, s20, 3
    v_add_u32 v3, s30, v3
    v_lshrrev_b32 v4, 4, v3
    v_mul_u32_u24 v4, 18432, v4
    v_and_b32 v5, 15, v3
    v_lshlrev_b32 v5, 4, v5
    v_add_u32 v4, v4, v5
    v_bfe_u32 v5, v0, 2, 1
    v_lshlrev_b32 v5, 10, v5
    v_add_u32 v4, v4, v5
    v_and_b32 v5, 1, v0
    v_lshlrev_b32 v5, 9, v5
    v_add_u32 v4, v4, v5
    v_bfe_u32 v5, v0, 1, 1
    v_lshlrev_b32 v5, 3, v5
    v_add_u32 v18, v4, v5
    s_mov_b32 s34, 0xffff0000
    s_mov_b32 s35, 0x3ae38e39
    s_waitcnt vmcnt(26)
    v_add_f32 v3, v60, v62
    v_add_f32 v3, v3, v64
    v_add_f32 v3, v3, v66
    v_add_f32 v3, v3, v68
    v_add_f32 v3, v3, v70
    v_add_f32 v3, v3, v72
    v_add_f32 v3, v3, v74
    v_mul_f32 v3, s35, v3
    v_add_f32 v4, v61, v63
    v_add_f32 v4, v4, v65
    v_add_f32 v4, v4, v67
    v_add_f32 v4, v4, v69
    v_add_f32 v4, v4, v71
    v_add_f32 v4, v4, v73
    v_add_f32 v4, v4, v75
    s_mov_b32 s31, 0x3c638e39
    v_mov_b32 v6, 0
    v_fma_f32 v5, v60, s31, -v3
    v_fma_f32 v6, v5, v5, v6
    v_fma_f32 v5, v62, s31, -v3
    v_fma_f32 v6, v5, v5, v6
    v_fma_f32 v5, v64, s31, -v3
    v_fma_f32 v6, v5, v5, v6
    v_fma_f32 v5, v66, s31, -v3
    v_fma_f32 v6, v5, v5, v6
    v_fma_f32 v5, v68, s31, -v3
    v_fma_f32 v6, v5, v5, v6
    v_fma_f32 v5, v70, s31, -v3
    v_fma_f32 v6, v5, v5, v6
    v_fma_f32 v5, v72, s31, -v3
    v_fma_f32 v6, v5, v5, v6
    v_fma_f32 v5, v74, s31, -v3
    v_fma_f32 v6, v5, v5, v6
    s_mov_b32 s31, 0x42900000
    v_fma_f32 v4, v6, s31, v4
    v_mul_f32 v21, s35, v4
    v_mov_b32 v20, v3
    s_waitcnt vmcnt(22)
    v_add_f32 v3, v76, v78
    v_add_f32 v3, v3, v80
    v_add_f32 v3, v3, v82
    v_add_f32 v3, v3, v84
    v_add_f32 v3, v3, v86
    v_add_f32 v3, v3, v88
    v_add_f32 v3, v3, v90
    v_mul_f32 v3, s35, v3
    v_add_f32 v4, v77, v79
    v_add_f32 v4, v4, v81
    v_add_f32 v4, v4, v83
    v_add_f32 v4, v4, v85
    v_add_f32 v4, v4, v87
    v_add_f32 v4, v4, v89
    v_add_f32 v4, v4, v91
    s_mov_b32 s31, 0x3c638e39
    v_mov_b32 v6, 0
    v_fma_f32 v5, v76, s31, -v3
    v_fma_f32 v6, v5, v5, v6
    v_fma_f32 v5, v78, s31, -v3
    v_fma_f32 v6, v5, v5, v6
    v_fma_f32 v5, v80, s31, -v3
    v_fma_f32 v6, v5, v5, v6
    v_fma_f32 v5, v82, s31, -v3
    v_fma_f32 v6, v5, v5, v6
    v_fma_f32 v5, v84, s31, -v3
    v_fma_f32 v6, v5, v5, v6
    v_fma_f32 v5, v86, s31, -v3
    v_fma_f32 v6, v5, v5, v6
    v_fma_f32 v5, v88, s31, -v3
    v_fma_f32 v6, v5, v5, v6
    v_fma_f32 v5, v90, s31, -v3
    v_fma_f32 v6, v5, v5, v6
    s_mov_b32 s31, 0x42900000
    v_fma_f32 v4, v6, s31, v4
    v_mul_f32 v23, s35, v4
    v_mov_b32 v22, v3
    s_waitcnt vmcnt(18)
    v_add_f32 v3, v92, v94
    v_add_f32 v3, v3, v96
    v_add_f32 v3, v3, v98
    v_add_f32 v3, v3, v100
    v_add_f32 v3, v3, v102
    v_add_f32 v3, v3, v104
    v_add_f32 v3, v3, v106
    v_mul_f32 v3, s35, v3
    v_add_f32 v4, v93, v95
    v_add_f32 v4, v4, v97
    v_add_f32 v4, v4, v99
    v_add_f32 v4, v4, v101
    v_add_f32 v4, v4, v103
    v_add_f32 v4, v4, v105
    v_add_f32 v4, v4, v107
    s_mov_b32 s31, 0x3c638e39
    v_mov_b32 v6, 0
    v_fma_f32 v5, v92, s31, -v3
    v_fma_f32 v6, v5, v5, v6
    v_fma_f32 v5, v94, s31, -v3
    v_fma_f32 v6, v5, v5, v6
    v_fma_f32 v5, v96, s31, -v3
    v_fma_f32 v6, v5, v5, v6
    v_fma_f32 v5, v98, s31, -v3
    v_fma_f32 v6, v5, v5, v6
    v_fma_f32 v5, v100, s31, -v3
    v_fma_f32 v6, v5, v5, v6
    v_fma_f32 v5, v102, s31, -v3
    v_fma_f32 v6, v5, v5, v6
    v_fma_f32 v5, v104, s31, -v3
    v_fma_f32 v6, v5, v5, v6
    v_fma_f32 v5, v106, s31, -v3
    v_fma_f32 v6, v5, v5, v6
    s_mov_b32 s31, 0x42900000
    v_fma_f32 v4, v6, s31, v4
    v_mul_f32 v25, s35, v4
    v_mov_b32 v24, v3
    v_mov_b32 v3, v20
    v_mov_b32 v4, v21
    s_waitcnt vmcnt(9)
    v_lshlrev_b32 v60, 16, v148
    v_and_b32 v61, s34, v148
    v_lshlrev_b32 v62, 16, v149
    v_and_b32 v63, s34, v149
    v_lshlrev_b32 v64, 16, v150
    v_and_b32 v65, s34, v150
    v_lshlrev_b32 v66, 16, v151
    v_and_b32 v67, s34, v151
    v_lshlrev_b32 v68, 16, v152
    v_and_b32 v69, s34, v152
    v_lshlrev_b32 v70, 16, v153
    v_and_b32 v71, s34, v153
    v_lshlrev_b32 v72, 16, v154
    v_and_b32 v73, s34, v154
    v_lshlrev_b32 v74, 16, v155
    v_and_b32 v75, s34, v155
    v_lshlrev_b32 v76, 16, v156
    v_and_b32 v77, s34, v156
    v_lshlrev_b32 v78, 16, v157
    v_and_b32 v79, s34, v157
    v_lshlrev_b32 v80, 16, v158
    v_and_b32 v81, s34, v158
    v_lshlrev_b32 v82, 16, v159
    v_and_b32 v83, s34, v159
    v_lshlrev_b32 v84, 16, v160
    v_and_b32 v85, s34, v160
    v_lshlrev_b32 v86, 16, v161
    v_and_b32 v87, s34, v161
    v_lshlrev_b32 v88, 16, v162
    v_and_b32 v89, s34, v162
    v_lshlrev_b32 v90, 16, v163
    v_and_b32 v91, s34, v163
    v_lshlrev_b32 v92, 16, v164
    v_and_b32 v93, s34, v164
    v_lshlrev_b32 v94, 16, v165
    v_and_b32 v95, s34, v165
    v_lshlrev_b32 v96, 16, v166
    v_and_b32 v97, s34, v166
    v_lshlrev_b32 v98, 16, v167
    v_and_b32 v99, s34, v167
    v_lshlrev_b32 v100, 16, v168
    v_and_b32 v101, s34, v168
    v_lshlrev_b32 v102, 16, v169
    v_and_b32 v103, s34, v169
    v_lshlrev_b32 v104, 16, v170
    v_and_b32 v105, s34, v170
    v_lshlrev_b32 v106, 16, v171
    v_and_b32 v107, s34, v171
    v_lshlrev_b32 v108, 16, v172
    v_and_b32 v109, s34, v172
    v_lshlrev_b32 v110, 16, v173
    v_and_b32 v111, s34, v173
    v_lshlrev_b32 v112, 16, v174
    v_and_b32 v113, s34, v174
    v_lshlrev_b32 v114, 16, v175
    v_and_b32 v115, s34, v175
    v_lshlrev_b32 v116, 16, v176
    v_and_b32 v117, s34, v176
    v_lshlrev_b32 v118, 16, v177
    v_and_b32 v119, s34, v177
    v_lshlrev_b32 v120, 16, v178
    v_and_b32 v121, s34, v178
    v_lshlrev_b32 v122, 16, v179
    v_and_b32 v123, s34, v179
    v_lshlrev_b32 v124, 16, v180
    v_and_b32 v125, s34, v180
    v_lshlrev_b32 v126, 16, v181
    v_and_b32 v127, s34, v181
    v_lshlrev_b32 v128, 16, v182
    v_and_b32 v129, s34, v182
    v_lshlrev_b32 v130, 16, v183
    v_and_b32 v131, s34, v183
    v_cvt_pk_bf16_f32 v3, v3, v3
    v_lshlrev_b32 v3, 16, v3
    v_cvt_pk_bf16_f32 v4, v4, v4
    v_lshlrev_b32 v4, 16, v4
    v_add_f32 v4, 0x3727c5ac, v4
    v_cvt_pk_bf16_f32 v4, v4, v4
    v_lshlrev_b32 v4, 16, v4
    v_sqrt_f32 v4, v4
    s_nop 0
    v_cvt_pk_bf16_f32 v4, v4, v4
    v_lshlrev_b32 v4, 16, v4
    v_rcp_f32 v4, v4
    s_nop 0
    v_mul_f32 v3, v3, v4
    v_sub_f32 v6, 0, v3
    v_mov_b32 v7, v6
    v_mov_b32 v5, v4
    v_pk_fma_f32 v[60:61], v[60:61], v[4:5], v[6:7]
    v_pk_fma_f32 v[62:63], v[62:63], v[4:5], v[6:7]
    v_pk_fma_f32 v[64:65], v[64:65], v[4:5], v[6:7]
    v_pk_fma_f32 v[66:67], v[66:67], v[4:5], v[6:7]
    v_cvt_pk_bf16_f32 v148, v60, v61
    v_cvt_pk_bf16_f32 v149, v62, v63
    v_cvt_pk_bf16_f32 v150, v64, v65
    v_cvt_pk_bf16_f32 v151, v66, v67
    ds_write_b64 v18, v[148:149] offset:0
    ds_write_b64 v18, v[150:151] offset:256
    buffer_load_dwordx4 v[220:223], v14, s[16:19], s33 offen offset:0
    v_pk_fma_f32 v[68:69], v[68:69], v[4:5], v[6:7]
    v_pk_fma_f32 v[70:71], v[70:71], v[4:5], v[6:7]
    v_pk_fma_f32 v[72:73], v[72:73], v[4:5], v[6:7]
    v_pk_fma_f32 v[74:75], v[74:75], v[4:5], v[6:7]
    v_cvt_pk_bf16_f32 v152, v68, v69
    v_cvt_pk_bf16_f32 v153, v70, v71
    v_cvt_pk_bf16_f32 v154, v72, v73
    v_cvt_pk_bf16_f32 v155, v74, v75
    ds_write_b64 v18, v[152:153] offset:2048
    ds_write_b64 v18, v[154:155] offset:2304
    buffer_load_dwordx4 v[224:227], v14, s[16:19], s33 offen offset:128
    v_pk_fma_f32 v[76:77], v[76:77], v[4:5], v[6:7]
    v_pk_fma_f32 v[78:79], v[78:79], v[4:5], v[6:7]
    v_pk_fma_f32 v[80:81], v[80:81], v[4:5], v[6:7]
    v_pk_fma_f32 v[82:83], v[82:83], v[4:5], v[6:7]
    v_cvt_pk_bf16_f32 v156, v76, v77
    v_cvt_pk_bf16_f32 v157, v78, v79
    v_cvt_pk_bf16_f32 v158, v80, v81
    v_cvt_pk_bf16_f32 v159, v82, v83
    ds_write_b64 v18, v[156:157] offset:4096
    ds_write_b64 v18, v[158:159] offset:4352
    buffer_load_dwordx4 v[228:231], v14, s[16:19], s33 offen offset:256
    v_pk_fma_f32 v[84:85], v[84:85], v[4:5], v[6:7]
    v_pk_fma_f32 v[86:87], v[86:87], v[4:5], v[6:7]
    v_pk_fma_f32 v[88:89], v[88:89], v[4:5], v[6:7]
    v_pk_fma_f32 v[90:91], v[90:91], v[4:5], v[6:7]
    v_cvt_pk_bf16_f32 v160, v84, v85
    v_cvt_pk_bf16_f32 v161, v86, v87
    v_cvt_pk_bf16_f32 v162, v88, v89
    v_cvt_pk_bf16_f32 v163, v90, v91
    ds_write_b64 v18, v[160:161] offset:6144
    ds_write_b64 v18, v[162:163] offset:6400
    buffer_load_dwordx4 v[232:235], v14, s[16:19], s33 offen offset:384
    v_pk_fma_f32 v[92:93], v[92:93], v[4:5], v[6:7]
    v_pk_fma_f32 v[94:95], v[94:95], v[4:5], v[6:7]
    v_pk_fma_f32 v[96:97], v[96:97], v[4:5], v[6:7]
    v_pk_fma_f32 v[98:99], v[98:99], v[4:5], v[6:7]
    v_cvt_pk_bf16_f32 v164, v92, v93
    v_cvt_pk_bf16_f32 v165, v94, v95
    v_cvt_pk_bf16_f32 v166, v96, v97
    v_cvt_pk_bf16_f32 v167, v98, v99
    ds_write_b64 v18, v[164:165] offset:8192
    ds_write_b64 v18, v[166:167] offset:8448
    buffer_load_dwordx4 v[236:239], v14, s[16:19], s33 offen offset:512
    v_pk_fma_f32 v[100:101], v[100:101], v[4:5], v[6:7]
    v_pk_fma_f32 v[102:103], v[102:103], v[4:5], v[6:7]
    v_pk_fma_f32 v[104:105], v[104:105], v[4:5], v[6:7]
    v_pk_fma_f32 v[106:107], v[106:107], v[4:5], v[6:7]
    v_cvt_pk_bf16_f32 v168, v100, v101
    v_cvt_pk_bf16_f32 v169, v102, v103
    v_cvt_pk_bf16_f32 v170, v104, v105
    v_cvt_pk_bf16_f32 v171, v106, v107
    ds_write_b64 v18, v[168:169] offset:10240
    ds_write_b64 v18, v[170:171] offset:10496
    buffer_load_dwordx4 v[240:243], v14, s[16:19], s33 offen offset:640
    v_pk_fma_f32 v[108:109], v[108:109], v[4:5], v[6:7]
    v_pk_fma_f32 v[110:111], v[110:111], v[4:5], v[6:7]
    v_pk_fma_f32 v[112:113], v[112:113], v[4:5], v[6:7]
    v_pk_fma_f32 v[114:115], v[114:115], v[4:5], v[6:7]
    v_cvt_pk_bf16_f32 v172, v108, v109
    v_cvt_pk_bf16_f32 v173, v110, v111
    v_cvt_pk_bf16_f32 v174, v112, v113
    v_cvt_pk_bf16_f32 v175, v114, v115
    ds_write_b64 v18, v[172:173] offset:12288
    ds_write_b64 v18, v[174:175] offset:12544
    buffer_load_dwordx4 v[244:247], v14, s[16:19], s33 offen offset:768
    v_pk_fma_f32 v[116:117], v[116:117], v[4:5], v[6:7]
    v_pk_fma_f32 v[118:119], v[118:119], v[4:5], v[6:7]
    v_pk_fma_f32 v[120:121], v[120:121], v[4:5], v[6:7]
    v_pk_fma_f32 v[122:123], v[122:123], v[4:5], v[6:7]
    v_cvt_pk_bf16_f32 v176, v116, v117
    v_cvt_pk_bf16_f32 v177, v118, v119
    v_cvt_pk_bf16_f32 v178, v120, v121
    v_cvt_pk_bf16_f32 v179, v122, v123
    ds_write_b64 v18, v[176:177] offset:14336
    ds_write_b64 v18, v[178:179] offset:14592
    buffer_load_dwordx4 v[248:251], v14, s[16:19], s33 offen offset:896
    v_pk_fma_f32 v[124:125], v[124:125], v[4:5], v[6:7]
    v_pk_fma_f32 v[126:127], v[126:127], v[4:5], v[6:7]
    v_pk_fma_f32 v[128:129], v[128:129], v[4:5], v[6:7]
    v_pk_fma_f32 v[130:131], v[130:131], v[4:5], v[6:7]
    v_cvt_pk_bf16_f32 v180, v124, v125
    v_cvt_pk_bf16_f32 v181, v126, v127
    v_cvt_pk_bf16_f32 v182, v128, v129
    v_cvt_pk_bf16_f32 v183, v130, v131
    ds_write_b64 v18, v[180:181] offset:16384
    ds_write_b64 v18, v[182:183] offset:16640
    buffer_load_dwordx4 v[252:255], v14, s[16:19], s33 offen offset:1024
    v_add_u32 v19, 36864, v18
    v_mov_b32 v3, v22
    v_mov_b32 v4, v23
    s_waitcnt vmcnt(9)
    v_lshlrev_b32 v60, 16, v184
    v_and_b32 v61, s34, v184
    v_lshlrev_b32 v62, 16, v185
    v_and_b32 v63, s34, v185
    v_lshlrev_b32 v64, 16, v186
    v_and_b32 v65, s34, v186
    v_lshlrev_b32 v66, 16, v187
    v_and_b32 v67, s34, v187
    v_lshlrev_b32 v68, 16, v188
    v_and_b32 v69, s34, v188
    v_lshlrev_b32 v70, 16, v189
    v_and_b32 v71, s34, v189
    v_lshlrev_b32 v72, 16, v190
    v_and_b32 v73, s34, v190
    v_lshlrev_b32 v74, 16, v191
    v_and_b32 v75, s34, v191
    v_lshlrev_b32 v76, 16, v192
    v_and_b32 v77, s34, v192
    v_lshlrev_b32 v78, 16, v193
    v_and_b32 v79, s34, v193
    v_lshlrev_b32 v80, 16, v194
    v_and_b32 v81, s34, v194
    v_lshlrev_b32 v82, 16, v195
    v_and_b32 v83, s34, v195
    v_lshlrev_b32 v84, 16, v196
    v_and_b32 v85, s34, v196
    v_lshlrev_b32 v86, 16, v197
    v_and_b32 v87, s34, v197
    v_lshlrev_b32 v88, 16, v198
    v_and_b32 v89, s34, v198
    v_lshlrev_b32 v90, 16, v199
    v_and_b32 v91, s34, v199
    v_lshlrev_b32 v92, 16, v200
    v_and_b32 v93, s34, v200
    v_lshlrev_b32 v94, 16, v201
    v_and_b32 v95, s34, v201
    v_lshlrev_b32 v96, 16, v202
    v_and_b32 v97, s34, v202
    v_lshlrev_b32 v98, 16, v203
    v_and_b32 v99, s34, v203
    v_lshlrev_b32 v100, 16, v204
    v_and_b32 v101, s34, v204
    v_lshlrev_b32 v102, 16, v205
    v_and_b32 v103, s34, v205
    v_lshlrev_b32 v104, 16, v206
    v_and_b32 v105, s34, v206
    v_lshlrev_b32 v106, 16, v207
    v_and_b32 v107, s34, v207
    v_lshlrev_b32 v108, 16, v208
    v_and_b32 v109, s34, v208
    v_lshlrev_b32 v110, 16, v209
    v_and_b32 v111, s34, v209
    v_lshlrev_b32 v112, 16, v210
    v_and_b32 v113, s34, v210
    v_lshlrev_b32 v114, 16, v211
    v_and_b32 v115, s34, v211
    v_lshlrev_b32 v116, 16, v212
    v_and_b32 v117, s34, v212
    v_lshlrev_b32 v118, 16, v213
    v_and_b32 v119, s34, v213
    v_lshlrev_b32 v120, 16, v214
    v_and_b32 v121, s34, v214
    v_lshlrev_b32 v122, 16, v215
    v_and_b32 v123, s34, v215
    v_lshlrev_b32 v124, 16, v216
    v_and_b32 v125, s34, v216
    v_lshlrev_b32 v126, 16, v217
    v_and_b32 v127, s34, v217
    v_lshlrev_b32 v128, 16, v218
    v_and_b32 v129, s34, v218
    v_lshlrev_b32 v130, 16, v219
    v_and_b32 v131, s34, v219
    v_cvt_pk_bf16_f32 v3, v3, v3
    v_lshlrev_b32 v3, 16, v3
    v_cvt_pk_bf16_f32 v4, v4, v4
    v_lshlrev_b32 v4, 16, v4
    v_add_f32 v4, 0x3727c5ac, v4
    v_cvt_pk_bf16_f32 v4, v4, v4
    v_lshlrev_b32 v4, 16, v4
    v_sqrt_f32 v4, v4
    s_nop 0
    v_cvt_pk_bf16_f32 v4, v4, v4
    v_lshlrev_b32 v4, 16, v4
    v_rcp_f32 v4, v4
    s_nop 0
    v_mul_f32 v3, v3, v4
    v_sub_f32 v6, 0, v3
    v_mov_b32 v7, v6
    v_mov_b32 v5, v4
    v_pk_fma_f32 v[60:61], v[60:61], v[4:5], v[6:7]
    v_pk_fma_f32 v[62:63], v[62:63], v[4:5], v[6:7]
    v_pk_fma_f32 v[64:65], v[64:65], v[4:5], v[6:7]
    v_pk_fma_f32 v[66:67], v[66:67], v[4:5], v[6:7]
    v_cvt_pk_bf16_f32 v184, v60, v61
    v_cvt_pk_bf16_f32 v185, v62, v63
    v_cvt_pk_bf16_f32 v186, v64, v65
    v_cvt_pk_bf16_f32 v187, v66, v67
    ds_write_b64 v19, v[184:185] offset:0
    ds_write_b64 v19, v[186:187] offset:256
    s_add_u32 m0, s40, 0
    s_add_u32 s25, s60, s40
    s_add_u32 s25, s25, 0
    buffer_load_dwordx4 v1, s[16:19], s25 offen lds
    s_add_u32 m0, s41, 0
    s_add_u32 s25, s60, s41
    s_add_u32 s25, s25, 0
    buffer_load_dwordx4 v1, s[16:19], s25 offen lds
    v_pk_fma_f32 v[68:69], v[68:69], v[4:5], v[6:7]
    v_pk_fma_f32 v[70:71], v[70:71], v[4:5], v[6:7]
    v_pk_fma_f32 v[72:73], v[72:73], v[4:5], v[6:7]
    v_pk_fma_f32 v[74:75], v[74:75], v[4:5], v[6:7]
    v_cvt_pk_bf16_f32 v188, v68, v69
    v_cvt_pk_bf16_f32 v189, v70, v71
    v_cvt_pk_bf16_f32 v190, v72, v73
    v_cvt_pk_bf16_f32 v191, v74, v75
    ds_write_b64 v19, v[188:189] offset:2048
    ds_write_b64 v19, v[190:191] offset:2304
    s_add_u32 m0, s42, 0
    s_add_u32 s25, s60, s42
    s_add_u32 s25, s25, 0
    buffer_load_dwordx4 v1, s[16:19], s25 offen lds
    s_add_u32 m0, s43, 0
    s_add_u32 s25, s60, s43
    s_add_u32 s25, s25, 0
    buffer_load_dwordx4 v1, s[16:19], s25 offen lds
    v_pk_fma_f32 v[76:77], v[76:77], v[4:5], v[6:7]
    v_pk_fma_f32 v[78:79], v[78:79], v[4:5], v[6:7]
    v_pk_fma_f32 v[80:81], v[80:81], v[4:5], v[6:7]
    v_pk_fma_f32 v[82:83], v[82:83], v[4:5], v[6:7]
    v_cvt_pk_bf16_f32 v192, v76, v77
    v_cvt_pk_bf16_f32 v193, v78, v79
    v_cvt_pk_bf16_f32 v194, v80, v81
    v_cvt_pk_bf16_f32 v195, v82, v83
    ds_write_b64 v19, v[192:193] offset:4096
    ds_write_b64 v19, v[194:195] offset:4352
    s_add_u32 s25, s61, 0
    buffer_load_dwordx4 v[132:135], v1, s[16:19], s25 offen
    s_add_u32 s25, s61, 4096
    buffer_load_dwordx4 v[132:135], v1, s[16:19], s25 offen
    v_pk_fma_f32 v[84:85], v[84:85], v[4:5], v[6:7]
    v_pk_fma_f32 v[86:87], v[86:87], v[4:5], v[6:7]
    v_pk_fma_f32 v[88:89], v[88:89], v[4:5], v[6:7]
    v_pk_fma_f32 v[90:91], v[90:91], v[4:5], v[6:7]
    v_cvt_pk_bf16_f32 v196, v84, v85
    v_cvt_pk_bf16_f32 v197, v86, v87
    v_cvt_pk_bf16_f32 v198, v88, v89
    v_cvt_pk_bf16_f32 v199, v90, v91
    ds_write_b64 v19, v[196:197] offset:6144
    ds_write_b64 v19, v[198:199] offset:6400
    s_add_u32 s25, s61, 8192
    buffer_load_dwordx4 v[132:135], v1, s[16:19], s25 offen
    s_add_u32 s25, s61, 12288
    buffer_load_dwordx4 v[132:135], v1, s[16:19], s25 offen
    v_pk_fma_f32 v[92:93], v[92:93], v[4:5], v[6:7]
    v_pk_fma_f32 v[94:95], v[94:95], v[4:5], v[6:7]
    v_pk_fma_f32 v[96:97], v[96:97], v[4:5], v[6:7]
    v_pk_fma_f32 v[98:99], v[98:99], v[4:5], v[6:7]
    v_cvt_pk_bf16_f32 v200, v92, v93
    v_cvt_pk_bf16_f32 v201, v94, v95
    v_cvt_pk_bf16_f32 v202, v96, v97
    v_cvt_pk_bf16_f32 v203, v98, v99
    ds_write_b64 v19, v[200:201] offset:8192
    ds_write_b64 v19, v[202:203] offset:8448
    s_add_u32 s25, s61, 16384
    buffer_load_dwordx4 v[132:135], v1, s[16:19], s25 offen
    s_add_u32 s25, s61, 20480
    buffer_load_dwordx4 v[132:135], v1, s[16:19], s25 offen
    v_pk_fma_f32 v[100:101], v[100:101], v[4:5], v[6:7]
    v_pk_fma_f32 v[102:103], v[102:103], v[4:5], v[6:7]
    v_pk_fma_f32 v[104:105], v[104:105], v[4:5], v[6:7]
    v_pk_fma_f32 v[106:107], v[106:107], v[4:5], v[6:7]
    v_cvt_pk_bf16_f32 v204, v100, v101
    v_cvt_pk_bf16_f32 v205, v102, v103
    v_cvt_pk_bf16_f32 v206, v104, v105
    v_cvt_pk_bf16_f32 v207, v106, v107
    ds_write_b64 v19, v[204:205] offset:10240
    ds_write_b64 v19, v[206:207] offset:10496
    s_add_u32 s25, s61, 24576
    buffer_load_dwordx4 v[132:135], v1, s[16:19], s25 offen
    s_add_u32 s25, s61, 28672
    buffer_load_dwordx4 v[132:135], v1, s[16:19], s25 offen
    v_pk_fma_f32 v[108:109], v[108:109], v[4:5], v[6:7]
    v_pk_fma_f32 v[110:111], v[110:111], v[4:5], v[6:7]
    v_pk_fma_f32 v[112:113], v[112:113], v[4:5], v[6:7]
    v_pk_fma_f32 v[114:115], v[114:115], v[4:5], v[6:7]
    v_cvt_pk_bf16_f32 v208, v108, v109
    v_cvt_pk_bf16_f32 v209, v110, v111
    v_cvt_pk_bf16_f32 v210, v112, v113
    v_cvt_pk_bf16_f32 v211, v114, v115
    ds_write_b64 v19, v[208:209] offset:12288
    ds_write_b64 v19, v[210:211] offset:12544
    s_add_u32 s25, s61, 32768
    buffer_load_dwordx4 v[132:135], v1, s[16:19], s25 offen
    s_add_u32 m0, s40, 15360
    s_add_u32 s25, s60, s40
    s_add_u32 s25, s25, 15360
    buffer_load_dwordx4 v1, s[16:19], s25 offen lds
    v_pk_fma_f32 v[116:117], v[116:117], v[4:5], v[6:7]
    v_pk_fma_f32 v[118:119], v[118:119], v[4:5], v[6:7]
    v_pk_fma_f32 v[120:121], v[120:121], v[4:5], v[6:7]
    v_pk_fma_f32 v[122:123], v[122:123], v[4:5], v[6:7]
    v_cvt_pk_bf16_f32 v212, v116, v117
    v_cvt_pk_bf16_f32 v213, v118, v119
    v_cvt_pk_bf16_f32 v214, v120, v121
    v_cvt_pk_bf16_f32 v215, v122, v123
    ds_write_b64 v19, v[212:213] offset:14336
    ds_write_b64 v19, v[214:215] offset:14592
    s_add_u32 m0, s41, 15360
    s_add_u32 s25, s60, s41
    s_add_u32 s25, s25, 15360
    buffer_load_dwordx4 v1, s[16:19], s25 offen lds
    s_add_u32 m0, s42, 15360
    s_add_u32 s25, s60, s42
    s_add_u32 s25, s25, 15360
    buffer_load_dwordx4 v1, s[16:19], s25 offen lds
    v_pk_fma_f32 v[124:125], v[124:125], v[4:5], v[6:7]
    v_pk_fma_f32 v[126:127], v[126:127], v[4:5], v[6:7]
    v_pk_fma_f32 v[128:129], v[128:129], v[4:5], v[6:7]
    v_pk_fma_f32 v[130:131], v[130:131], v[4:5], v[6:7]
    v_cvt_pk_bf16_f32 v216, v124, v125
    v_cvt_pk_bf16_f32 v217, v126, v127
    v_cvt_pk_bf16_f32 v218, v128, v129
    v_cvt_pk_bf16_f32 v219, v130, v131
    ds_write_b64 v19, v[216:217] offset:16384
    ds_write_b64 v19, v[218:219] offset:16640
    s_add_u32 m0, s43, 15360
    s_add_u32 s25, s60, s43
    s_add_u32 s25, s25, 15360
    buffer_load_dwordx4 v1, s[16:19], s25 offen lds
    s_add_u32 m0, s40, 30720
    s_add_u32 s25, s60, s40
    s_add_u32 s25, s25, 30720
    buffer_load_dwordx4 v1, s[16:19], s25 offen lds
    v_lshrrev_b32 v3, 3, v0
    s_lshl_b32 s30, s20, 3
    v_add_u32 v3, s30, v3
    v_lshrrev_b32 v4, 4, v3
    v_mul_u32_u24 v4, 18432, v4
    v_and_b32 v5, 15, v3
    v_lshlrev_b32 v5, 4, v5
    v_add_u32 v4, v4, v5
    v_sub_u32 v19, v18, v4
    v_bfe_u32 v5, v0, 3, 2
    s_lshl_b32 s30, s20, 2
    v_add_u32 v5, s30, v5
    v_lshlrev_b32 v5, 4, v5
    v_add3_u32 v19, v19, v5, 0
    v_add_u32 v19, 73728, v19
    v_mov_b32 v3, v24
    v_mov_b32 v4, v25
    s_waitcnt vmcnt(18)
    v_lshlrev_b32 v60, 16, v220
    v_and_b32 v61, s34, v220
    v_lshlrev_b32 v62, 16, v221
    v_and_b32 v63, s34, v221
    v_lshlrev_b32 v64, 16, v222
    v_and_b32 v65, s34, v222
    v_lshlrev_b32 v66, 16, v223
    v_and_b32 v67, s34, v223
    v_lshlrev_b32 v68, 16, v224
    v_and_b32 v69, s34, v224
    v_lshlrev_b32 v70, 16, v225
    v_and_b32 v71, s34, v225
    v_lshlrev_b32 v72, 16, v226
    v_and_b32 v73, s34, v226
    v_lshlrev_b32 v74, 16, v227
    v_and_b32 v75, s34, v227
    v_lshlrev_b32 v76, 16, v228
    v_and_b32 v77, s34, v228
    v_lshlrev_b32 v78, 16, v229
    v_and_b32 v79, s34, v229
    v_lshlrev_b32 v80, 16, v230
    v_and_b32 v81, s34, v230
    v_lshlrev_b32 v82, 16, v231
    v_and_b32 v83, s34, v231
    v_lshlrev_b32 v84, 16, v232
    v_and_b32 v85, s34, v232
    v_lshlrev_b32 v86, 16, v233
    v_and_b32 v87, s34, v233
    v_lshlrev_b32 v88, 16, v234
    v_and_b32 v89, s34, v234
    v_lshlrev_b32 v90, 16, v235
    v_and_b32 v91, s34, v235
    v_lshlrev_b32 v92, 16, v236
    v_and_b32 v93, s34, v236
    v_lshlrev_b32 v94, 16, v237
    v_and_b32 v95, s34, v237
    v_lshlrev_b32 v96, 16, v238
    v_and_b32 v97, s34, v238
    v_lshlrev_b32 v98, 16, v239
    v_and_b32 v99, s34, v239
    v_lshlrev_b32 v100, 16, v240
    v_and_b32 v101, s34, v240
    v_lshlrev_b32 v102, 16, v241
    v_and_b32 v103, s34, v241
    v_lshlrev_b32 v104, 16, v242
    v_and_b32 v105, s34, v242
    v_lshlrev_b32 v106, 16, v243
    v_and_b32 v107, s34, v243
    v_lshlrev_b32 v108, 16, v244
    v_and_b32 v109, s34, v244
    v_lshlrev_b32 v110, 16, v245
    v_and_b32 v111, s34, v245
    v_lshlrev_b32 v112, 16, v246
    v_and_b32 v113, s34, v246
    v_lshlrev_b32 v114, 16, v247
    v_and_b32 v115, s34, v247
    v_lshlrev_b32 v116, 16, v248
    v_and_b32 v117, s34, v248
    v_lshlrev_b32 v118, 16, v249
    v_and_b32 v119, s34, v249
    v_lshlrev_b32 v120, 16, v250
    v_and_b32 v121, s34, v250
    v_lshlrev_b32 v122, 16, v251
    v_and_b32 v123, s34, v251
    v_lshlrev_b32 v124, 16, v252
    v_and_b32 v125, s34, v252
    v_lshlrev_b32 v126, 16, v253
    v_and_b32 v127, s34, v253
    v_lshlrev_b32 v128, 16, v254
    v_and_b32 v129, s34, v254
    v_lshlrev_b32 v130, 16, v255
    v_and_b32 v131, s34, v255
    v_cvt_pk_bf16_f32 v3, v3, v3
    v_lshlrev_b32 v3, 16, v3
    v_cvt_pk_bf16_f32 v4, v4, v4
    v_lshlrev_b32 v4, 16, v4
    v_add_f32 v4, 0x3727c5ac, v4
    v_cvt_pk_bf16_f32 v4, v4, v4
    v_lshlrev_b32 v4, 16, v4
    v_sqrt_f32 v4, v4
    s_nop 0
    v_cvt_pk_bf16_f32 v4, v4, v4
    v_lshlrev_b32 v4, 16, v4
    v_rcp_f32 v4, v4
    s_nop 0
    v_mul_f32 v3, v3, v4
    v_sub_f32 v6, 0, v3
    v_mov_b32 v7, v6
    v_mov_b32 v5, v4
    v_pk_fma_f32 v[60:61], v[60:61], v[4:5], v[6:7]
    v_pk_fma_f32 v[62:63], v[62:63], v[4:5], v[6:7]
    v_pk_fma_f32 v[64:65], v[64:65], v[4:5], v[6:7]
    v_pk_fma_f32 v[66:67], v[66:67], v[4:5], v[6:7]
    v_cvt_pk_bf16_f32 v220, v60, v61
    v_cvt_pk_bf16_f32 v221, v62, v63
    v_cvt_pk_bf16_f32 v222, v64, v65
    v_cvt_pk_bf16_f32 v223, v66, v67
    ds_write_b64 v19, v[220:221] offset:0
    ds_write_b64 v19, v[222:223] offset:256
    s_add_u32 m0, s41, 30720
    s_add_u32 s25, s60, s41
    s_add_u32 s25, s25, 30720
    buffer_load_dwordx4 v1, s[16:19], s25 offen lds
    s_add_u32 m0, s42, 30720
    s_add_u32 s25, s60, s42
    s_add_u32 s25, s25, 30720
    buffer_load_dwordx4 v1, s[16:19], s25 offen lds
    v_pk_fma_f32 v[68:69], v[68:69], v[4:5], v[6:7]
    v_pk_fma_f32 v[70:71], v[70:71], v[4:5], v[6:7]
    v_pk_fma_f32 v[72:73], v[72:73], v[4:5], v[6:7]
    v_pk_fma_f32 v[74:75], v[74:75], v[4:5], v[6:7]
    v_cvt_pk_bf16_f32 v224, v68, v69
    v_cvt_pk_bf16_f32 v225, v70, v71
    v_cvt_pk_bf16_f32 v226, v72, v73
    v_cvt_pk_bf16_f32 v227, v74, v75
    ds_write_b64 v19, v[224:225] offset:2048
    ds_write_b64 v19, v[226:227] offset:2304
    s_add_u32 m0, s43, 30720
    s_add_u32 s25, s60, s43
    s_add_u32 s25, s25, 30720
    buffer_load_dwordx4 v1, s[16:19], s25 offen lds
    v_pk_fma_f32 v[76:77], v[76:77], v[4:5], v[6:7]
    v_pk_fma_f32 v[78:79], v[78:79], v[4:5], v[6:7]
    v_pk_fma_f32 v[80:81], v[80:81], v[4:5], v[6:7]
    v_pk_fma_f32 v[82:83], v[82:83], v[4:5], v[6:7]
    v_cvt_pk_bf16_f32 v228, v76, v77
    v_cvt_pk_bf16_f32 v229, v78, v79
    v_cvt_pk_bf16_f32 v230, v80, v81
    v_cvt_pk_bf16_f32 v231, v82, v83
    ds_write_b64 v19, v[228:229] offset:4096
    ds_write_b64 v19, v[230:231] offset:4352
    v_pk_fma_f32 v[84:85], v[84:85], v[4:5], v[6:7]
    v_pk_fma_f32 v[86:87], v[86:87], v[4:5], v[6:7]
    v_pk_fma_f32 v[88:89], v[88:89], v[4:5], v[6:7]
    v_pk_fma_f32 v[90:91], v[90:91], v[4:5], v[6:7]
    v_cvt_pk_bf16_f32 v232, v84, v85
    v_cvt_pk_bf16_f32 v233, v86, v87
    v_cvt_pk_bf16_f32 v234, v88, v89
    v_cvt_pk_bf16_f32 v235, v90, v91
    ds_write_b64 v19, v[232:233] offset:6144
    ds_write_b64 v19, v[234:235] offset:6400
    v_pk_fma_f32 v[92:93], v[92:93], v[4:5], v[6:7]
    v_pk_fma_f32 v[94:95], v[94:95], v[4:5], v[6:7]
    v_pk_fma_f32 v[96:97], v[96:97], v[4:5], v[6:7]
    v_pk_fma_f32 v[98:99], v[98:99], v[4:5], v[6:7]
    v_cvt_pk_bf16_f32 v236, v92, v93
    v_cvt_pk_bf16_f32 v237, v94, v95
    v_cvt_pk_bf16_f32 v238, v96, v97
    v_cvt_pk_bf16_f32 v239, v98, v99
    ds_write_b64 v19, v[236:237] offset:8192
    ds_write_b64 v19, v[238:239] offset:8448
    v_pk_fma_f32 v[100:101], v[100:101], v[4:5], v[6:7]
    v_pk_fma_f32 v[102:103], v[102:103], v[4:5], v[6:7]
    v_pk_fma_f32 v[104:105], v[104:105], v[4:5], v[6:7]
    v_pk_fma_f32 v[106:107], v[106:107], v[4:5], v[6:7]
    v_cvt_pk_bf16_f32 v240, v100, v101
    v_cvt_pk_bf16_f32 v241, v102, v103
    v_cvt_pk_bf16_f32 v242, v104, v105
    v_cvt_pk_bf16_f32 v243, v106, v107
    ds_write_b64 v19, v[240:241] offset:10240
    ds_write_b64 v19, v[242:243] offset:10496
    v_pk_fma_f32 v[108:109], v[108:109], v[4:5], v[6:7]
    v_pk_fma_f32 v[110:111], v[110:111], v[4:5], v[6:7]
    v_pk_fma_f32 v[112:113], v[112:113], v[4:5], v[6:7]
    v_pk_fma_f32 v[114:115], v[114:115], v[4:5], v[6:7]
    v_cvt_pk_bf16_f32 v244, v108, v109
    v_cvt_pk_bf16_f32 v245, v110, v111
    v_cvt_pk_bf16_f32 v246, v112, v113
    v_cvt_pk_bf16_f32 v247, v114, v115
    ds_write_b64 v19, v[244:245] offset:12288
    ds_write_b64 v19, v[246:247] offset:12544
    v_pk_fma_f32 v[116:117], v[116:117], v[4:5], v[6:7]
    v_pk_fma_f32 v[118:119], v[118:119], v[4:5], v[6:7]
    v_pk_fma_f32 v[120:121], v[120:121], v[4:5], v[6:7]
    v_pk_fma_f32 v[122:123], v[122:123], v[4:5], v[6:7]
    v_cvt_pk_bf16_f32 v248, v116, v117
    v_cvt_pk_bf16_f32 v249, v118, v119
    v_cvt_pk_bf16_f32 v250, v120, v121
    v_cvt_pk_bf16_f32 v251, v122, v123
    ds_write_b64 v19, v[248:249] offset:14336
    ds_write_b64 v19, v[250:251] offset:14592
    v_pk_fma_f32 v[124:125], v[124:125], v[4:5], v[6:7]
    v_pk_fma_f32 v[126:127], v[126:127], v[4:5], v[6:7]
    v_pk_fma_f32 v[128:129], v[128:129], v[4:5], v[6:7]
    v_pk_fma_f32 v[130:131], v[130:131], v[4:5], v[6:7]
    v_cvt_pk_bf16_f32 v252, v124, v125
    v_cvt_pk_bf16_f32 v253, v126, v127
    v_cvt_pk_bf16_f32 v254, v128, v129
    v_cvt_pk_bf16_f32 v255, v130, v131
    ds_write_b64 v19, v[252:253] offset:16384
    ds_write_b64 v19, v[254:255] offset:16640
k1b_kernel_lnskip:
    s_waitcnt lgkmcnt(0)
    v_lshrrev_b32 v3, 4, v0
    v_lshlrev_b32 v3, 2, v3
    v_bfe_u32 v4, v0, 2, 2
    v_add_u32 v3, v3, v4
    v_mul_u32_u24 v3, 480, v3
    v_and_b32 v4, 3, v0
    v_lshlrev_b32 v4, 3, v4
    v_add_u32 v3, v3, v4
    s_lshl_b32 s30, s20, 5
    s_add_u32 s30, s30, 92160
    v_add_u32 v19, s30, v3
    s_add_u32 s30, s20, 12
    s_min_u32 s30, s30, 13
    s_lshl_b32 s30, s30, 5
    s_add_u32 s30, s30, 92160
    v_add_u32 v20, s30, v3
    v_lshlrev_b32 v21, 4, v0
    v_add_u32 v22, 55296, v21
    s_waitcnt vmcnt(17)
    s_barrier
    ds_read_b128 v[96:99], v21 offset:0
    ds_read_b128 v[100:103], v21 offset:18432
    ds_read_b128 v[104:107], v21 offset:36864
    ds_read_b128 v[108:111], v22 offset:0
    ds_read_b128 v[112:115], v22 offset:18432
    ds_read_b64_tr_b16 v[136:137], v19 offset:0
    ds_read_b64_tr_b16 v[138:139], v19 offset:7680
    ds_read_b64_tr_b16 v[140:141], v19 offset:128
    ds_read_b64_tr_b16 v[142:143], v19 offset:7808
    ds_read_b64_tr_b16 v[144:145], v19 offset:256
    ds_read_b64_tr_b16 v[146:147], v19 offset:7936
    ds_read_b64_tr_b16 v[148:149], v20 offset:0
    ds_read_b64_tr_b16 v[150:151], v20 offset:7680
    s_waitcnt lgkmcnt(0)
    s_waitcnt vmcnt(4)
    s_barrier
    v_mfma_f32_16x16x32_bf16 v[168:171], v[136:139], v[96:99], 0
    ds_read_b128 v[116:119], v21 offset:1024
    v_mfma_f32_16x16x32_bf16 v[172:175], v[136:139], v[100:103], 0
    ds_read_b128 v[120:123], v21 offset:19456
    v_mfma_f32_16x16x32_bf16 v[176:179], v[136:139], v[104:107], 0
    ds_read_b128 v[124:127], v21 offset:37888
    v_mfma_f32_16x16x32_bf16 v[180:183], v[136:139], v[108:111], 0
    ds_read_b128 v[128:131], v22 offset:1024
    v_mfma_f32_16x16x32_bf16 v[184:187], v[136:139], v[112:115], 0
    ds_read_b128 v[132:135], v22 offset:19456
    v_mfma_f32_16x16x32_bf16 v[188:191], v[140:143], v[96:99], 0
    ds_read_b64_tr_b16 v[152:153], v19 offset:15360
    v_mfma_f32_16x16x32_bf16 v[192:195], v[140:143], v[100:103], 0
    ds_read_b64_tr_b16 v[154:155], v19 offset:23040
    v_mfma_f32_16x16x32_bf16 v[196:199], v[140:143], v[104:107], 0
    ds_read_b64_tr_b16 v[156:157], v19 offset:15488
    v_mfma_f32_16x16x32_bf16 v[200:203], v[140:143], v[108:111], 0
    ds_read_b64_tr_b16 v[158:159], v19 offset:23168
    v_mfma_f32_16x16x32_bf16 v[204:207], v[140:143], v[112:115], 0
    ds_read_b64_tr_b16 v[160:161], v19 offset:15616
    v_mfma_f32_16x16x32_bf16 v[208:211], v[144:147], v[96:99], 0
    ds_read_b64_tr_b16 v[162:163], v19 offset:23296
    v_mfma_f32_16x16x32_bf16 v[212:215], v[144:147], v[100:103], 0
    ds_read_b64_tr_b16 v[164:165], v20 offset:15360
    v_mfma_f32_16x16x32_bf16 v[216:219], v[144:147], v[104:107], 0
    ds_read_b64_tr_b16 v[166:167], v20 offset:23040
    v_mfma_f32_16x16x32_bf16 v[220:223], v[144:147], v[108:111], 0
    s_add_u32 m0, s40, 46080
    s_add_u32 s25, s60, s40
    s_add_u32 s25, s25, 46080
    buffer_load_dwordx4 v1, s[16:19], s25 offen lds
    v_mfma_f32_16x16x32_bf16 v[224:227], v[144:147], v[112:115], 0
    s_add_u32 m0, s41, 46080
    s_add_u32 s25, s60, s41
    s_add_u32 s25, s25, 46080
    buffer_load_dwordx4 v1, s[16:19], s25 offen lds
    v_mfma_f32_16x16x32_bf16 v[228:231], v[148:151], v[96:99], 0
    s_add_u32 m0, s42, 46080
    s_add_u32 s25, s60, s42
    s_add_u32 s25, s25, 46080
    buffer_load_dwordx4 v1, s[16:19], s25 offen lds
    v_mfma_f32_16x16x32_bf16 v[232:235], v[148:151], v[100:103], 0
    s_add_u32 m0, s43, 46080
    s_add_u32 s25, s60, s43
    s_add_u32 s25, s25, 46080
    buffer_load_dwordx4 v1, s[16:19], s25 offen lds
    v_mfma_f32_16x16x32_bf16 v[236:239], v[148:151], v[104:107], 0
    v_mfma_f32_16x16x32_bf16 v[240:243], v[148:151], v[108:111], 0
    v_mfma_f32_16x16x32_bf16 v[244:247], v[148:151], v[112:115], 0
    s_waitcnt lgkmcnt(0)
    s_waitcnt vmcnt(4)
    s_barrier
    v_mfma_f32_16x16x32_bf16 v[168:171], v[152:155], v[116:119], v[168:171]
    ds_read_b128 v[96:99], v21 offset:2048
    v_mfma_f32_16x16x32_bf16 v[172:175], v[152:155], v[120:123], v[172:175]
    ds_read_b128 v[100:103], v21 offset:20480
    v_mfma_f32_16x16x32_bf16 v[176:179], v[152:155], v[124:127], v[176:179]
    ds_read_b128 v[104:107], v21 offset:38912
    v_mfma_f32_16x16x32_bf16 v[180:183], v[152:155], v[128:131], v[180:183]
    ds_read_b128 v[108:111], v22 offset:2048
    v_mfma_f32_16x16x32_bf16 v[184:187], v[152:155], v[132:135], v[184:187]
    ds_read_b128 v[112:115], v22 offset:20480
    v_mfma_f32_16x16x32_bf16 v[188:191], v[156:159], v[116:119], v[188:191]
    ds_read_b64_tr_b16 v[136:137], v19 offset:30720
    v_mfma_f32_16x16x32_bf16 v[192:195], v[156:159], v[120:123], v[192:195]
    ds_read_b64_tr_b16 v[138:139], v19 offset:38400
    v_mfma_f32_16x16x32_bf16 v[196:199], v[156:159], v[124:127], v[196:199]
    ds_read_b64_tr_b16 v[140:141], v19 offset:30848
    v_mfma_f32_16x16x32_bf16 v[200:203], v[156:159], v[128:131], v[200:203]
    ds_read_b64_tr_b16 v[142:143], v19 offset:38528
    v_mfma_f32_16x16x32_bf16 v[204:207], v[156:159], v[132:135], v[204:207]
    ds_read_b64_tr_b16 v[144:145], v19 offset:30976
    v_mfma_f32_16x16x32_bf16 v[208:211], v[160:163], v[116:119], v[208:211]
    ds_read_b64_tr_b16 v[146:147], v19 offset:38656
    v_mfma_f32_16x16x32_bf16 v[212:215], v[160:163], v[120:123], v[212:215]
    ds_read_b64_tr_b16 v[148:149], v20 offset:30720
    v_mfma_f32_16x16x32_bf16 v[216:219], v[160:163], v[124:127], v[216:219]
    ds_read_b64_tr_b16 v[150:151], v20 offset:38400
    v_mfma_f32_16x16x32_bf16 v[220:223], v[160:163], v[128:131], v[220:223]
    s_add_u32 m0, s40, 0
    s_add_u32 s25, s60, s40
    s_add_u32 s25, s25, 61440
    buffer_load_dwordx4 v1, s[16:19], s25 offen lds
    v_mfma_f32_16x16x32_bf16 v[224:227], v[160:163], v[132:135], v[224:227]
    s_add_u32 m0, s41, 0
    s_add_u32 s25, s60, s41
    s_add_u32 s25, s25, 61440
    buffer_load_dwordx4 v1, s[16:19], s25 offen lds
    v_mfma_f32_16x16x32_bf16 v[228:231], v[164:167], v[116:119], v[228:231]
    s_add_u32 m0, s42, 0
    s_add_u32 s25, s60, s42
    s_add_u32 s25, s25, 61440
    buffer_load_dwordx4 v1, s[16:19], s25 offen lds
    v_mfma_f32_16x16x32_bf16 v[232:235], v[164:167], v[120:123], v[232:235]
    s_add_u32 m0, s43, 0
    s_add_u32 s25, s60, s43
    s_add_u32 s25, s25, 61440
    buffer_load_dwordx4 v1, s[16:19], s25 offen lds
    v_mfma_f32_16x16x32_bf16 v[236:239], v[164:167], v[124:127], v[236:239]
    v_mfma_f32_16x16x32_bf16 v[240:243], v[164:167], v[128:131], v[240:243]
    v_mfma_f32_16x16x32_bf16 v[244:247], v[164:167], v[132:135], v[244:247]
    s_waitcnt lgkmcnt(0)
    s_waitcnt vmcnt(4)
    s_barrier
    v_mfma_f32_16x16x32_bf16 v[168:171], v[136:139], v[96:99], v[168:171]
    ds_read_b128 v[116:119], v21 offset:3072
    v_mfma_f32_16x16x32_bf16 v[172:175], v[136:139], v[100:103], v[172:175]
    ds_read_b128 v[120:123], v21 offset:21504
    v_mfma_f32_16x16x32_bf16 v[176:179], v[136:139], v[104:107], v[176:179]
    ds_read_b128 v[124:127], v21 offset:39936
    v_mfma_f32_16x16x32_bf16 v[180:183], v[136:139], v[108:111], v[180:183]
    ds_read_b128 v[128:131], v22 offset:3072
    v_mfma_f32_16x16x32_bf16 v[184:187], v[136:139], v[112:115], v[184:187]
    ds_read_b128 v[132:135], v22 offset:21504
    v_mfma_f32_16x16x32_bf16 v[188:191], v[140:143], v[96:99], v[188:191]
    ds_read_b64_tr_b16 v[152:153], v19 offset:46080
    v_mfma_f32_16x16x32_bf16 v[192:195], v[140:143], v[100:103], v[192:195]
    ds_read_b64_tr_b16 v[154:155], v19 offset:53760
    v_mfma_f32_16x16x32_bf16 v[196:199], v[140:143], v[104:107], v[196:199]
    ds_read_b64_tr_b16 v[156:157], v19 offset:46208
    v_mfma_f32_16x16x32_bf16 v[200:203], v[140:143], v[108:111], v[200:203]
    ds_read_b64_tr_b16 v[158:159], v19 offset:53888
    v_mfma_f32_16x16x32_bf16 v[204:207], v[140:143], v[112:115], v[204:207]
    ds_read_b64_tr_b16 v[160:161], v19 offset:46336
    v_mfma_f32_16x16x32_bf16 v[208:211], v[144:147], v[96:99], v[208:211]
    ds_read_b64_tr_b16 v[162:163], v19 offset:54016
    v_mfma_f32_16x16x32_bf16 v[212:215], v[144:147], v[100:103], v[212:215]
    ds_read_b64_tr_b16 v[164:165], v20 offset:46080
    v_mfma_f32_16x16x32_bf16 v[216:219], v[144:147], v[104:107], v[216:219]
    ds_read_b64_tr_b16 v[166:167], v20 offset:53760
    v_mfma_f32_16x16x32_bf16 v[220:223], v[144:147], v[108:111], v[220:223]
    s_add_u32 m0, s40, 15360
    s_add_u32 s25, s60, s40
    s_add_u32 s25, s25, 76800
    buffer_load_dwordx4 v1, s[16:19], s25 offen lds
    v_mfma_f32_16x16x32_bf16 v[224:227], v[144:147], v[112:115], v[224:227]
    s_add_u32 m0, s41, 15360
    s_add_u32 s25, s60, s41
    s_add_u32 s25, s25, 76800
    buffer_load_dwordx4 v1, s[16:19], s25 offen lds
    v_mfma_f32_16x16x32_bf16 v[228:231], v[148:151], v[96:99], v[228:231]
    s_add_u32 m0, s42, 15360
    s_add_u32 s25, s60, s42
    s_add_u32 s25, s25, 76800
    buffer_load_dwordx4 v1, s[16:19], s25 offen lds
    v_mfma_f32_16x16x32_bf16 v[232:235], v[148:151], v[100:103], v[232:235]
    s_add_u32 m0, s43, 15360
    s_add_u32 s25, s60, s43
    s_add_u32 s25, s25, 76800
    buffer_load_dwordx4 v1, s[16:19], s25 offen lds
    v_mfma_f32_16x16x32_bf16 v[236:239], v[148:151], v[104:107], v[236:239]
    v_mfma_f32_16x16x32_bf16 v[240:243], v[148:151], v[108:111], v[240:243]
    v_mfma_f32_16x16x32_bf16 v[244:247], v[148:151], v[112:115], v[244:247]
    s_waitcnt lgkmcnt(0)
    s_waitcnt vmcnt(4)
    s_barrier
    v_mfma_f32_16x16x32_bf16 v[168:171], v[152:155], v[116:119], v[168:171]
    ds_read_b128 v[96:99], v21 offset:4096
    v_mfma_f32_16x16x32_bf16 v[172:175], v[152:155], v[120:123], v[172:175]
    ds_read_b128 v[100:103], v21 offset:22528
    v_mfma_f32_16x16x32_bf16 v[176:179], v[152:155], v[124:127], v[176:179]
    ds_read_b128 v[104:107], v21 offset:40960
    v_mfma_f32_16x16x32_bf16 v[180:183], v[152:155], v[128:131], v[180:183]
    ds_read_b128 v[108:111], v22 offset:4096
    v_mfma_f32_16x16x32_bf16 v[184:187], v[152:155], v[132:135], v[184:187]
    ds_read_b128 v[112:115], v22 offset:22528
    v_mfma_f32_16x16x32_bf16 v[188:191], v[156:159], v[116:119], v[188:191]
    ds_read_b64_tr_b16 v[136:137], v19 offset:0
    v_mfma_f32_16x16x32_bf16 v[192:195], v[156:159], v[120:123], v[192:195]
    ds_read_b64_tr_b16 v[138:139], v19 offset:7680
    v_mfma_f32_16x16x32_bf16 v[196:199], v[156:159], v[124:127], v[196:199]
    ds_read_b64_tr_b16 v[140:141], v19 offset:128
    v_mfma_f32_16x16x32_bf16 v[200:203], v[156:159], v[128:131], v[200:203]
    ds_read_b64_tr_b16 v[142:143], v19 offset:7808
    v_mfma_f32_16x16x32_bf16 v[204:207], v[156:159], v[132:135], v[204:207]
    ds_read_b64_tr_b16 v[144:145], v19 offset:256
    v_mfma_f32_16x16x32_bf16 v[208:211], v[160:163], v[116:119], v[208:211]
    ds_read_b64_tr_b16 v[146:147], v19 offset:7936
    v_mfma_f32_16x16x32_bf16 v[212:215], v[160:163], v[120:123], v[212:215]
    ds_read_b64_tr_b16 v[148:149], v20 offset:0
    v_mfma_f32_16x16x32_bf16 v[216:219], v[160:163], v[124:127], v[216:219]
    ds_read_b64_tr_b16 v[150:151], v20 offset:7680
    v_mfma_f32_16x16x32_bf16 v[220:223], v[160:163], v[128:131], v[220:223]
    s_add_u32 m0, s40, 30720
    s_add_u32 s25, s60, s40
    s_add_u32 s25, s25, 92160
    buffer_load_dwordx4 v1, s[16:19], s25 offen lds
    v_mfma_f32_16x16x32_bf16 v[224:227], v[160:163], v[132:135], v[224:227]
    s_add_u32 m0, s41, 30720
    s_add_u32 s25, s60, s41
    s_add_u32 s25, s25, 92160
    buffer_load_dwordx4 v1, s[16:19], s25 offen lds
    v_mfma_f32_16x16x32_bf16 v[228:231], v[164:167], v[116:119], v[228:231]
    s_add_u32 m0, s42, 30720
    s_add_u32 s25, s60, s42
    s_add_u32 s25, s25, 92160
    buffer_load_dwordx4 v1, s[16:19], s25 offen lds
    v_mfma_f32_16x16x32_bf16 v[232:235], v[164:167], v[120:123], v[232:235]
    s_add_u32 m0, s43, 30720
    s_add_u32 s25, s60, s43
    s_add_u32 s25, s25, 92160
    buffer_load_dwordx4 v1, s[16:19], s25 offen lds
    v_mfma_f32_16x16x32_bf16 v[236:239], v[164:167], v[124:127], v[236:239]
    v_mfma_f32_16x16x32_bf16 v[240:243], v[164:167], v[128:131], v[240:243]
    v_mfma_f32_16x16x32_bf16 v[244:247], v[164:167], v[132:135], v[244:247]
    s_waitcnt lgkmcnt(0)
    s_waitcnt vmcnt(4)
    s_barrier
    v_mfma_f32_16x16x32_bf16 v[168:171], v[136:139], v[96:99], v[168:171]
    ds_read_b128 v[116:119], v21 offset:5120
    v_mfma_f32_16x16x32_bf16 v[172:175], v[136:139], v[100:103], v[172:175]
    ds_read_b128 v[120:123], v21 offset:23552
    v_mfma_f32_16x16x32_bf16 v[176:179], v[136:139], v[104:107], v[176:179]
    ds_read_b128 v[124:127], v21 offset:41984
    v_mfma_f32_16x16x32_bf16 v[180:183], v[136:139], v[108:111], v[180:183]
    ds_read_b128 v[128:131], v22 offset:5120
    v_mfma_f32_16x16x32_bf16 v[184:187], v[136:139], v[112:115], v[184:187]
    ds_read_b128 v[132:135], v22 offset:23552
    v_mfma_f32_16x16x32_bf16 v[188:191], v[140:143], v[96:99], v[188:191]
    ds_read_b64_tr_b16 v[152:153], v19 offset:15360
    v_mfma_f32_16x16x32_bf16 v[192:195], v[140:143], v[100:103], v[192:195]
    ds_read_b64_tr_b16 v[154:155], v19 offset:23040
    v_mfma_f32_16x16x32_bf16 v[196:199], v[140:143], v[104:107], v[196:199]
    ds_read_b64_tr_b16 v[156:157], v19 offset:15488
    v_mfma_f32_16x16x32_bf16 v[200:203], v[140:143], v[108:111], v[200:203]
    ds_read_b64_tr_b16 v[158:159], v19 offset:23168
    v_mfma_f32_16x16x32_bf16 v[204:207], v[140:143], v[112:115], v[204:207]
    ds_read_b64_tr_b16 v[160:161], v19 offset:15616
    v_mfma_f32_16x16x32_bf16 v[208:211], v[144:147], v[96:99], v[208:211]
    ds_read_b64_tr_b16 v[162:163], v19 offset:23296
    v_mfma_f32_16x16x32_bf16 v[212:215], v[144:147], v[100:103], v[212:215]
    ds_read_b64_tr_b16 v[164:165], v20 offset:15360
    v_mfma_f32_16x16x32_bf16 v[216:219], v[144:147], v[104:107], v[216:219]
    ds_read_b64_tr_b16 v[166:167], v20 offset:23040
    v_mfma_f32_16x16x32_bf16 v[220:223], v[144:147], v[108:111], v[220:223]
    s_add_u32 m0, s40, 46080
    s_add_u32 s25, s60, s40
    s_add_u32 s25, s25, 107520
    buffer_load_dwordx4 v1, s[16:19], s25 offen lds
    v_mfma_f32_16x16x32_bf16 v[224:227], v[144:147], v[112:115], v[224:227]
    s_add_u32 m0, s41, 46080
    s_add_u32 s25, s60, s41
    s_add_u32 s25, s25, 107520
    buffer_load_dwordx4 v1, s[16:19], s25 offen lds
    v_mfma_f32_16x16x32_bf16 v[228:231], v[148:151], v[96:99], v[228:231]
    s_add_u32 m0, s42, 46080
    s_add_u32 s25, s60, s42
    s_add_u32 s25, s25, 107520
    buffer_load_dwordx4 v1, s[16:19], s25 offen lds
    v_mfma_f32_16x16x32_bf16 v[232:235], v[148:151], v[100:103], v[232:235]
    s_add_u32 m0, s43, 46080
    s_add_u32 s25, s60, s43
    s_add_u32 s25, s25, 107520
    buffer_load_dwordx4 v1, s[16:19], s25 offen lds
    v_mfma_f32_16x16x32_bf16 v[236:239], v[148:151], v[104:107], v[236:239]
    v_mfma_f32_16x16x32_bf16 v[240:243], v[148:151], v[108:111], v[240:243]
    v_mfma_f32_16x16x32_bf16 v[244:247], v[148:151], v[112:115], v[244:247]
    s_waitcnt lgkmcnt(0)
    s_waitcnt vmcnt(4)
    s_barrier
    v_mfma_f32_16x16x32_bf16 v[168:171], v[152:155], v[116:119], v[168:171]
    ds_read_b128 v[96:99], v21 offset:6144
    v_mfma_f32_16x16x32_bf16 v[172:175], v[152:155], v[120:123], v[172:175]
    ds_read_b128 v[100:103], v21 offset:24576
    v_mfma_f32_16x16x32_bf16 v[176:179], v[152:155], v[124:127], v[176:179]
    ds_read_b128 v[104:107], v21 offset:43008
    v_mfma_f32_16x16x32_bf16 v[180:183], v[152:155], v[128:131], v[180:183]
    ds_read_b128 v[108:111], v22 offset:6144
    v_mfma_f32_16x16x32_bf16 v[184:187], v[152:155], v[132:135], v[184:187]
    ds_read_b128 v[112:115], v22 offset:24576
    v_mfma_f32_16x16x32_bf16 v[188:191], v[156:159], v[116:119], v[188:191]
    ds_read_b64_tr_b16 v[136:137], v19 offset:30720
    v_mfma_f32_16x16x32_bf16 v[192:195], v[156:159], v[120:123], v[192:195]
    ds_read_b64_tr_b16 v[138:139], v19 offset:38400
    v_mfma_f32_16x16x32_bf16 v[196:199], v[156:159], v[124:127], v[196:199]
    ds_read_b64_tr_b16 v[140:141], v19 offset:30848
    v_mfma_f32_16x16x32_bf16 v[200:203], v[156:159], v[128:131], v[200:203]
    ds_read_b64_tr_b16 v[142:143], v19 offset:38528
    v_mfma_f32_16x16x32_bf16 v[204:207], v[156:159], v[132:135], v[204:207]
    ds_read_b64_tr_b16 v[144:145], v19 offset:30976
    v_mfma_f32_16x16x32_bf16 v[208:211], v[160:163], v[116:119], v[208:211]
    ds_read_b64_tr_b16 v[146:147], v19 offset:38656
    v_mfma_f32_16x16x32_bf16 v[212:215], v[160:163], v[120:123], v[212:215]
    ds_read_b64_tr_b16 v[148:149], v20 offset:30720
    v_mfma_f32_16x16x32_bf16 v[216:219], v[160:163], v[124:127], v[216:219]
    ds_read_b64_tr_b16 v[150:151], v20 offset:38400
    v_mfma_f32_16x16x32_bf16 v[220:223], v[160:163], v[128:131], v[220:223]
    s_add_u32 m0, s40, 0
    s_add_u32 s25, s60, s40
    s_add_u32 s25, s25, 122880
    buffer_load_dwordx4 v1, s[16:19], s25 offen lds
    v_mfma_f32_16x16x32_bf16 v[224:227], v[160:163], v[132:135], v[224:227]
    s_add_u32 m0, s41, 0
    s_add_u32 s25, s60, s41
    s_add_u32 s25, s25, 122880
    buffer_load_dwordx4 v1, s[16:19], s25 offen lds
    v_mfma_f32_16x16x32_bf16 v[228:231], v[164:167], v[116:119], v[228:231]
    s_add_u32 m0, s42, 0
    s_add_u32 s25, s60, s42
    s_add_u32 s25, s25, 122880
    buffer_load_dwordx4 v1, s[16:19], s25 offen lds
    v_mfma_f32_16x16x32_bf16 v[232:235], v[164:167], v[120:123], v[232:235]
    s_add_u32 m0, s43, 0
    s_add_u32 s25, s60, s43
    s_add_u32 s25, s25, 122880
    buffer_load_dwordx4 v1, s[16:19], s25 offen lds
    v_mfma_f32_16x16x32_bf16 v[236:239], v[164:167], v[124:127], v[236:239]
    v_mfma_f32_16x16x32_bf16 v[240:243], v[164:167], v[128:131], v[240:243]
    v_mfma_f32_16x16x32_bf16 v[244:247], v[164:167], v[132:135], v[244:247]
    s_waitcnt lgkmcnt(0)
    s_waitcnt vmcnt(4)
    s_barrier
    v_mfma_f32_16x16x32_bf16 v[168:171], v[136:139], v[96:99], v[168:171]
    ds_read_b128 v[116:119], v21 offset:7168
    v_mfma_f32_16x16x32_bf16 v[172:175], v[136:139], v[100:103], v[172:175]
    ds_read_b128 v[120:123], v21 offset:25600
    v_mfma_f32_16x16x32_bf16 v[176:179], v[136:139], v[104:107], v[176:179]
    ds_read_b128 v[124:127], v21 offset:44032
    v_mfma_f32_16x16x32_bf16 v[180:183], v[136:139], v[108:111], v[180:183]
    ds_read_b128 v[128:131], v22 offset:7168
    v_mfma_f32_16x16x32_bf16 v[184:187], v[136:139], v[112:115], v[184:187]
    ds_read_b128 v[132:135], v22 offset:25600
    v_mfma_f32_16x16x32_bf16 v[188:191], v[140:143], v[96:99], v[188:191]
    ds_read_b64_tr_b16 v[152:153], v19 offset:46080
    v_mfma_f32_16x16x32_bf16 v[192:195], v[140:143], v[100:103], v[192:195]
    ds_read_b64_tr_b16 v[154:155], v19 offset:53760
    v_mfma_f32_16x16x32_bf16 v[196:199], v[140:143], v[104:107], v[196:199]
    ds_read_b64_tr_b16 v[156:157], v19 offset:46208
    v_mfma_f32_16x16x32_bf16 v[200:203], v[140:143], v[108:111], v[200:203]
    ds_read_b64_tr_b16 v[158:159], v19 offset:53888
    v_mfma_f32_16x16x32_bf16 v[204:207], v[140:143], v[112:115], v[204:207]
    ds_read_b64_tr_b16 v[160:161], v19 offset:46336
    v_mfma_f32_16x16x32_bf16 v[208:211], v[144:147], v[96:99], v[208:211]
    ds_read_b64_tr_b16 v[162:163], v19 offset:54016
    v_mfma_f32_16x16x32_bf16 v[212:215], v[144:147], v[100:103], v[212:215]
    ds_read_b64_tr_b16 v[164:165], v20 offset:46080
    v_mfma_f32_16x16x32_bf16 v[216:219], v[144:147], v[104:107], v[216:219]
    ds_read_b64_tr_b16 v[166:167], v20 offset:53760
    v_mfma_f32_16x16x32_bf16 v[220:223], v[144:147], v[108:111], v[220:223]
    s_add_u32 m0, s40, 15360
    s_add_u32 s25, s60, s40
    s_add_u32 s25, s25, 138240
    buffer_load_dwordx4 v1, s[16:19], s25 offen lds
    v_mfma_f32_16x16x32_bf16 v[224:227], v[144:147], v[112:115], v[224:227]
    s_add_u32 m0, s41, 15360
    s_add_u32 s25, s60, s41
    s_add_u32 s25, s25, 138240
    buffer_load_dwordx4 v1, s[16:19], s25 offen lds
    v_mfma_f32_16x16x32_bf16 v[228:231], v[148:151], v[96:99], v[228:231]
    s_add_u32 m0, s42, 15360
    s_add_u32 s25, s60, s42
    s_add_u32 s25, s25, 138240
    buffer_load_dwordx4 v1, s[16:19], s25 offen lds
    v_mfma_f32_16x16x32_bf16 v[232:235], v[148:151], v[100:103], v[232:235]
    s_add_u32 m0, s43, 15360
    s_add_u32 s25, s60, s43
    s_add_u32 s25, s25, 138240
    buffer_load_dwordx4 v1, s[16:19], s25 offen lds
    v_mfma_f32_16x16x32_bf16 v[236:239], v[148:151], v[104:107], v[236:239]
    v_mfma_f32_16x16x32_bf16 v[240:243], v[148:151], v[108:111], v[240:243]
    v_mfma_f32_16x16x32_bf16 v[244:247], v[148:151], v[112:115], v[244:247]
    s_waitcnt lgkmcnt(0)
    s_waitcnt vmcnt(4)
    s_barrier
    v_mfma_f32_16x16x32_bf16 v[168:171], v[152:155], v[116:119], v[168:171]
    ds_read_b128 v[96:99], v21 offset:8192
    v_mfma_f32_16x16x32_bf16 v[172:175], v[152:155], v[120:123], v[172:175]
    ds_read_b128 v[100:103], v21 offset:26624
    v_mfma_f32_16x16x32_bf16 v[176:179], v[152:155], v[124:127], v[176:179]
    ds_read_b128 v[104:107], v21 offset:45056
    v_mfma_f32_16x16x32_bf16 v[180:183], v[152:155], v[128:131], v[180:183]
    ds_read_b128 v[108:111], v22 offset:8192
    v_mfma_f32_16x16x32_bf16 v[184:187], v[152:155], v[132:135], v[184:187]
    ds_read_b128 v[112:115], v22 offset:26624
    v_mfma_f32_16x16x32_bf16 v[188:191], v[156:159], v[116:119], v[188:191]
    ds_read_b64_tr_b16 v[136:137], v19 offset:0
    v_mfma_f32_16x16x32_bf16 v[192:195], v[156:159], v[120:123], v[192:195]
    ds_read_b64_tr_b16 v[138:139], v19 offset:7680
    v_mfma_f32_16x16x32_bf16 v[196:199], v[156:159], v[124:127], v[196:199]
    ds_read_b64_tr_b16 v[140:141], v19 offset:128
    v_mfma_f32_16x16x32_bf16 v[200:203], v[156:159], v[128:131], v[200:203]
    ds_read_b64_tr_b16 v[142:143], v19 offset:7808
    v_mfma_f32_16x16x32_bf16 v[204:207], v[156:159], v[132:135], v[204:207]
    ds_read_b64_tr_b16 v[144:145], v19 offset:256
    v_mfma_f32_16x16x32_bf16 v[208:211], v[160:163], v[116:119], v[208:211]
    ds_read_b64_tr_b16 v[146:147], v19 offset:7936
    v_mfma_f32_16x16x32_bf16 v[212:215], v[160:163], v[120:123], v[212:215]
    ds_read_b64_tr_b16 v[148:149], v20 offset:0
    v_mfma_f32_16x16x32_bf16 v[216:219], v[160:163], v[124:127], v[216:219]
    ds_read_b64_tr_b16 v[150:151], v20 offset:7680
    v_mfma_f32_16x16x32_bf16 v[220:223], v[160:163], v[128:131], v[220:223]
    s_add_u32 m0, s40, 30720
    s_add_u32 s25, s60, s40
    s_add_u32 s25, s25, 153600
    buffer_load_dwordx4 v1, s[16:19], s25 offen lds
    v_mfma_f32_16x16x32_bf16 v[224:227], v[160:163], v[132:135], v[224:227]
    s_add_u32 m0, s41, 30720
    s_add_u32 s25, s60, s41
    s_add_u32 s25, s25, 153600
    buffer_load_dwordx4 v1, s[16:19], s25 offen lds
    v_mfma_f32_16x16x32_bf16 v[228:231], v[164:167], v[116:119], v[228:231]
    s_add_u32 m0, s42, 30720
    s_add_u32 s25, s60, s42
    s_add_u32 s25, s25, 153600
    buffer_load_dwordx4 v1, s[16:19], s25 offen lds
    v_mfma_f32_16x16x32_bf16 v[232:235], v[164:167], v[120:123], v[232:235]
    s_add_u32 m0, s43, 30720
    s_add_u32 s25, s60, s43
    s_add_u32 s25, s25, 153600
    buffer_load_dwordx4 v1, s[16:19], s25 offen lds
    v_mfma_f32_16x16x32_bf16 v[236:239], v[164:167], v[124:127], v[236:239]
    v_mfma_f32_16x16x32_bf16 v[240:243], v[164:167], v[128:131], v[240:243]
    v_mfma_f32_16x16x32_bf16 v[244:247], v[164:167], v[132:135], v[244:247]
    s_waitcnt lgkmcnt(0)
    s_waitcnt vmcnt(4)
    s_barrier
    v_mfma_f32_16x16x32_bf16 v[168:171], v[136:139], v[96:99], v[168:171]
    ds_read_b128 v[116:119], v21 offset:9216
    v_mfma_f32_16x16x32_bf16 v[172:175], v[136:139], v[100:103], v[172:175]
    ds_read_b128 v[120:123], v21 offset:27648
    v_mfma_f32_16x16x32_bf16 v[176:179], v[136:139], v[104:107], v[176:179]
    ds_read_b128 v[124:127], v21 offset:46080
    v_mfma_f32_16x16x32_bf16 v[180:183], v[136:139], v[108:111], v[180:183]
    ds_read_b128 v[128:131], v22 offset:9216
    v_mfma_f32_16x16x32_bf16 v[184:187], v[136:139], v[112:115], v[184:187]
    ds_read_b128 v[132:135], v22 offset:27648
    v_mfma_f32_16x16x32_bf16 v[188:191], v[140:143], v[96:99], v[188:191]
    ds_read_b64_tr_b16 v[152:153], v19 offset:15360
    v_mfma_f32_16x16x32_bf16 v[192:195], v[140:143], v[100:103], v[192:195]
    ds_read_b64_tr_b16 v[154:155], v19 offset:23040
    v_mfma_f32_16x16x32_bf16 v[196:199], v[140:143], v[104:107], v[196:199]
    ds_read_b64_tr_b16 v[156:157], v19 offset:15488
    v_mfma_f32_16x16x32_bf16 v[200:203], v[140:143], v[108:111], v[200:203]
    ds_read_b64_tr_b16 v[158:159], v19 offset:23168
    v_mfma_f32_16x16x32_bf16 v[204:207], v[140:143], v[112:115], v[204:207]
    ds_read_b64_tr_b16 v[160:161], v19 offset:15616
    v_mfma_f32_16x16x32_bf16 v[208:211], v[144:147], v[96:99], v[208:211]
    ds_read_b64_tr_b16 v[162:163], v19 offset:23296
    v_mfma_f32_16x16x32_bf16 v[212:215], v[144:147], v[100:103], v[212:215]
    ds_read_b64_tr_b16 v[164:165], v20 offset:15360
    v_mfma_f32_16x16x32_bf16 v[216:219], v[144:147], v[104:107], v[216:219]
    ds_read_b64_tr_b16 v[166:167], v20 offset:23040
    v_mfma_f32_16x16x32_bf16 v[220:223], v[144:147], v[108:111], v[220:223]
    s_add_u32 m0, s40, 46080
    s_add_u32 s25, s60, s40
    s_add_u32 s25, s25, 168960
    buffer_load_dwordx4 v1, s[16:19], s25 offen lds
    v_mfma_f32_16x16x32_bf16 v[224:227], v[144:147], v[112:115], v[224:227]
    s_add_u32 m0, s41, 46080
    s_add_u32 s25, s60, s41
    s_add_u32 s25, s25, 168960
    buffer_load_dwordx4 v1, s[16:19], s25 offen lds
    v_mfma_f32_16x16x32_bf16 v[228:231], v[148:151], v[96:99], v[228:231]
    s_add_u32 m0, s42, 46080
    s_add_u32 s25, s60, s42
    s_add_u32 s25, s25, 168960
    buffer_load_dwordx4 v1, s[16:19], s25 offen lds
    v_mfma_f32_16x16x32_bf16 v[232:235], v[148:151], v[100:103], v[232:235]
    s_add_u32 m0, s43, 46080
    s_add_u32 s25, s60, s43
    s_add_u32 s25, s25, 168960
    buffer_load_dwordx4 v1, s[16:19], s25 offen lds
    v_mfma_f32_16x16x32_bf16 v[236:239], v[148:151], v[104:107], v[236:239]
    v_mfma_f32_16x16x32_bf16 v[240:243], v[148:151], v[108:111], v[240:243]
    v_mfma_f32_16x16x32_bf16 v[244:247], v[148:151], v[112:115], v[244:247]
    s_waitcnt lgkmcnt(0)
    s_waitcnt vmcnt(4)
    s_barrier
    v_mfma_f32_16x16x32_bf16 v[168:171], v[152:155], v[116:119], v[168:171]
    ds_read_b128 v[96:99], v21 offset:10240
    v_mfma_f32_16x16x32_bf16 v[172:175], v[152:155], v[120:123], v[172:175]
    ds_read_b128 v[100:103], v21 offset:28672
    v_mfma_f32_16x16x32_bf16 v[176:179], v[152:155], v[124:127], v[176:179]
    ds_read_b128 v[104:107], v21 offset:47104
    v_mfma_f32_16x16x32_bf16 v[180:183], v[152:155], v[128:131], v[180:183]
    ds_read_b128 v[108:111], v22 offset:10240
    v_mfma_f32_16x16x32_bf16 v[184:187], v[152:155], v[132:135], v[184:187]
    ds_read_b128 v[112:115], v22 offset:28672
    v_mfma_f32_16x16x32_bf16 v[188:191], v[156:159], v[116:119], v[188:191]
    ds_read_b64_tr_b16 v[136:137], v19 offset:30720
    v_mfma_f32_16x16x32_bf16 v[192:195], v[156:159], v[120:123], v[192:195]
    ds_read_b64_tr_b16 v[138:139], v19 offset:38400
    v_mfma_f32_16x16x32_bf16 v[196:199], v[156:159], v[124:127], v[196:199]
    ds_read_b64_tr_b16 v[140:141], v19 offset:30848
    v_mfma_f32_16x16x32_bf16 v[200:203], v[156:159], v[128:131], v[200:203]
    ds_read_b64_tr_b16 v[142:143], v19 offset:38528
    v_mfma_f32_16x16x32_bf16 v[204:207], v[156:159], v[132:135], v[204:207]
    ds_read_b64_tr_b16 v[144:145], v19 offset:30976
    v_mfma_f32_16x16x32_bf16 v[208:211], v[160:163], v[116:119], v[208:211]
    ds_read_b64_tr_b16 v[146:147], v19 offset:38656
    v_mfma_f32_16x16x32_bf16 v[212:215], v[160:163], v[120:123], v[212:215]
    ds_read_b64_tr_b16 v[148:149], v20 offset:30720
    v_mfma_f32_16x16x32_bf16 v[216:219], v[160:163], v[124:127], v[216:219]
    ds_read_b64_tr_b16 v[150:151], v20 offset:38400
    v_mfma_f32_16x16x32_bf16 v[220:223], v[160:163], v[128:131], v[220:223]
    s_add_u32 m0, s40, 0
    s_add_u32 s25, s60, s40
    s_add_u32 s25, s25, 184320
    buffer_load_dwordx4 v1, s[16:19], s25 offen lds
    v_mfma_f32_16x16x32_bf16 v[224:227], v[160:163], v[132:135], v[224:227]
    s_add_u32 m0, s41, 0
    s_add_u32 s25, s60, s41
    s_add_u32 s25, s25, 184320
    buffer_load_dwordx4 v1, s[16:19], s25 offen lds
    v_mfma_f32_16x16x32_bf16 v[228:231], v[164:167], v[116:119], v[228:231]
    s_add_u32 m0, s42, 0
    s_add_u32 s25, s60, s42
    s_add_u32 s25, s25, 184320
    buffer_load_dwordx4 v1, s[16:19], s25 offen lds
    v_mfma_f32_16x16x32_bf16 v[232:235], v[164:167], v[120:123], v[232:235]
    s_add_u32 m0, s43, 0
    s_add_u32 s25, s60, s43
    s_add_u32 s25, s25, 184320
    buffer_load_dwordx4 v1, s[16:19], s25 offen lds
    v_mfma_f32_16x16x32_bf16 v[236:239], v[164:167], v[124:127], v[236:239]
    v_mfma_f32_16x16x32_bf16 v[240:243], v[164:167], v[128:131], v[240:243]
    v_mfma_f32_16x16x32_bf16 v[244:247], v[164:167], v[132:135], v[244:247]
    s_waitcnt lgkmcnt(0)
    s_waitcnt vmcnt(4)
    s_barrier
    v_mfma_f32_16x16x32_bf16 v[168:171], v[136:139], v[96:99], v[168:171]
    ds_read_b128 v[116:119], v21 offset:11264
    v_mfma_f32_16x16x32_bf16 v[172:175], v[136:139], v[100:103], v[172:175]
    ds_read_b128 v[120:123], v21 offset:29696
    v_mfma_f32_16x16x32_bf16 v[176:179], v[136:139], v[104:107], v[176:179]
    ds_read_b128 v[124:127], v21 offset:48128
    v_mfma_f32_16x16x32_bf16 v[180:183], v[136:139], v[108:111], v[180:183]
    ds_read_b128 v[128:131], v22 offset:11264
    v_mfma_f32_16x16x32_bf16 v[184:187], v[136:139], v[112:115], v[184:187]
    ds_read_b128 v[132:135], v22 offset:29696
    v_mfma_f32_16x16x32_bf16 v[188:191], v[140:143], v[96:99], v[188:191]
    ds_read_b64_tr_b16 v[152:153], v19 offset:46080
    v_mfma_f32_16x16x32_bf16 v[192:195], v[140:143], v[100:103], v[192:195]
    ds_read_b64_tr_b16 v[154:155], v19 offset:53760
    v_mfma_f32_16x16x32_bf16 v[196:199], v[140:143], v[104:107], v[196:199]
    ds_read_b64_tr_b16 v[156:157], v19 offset:46208
    v_mfma_f32_16x16x32_bf16 v[200:203], v[140:143], v[108:111], v[200:203]
    ds_read_b64_tr_b16 v[158:159], v19 offset:53888
    v_mfma_f32_16x16x32_bf16 v[204:207], v[140:143], v[112:115], v[204:207]
    ds_read_b64_tr_b16 v[160:161], v19 offset:46336
    v_mfma_f32_16x16x32_bf16 v[208:211], v[144:147], v[96:99], v[208:211]
    ds_read_b64_tr_b16 v[162:163], v19 offset:54016
    v_mfma_f32_16x16x32_bf16 v[212:215], v[144:147], v[100:103], v[212:215]
    ds_read_b64_tr_b16 v[164:165], v20 offset:46080
    v_mfma_f32_16x16x32_bf16 v[216:219], v[144:147], v[104:107], v[216:219]
    ds_read_b64_tr_b16 v[166:167], v20 offset:53760
    v_mfma_f32_16x16x32_bf16 v[220:223], v[144:147], v[108:111], v[220:223]
    s_add_u32 m0, s40, 15360
    s_add_u32 s25, s60, s40
    s_add_u32 s25, s25, 199680
    buffer_load_dwordx4 v1, s[16:19], s25 offen lds
    v_mfma_f32_16x16x32_bf16 v[224:227], v[144:147], v[112:115], v[224:227]
    s_add_u32 m0, s41, 15360
    s_add_u32 s25, s60, s41
    s_add_u32 s25, s25, 199680
    buffer_load_dwordx4 v1, s[16:19], s25 offen lds
    v_mfma_f32_16x16x32_bf16 v[228:231], v[148:151], v[96:99], v[228:231]
    s_add_u32 m0, s42, 15360
    s_add_u32 s25, s60, s42
    s_add_u32 s25, s25, 199680
    buffer_load_dwordx4 v1, s[16:19], s25 offen lds
    v_mfma_f32_16x16x32_bf16 v[232:235], v[148:151], v[100:103], v[232:235]
    s_add_u32 m0, s43, 15360
    s_add_u32 s25, s60, s43
    s_add_u32 s25, s25, 199680
    buffer_load_dwordx4 v1, s[16:19], s25 offen lds
    v_mfma_f32_16x16x32_bf16 v[236:239], v[148:151], v[104:107], v[236:239]
    v_mfma_f32_16x16x32_bf16 v[240:243], v[148:151], v[108:111], v[240:243]
    v_mfma_f32_16x16x32_bf16 v[244:247], v[148:151], v[112:115], v[244:247]
    s_waitcnt lgkmcnt(0)
    s_waitcnt vmcnt(4)
    s_barrier
    v_mfma_f32_16x16x32_bf16 v[168:171], v[152:155], v[116:119], v[168:171]
    ds_read_b128 v[96:99], v21 offset:12288
    v_mfma_f32_16x16x32_bf16 v[172:175], v[152:155], v[120:123], v[172:175]
    ds_read_b128 v[100:103], v21 offset:30720
    v_mfma_f32_16x16x32_bf16 v[176:179], v[152:155], v[124:127], v[176:179]
    ds_read_b128 v[104:107], v21 offset:49152
    v_mfma_f32_16x16x32_bf16 v[180:183], v[152:155], v[128:131], v[180:183]
    ds_read_b128 v[108:111], v22 offset:12288
    v_mfma_f32_16x16x32_bf16 v[184:187], v[152:155], v[132:135], v[184:187]
    ds_read_b128 v[112:115], v22 offset:30720
    v_mfma_f32_16x16x32_bf16 v[188:191], v[156:159], v[116:119], v[188:191]
    ds_read_b64_tr_b16 v[136:137], v19 offset:0
    v_mfma_f32_16x16x32_bf16 v[192:195], v[156:159], v[120:123], v[192:195]
    ds_read_b64_tr_b16 v[138:139], v19 offset:7680
    v_mfma_f32_16x16x32_bf16 v[196:199], v[156:159], v[124:127], v[196:199]
    ds_read_b64_tr_b16 v[140:141], v19 offset:128
    v_mfma_f32_16x16x32_bf16 v[200:203], v[156:159], v[128:131], v[200:203]
    ds_read_b64_tr_b16 v[142:143], v19 offset:7808
    v_mfma_f32_16x16x32_bf16 v[204:207], v[156:159], v[132:135], v[204:207]
    ds_read_b64_tr_b16 v[144:145], v19 offset:256
    v_mfma_f32_16x16x32_bf16 v[208:211], v[160:163], v[116:119], v[208:211]
    ds_read_b64_tr_b16 v[146:147], v19 offset:7936
    v_mfma_f32_16x16x32_bf16 v[212:215], v[160:163], v[120:123], v[212:215]
    ds_read_b64_tr_b16 v[148:149], v20 offset:0
    v_mfma_f32_16x16x32_bf16 v[216:219], v[160:163], v[124:127], v[216:219]
    ds_read_b64_tr_b16 v[150:151], v20 offset:7680
    v_mfma_f32_16x16x32_bf16 v[220:223], v[160:163], v[128:131], v[220:223]
    s_add_u32 m0, s40, 30720
    s_add_u32 s25, s60, s40
    s_add_u32 s25, s25, 215040
    buffer_load_dwordx4 v1, s[16:19], s25 offen lds
    v_mfma_f32_16x16x32_bf16 v[224:227], v[160:163], v[132:135], v[224:227]
    s_add_u32 m0, s41, 30720
    s_add_u32 s25, s60, s41
    s_add_u32 s25, s25, 215040
    buffer_load_dwordx4 v1, s[16:19], s25 offen lds
    v_mfma_f32_16x16x32_bf16 v[228:231], v[164:167], v[116:119], v[228:231]
    s_add_u32 m0, s42, 30720
    s_add_u32 s25, s60, s42
    s_add_u32 s25, s25, 215040
    buffer_load_dwordx4 v1, s[16:19], s25 offen lds
    v_mfma_f32_16x16x32_bf16 v[232:235], v[164:167], v[120:123], v[232:235]
    s_add_u32 m0, s43, 30720
    s_add_u32 s25, s60, s43
    s_add_u32 s25, s25, 215040
    buffer_load_dwordx4 v1, s[16:19], s25 offen lds
    v_mfma_f32_16x16x32_bf16 v[236:239], v[164:167], v[124:127], v[236:239]
    v_mfma_f32_16x16x32_bf16 v[240:243], v[164:167], v[128:131], v[240:243]
    v_mfma_f32_16x16x32_bf16 v[244:247], v[164:167], v[132:135], v[244:247]
    s_waitcnt lgkmcnt(0)
    s_waitcnt vmcnt(4)
    s_barrier
    v_mfma_f32_16x16x32_bf16 v[168:171], v[136:139], v[96:99], v[168:171]
    ds_read_b128 v[116:119], v21 offset:13312
    v_mfma_f32_16x16x32_bf16 v[172:175], v[136:139], v[100:103], v[172:175]
    ds_read_b128 v[120:123], v21 offset:31744
    v_mfma_f32_16x16x32_bf16 v[176:179], v[136:139], v[104:107], v[176:179]
    ds_read_b128 v[124:127], v21 offset:50176
    v_mfma_f32_16x16x32_bf16 v[180:183], v[136:139], v[108:111], v[180:183]
    ds_read_b128 v[128:131], v22 offset:13312
    v_mfma_f32_16x16x32_bf16 v[184:187], v[136:139], v[112:115], v[184:187]
    ds_read_b128 v[132:135], v22 offset:31744
    v_mfma_f32_16x16x32_bf16 v[188:191], v[140:143], v[96:99], v[188:191]
    ds_read_b64_tr_b16 v[152:153], v19 offset:15360
    v_mfma_f32_16x16x32_bf16 v[192:195], v[140:143], v[100:103], v[192:195]
    ds_read_b64_tr_b16 v[154:155], v19 offset:23040
    v_mfma_f32_16x16x32_bf16 v[196:199], v[140:143], v[104:107], v[196:199]
    ds_read_b64_tr_b16 v[156:157], v19 offset:15488
    v_mfma_f32_16x16x32_bf16 v[200:203], v[140:143], v[108:111], v[200:203]
    ds_read_b64_tr_b16 v[158:159], v19 offset:23168
    v_mfma_f32_16x16x32_bf16 v[204:207], v[140:143], v[112:115], v[204:207]
    ds_read_b64_tr_b16 v[160:161], v19 offset:15616
    v_mfma_f32_16x16x32_bf16 v[208:211], v[144:147], v[96:99], v[208:211]
    ds_read_b64_tr_b16 v[162:163], v19 offset:23296
    v_mfma_f32_16x16x32_bf16 v[212:215], v[144:147], v[100:103], v[212:215]
    ds_read_b64_tr_b16 v[164:165], v20 offset:15360
    v_mfma_f32_16x16x32_bf16 v[216:219], v[144:147], v[104:107], v[216:219]
    ds_read_b64_tr_b16 v[166:167], v20 offset:23040
    v_mfma_f32_16x16x32_bf16 v[220:223], v[144:147], v[108:111], v[220:223]
    s_add_u32 m0, s40, 46080
    s_add_u32 s25, s60, s40
    s_add_u32 s25, s25, 230400
    buffer_load_dwordx4 v1, s[16:19], s25 offen lds
    v_mfma_f32_16x16x32_bf16 v[224:227], v[144:147], v[112:115], v[224:227]
    s_add_u32 m0, s41, 46080
    s_add_u32 s25, s60, s41
    s_add_u32 s25, s25, 230400
    buffer_load_dwordx4 v1, s[16:19], s25 offen lds
    v_mfma_f32_16x16x32_bf16 v[228:231], v[148:151], v[96:99], v[228:231]
    s_add_u32 m0, s42, 46080
    s_add_u32 s25, s60, s42
    s_add_u32 s25, s25, 230400
    buffer_load_dwordx4 v1, s[16:19], s25 offen lds
    v_mfma_f32_16x16x32_bf16 v[232:235], v[148:151], v[100:103], v[232:235]
    s_add_u32 m0, s43, 46080
    s_add_u32 s25, s60, s43
    s_add_u32 s25, s25, 230400
    buffer_load_dwordx4 v1, s[16:19], s25 offen lds
    v_mfma_f32_16x16x32_bf16 v[236:239], v[148:151], v[104:107], v[236:239]
    v_mfma_f32_16x16x32_bf16 v[240:243], v[148:151], v[108:111], v[240:243]
    v_mfma_f32_16x16x32_bf16 v[244:247], v[148:151], v[112:115], v[244:247]
    s_waitcnt lgkmcnt(0)
    s_waitcnt vmcnt(4)
    s_barrier
    v_mfma_f32_16x16x32_bf16 v[168:171], v[152:155], v[116:119], v[168:171]
    ds_read_b128 v[96:99], v21 offset:14336
    v_mfma_f32_16x16x32_bf16 v[172:175], v[152:155], v[120:123], v[172:175]
    ds_read_b128 v[100:103], v21 offset:32768
    v_mfma_f32_16x16x32_bf16 v[176:179], v[152:155], v[124:127], v[176:179]
    ds_read_b128 v[104:107], v21 offset:51200
    v_mfma_f32_16x16x32_bf16 v[180:183], v[152:155], v[128:131], v[180:183]
    ds_read_b128 v[108:111], v22 offset:14336
    v_mfma_f32_16x16x32_bf16 v[184:187], v[152:155], v[132:135], v[184:187]
    ds_read_b128 v[112:115], v22 offset:32768
    v_mfma_f32_16x16x32_bf16 v[188:191], v[156:159], v[116:119], v[188:191]
    ds_read_b64_tr_b16 v[136:137], v19 offset:30720
    v_mfma_f32_16x16x32_bf16 v[192:195], v[156:159], v[120:123], v[192:195]
    ds_read_b64_tr_b16 v[138:139], v19 offset:38400
    v_mfma_f32_16x16x32_bf16 v[196:199], v[156:159], v[124:127], v[196:199]
    ds_read_b64_tr_b16 v[140:141], v19 offset:30848
    v_mfma_f32_16x16x32_bf16 v[200:203], v[156:159], v[128:131], v[200:203]
    ds_read_b64_tr_b16 v[142:143], v19 offset:38528
    v_mfma_f32_16x16x32_bf16 v[204:207], v[156:159], v[132:135], v[204:207]
    ds_read_b64_tr_b16 v[144:145], v19 offset:30976
    v_mfma_f32_16x16x32_bf16 v[208:211], v[160:163], v[116:119], v[208:211]
    ds_read_b64_tr_b16 v[146:147], v19 offset:38656
    v_mfma_f32_16x16x32_bf16 v[212:215], v[160:163], v[120:123], v[212:215]
    ds_read_b64_tr_b16 v[148:149], v20 offset:30720
    v_mfma_f32_16x16x32_bf16 v[216:219], v[160:163], v[124:127], v[216:219]
    ds_read_b64_tr_b16 v[150:151], v20 offset:38400
    v_mfma_f32_16x16x32_bf16 v[220:223], v[160:163], v[128:131], v[220:223]
    s_add_u32 m0, s40, 0
    s_add_u32 s25, s60, s40
    s_add_u32 s25, s25, 245760
    buffer_load_dwordx4 v1, s[16:19], s25 offen lds
    v_mfma_f32_16x16x32_bf16 v[224:227], v[160:163], v[132:135], v[224:227]
    s_add_u32 m0, s41, 0
    s_add_u32 s25, s60, s41
    s_add_u32 s25, s25, 245760
    buffer_load_dwordx4 v1, s[16:19], s25 offen lds
    v_mfma_f32_16x16x32_bf16 v[228:231], v[164:167], v[116:119], v[228:231]
    s_add_u32 m0, s42, 0
    s_add_u32 s25, s60, s42
    s_add_u32 s25, s25, 245760
    buffer_load_dwordx4 v1, s[16:19], s25 offen lds
    v_mfma_f32_16x16x32_bf16 v[232:235], v[164:167], v[120:123], v[232:235]
    s_add_u32 m0, s43, 0
    s_add_u32 s25, s60, s43
    s_add_u32 s25, s25, 245760
    buffer_load_dwordx4 v1, s[16:19], s25 offen lds
    v_mfma_f32_16x16x32_bf16 v[236:239], v[164:167], v[124:127], v[236:239]
    v_mfma_f32_16x16x32_bf16 v[240:243], v[164:167], v[128:131], v[240:243]
    v_mfma_f32_16x16x32_bf16 v[244:247], v[164:167], v[132:135], v[244:247]
    s_waitcnt lgkmcnt(0)
    s_waitcnt vmcnt(4)
    s_barrier
    v_mfma_f32_16x16x32_bf16 v[168:171], v[136:139], v[96:99], v[168:171]
    ds_read_b128 v[116:119], v21 offset:15360
    v_mfma_f32_16x16x32_bf16 v[172:175], v[136:139], v[100:103], v[172:175]
    ds_read_b128 v[120:123], v21 offset:33792
    v_mfma_f32_16x16x32_bf16 v[176:179], v[136:139], v[104:107], v[176:179]
    ds_read_b128 v[124:127], v21 offset:52224
    v_mfma_f32_16x16x32_bf16 v[180:183], v[136:139], v[108:111], v[180:183]
    ds_read_b128 v[128:131], v22 offset:15360
    v_mfma_f32_16x16x32_bf16 v[184:187], v[136:139], v[112:115], v[184:187]
    ds_read_b128 v[132:135], v22 offset:33792
    v_mfma_f32_16x16x32_bf16 v[188:191], v[140:143], v[96:99], v[188:191]
    ds_read_b64_tr_b16 v[152:153], v19 offset:46080
    v_mfma_f32_16x16x32_bf16 v[192:195], v[140:143], v[100:103], v[192:195]
    ds_read_b64_tr_b16 v[154:155], v19 offset:53760
    v_mfma_f32_16x16x32_bf16 v[196:199], v[140:143], v[104:107], v[196:199]
    ds_read_b64_tr_b16 v[156:157], v19 offset:46208
    v_mfma_f32_16x16x32_bf16 v[200:203], v[140:143], v[108:111], v[200:203]
    ds_read_b64_tr_b16 v[158:159], v19 offset:53888
    v_mfma_f32_16x16x32_bf16 v[204:207], v[140:143], v[112:115], v[204:207]
    ds_read_b64_tr_b16 v[160:161], v19 offset:46336
    v_mfma_f32_16x16x32_bf16 v[208:211], v[144:147], v[96:99], v[208:211]
    ds_read_b64_tr_b16 v[162:163], v19 offset:54016
    v_mfma_f32_16x16x32_bf16 v[212:215], v[144:147], v[100:103], v[212:215]
    ds_read_b64_tr_b16 v[164:165], v20 offset:46080
    v_mfma_f32_16x16x32_bf16 v[216:219], v[144:147], v[104:107], v[216:219]
    ds_read_b64_tr_b16 v[166:167], v20 offset:53760
    v_mfma_f32_16x16x32_bf16 v[220:223], v[144:147], v[108:111], v[220:223]
    s_add_u32 m0, s40, 15360
    s_add_u32 s25, s60, s40
    s_add_u32 s25, s25, 261120
    buffer_load_dwordx4 v1, s[16:19], s25 offen lds
    v_mfma_f32_16x16x32_bf16 v[224:227], v[144:147], v[112:115], v[224:227]
    s_add_u32 m0, s41, 15360
    s_add_u32 s25, s60, s41
    s_add_u32 s25, s25, 261120
    buffer_load_dwordx4 v1, s[16:19], s25 offen lds
    v_mfma_f32_16x16x32_bf16 v[228:231], v[148:151], v[96:99], v[228:231]
    s_add_u32 m0, s42, 15360
    s_add_u32 s25, s60, s42
    s_add_u32 s25, s25, 261120
    buffer_load_dwordx4 v1, s[16:19], s25 offen lds
    v_mfma_f32_16x16x32_bf16 v[232:235], v[148:151], v[100:103], v[232:235]
    s_add_u32 m0, s43, 15360
    s_add_u32 s25, s60, s43
    s_add_u32 s25, s25, 261120
    buffer_load_dwordx4 v1, s[16:19], s25 offen lds
    v_mfma_f32_16x16x32_bf16 v[236:239], v[148:151], v[104:107], v[236:239]
    v_mfma_f32_16x16x32_bf16 v[240:243], v[148:151], v[108:111], v[240:243]
    v_mfma_f32_16x16x32_bf16 v[244:247], v[148:151], v[112:115], v[244:247]
    s_waitcnt lgkmcnt(0)
    s_waitcnt vmcnt(4)
    s_barrier
    v_mfma_f32_16x16x32_bf16 v[168:171], v[152:155], v[116:119], v[168:171]
    ds_read_b128 v[96:99], v21 offset:16384
    v_mfma_f32_16x16x32_bf16 v[172:175], v[152:155], v[120:123], v[172:175]
    ds_read_b128 v[100:103], v21 offset:34816
    v_mfma_f32_16x16x32_bf16 v[176:179], v[152:155], v[124:127], v[176:179]
    ds_read_b128 v[104:107], v21 offset:53248
    v_mfma_f32_16x16x32_bf16 v[180:183], v[152:155], v[128:131], v[180:183]
    ds_read_b128 v[108:111], v22 offset:16384
    v_mfma_f32_16x16x32_bf16 v[184:187], v[152:155], v[132:135], v[184:187]
    ds_read_b128 v[112:115], v22 offset:34816
    v_mfma_f32_16x16x32_bf16 v[188:191], v[156:159], v[116:119], v[188:191]
    ds_read_b64_tr_b16 v[136:137], v19 offset:0
    v_mfma_f32_16x16x32_bf16 v[192:195], v[156:159], v[120:123], v[192:195]
    ds_read_b64_tr_b16 v[138:139], v19 offset:7680
    v_mfma_f32_16x16x32_bf16 v[196:199], v[156:159], v[124:127], v[196:199]
    ds_read_b64_tr_b16 v[140:141], v19 offset:128
    v_mfma_f32_16x16x32_bf16 v[200:203], v[156:159], v[128:131], v[200:203]
    ds_read_b64_tr_b16 v[142:143], v19 offset:7808
    v_mfma_f32_16x16x32_bf16 v[204:207], v[156:159], v[132:135], v[204:207]
    ds_read_b64_tr_b16 v[144:145], v19 offset:256
    v_mfma_f32_16x16x32_bf16 v[208:211], v[160:163], v[116:119], v[208:211]
    ds_read_b64_tr_b16 v[146:147], v19 offset:7936
    v_mfma_f32_16x16x32_bf16 v[212:215], v[160:163], v[120:123], v[212:215]
    ds_read_b64_tr_b16 v[148:149], v20 offset:0
    v_mfma_f32_16x16x32_bf16 v[216:219], v[160:163], v[124:127], v[216:219]
    ds_read_b64_tr_b16 v[150:151], v20 offset:7680
    v_mfma_f32_16x16x32_bf16 v[220:223], v[160:163], v[128:131], v[220:223]
    v_mfma_f32_16x16x32_bf16 v[224:227], v[160:163], v[132:135], v[224:227]
    v_mfma_f32_16x16x32_bf16 v[228:231], v[164:167], v[116:119], v[228:231]
    v_mfma_f32_16x16x32_bf16 v[232:235], v[164:167], v[120:123], v[232:235]
    v_mfma_f32_16x16x32_bf16 v[236:239], v[164:167], v[124:127], v[236:239]
    v_mfma_f32_16x16x32_bf16 v[240:243], v[164:167], v[128:131], v[240:243]
    v_mfma_f32_16x16x32_bf16 v[244:247], v[164:167], v[132:135], v[244:247]
    s_waitcnt lgkmcnt(0)
    s_waitcnt vmcnt(0)
    s_barrier
    v_mfma_f32_16x16x32_bf16 v[168:171], v[136:139], v[96:99], v[168:171]
    ds_read_b128 v[116:119], v21 offset:17408
    v_mfma_f32_16x16x32_bf16 v[172:175], v[136:139], v[100:103], v[172:175]
    ds_read_b128 v[120:123], v21 offset:35840
    v_mfma_f32_16x16x32_bf16 v[176:179], v[136:139], v[104:107], v[176:179]
    ds_read_b128 v[124:127], v21 offset:54272
    v_mfma_f32_16x16x32_bf16 v[180:183], v[136:139], v[108:111], v[180:183]
    ds_read_b128 v[128:131], v22 offset:17408
    v_mfma_f32_16x16x32_bf16 v[184:187], v[136:139], v[112:115], v[184:187]
    ds_read_b128 v[132:135], v22 offset:35840
    v_mfma_f32_16x16x32_bf16 v[188:191], v[140:143], v[96:99], v[188:191]
    ds_read_b64_tr_b16 v[152:153], v19 offset:15360
    v_mfma_f32_16x16x32_bf16 v[192:195], v[140:143], v[100:103], v[192:195]
    ds_read_b64_tr_b16 v[154:155], v19 offset:23040
    v_mfma_f32_16x16x32_bf16 v[196:199], v[140:143], v[104:107], v[196:199]
    ds_read_b64_tr_b16 v[156:157], v19 offset:15488
    v_mfma_f32_16x16x32_bf16 v[200:203], v[140:143], v[108:111], v[200:203]
    ds_read_b64_tr_b16 v[158:159], v19 offset:23168
    v_mfma_f32_16x16x32_bf16 v[204:207], v[140:143], v[112:115], v[204:207]
    ds_read_b64_tr_b16 v[160:161], v19 offset:15616
    v_mfma_f32_16x16x32_bf16 v[208:211], v[144:147], v[96:99], v[208:211]
    ds_read_b64_tr_b16 v[162:163], v19 offset:23296
    v_mfma_f32_16x16x32_bf16 v[212:215], v[144:147], v[100:103], v[212:215]
    ds_read_b64_tr_b16 v[164:165], v20 offset:15360
    v_mfma_f32_16x16x32_bf16 v[216:219], v[144:147], v[104:107], v[216:219]
    ds_read_b64_tr_b16 v[166:167], v20 offset:23040
    v_mfma_f32_16x16x32_bf16 v[220:223], v[144:147], v[108:111], v[220:223]
    v_mfma_f32_16x16x32_bf16 v[224:227], v[144:147], v[112:115], v[224:227]
    v_mfma_f32_16x16x32_bf16 v[228:231], v[148:151], v[96:99], v[228:231]
    v_mfma_f32_16x16x32_bf16 v[232:235], v[148:151], v[100:103], v[232:235]
    v_mfma_f32_16x16x32_bf16 v[236:239], v[148:151], v[104:107], v[236:239]
    v_mfma_f32_16x16x32_bf16 v[240:243], v[148:151], v[108:111], v[240:243]
    v_mfma_f32_16x16x32_bf16 v[244:247], v[148:151], v[112:115], v[244:247]
    s_waitcnt lgkmcnt(0)
    v_mfma_f32_16x16x32_bf16 v[168:171], v[152:155], v[116:119], v[168:171]
    v_mfma_f32_16x16x32_bf16 v[172:175], v[152:155], v[120:123], v[172:175]
    v_mfma_f32_16x16x32_bf16 v[176:179], v[152:155], v[124:127], v[176:179]
    v_mfma_f32_16x16x32_bf16 v[180:183], v[152:155], v[128:131], v[180:183]
    v_mfma_f32_16x16x32_bf16 v[184:187], v[152:155], v[132:135], v[184:187]
    v_mfma_f32_16x16x32_bf16 v[188:191], v[156:159], v[116:119], v[188:191]
    v_mfma_f32_16x16x32_bf16 v[192:195], v[156:159], v[120:123], v[192:195]
    v_mfma_f32_16x16x32_bf16 v[196:199], v[156:159], v[124:127], v[196:199]
    v_mfma_f32_16x16x32_bf16 v[200:203], v[156:159], v[128:131], v[200:203]
    v_mfma_f32_16x16x32_bf16 v[204:207], v[156:159], v[132:135], v[204:207]
    v_mfma_f32_16x16x32_bf16 v[208:211], v[160:163], v[116:119], v[208:211]
    v_mfma_f32_16x16x32_bf16 v[212:215], v[160:163], v[120:123], v[212:215]
    v_mfma_f32_16x16x32_bf16 v[216:219], v[160:163], v[124:127], v[216:219]
    v_mfma_f32_16x16x32_bf16 v[220:223], v[160:163], v[128:131], v[220:223]
    v_mfma_f32_16x16x32_bf16 v[224:227], v[160:163], v[132:135], v[224:227]
    v_mfma_f32_16x16x32_bf16 v[228:231], v[164:167], v[116:119], v[228:231]
    v_mfma_f32_16x16x32_bf16 v[232:235], v[164:167], v[120:123], v[232:235]
    v_mfma_f32_16x16x32_bf16 v[236:239], v[164:167], v[124:127], v[236:239]
    v_mfma_f32_16x16x32_bf16 v[240:243], v[164:167], v[128:131], v[240:243]
    v_mfma_f32_16x16x32_bf16 v[244:247], v[164:167], v[132:135], v[244:247]
    s_barrier
    v_and_b32 v3, 15, v0
    v_mul_u32_u24 v3, 1056, v3
    v_lshrrev_b32 v4, 4, v0
    v_lshlrev_b32 v4, 4, v4
    v_add_u32 v3, v3, v4
    s_lshl_b32 s30, s20, 6
    v_add_u32 v3, s30, v3
    v_add_u32 v4, 50688, v3
    v_cvt_pk_bf16_f32 v5, v168, v169
    v_cvt_pk_bf16_f32 v6, v170, v171
    v_lshlrev_b32 v168, 16, v5
    v_and_b32 v169, s34, v5
    v_lshlrev_b32 v170, 16, v6
    v_and_b32 v171, s34, v6
    ds_write_b128 v3, v[168:171] offset:0
    v_cvt_pk_bf16_f32 v5, v172, v173
    v_cvt_pk_bf16_f32 v6, v174, v175
    v_lshlrev_b32 v172, 16, v5
    v_and_b32 v173, s34, v5
    v_lshlrev_b32 v174, 16, v6
    v_and_b32 v175, s34, v6
    ds_write_b128 v3, v[172:175] offset:16896
    v_cvt_pk_bf16_f32 v5, v176, v177
    v_cvt_pk_bf16_f32 v6, v178, v179
    v_lshlrev_b32 v176, 16, v5
    v_and_b32 v177, s34, v5
    v_lshlrev_b32 v178, 16, v6
    v_and_b32 v179, s34, v6
    ds_write_b128 v3, v[176:179] offset:33792
    v_cvt_pk_bf16_f32 v5, v180, v181
    v_cvt_pk_bf16_f32 v6, v182, v183
    v_lshlrev_b32 v180, 16, v5
    v_and_b32 v181, s34, v5
    v_lshlrev_b32 v182, 16, v6
    v_and_b32 v183, s34, v6
    ds_write_b128 v4, v[180:183] offset:0
    v_cvt_pk_bf16_f32 v5, v184, v185
    v_cvt_pk_bf16_f32 v6, v186, v187
    v_lshlrev_b32 v184, 16, v5
    v_and_b32 v185, s34, v5
    v_lshlrev_b32 v186, 16, v6
    v_and_b32 v187, s34, v6
    ds_write_b128 v4, v[184:187] offset:16896
    v_cvt_pk_bf16_f32 v5, v188, v189
    v_cvt_pk_bf16_f32 v6, v190, v191
    v_lshlrev_b32 v188, 16, v5
    v_and_b32 v189, s34, v5
    v_lshlrev_b32 v190, 16, v6
    v_and_b32 v191, s34, v6
    ds_write_b128 v3, v[188:191] offset:256
    v_cvt_pk_bf16_f32 v5, v192, v193
    v_cvt_pk_bf16_f32 v6, v194, v195
    v_lshlrev_b32 v192, 16, v5
    v_and_b32 v193, s34, v5
    v_lshlrev_b32 v194, 16, v6
    v_and_b32 v195, s34, v6
    ds_write_b128 v3, v[192:195] offset:17152
    v_cvt_pk_bf16_f32 v5, v196, v197
    v_cvt_pk_bf16_f32 v6, v198, v199
    v_lshlrev_b32 v196, 16, v5
    v_and_b32 v197, s34, v5
    v_lshlrev_b32 v198, 16, v6
    v_and_b32 v199, s34, v6
    ds_write_b128 v3, v[196:199] offset:34048
    v_cvt_pk_bf16_f32 v5, v200, v201
    v_cvt_pk_bf16_f32 v6, v202, v203
    v_lshlrev_b32 v200, 16, v5
    v_and_b32 v201, s34, v5
    v_lshlrev_b32 v202, 16, v6
    v_and_b32 v203, s34, v6
    ds_write_b128 v4, v[200:203] offset:256
    v_cvt_pk_bf16_f32 v5, v204, v205
    v_cvt_pk_bf16_f32 v6, v206, v207
    v_lshlrev_b32 v204, 16, v5
    v_and_b32 v205, s34, v5
    v_lshlrev_b32 v206, 16, v6
    v_and_b32 v207, s34, v6
    ds_write_b128 v4, v[204:207] offset:17152
    v_cvt_pk_bf16_f32 v5, v208, v209
    v_cvt_pk_bf16_f32 v6, v210, v211
    v_lshlrev_b32 v208, 16, v5
    v_and_b32 v209, s34, v5
    v_lshlrev_b32 v210, 16, v6
    v_and_b32 v211, s34, v6
    ds_write_b128 v3, v[208:211] offset:512
    v_cvt_pk_bf16_f32 v5, v212, v213
    v_cvt_pk_bf16_f32 v6, v214, v215
    v_lshlrev_b32 v212, 16, v5
    v_and_b32 v213, s34, v5
    v_lshlrev_b32 v214, 16, v6
    v_and_b32 v215, s34, v6
    ds_write_b128 v3, v[212:215] offset:17408
    v_cvt_pk_bf16_f32 v5, v216, v217
    v_cvt_pk_bf16_f32 v6, v218, v219
    v_lshlrev_b32 v216, 16, v5
    v_and_b32 v217, s34, v5
    v_lshlrev_b32 v218, 16, v6
    v_and_b32 v219, s34, v6
    ds_write_b128 v3, v[216:219] offset:34304
    v_cvt_pk_bf16_f32 v5, v220, v221
    v_cvt_pk_bf16_f32 v6, v222, v223
    v_lshlrev_b32 v220, 16, v5
    v_and_b32 v221, s34, v5
    v_lshlrev_b32 v222, 16, v6
    v_and_b32 v223, s34, v6
    ds_write_b128 v4, v[220:223] offset:512
    v_cvt_pk_bf16_f32 v5, v224, v225
    v_cvt_pk_bf16_f32 v6, v226, v227
    v_lshlrev_b32 v224, 16, v5
    v_and_b32 v225, s34, v5
    v_lshlrev_b32 v226, 16, v6
    v_and_b32 v227, s34, v6
    ds_write_b128 v4, v[224:227] offset:17408
    s_cmp_ge_u32 s20, 2
    s_cbranch_scc1 k1b_kernel_qskip
    s_mov_b64 s[44:45], exec
    s_cmp_eq_u32 s20, 1
    s_cselect_b32 s46, 0, -1
    s_mov_b32 exec_hi, s46
    v_cvt_pk_bf16_f32 v5, v228, v229
    v_cvt_pk_bf16_f32 v6, v230, v231
    v_lshlrev_b32 v228, 16, v5
    v_and_b32 v229, s34, v5
    v_lshlrev_b32 v230, 16, v6
    v_and_b32 v231, s34, v6
    ds_write_b128 v3, v[228:231] offset:768
    v_cvt_pk_bf16_f32 v5, v232, v233
    v_cvt_pk_bf16_f32 v6, v234, v235
    v_lshlrev_b32 v232, 16, v5
    v_and_b32 v233, s34, v5
    v_lshlrev_b32 v234, 16, v6
    v_and_b32 v235, s34, v6
    ds_write_b128 v3, v[232:235] offset:17664
    v_cvt_pk_bf16_f32 v5, v236, v237
    v_cvt_pk_bf16_f32 v6, v238, v239
    v_lshlrev_b32 v236, 16, v5
    v_and_b32 v237, s34, v5
    v_lshlrev_b32 v238, 16, v6
    v_and_b32 v239, s34, v6
    ds_write_b128 v3, v[236:239] offset:34560
    v_cvt_pk_bf16_f32 v5, v240, v241
    v_cvt_pk_bf16_f32 v6, v242, v243
    v_lshlrev_b32 v240, 16, v5
    v_and_b32 v241, s34, v5
    v_lshlrev_b32 v242, 16, v6
    v_and_b32 v243, s34, v6
    ds_write_b128 v4, v[240:243] offset:768
    v_cvt_pk_bf16_f32 v5, v244, v245
    v_cvt_pk_bf16_f32 v6, v246, v247
    v_lshlrev_b32 v244, 16, v5
    v_and_b32 v245, s34, v5
    v_lshlrev_b32 v246, 16, v6
    v_and_b32 v247, s34, v6
    ds_write_b128 v4, v[244:247] offset:17664
    s_mov_b64 exec, s[44:45]
k1b_kernel_qskip:
    s_waitcnt lgkmcnt(0)
    s_barrier
    v_lshrrev_b32 v3, 2, v2
    v_and_b32 v4, 3, v2
    v_mul_u32_u24 v5, 1056, v3
    v_mul_u32_u24 v6, 72, v4
    v_add_u32 v5, v5, v6
    s_lshl_b32 s30, s22, 6
    v_add_u32 v7, s30, v3
    ds_read_b64 v[20:21], v5 offset:16896
    ds_read_b64 v[22:23], v5 offset:16904
    ds_read_b64 v[24:25], v5 offset:16912
    ds_read_b64 v[26:27], v5 offset:16920
    ds_read_b64 v[28:29], v5 offset:16928
    ds_read_b64 v[30:31], v5 offset:16936
    ds_read_b64 v[32:33], v5 offset:16944
    ds_read_b64 v[34:35], v5 offset:16952
    ds_read_b64 v[36:37], v5 offset:16960
    ds_read_b64 v[40:41], v5 offset:17184
    ds_read_b64 v[42:43], v5 offset:17192
    ds_read_b64 v[44:45], v5 offset:17200
    ds_read_b64 v[46:47], v5 offset:17208
    ds_read_b64 v[48:49], v5 offset:17216
    ds_read_b64 v[50:51], v5 offset:17224
    ds_read_b64 v[52:53], v5 offset:17232
    ds_read_b64 v[54:55], v5 offset:17240
    ds_read_b64 v[56:57], v5 offset:17248
    s_mov_b32 s31, 0x3e715bef
    ds_read_b64 v[58:59], v5 offset:15072
    ds_read_b64 v[60:61], v5 offset:15080
    ds_read_b64 v[62:63], v5 offset:15088
    ds_read_b64 v[64:65], v5 offset:15096
    ds_read_b64 v[66:67], v5 offset:15104
    ds_read_b64 v[68:69], v5 offset:15112
    ds_read_b64 v[70:71], v5 offset:15120
    ds_read_b64 v[72:73], v5 offset:15128
    ds_read_b64 v[74:75], v5 offset:15136
    s_waitcnt lgkmcnt(9)
    v_mul_f32 v112, v20, v40
    v_mul_f32 v8, v21, v41
    v_fma_f32 v112, v22, v42, v112
    v_fma_f32 v8, v23, v43, v8
    v_fma_f32 v112, v24, v44, v112
    v_fma_f32 v8, v25, v45, v8
    v_fma_f32 v112, v26, v46, v112
    v_fma_f32 v8, v27, v47, v8
    v_fma_f32 v112, v28, v48, v112
    v_fma_f32 v8, v29, v49, v8
    v_fma_f32 v112, v30, v50, v112
    v_fma_f32 v8, v31, v51, v8
    v_fma_f32 v112, v32, v52, v112
    v_fma_f32 v8, v33, v53, v8
    v_fma_f32 v112, v34, v54, v112
    v_fma_f32 v8, v35, v55, v8
    v_fma_f32 v112, v36, v56, v112
    v_fma_f32 v8, v37, v57, v8
    v_add_f32 v112, v112, v8
    v_cvt_pk_bf16_f32 v112, v112, v112
    v_lshlrev_b32 v112, 16, v112
    v_mul_f32 v112, s31, v112
    v_cvt_pk_bf16_f32 v112, v112, v112
    v_lshlrev_b32 v112, 16, v112
    ds_read_b64 v[40:41], v5 offset:12960
    ds_read_b64 v[42:43], v5 offset:12968
    ds_read_b64 v[44:45], v5 offset:12976
    ds_read_b64 v[46:47], v5 offset:12984
    ds_read_b64 v[48:49], v5 offset:12992
    ds_read_b64 v[50:51], v5 offset:13000
    ds_read_b64 v[52:53], v5 offset:13008
    ds_read_b64 v[54:55], v5 offset:13016
    ds_read_b64 v[56:57], v5 offset:13024
    s_waitcnt lgkmcnt(9)
    v_mul_f32 v113, v20, v58
    v_mul_f32 v8, v21, v59
    v_fma_f32 v113, v22, v60, v113
    v_fma_f32 v8, v23, v61, v8
    v_fma_f32 v113, v24, v62, v113
    v_fma_f32 v8, v25, v63, v8
    v_fma_f32 v113, v26, v64, v113
    v_fma_f32 v8, v27, v65, v8
    v_fma_f32 v113, v28, v66, v113
    v_fma_f32 v8, v29, v67, v8
    v_fma_f32 v113, v30, v68, v113
    v_fma_f32 v8, v31, v69, v8
    v_fma_f32 v113, v32, v70, v113
    v_fma_f32 v8, v33, v71, v8
    v_fma_f32 v113, v34, v72, v113
    v_fma_f32 v8, v35, v73, v8
    v_fma_f32 v113, v36, v74, v113
    v_fma_f32 v8, v37, v75, v8
    v_add_f32 v113, v113, v8
    v_cvt_pk_bf16_f32 v113, v113, v113
    v_lshlrev_b32 v113, 16, v113
    v_mul_f32 v113, s31, v113
    v_cvt_pk_bf16_f32 v113, v113, v113
    v_lshlrev_b32 v113, 16, v113
    v_cmp_le_u32 vcc, 2, v7
    v_mov_b32 v8, 0xce6e6b28
    s_nop 0
    v_cndmask_b32 v113, v8, v113, vcc
    ds_read_b64 v[58:59], v5 offset:10848
    ds_read_b64 v[60:61], v5 offset:10856
    ds_read_b64 v[62:63], v5 offset:10864
    ds_read_b64 v[64:65], v5 offset:10872
    ds_read_b64 v[66:67], v5 offset:10880
    ds_read_b64 v[68:69], v5 offset:10888
    ds_read_b64 v[70:71], v5 offset:10896
    ds_read_b64 v[72:73], v5 offset:10904
    ds_read_b64 v[74:75], v5 offset:10912
    s_waitcnt lgkmcnt(9)
    v_mul_f32 v114, v20, v40
    v_mul_f32 v8, v21, v41
    v_fma_f32 v114, v22, v42, v114
    v_fma_f32 v8, v23, v43, v8
    v_fma_f32 v114, v24, v44, v114
    v_fma_f32 v8, v25, v45, v8
    v_fma_f32 v114, v26, v46, v114
    v_fma_f32 v8, v27, v47, v8
    v_fma_f32 v114, v28, v48, v114
    v_fma_f32 v8, v29, v49, v8
    v_fma_f32 v114, v30, v50, v114
    v_fma_f32 v8, v31, v51, v8
    v_fma_f32 v114, v32, v52, v114
    v_fma_f32 v8, v33, v53, v8
    v_fma_f32 v114, v34, v54, v114
    v_fma_f32 v8, v35, v55, v8
    v_fma_f32 v114, v36, v56, v114
    v_fma_f32 v8, v37, v57, v8
    v_add_f32 v114, v114, v8
    v_cvt_pk_bf16_f32 v114, v114, v114
    v_lshlrev_b32 v114, 16, v114
    v_mul_f32 v114, s31, v114
    v_cvt_pk_bf16_f32 v114, v114, v114
    v_lshlrev_b32 v114, 16, v114
    v_cmp_le_u32 vcc, 4, v7
    v_mov_b32 v8, 0xce6e6b28
    s_nop 0
    v_cndmask_b32 v114, v8, v114, vcc
    ds_read_b64 v[40:41], v5 offset:8736
    ds_read_b64 v[42:43], v5 offset:8744
    ds_read_b64 v[44:45], v5 offset:8752
    ds_read_b64 v[46:47], v5 offset:8760
    ds_read_b64 v[48:49], v5 offset:8768
    ds_read_b64 v[50:51], v5 offset:8776
    ds_read_b64 v[52:53], v5 offset:8784
    ds_read_b64 v[54:55], v5 offset:8792
    ds_read_b64 v[56:57], v5 offset:8800
    s_waitcnt lgkmcnt(9)
    v_mul_f32 v115, v20, v58
    v_mul_f32 v8, v21, v59
    v_fma_f32 v115, v22, v60, v115
    v_fma_f32 v8, v23, v61, v8
    v_fma_f32 v115, v24, v62, v115
    v_fma_f32 v8, v25, v63, v8
    v_fma_f32 v115, v26, v64, v115
    v_fma_f32 v8, v27, v65, v8
    v_fma_f32 v115, v28, v66, v115
    v_fma_f32 v8, v29, v67, v8
    v_fma_f32 v115, v30, v68, v115
    v_fma_f32 v8, v31, v69, v8
    v_fma_f32 v115, v32, v70, v115
    v_fma_f32 v8, v33, v71, v8
    v_fma_f32 v115, v34, v72, v115
    v_fma_f32 v8, v35, v73, v8
    v_fma_f32 v115, v36, v74, v115
    v_fma_f32 v8, v37, v75, v8
    v_add_f32 v115, v115, v8
    v_cvt_pk_bf16_f32 v115, v115, v115
    v_lshlrev_b32 v115, 16, v115
    v_mul_f32 v115, s31, v115
    v_cvt_pk_bf16_f32 v115, v115, v115
    v_lshlrev_b32 v115, 16, v115
    v_cmp_le_u32 vcc, 6, v7
    v_mov_b32 v8, 0xce6e6b28
    s_nop 0
    v_cndmask_b32 v115, v8, v115, vcc
    ds_read_b64 v[58:59], v5 offset:6624
    ds_read_b64 v[60:61], v5 offset:6632
    ds_read_b64 v[62:63], v5 offset:6640
    ds_read_b64 v[64:65], v5 offset:6648
    ds_read_b64 v[66:67], v5 offset:6656
    ds_read_b64 v[68:69], v5 offset:6664
    ds_read_b64 v[70:71], v5 offset:6672
    ds_read_b64 v[72:73], v5 offset:6680
    ds_read_b64 v[74:75], v5 offset:6688
    s_waitcnt lgkmcnt(9)
    v_mul_f32 v116, v20, v40
    v_mul_f32 v8, v21, v41
    v_fma_f32 v116, v22, v42, v116
    v_fma_f32 v8, v23, v43, v8
    v_fma_f32 v116, v24, v44, v116
    v_fma_f32 v8, v25, v45, v8
    v_fma_f32 v116, v26, v46, v116
    v_fma_f32 v8, v27, v47, v8
    v_fma_f32 v116, v28, v48, v116
    v_fma_f32 v8, v29, v49, v8
    v_fma_f32 v116, v30, v50, v116
    v_fma_f32 v8, v31, v51, v8
    v_fma_f32 v116, v32, v52, v116
    v_fma_f32 v8, v33, v53, v8
    v_fma_f32 v116, v34, v54, v116
    v_fma_f32 v8, v35, v55, v8
    v_fma_f32 v116, v36, v56, v116
    v_fma_f32 v8, v37, v57, v8
    v_add_f32 v116, v116, v8
    v_cvt_pk_bf16_f32 v116, v116, v116
    v_lshlrev_b32 v116, 16, v116
    v_mul_f32 v116, s31, v116
    v_cvt_pk_bf16_f32 v116, v116, v116
    v_lshlrev_b32 v116, 16, v116
    v_cmp_le_u32 vcc, 8, v7
    v_mov_b32 v8, 0xce6e6b28
    s_nop 0
    v_cndmask_b32 v116, v8, v116, vcc
    ds_read_b64 v[40:41], v5 offset:4512
    ds_read_b64 v[42:43], v5 offset:4520
    ds_read_b64 v[44:45], v5 offset:4528
    ds_read_b64 v[46:47], v5 offset:4536
    ds_read_b64 v[48:49], v5 offset:4544
    ds_read_b64 v[50:51], v5 offset:4552
    ds_read_b64 v[52:53], v5 offset:4560
    ds_read_b64 v[54:55], v5 offset:4568
    ds_read_b64 v[56:57], v5 offset:4576
    s_waitcnt lgkmcnt(9)
    v_mul_f32 v117, v20, v58
    v_mul_f32 v8, v21, v59
    v_fma_f32 v117, v22, v60, v117
    v_fma_f32 v8, v23, v61, v8
    v_fma_f32 v117, v24, v62, v117
    v_fma_f32 v8, v25, v63, v8
    v_fma_f32 v117, v26, v64, v117
    v_fma_f32 v8, v27, v65, v8
    v_fma_f32 v117, v28, v66, v117
    v_fma_f32 v8, v29, v67, v8
    v_fma_f32 v117, v30, v68, v117
    v_fma_f32 v8, v31, v69, v8
    v_fma_f32 v117, v32, v70, v117
    v_fma_f32 v8, v33, v71, v8
    v_fma_f32 v117, v34, v72, v117
    v_fma_f32 v8, v35, v73, v8
    v_fma_f32 v117, v36, v74, v117
    v_fma_f32 v8, v37, v75, v8
    v_add_f32 v117, v117, v8
    v_cvt_pk_bf16_f32 v117, v117, v117
    v_lshlrev_b32 v117, 16, v117
    v_mul_f32 v117, s31, v117
    v_cvt_pk_bf16_f32 v117, v117, v117
    v_lshlrev_b32 v117, 16, v117
    v_cmp_le_u32 vcc, 10, v7
    v_mov_b32 v8, 0xce6e6b28
    s_nop 0
    v_cndmask_b32 v117, v8, v117, vcc
    ds_read_b64 v[58:59], v5 offset:2400
    ds_read_b64 v[60:61], v5 offset:2408
    ds_read_b64 v[62:63], v5 offset:2416
    ds_read_b64 v[64:65], v5 offset:2424
    ds_read_b64 v[66:67], v5 offset:2432
    ds_read_b64 v[68:69], v5 offset:2440
    ds_read_b64 v[70:71], v5 offset:2448
    ds_read_b64 v[72:73], v5 offset:2456
    ds_read_b64 v[74:75], v5 offset:2464
    s_waitcnt lgkmcnt(9)
    v_mul_f32 v118, v20, v40
    v_mul_f32 v8, v21, v41
    v_fma_f32 v118, v22, v42, v118
    v_fma_f32 v8, v23, v43, v8
    v_fma_f32 v118, v24, v44, v118
    v_fma_f32 v8, v25, v45, v8
    v_fma_f32 v118, v26, v46, v118
    v_fma_f32 v8, v27, v47, v8
    v_fma_f32 v118, v28, v48, v118
    v_fma_f32 v8, v29, v49, v8
    v_fma_f32 v118, v30, v50, v118
    v_fma_f32 v8, v31, v51, v8
    v_fma_f32 v118, v32, v52, v118
    v_fma_f32 v8, v33, v53, v8
    v_fma_f32 v118, v34, v54, v118
    v_fma_f32 v8, v35, v55, v8
    v_fma_f32 v118, v36, v56, v118
    v_fma_f32 v8, v37, v57, v8
    v_add_f32 v118, v118, v8
    v_cvt_pk_bf16_f32 v118, v118, v118
    v_lshlrev_b32 v118, 16, v118
    v_mul_f32 v118, s31, v118
    v_cvt_pk_bf16_f32 v118, v118, v118
    v_lshlrev_b32 v118, 16, v118
    v_cmp_le_u32 vcc, 12, v7
    v_mov_b32 v8, 0xce6e6b28
    s_nop 0
    v_cndmask_b32 v118, v8, v118, vcc
    ds_read_b64 v[40:41], v5 offset:17472
    ds_read_b64 v[42:43], v5 offset:17480
    ds_read_b64 v[44:45], v5 offset:17488
    ds_read_b64 v[46:47], v5 offset:17496
    ds_read_b64 v[48:49], v5 offset:17504
    ds_read_b64 v[50:51], v5 offset:17512
    ds_read_b64 v[52:53], v5 offset:17520
    ds_read_b64 v[54:55], v5 offset:17528
    ds_read_b64 v[56:57], v5 offset:17536
    s_waitcnt lgkmcnt(9)
    v_mul_f32 v119, v20, v58
    v_mul_f32 v8, v21, v59
    v_fma_f32 v119, v22, v60, v119
    v_fma_f32 v8, v23, v61, v8
    v_fma_f32 v119, v24, v62, v119
    v_fma_f32 v8, v25, v63, v8
    v_fma_f32 v119, v26, v64, v119
    v_fma_f32 v8, v27, v65, v8
    v_fma_f32 v119, v28, v66, v119
    v_fma_f32 v8, v29, v67, v8
    v_fma_f32 v119, v30, v68, v119
    v_fma_f32 v8, v31, v69, v8
    v_fma_f32 v119, v32, v70, v119
    v_fma_f32 v8, v33, v71, v8
    v_fma_f32 v119, v34, v72, v119
    v_fma_f32 v8, v35, v73, v8
    v_fma_f32 v119, v36, v74, v119
    v_fma_f32 v8, v37, v75, v8
    v_add_f32 v119, v119, v8
    v_cvt_pk_bf16_f32 v119, v119, v119
    v_lshlrev_b32 v119, 16, v119
    v_mul_f32 v119, s31, v119
    v_cvt_pk_bf16_f32 v119, v119, v119
    v_lshlrev_b32 v119, 16, v119
    v_cmp_le_u32 vcc, 14, v7
    v_mov_b32 v8, 0xce6e6b28
    s_nop 0
    v_cndmask_b32 v119, v8, v119, vcc
    v_max_f32 v8, v112, v113
    v_max_f32 v8, v8, v114
    v_max_f32 v8, v8, v115
    v_max_f32 v8, v8, v116
    v_max_f32 v8, v8, v117
    v_max_f32 v8, v8, v118
    v_max_f32 v8, v8, v119
    s_mov_b32 s31, 0x3fb8aa3b
    v_sub_f32 v112, v112, v8
    v_mul_f32 v112, s31, v112
    v_exp_f32 v112, v112
    v_sub_f32 v113, v113, v8
    v_mul_f32 v113, s31, v113
    v_exp_f32 v113, v113
    v_sub_f32 v114, v114, v8
    v_mul_f32 v114, s31, v114
    v_exp_f32 v114, v114
    v_sub_f32 v115, v115, v8
    v_mul_f32 v115, s31, v115
    v_exp_f32 v115, v115
    v_sub_f32 v116, v116, v8
    v_mul_f32 v116, s31, v116
    v_exp_f32 v116, v116
    v_sub_f32 v117, v117, v8
    v_mul_f32 v117, s31, v117
    v_exp_f32 v117, v117
    v_sub_f32 v118, v118, v8
    v_mul_f32 v118, s31, v118
    v_exp_f32 v118, v118
    v_sub_f32 v119, v119, v8
    v_mul_f32 v119, s31, v119
    v_exp_f32 v119, v119
    s_nop 0
    v_add_f32 v8, v112, v113
    v_add_f32 v8, v8, v114
    v_add_f32 v8, v8, v115
    v_add_f32 v8, v8, v116
    v_add_f32 v8, v8, v117
    v_add_f32 v8, v8, v118
    v_add_f32 v8, v8, v119
    v_rcp_f32 v8, v8
    s_nop 0
    v_mul_f32 v112, v112, v8
    v_cvt_pk_bf16_f32 v112, v112, v112
    v_lshlrev_b32 v112, 16, v112
    v_mul_f32 v113, v113, v8
    v_cvt_pk_bf16_f32 v113, v113, v113
    v_lshlrev_b32 v113, 16, v113
    v_mul_f32 v114, v114, v8
    v_cvt_pk_bf16_f32 v114, v114, v114
    v_lshlrev_b32 v114, 16, v114
    v_mul_f32 v115, v115, v8
    v_cvt_pk_bf16_f32 v115, v115, v115
    v_lshlrev_b32 v115, 16, v115
    v_mul_f32 v116, v116, v8
    v_cvt_pk_bf16_f32 v116, v116, v116
    v_lshlrev_b32 v116, 16, v116
    v_mul_f32 v117, v117, v8
    v_cvt_pk_bf16_f32 v117, v117, v117
    v_lshlrev_b32 v117, 16, v117
    v_mul_f32 v118, v118, v8
    v_cvt_pk_bf16_f32 v118, v118, v118
    v_lshlrev_b32 v118, 16, v118
    v_mul_f32 v119, v119, v8
    v_cvt_pk_bf16_f32 v119, v119, v119
    v_lshlrev_b32 v119, 16, v119
    ds_read_b64 v[58:59], v5 offset:15360
    ds_read_b64 v[60:61], v5 offset:15368
    ds_read_b64 v[62:63], v5 offset:15376
    ds_read_b64 v[64:65], v5 offset:15384
    ds_read_b64 v[66:67], v5 offset:15392
    ds_read_b64 v[68:69], v5 offset:15400
    ds_read_b64 v[70:71], v5 offset:15408
    ds_read_b64 v[72:73], v5 offset:15416
    ds_read_b64 v[74:75], v5 offset:15424
    s_waitcnt lgkmcnt(9)
    v_mul_f32 v120, v112, v40
    v_mul_f32 v121, v112, v41
    v_mul_f32 v122, v112, v42
    v_mul_f32 v123, v112, v43
    v_mul_f32 v124, v112, v44
    v_mul_f32 v125, v112, v45
    v_mul_f32 v126, v112, v46
    v_mul_f32 v127, v112, v47
    v_mul_f32 v128, v112, v48
    v_mul_f32 v129, v112, v49
    v_mul_f32 v130, v112, v50
    v_mul_f32 v131, v112, v51
    v_mul_f32 v132, v112, v52
    v_mul_f32 v133, v112, v53
    v_mul_f32 v134, v112, v54
    v_mul_f32 v135, v112, v55
    v_mul_f32 v136, v112, v56
    v_mul_f32 v137, v112, v57
    ds_read_b64 v[40:41], v5 offset:13248
    ds_read_b64 v[42:43], v5 offset:13256
    ds_read_b64 v[44:45], v5 offset:13264
    ds_read_b64 v[46:47], v5 offset:13272
    ds_read_b64 v[48:49], v5 offset:13280
    ds_read_b64 v[50:51], v5 offset:13288
    ds_read_b64 v[52:53], v5 offset:13296
    ds_read_b64 v[54:55], v5 offset:13304
    ds_read_b64 v[56:57], v5 offset:13312
    s_waitcnt lgkmcnt(9)
    v_fma_f32 v120, v113, v58, v120
    v_fma_f32 v121, v113, v59, v121
    v_fma_f32 v122, v113, v60, v122
    v_fma_f32 v123, v113, v61, v123
    v_fma_f32 v124, v113, v62, v124
    v_fma_f32 v125, v113, v63, v125
    v_fma_f32 v126, v113, v64, v126
    v_fma_f32 v127, v113, v65, v127
    v_fma_f32 v128, v113, v66, v128
    v_fma_f32 v129, v113, v67, v129
    v_fma_f32 v130, v113, v68, v130
    v_fma_f32 v131, v113, v69, v131
    v_fma_f32 v132, v113, v70, v132
    v_fma_f32 v133, v113, v71, v133
    v_fma_f32 v134, v113, v72, v134
    v_fma_f32 v135, v113, v73, v135
    v_fma_f32 v136, v113, v74, v136
    v_fma_f32 v137, v113, v75, v137
    ds_read_b64 v[58:59], v5 offset:11136
    ds_read_b64 v[60:61], v5 offset:11144
    ds_read_b64 v[62:63], v5 offset:11152
    ds_read_b64 v[64:65], v5 offset:11160
    ds_read_b64 v[66:67], v5 offset:11168
    ds_read_b64 v[68:69], v5 offset:11176
    ds_read_b64 v[70:71], v5 offset:11184
    ds_read_b64 v[72:73], v5 offset:11192
    ds_read_b64 v[74:75], v5 offset:11200
    s_waitcnt lgkmcnt(9)
    v_fma_f32 v120, v114, v40, v120
    v_fma_f32 v121, v114, v41, v121
    v_fma_f32 v122, v114, v42, v122
    v_fma_f32 v123, v114, v43, v123
    v_fma_f32 v124, v114, v44, v124
    v_fma_f32 v125, v114, v45, v125
    v_fma_f32 v126, v114, v46, v126
    v_fma_f32 v127, v114, v47, v127
    v_fma_f32 v128, v114, v48, v128
    v_fma_f32 v129, v114, v49, v129
    v_fma_f32 v130, v114, v50, v130
    v_fma_f32 v131, v114, v51, v131
    v_fma_f32 v132, v114, v52, v132
    v_fma_f32 v133, v114, v53, v133
    v_fma_f32 v134, v114, v54, v134
    v_fma_f32 v135, v114, v55, v135
    v_fma_f32 v136, v114, v56, v136
    v_fma_f32 v137, v114, v57, v137
    ds_read_b64 v[40:41], v5 offset:9024
    ds_read_b64 v[42:43], v5 offset:9032
    ds_read_b64 v[44:45], v5 offset:9040
    ds_read_b64 v[46:47], v5 offset:9048
    ds_read_b64 v[48:49], v5 offset:9056
    ds_read_b64 v[50:51], v5 offset:9064
    ds_read_b64 v[52:53], v5 offset:9072
    ds_read_b64 v[54:55], v5 offset:9080
    ds_read_b64 v[56:57], v5 offset:9088
    s_waitcnt lgkmcnt(9)
    v_fma_f32 v120, v115, v58, v120
    v_fma_f32 v121, v115, v59, v121
    v_fma_f32 v122, v115, v60, v122
    v_fma_f32 v123, v115, v61, v123
    v_fma_f32 v124, v115, v62, v124
    v_fma_f32 v125, v115, v63, v125
    v_fma_f32 v126, v115, v64, v126
    v_fma_f32 v127, v115, v65, v127
    v_fma_f32 v128, v115, v66, v128
    v_fma_f32 v129, v115, v67, v129
    v_fma_f32 v130, v115, v68, v130
    v_fma_f32 v131, v115, v69, v131
    v_fma_f32 v132, v115, v70, v132
    v_fma_f32 v133, v115, v71, v133
    v_fma_f32 v134, v115, v72, v134
    v_fma_f32 v135, v115, v73, v135
    v_fma_f32 v136, v115, v74, v136
    v_fma_f32 v137, v115, v75, v137
    ds_read_b64 v[58:59], v5 offset:6912
    ds_read_b64 v[60:61], v5 offset:6920
    ds_read_b64 v[62:63], v5 offset:6928
    ds_read_b64 v[64:65], v5 offset:6936
    ds_read_b64 v[66:67], v5 offset:6944
    ds_read_b64 v[68:69], v5 offset:6952
    ds_read_b64 v[70:71], v5 offset:6960
    ds_read_b64 v[72:73], v5 offset:6968
    ds_read_b64 v[74:75], v5 offset:6976
    s_waitcnt lgkmcnt(9)
    v_fma_f32 v120, v116, v40, v120
    v_fma_f32 v121, v116, v41, v121
    v_fma_f32 v122, v116, v42, v122
    v_fma_f32 v123, v116, v43, v123
    v_fma_f32 v124, v116, v44, v124
    v_fma_f32 v125, v116, v45, v125
    v_fma_f32 v126, v116, v46, v126
    v_fma_f32 v127, v116, v47, v127
    v_fma_f32 v128, v116, v48, v128
    v_fma_f32 v129, v116, v49, v129
    v_fma_f32 v130, v116, v50, v130
    v_fma_f32 v131, v116, v51, v131
    v_fma_f32 v132, v116, v52, v132
    v_fma_f32 v133, v116, v53, v133
    v_fma_f32 v134, v116, v54, v134
    v_fma_f32 v135, v116, v55, v135
    v_fma_f32 v136, v116, v56, v136
    v_fma_f32 v137, v116, v57, v137
    ds_read_b64 v[40:41], v5 offset:4800
    ds_read_b64 v[42:43], v5 offset:4808
    ds_read_b64 v[44:45], v5 offset:4816
    ds_read_b64 v[46:47], v5 offset:4824
    ds_read_b64 v[48:49], v5 offset:4832
    ds_read_b64 v[50:51], v5 offset:4840
    ds_read_b64 v[52:53], v5 offset:4848
    ds_read_b64 v[54:55], v5 offset:4856
    ds_read_b64 v[56:57], v5 offset:4864
    s_waitcnt lgkmcnt(9)
    v_fma_f32 v120, v117, v58, v120
    v_fma_f32 v121, v117, v59, v121
    v_fma_f32 v122, v117, v60, v122
    v_fma_f32 v123, v117, v61, v123
    v_fma_f32 v124, v117, v62, v124
    v_fma_f32 v125, v117, v63, v125
    v_fma_f32 v126, v117, v64, v126
    v_fma_f32 v127, v117, v65, v127
    v_fma_f32 v128, v117, v66, v128
    v_fma_f32 v129, v117, v67, v129
    v_fma_f32 v130, v117, v68, v130
    v_fma_f32 v131, v117, v69, v131
    v_fma_f32 v132, v117, v70, v132
    v_fma_f32 v133, v117, v71, v133
    v_fma_f32 v134, v117, v72, v134
    v_fma_f32 v135, v117, v73, v135
    v_fma_f32 v136, v117, v74, v136
    v_fma_f32 v137, v117, v75, v137
    ds_read_b64 v[58:59], v5 offset:2688
    ds_read_b64 v[60:61], v5 offset:2696
    ds_read_b64 v[62:63], v5 offset:2704
    ds_read_b64 v[64:65], v5 offset:2712
    ds_read_b64 v[66:67], v5 offset:2720
    ds_read_b64 v[68:69], v5 offset:2728
    ds_read_b64 v[70:71], v5 offset:2736
    ds_read_b64 v[72:73], v5 offset:2744
    ds_read_b64 v[74:75], v5 offset:2752
    s_waitcnt lgkmcnt(9)
    v_fma_f32 v120, v118, v40, v120
    v_fma_f32 v121, v118, v41, v121
    v_fma_f32 v122, v118, v42, v122
    v_fma_f32 v123, v118, v43, v123
    v_fma_f32 v124, v118, v44, v124
    v_fma_f32 v125, v118, v45, v125
    v_fma_f32 v126, v118, v46, v126
    v_fma_f32 v127, v118, v47, v127
    v_fma_f32 v128, v118, v48, v128
    v_fma_f32 v129, v118, v49, v129
    v_fma_f32 v130, v118, v50, v130
    v_fma_f32 v131, v118, v51, v131
    v_fma_f32 v132, v118, v52, v132
    v_fma_f32 v133, v118, v53, v133
    v_fma_f32 v134, v118, v54, v134
    v_fma_f32 v135, v118, v55, v135
    v_fma_f32 v136, v118, v56, v136
    v_fma_f32 v137, v118, v57, v137
    s_waitcnt lgkmcnt(0)
    v_fma_f32 v120, v119, v58, v120
    v_fma_f32 v121, v119, v59, v121
    v_fma_f32 v122, v119, v60, v122
    v_fma_f32 v123, v119, v61, v123
    v_fma_f32 v124, v119, v62, v124
    v_fma_f32 v125, v119, v63, v125
    v_fma_f32 v126, v119, v64, v126
    v_fma_f32 v127, v119, v65, v127
    v_fma_f32 v128, v119, v66, v128
    v_fma_f32 v129, v119, v67, v129
    v_fma_f32 v130, v119, v68, v130
    v_fma_f32 v131, v119, v69, v131
    v_fma_f32 v132, v119, v70, v132
    v_fma_f32 v133, v119, v71, v133
    v_fma_f32 v134, v119, v72, v134
    v_fma_f32 v135, v119, v73, v135
    v_fma_f32 v136, v119, v74, v136
    v_fma_f32 v137, v119, v75, v137
    v_cvt_pk_bf16_f32 v20, v120, v121
    v_cvt_pk_bf16_f32 v21, v122, v123
    v_cvt_pk_bf16_f32 v22, v124, v125
    v_cvt_pk_bf16_f32 v23, v126, v127
    v_cvt_pk_bf16_f32 v24, v128, v129
    v_cvt_pk_bf16_f32 v25, v130, v131
    v_cvt_pk_bf16_f32 v26, v132, v133
    v_cvt_pk_bf16_f32 v27, v134, v135
    v_cvt_pk_bf16_f32 v28, v136, v137
    v_mul_u32_u24 v5, 160, v3
    v_mul_u32_u24 v6, 36, v4
    s_mov_b32 s30, 92160
    v_add3_u32 v5, v5, v6, s30
    ds_write_b32 v5, v20 offset:0
    ds_write_b32 v5, v21 offset:4
    ds_write_b32 v5, v22 offset:8
    ds_write_b32 v5, v23 offset:12
    ds_write_b32 v5, v24 offset:16
    ds_write_b32 v5, v25 offset:20
    ds_write_b32 v5, v26 offset:24
    ds_write_b32 v5, v27 offset:28
    ds_write_b32 v5, v28 offset:32
    s_waitcnt lgkmcnt(0)
    s_barrier
    s_mov_b32 s32, 0x1c72
    s_mul_i32 s31, s21, 9
    s_mov_b32 s33, 2621440
    v_add_u32 v3, 0, v2
    v_mul_lo_u32 v4, v3, s32
    v_lshrrev_b32 v4, 16, v4
    v_mul_u32_u24 v5, 9, v4
    v_sub_u32 v5, v3, v5
    v_mul_u32_u24 v6, 160, v4
    v_lshlrev_b32 v8, 4, v5
    v_add3_u32 v6, v6, v8, s30
    ds_read_b128 v[20:23], v6
    v_add_u32 v5, s31, v5
    s_lshl_b32 s35, s22, 6
    v_add_u32 v4, s35, v4
    v_lshrrev_b32 v6, 5, v4
    v_mul_u32_u24 v6, 36, v6
    v_lshrrev_b32 v8, 1, v5
    v_add_u32 v6, v6, v8
    v_lshlrev_b32 v6, 10, v6
    v_and_b32 v8, 1, v5
    v_lshlrev_b32 v8, 5, v8
    v_and_b32 v4, 31, v4
    v_add_u32 v8, v8, v4
    v_lshlrev_b32 v8, 4, v8
    v_add_u32 v32, v6, v8
    s_waitcnt lgkmcnt(0)
    buffer_store_dwordx4 v[20:23], v32, s[16:19], s33 offen
    v_add_u32 v3, 256, v2
    v_mul_lo_u32 v4, v3, s32
    v_lshrrev_b32 v4, 16, v4
    v_mul_u32_u24 v5, 9, v4
    v_sub_u32 v5, v3, v5
    v_mul_u32_u24 v6, 160, v4
    v_lshlrev_b32 v8, 4, v5
    v_add3_u32 v6, v6, v8, s30
    ds_read_b128 v[24:27], v6
    v_add_u32 v5, s31, v5
    s_lshl_b32 s35, s22, 6
    v_add_u32 v4, s35, v4
    v_lshrrev_b32 v6, 5, v4
    v_mul_u32_u24 v6, 36, v6
    v_lshrrev_b32 v8, 1, v5
    v_add_u32 v6, v6, v8
    v_lshlrev_b32 v6, 10, v6
    v_and_b32 v8, 1, v5
    v_lshlrev_b32 v8, 5, v8
    v_and_b32 v4, 31, v4
    v_add_u32 v8, v8, v4
    v_lshlrev_b32 v8, 4, v8
    v_add_u32 v33, v6, v8
    s_waitcnt lgkmcnt(0)
    buffer_store_dwordx4 v[24:27], v33, s[16:19], s33 offen
    v_add_u32 v3, 512, v2
    v_mul_lo_u32 v4, v3, s32
    v_lshrrev_b32 v4, 16, v4
    v_mul_u32_u24 v5, 9, v4
    v_sub_u32 v5, v3, v5
    v_mul_u32_u24 v6, 160, v4
    v_lshlrev_b32 v8, 4, v5
    v_add3_u32 v6, v6, v8, s30
    v_cmp_gt_u32 vcc, 64, v2
    s_and_saveexec_b64 s[44:45], vcc
    s_cbranch_execz k1b_kernel_end
    ds_read_b128 v[28:31], v6
    v_add_u32 v5, s31, v5
    s_lshl_b32 s35, s22, 6
    v_add_u32 v4, s35, v4
    v_lshrrev_b32 v6, 5, v4
    v_mul_u32_u24 v6, 36, v6
    v_lshrrev_b32 v8, 1, v5
    v_add_u32 v6, v6, v8
    v_lshlrev_b32 v6, 10, v6
    v_and_b32 v8, 1, v5
    v_lshlrev_b32 v8, 5, v8
    v_and_b32 v4, 31, v4
    v_add_u32 v8, v8, v4
    v_lshlrev_b32 v8, 4, v8
    v_add_u32 v34, v6, v8
    s_waitcnt lgkmcnt(0)
    buffer_store_dwordx4 v[28:31], v34, s[16:19], s33 offen
k1b_kernel_end:
    s_endpgm
.globl k2b_kernel
.p2align 8
.type k2b_kernel,@function
k2b_kernel:
    s_cmp_ge_u32 s2, 192
    s_cbranch_scc1 k2b_kernel_end
    s_load_dwordx2 s[4:5], s[0:1], 16
    s_load_dwordx2 s[8:9], s[0:1], 72
    v_lshrrev_b32 v1, 6, v0
    v_mov_b32 v13, v0
    v_and_b32 v0, 63, v0
    v_readfirstlane_b32 s20, v1
    s_lshr_b32 s21, s2, 3
    s_mul_i32 s22, s21, 43
    s_lshr_b32 s22, s22, 8
    s_mul_i32 s23, s22, 6
    s_sub_u32 s21, s21, s23
    s_and_b32 s23, s2, 7
    s_lshl_b32 s23, s23, 2
    s_add_u32 s22, s22, s23
    s_mul_i32 s23, s22, 73728
    s_lshl_b32 s24, s20, 10
    s_add_u32 s23, s23, s24
    s_add_u32 s23, s23, 2621440
    s_mul_i32 s26, s20, 18432
    s_mul_i32 s27, s20, 24576
    s_mul_i32 s30, s21, 192
    s_mov_b32 s31, 0x5556
    v_add_u32 v2, 0, v0
    v_mul_lo_u32 v3, v2, s31
    v_lshrrev_b32 v3, 18, v3
    v_mul_u32_u24 v4, 12, v3
    v_sub_u32 v4, v2, v4
    v_mul_u32_u24 v3, 1152, v3
    v_lshlrev_b32 v4, 4, v4
    v_add3_u32 v8, v3, v4, s30
    v_add_u32 v2, 64, v0
    v_mul_lo_u32 v3, v2, s31
    v_lshrrev_b32 v3, 18, v3
    v_mul_u32_u24 v4, 12, v3
    v_sub_u32 v4, v2, v4
    v_mul_u32_u24 v3, 1152, v3
    v_lshlrev_b32 v4, 4, v4
    v_add3_u32 v9, v3, v4, s30
    v_add_u32 v2, 128, v0
    v_mul_lo_u32 v3, v2, s31
    v_lshrrev_b32 v3, 18, v3
    v_mul_u32_u24 v4, 12, v3
    v_sub_u32 v4, v2, v4
    v_mul_u32_u24 v3, 1152, v3
    v_lshlrev_b32 v4, 4, v4
    v_add3_u32 v10, v3, v4, s30
    v_lshrrev_b32 v2, 5, v0
    v_lshlrev_b32 v2, 3, v2
    v_bfe_u32 v3, v0, 2, 2
    v_add_u32 v2, v2, v3
    v_mul_u32_u24 v2, 192, v2
    v_bfe_u32 v3, v0, 4, 1
    v_lshlrev_b32 v3, 5, v3
    v_add_u32 v2, v2, v3
    v_and_b32 v3, 3, v0
    v_lshlrev_b32 v3, 3, v3
    v_add3_u32 v11, v2, v3, s27
    v_lshlrev_b32 v12, 4, v0
    s_waitcnt lgkmcnt(0)
    s_mov_b32 s12, s4
    s_and_b32 s13, s5, 0xffff
    s_mov_b32 s14, 663552
    s_mov_b32 s15, 0x00020000
    s_mov_b32 s16, s8
    s_and_b32 s17, s9, 0xffff
    s_mov_b32 s18, 268435456
    s_mov_b32 s19, 0x00020000
    s_add_u32 s24, s23, 0
    buffer_load_dwordx4 v[32:35], v12, s[16:19], s24 offen
    s_add_u32 s24, s23, 36864
    buffer_load_dwordx4 v[36:39], v12, s[16:19], s24 offen
    s_add_u32 s25, s26, 0
    s_add_u32 m0, s27, 0
    s_nop 0
    buffer_load_dwordx4 v8, s[12:15], s25 offen lds
    s_add_u32 m0, s27, 1024
    s_nop 0
    buffer_load_dwordx4 v9, s[12:15], s25 offen lds
    s_add_u32 m0, s27, 2048
    s_nop 0
    buffer_load_dwordx4 v10, s[12:15], s25 offen lds
    s_add_u32 s24, s23, 4096
    buffer_load_dwordx4 v[40:43], v12, s[16:19], s24 offen
    s_add_u32 s24, s23, 40960
    buffer_load_dwordx4 v[44:47], v12, s[16:19], s24 offen
    s_add_u32 s25, s26, 73728
    s_add_u32 m0, s27, 3072
    s_nop 0
    buffer_load_dwordx4 v8, s[12:15], s25 offen lds
    s_add_u32 m0, s27, 4096
    s_nop 0
    buffer_load_dwordx4 v9, s[12:15], s25 offen lds
    s_add_u32 m0, s27, 5120
    s_nop 0
    buffer_load_dwordx4 v10, s[12:15], s25 offen lds
    s_add_u32 s24, s23, 8192
    buffer_load_dwordx4 v[48:51], v12, s[16:19], s24 offen
    s_add_u32 s24, s23, 45056
    buffer_load_dwordx4 v[52:55], v12, s[16:19], s24 offen
    s_add_u32 s25, s26, 147456
    s_add_u32 m0, s27, 6144
    s_nop 0
    buffer_load_dwordx4 v8, s[12:15], s25 offen lds
    s_add_u32 m0, s27, 7168
    s_nop 0
    buffer_load_dwordx4 v9, s[12:15], s25 offen lds
    s_add_u32 m0, s27, 8192
    s_nop 0
    buffer_load_dwordx4 v10, s[12:15], s25 offen lds
    s_add_u32 s24, s23, 12288
    buffer_load_dwordx4 v[56:59], v12, s[16:19], s24 offen
    s_add_u32 s24, s23, 49152
    buffer_load_dwordx4 v[60:63], v12, s[16:19], s24 offen
    s_add_u32 s25, s26, 221184
    s_add_u32 m0, s27, 9216
    s_nop 0
    buffer_load_dwordx4 v8, s[12:15], s25 offen lds
    s_add_u32 m0, s27, 10240
    s_nop 0
    buffer_load_dwordx4 v9, s[12:15], s25 offen lds
    s_add_u32 m0, s27, 11264
    s_nop 0
    buffer_load_dwordx4 v10, s[12:15], s25 offen lds
    s_add_u32 s24, s23, 16384
    buffer_load_dwordx4 v[64:67], v12, s[16:19], s24 offen
    s_add_u32 s24, s23, 53248
    buffer_load_dwordx4 v[68:71], v12, s[16:19], s24 offen
    s_add_u32 s25, s26, 294912
    s_add_u32 m0, s27, 12288
    s_nop 0
    buffer_load_dwordx4 v8, s[12:15], s25 offen lds
    s_add_u32 m0, s27, 13312
    s_nop 0
    buffer_load_dwordx4 v9, s[12:15], s25 offen lds
    s_add_u32 m0, s27, 14336
    s_nop 0
    buffer_load_dwordx4 v10, s[12:15], s25 offen lds
    s_add_u32 s24, s23, 20480
    buffer_load_dwordx4 v[72:75], v12, s[16:19], s24 offen
    s_add_u32 s24, s23, 57344
    buffer_load_dwordx4 v[76:79], v12, s[16:19], s24 offen
    s_add_u32 s25, s26, 368640
    s_add_u32 m0, s27, 15360
    s_nop 0
    buffer_load_dwordx4 v8, s[12:15], s25 offen lds
    s_add_u32 m0, s27, 16384
    s_nop 0
    buffer_load_dwordx4 v9, s[12:15], s25 offen lds
    s_add_u32 m0, s27, 17408
    s_nop 0
    buffer_load_dwordx4 v10, s[12:15], s25 offen lds
    s_add_u32 s24, s23, 24576
    buffer_load_dwordx4 v[80:83], v12, s[16:19], s24 offen
    s_add_u32 s24, s23, 61440
    buffer_load_dwordx4 v[84:87], v12, s[16:19], s24 offen
    s_add_u32 s25, s26, 442368
    s_add_u32 m0, s27, 18432
    s_nop 0
    buffer_load_dwordx4 v8, s[12:15], s25 offen lds
    s_add_u32 m0, s27, 19456
    s_nop 0
    buffer_load_dwordx4 v9, s[12:15], s25 offen lds
    s_add_u32 m0, s27, 20480
    s_nop 0
    buffer_load_dwordx4 v10, s[12:15], s25 offen lds
    s_waitcnt vmcnt(30)
    ds_read_b64_tr_b16 v[96:97], v11 offset:0
    ds_read_b64_tr_b16 v[98:99], v11 offset:768
    ds_read_b64_tr_b16 v[100:101], v11 offset:64
    ds_read_b64_tr_b16 v[102:103], v11 offset:832
    ds_read_b64_tr_b16 v[104:105], v11 offset:128
    ds_read_b64_tr_b16 v[106:107], v11 offset:896
    s_waitcnt lgkmcnt(0)
    s_waitcnt vmcnt(25)
    v_mfma_f32_32x32x16_bf16 v[128:143], v[96:99], v[32:35], 0
    ds_read_b64_tr_b16 v[108:109], v11 offset:3072
    ds_read_b64_tr_b16 v[110:111], v11 offset:3840
    v_mfma_f32_32x32x16_bf16 v[144:159], v[96:99], v[36:39], 0
    ds_read_b64_tr_b16 v[112:113], v11 offset:3136
    ds_read_b64_tr_b16 v[114:115], v11 offset:3904
    v_mfma_f32_32x32x16_bf16 v[160:175], v[100:103], v[32:35], 0
    ds_read_b64_tr_b16 v[116:117], v11 offset:3200
    ds_read_b64_tr_b16 v[118:119], v11 offset:3968
    v_mfma_f32_32x32x16_bf16 v[176:191], v[100:103], v[36:39], 0
    s_add_u32 s24, s23, 28672
    buffer_load_dwordx4 v[88:91], v12, s[16:19], s24 offen
    s_add_u32 s24, s23, 65536
    buffer_load_dwordx4 v[92:95], v12, s[16:19], s24 offen
    s_add_u32 s25, s26, 516096
    s_add_u32 m0, s27, 21504
    s_nop 0
    buffer_load_dwordx4 v8, s[12:15], s25 offen lds
    s_add_u32 m0, s27, 22528
    s_nop 0
    buffer_load_dwordx4 v9, s[12:15], s25 offen lds
    s_add_u32 m0, s27, 23552
    s_nop 0
    buffer_load_dwordx4 v10, s[12:15], s25 offen lds
    v_mfma_f32_32x32x16_bf16 v[192:207], v[104:107], v[32:35], 0
    v_mfma_f32_32x32x16_bf16 v[208:223], v[104:107], v[36:39], 0
    s_waitcnt lgkmcnt(0)
    s_waitcnt vmcnt(25)
    v_mfma_f32_32x32x16_bf16 v[128:143], v[108:111], v[40:43], v[128:143]
    ds_read_b64_tr_b16 v[96:97], v11 offset:6144
    ds_read_b64_tr_b16 v[98:99], v11 offset:6912
    v_mfma_f32_32x32x16_bf16 v[144:159], v[108:111], v[44:47], v[144:159]
    ds_read_b64_tr_b16 v[100:101], v11 offset:6208
    ds_read_b64_tr_b16 v[102:103], v11 offset:6976
    v_mfma_f32_32x32x16_bf16 v[160:175], v[112:115], v[40:43], v[160:175]
    ds_read_b64_tr_b16 v[104:105], v11 offset:6272
    ds_read_b64_tr_b16 v[106:107], v11 offset:7040
    v_mfma_f32_32x32x16_bf16 v[176:191], v[112:115], v[44:47], v[176:191]
    s_add_u32 s24, s23, 32768
    buffer_load_dwordx4 v[32:35], v12, s[16:19], s24 offen
    s_add_u32 s24, s23, 69632
    buffer_load_dwordx4 v[36:39], v12, s[16:19], s24 offen
    s_add_u32 s25, s26, 589824
    s_add_u32 m0, s27, 0
    s_nop 0
    buffer_load_dwordx4 v8, s[12:15], s25 offen lds
    s_add_u32 m0, s27, 1024
    s_nop 0
    buffer_load_dwordx4 v9, s[12:15], s25 offen lds
    s_add_u32 m0, s27, 2048
    s_nop 0
    buffer_load_dwordx4 v10, s[12:15], s25 offen lds
    v_mfma_f32_32x32x16_bf16 v[192:207], v[116:119], v[40:43], v[192:207]
    v_mfma_f32_32x32x16_bf16 v[208:223], v[116:119], v[44:47], v[208:223]
    s_waitcnt lgkmcnt(0)
    s_waitcnt vmcnt(25)
    v_mfma_f32_32x32x16_bf16 v[128:143], v[96:99], v[48:51], v[128:143]
    ds_read_b64_tr_b16 v[108:109], v11 offset:9216
    ds_read_b64_tr_b16 v[110:111], v11 offset:9984
    v_mfma_f32_32x32x16_bf16 v[144:159], v[96:99], v[52:55], v[144:159]
    ds_read_b64_tr_b16 v[112:113], v11 offset:9280
    ds_read_b64_tr_b16 v[114:115], v11 offset:10048
    v_mfma_f32_32x32x16_bf16 v[160:175], v[100:103], v[48:51], v[160:175]
    ds_read_b64_tr_b16 v[116:117], v11 offset:9344
    ds_read_b64_tr_b16 v[118:119], v11 offset:10112
    v_mfma_f32_32x32x16_bf16 v[176:191], v[100:103], v[52:55], v[176:191]
    v_mfma_f32_32x32x16_bf16 v[192:207], v[104:107], v[48:51], v[192:207]
    v_mfma_f32_32x32x16_bf16 v[208:223], v[104:107], v[52:55], v[208:223]
    s_waitcnt lgkmcnt(0)
    s_waitcnt vmcnt(20)
    v_mfma_f32_32x32x16_bf16 v[128:143], v[108:111], v[56:59], v[128:143]
    ds_read_b64_tr_b16 v[96:97], v11 offset:12288
    ds_read_b64_tr_b16 v[98:99], v11 offset:13056
    v_mfma_f32_32x32x16_bf16 v[144:159], v[108:111], v[60:63], v[144:159]
    ds_read_b64_tr_b16 v[100:101], v11 offset:12352
    ds_read_b64_tr_b16 v[102:103], v11 offset:13120
    v_mfma_f32_32x32x16_bf16 v[160:175], v[112:115], v[56:59], v[160:175]
    ds_read_b64_tr_b16 v[104:105], v11 offset:12416
    ds_read_b64_tr_b16 v[106:107], v11 offset:13184
    v_mfma_f32_32x32x16_bf16 v[176:191], v[112:115], v[60:63], v[176:191]
    v_mfma_f32_32x32x16_bf16 v[192:207], v[116:119], v[56:59], v[192:207]
    v_mfma_f32_32x32x16_bf16 v[208:223], v[116:119], v[60:63], v[208:223]
    s_waitcnt lgkmcnt(0)
    s_waitcnt vmcnt(15)
    v_mfma_f32_32x32x16_bf16 v[128:143], v[96:99], v[64:67], v[128:143]
    ds_read_b64_tr_b16 v[108:109], v11 offset:15360
    ds_read_b64_tr_b16 v[110:111], v11 offset:16128
    v_mfma_f32_32x32x16_bf16 v[144:159], v[96:99], v[68:71], v[144:159]
    ds_read_b64_tr_b16 v[112:113], v11 offset:15424
    ds_read_b64_tr_b16 v[114:115], v11 offset:16192
    v_mfma_f32_32x32x16_bf16 v[160:175], v[100:103], v[64:67], v[160:175]
    ds_read_b64_tr_b16 v[116:117], v11 offset:15488
    ds_read_b64_tr_b16 v[118:119], v11 offset:16256
    v_mfma_f32_32x32x16_bf16 v[176:191], v[100:103], v[68:71], v[176:191]
    v_mfma_f32_32x32x16_bf16 v[192:207], v[104:107], v[64:67], v[192:207]
    v_mfma_f32_32x32x16_bf16 v[208:223], v[104:107], v[68:71], v[208:223]
    s_waitcnt lgkmcnt(0)
    s_waitcnt vmcnt(10)
    v_mfma_f32_32x32x16_bf16 v[128:143], v[108:111], v[72:75], v[128:143]
    ds_read_b64_tr_b16 v[96:97], v11 offset:18432
    ds_read_b64_tr_b16 v[98:99], v11 offset:19200
    v_mfma_f32_32x32x16_bf16 v[144:159], v[108:111], v[76:79], v[144:159]
    ds_read_b64_tr_b16 v[100:101], v11 offset:18496
    ds_read_b64_tr_b16 v[102:103], v11 offset:19264
    v_mfma_f32_32x32x16_bf16 v[160:175], v[112:115], v[72:75], v[160:175]
    ds_read_b64_tr_b16 v[104:105], v11 offset:18560
    ds_read_b64_tr_b16 v[106:107], v11 offset:19328
    v_mfma_f32_32x32x16_bf16 v[176:191], v[112:115], v[76:79], v[176:191]
    v_mfma_f32_32x32x16_bf16 v[192:207], v[116:119], v[72:75], v[192:207]
    v_mfma_f32_32x32x16_bf16 v[208:223], v[116:119], v[76:79], v[208:223]
    s_waitcnt lgkmcnt(0)
    s_waitcnt vmcnt(5)
    v_mfma_f32_32x32x16_bf16 v[128:143], v[96:99], v[80:83], v[128:143]
    ds_read_b64_tr_b16 v[108:109], v11 offset:21504
    ds_read_b64_tr_b16 v[110:111], v11 offset:22272
    v_mfma_f32_32x32x16_bf16 v[144:159], v[96:99], v[84:87], v[144:159]
    ds_read_b64_tr_b16 v[112:113], v11 offset:21568
    ds_read_b64_tr_b16 v[114:115], v11 offset:22336
    v_mfma_f32_32x32x16_bf16 v[160:175], v[100:103], v[80:83], v[160:175]
    ds_read_b64_tr_b16 v[116:117], v11 offset:21632
    ds_read_b64_tr_b16 v[118:119], v11 offset:22400
    v_mfma_f32_32x32x16_bf16 v[176:191], v[100:103], v[84:87], v[176:191]
    v_mfma_f32_32x32x16_bf16 v[192:207], v[104:107], v[80:83], v[192:207]
    v_mfma_f32_32x32x16_bf16 v[208:223], v[104:107], v[84:87], v[208:223]
    s_waitcnt lgkmcnt(0)
    s_waitcnt vmcnt(0)
    v_mfma_f32_32x32x16_bf16 v[128:143], v[108:111], v[88:91], v[128:143]
    ds_read_b64_tr_b16 v[96:97], v11 offset:0
    ds_read_b64_tr_b16 v[98:99], v11 offset:768
    v_mfma_f32_32x32x16_bf16 v[144:159], v[108:111], v[92:95], v[144:159]
    ds_read_b64_tr_b16 v[100:101], v11 offset:64
    ds_read_b64_tr_b16 v[102:103], v11 offset:832
    v_mfma_f32_32x32x16_bf16 v[160:175], v[112:115], v[88:91], v[160:175]
    ds_read_b64_tr_b16 v[104:105], v11 offset:128
    ds_read_b64_tr_b16 v[106:107], v11 offset:896
    v_mfma_f32_32x32x16_bf16 v[176:191], v[112:115], v[92:95], v[176:191]
    v_mfma_f32_32x32x16_bf16 v[192:207], v[116:119], v[88:91], v[192:207]
    v_mfma_f32_32x32x16_bf16 v[208:223], v[116:119], v[92:95], v[208:223]
    s_waitcnt lgkmcnt(0)
    v_mfma_f32_32x32x16_bf16 v[128:143], v[96:99], v[32:35], v[128:143]
    v_mfma_f32_32x32x16_bf16 v[144:159], v[96:99], v[36:39], v[144:159]
    v_mfma_f32_32x32x16_bf16 v[160:175], v[100:103], v[32:35], v[160:175]
    v_mfma_f32_32x32x16_bf16 v[176:191], v[100:103], v[36:39], v[176:191]
    v_mfma_f32_32x32x16_bf16 v[192:207], v[104:107], v[32:35], v[192:207]
    v_mfma_f32_32x32x16_bf16 v[208:223], v[104:107], v[36:39], v[208:223]
    v_lshrrev_b32 v1, 2, v13
    v_and_b32 v2, 3, v13
    s_lshl_b32 s30, s22, 6
    v_add_u32 v3, s30, v1
    v_mul_u32_u24 v4, 1152, v3
    v_lshlrev_b32 v5, 4, v2
    v_add_u32 v4, v4, v5
    s_mul_i32 s30, s21, 192
    s_add_u32 s30, s30, 5242880
    buffer_load_dwordx4 v[16:19], v4, s[16:19], s30 offen offset:0
    buffer_load_dwordx4 v[20:23], v4, s[16:19], s30 offen offset:64
    buffer_load_dwordx4 v[24:27], v4, s[16:19], s30 offen offset:128
    v_lshrrev_b32 v5, 5, v3
    v_mul_u32_u24 v5, 36864, v5
    v_lshrrev_b32 v6, 1, v2
    v_lshlrev_b32 v6, 10, v6
    v_add_u32 v5, v5, v6
    v_and_b32 v6, 1, v2
    v_lshlrev_b32 v6, 5, v6
    v_and_b32 v7, 31, v3
    v_add_u32 v6, v6, v7
    v_lshlrev_b32 v6, 4, v6
    v_add_u32 v5, v5, v6
    s_mul_i32 s31, s21, 6144
    s_add_u32 s31, s31, 0
    s_barrier
    v_and_b32 v7, 31, v0
    v_mul_u32_u24 v7, 400, v7
    v_lshrrev_b32 v28, 5, v0
    v_lshlrev_b32 v28, 4, v28
    s_mul_i32 s32, s20, 25600
    v_add3_u32 v7, v7, v28, s32
    s_nop 4
    ds_write_b128 v7, v[128:131] offset:0
    ds_write_b128 v7, v[132:135] offset:32
    ds_write_b128 v7, v[136:139] offset:64
    ds_write_b128 v7, v[140:143] offset:96
    ds_write_b128 v7, v[144:147] offset:12800
    ds_write_b128 v7, v[148:151] offset:12832
    ds_write_b128 v7, v[152:155] offset:12864
    ds_write_b128 v7, v[156:159] offset:12896
    ds_write_b128 v7, v[160:163] offset:128
    ds_write_b128 v7, v[164:167] offset:160
    ds_write_b128 v7, v[168:171] offset:192
    ds_write_b128 v7, v[172:175] offset:224
    ds_write_b128 v7, v[176:179] offset:12928
    ds_write_b128 v7, v[180:183] offset:12960
    ds_write_b128 v7, v[184:187] offset:12992
    ds_write_b128 v7, v[188:191] offset:13024
    ds_write_b128 v7, v[192:195] offset:256
    ds_write_b128 v7, v[196:199] offset:288
    ds_write_b128 v7, v[200:203] offset:320
    ds_write_b128 v7, v[204:207] offset:352
    ds_write_b128 v7, v[208:211] offset:13056
    ds_write_b128 v7, v[212:215] offset:13088
    ds_write_b128 v7, v[216:219] offset:13120
    ds_write_b128 v7, v[220:223] offset:13152
    s_waitcnt lgkmcnt(0)
    s_barrier
    v_mul_u32_u24 v7, 400, v1
    v_lshlrev_b32 v28, 5, v2
    v_add_u32 v7, v7, v28
    v_add_u32 v28, 51200, v7
    ds_read_b128 v[32:35], v7 offset:0
    ds_read_b128 v[36:39], v7 offset:16
    ds_read_b128 v[40:43], v7 offset:128
    ds_read_b128 v[44:47], v7 offset:144
    ds_read_b128 v[48:51], v7 offset:256
    ds_read_b128 v[52:55], v7 offset:272
    ds_read_b128 v[56:59], v7 offset:25600
    ds_read_b128 v[60:63], v7 offset:25616
    ds_read_b128 v[64:67], v7 offset:25728
    ds_read_b128 v[68:71], v7 offset:25744
    ds_read_b128 v[72:75], v7 offset:25856
    ds_read_b128 v[76:79], v7 offset:25872
    ds_read_b128 v[80:83], v28 offset:0
    ds_read_b128 v[84:87], v28 offset:16
    ds_read_b128 v[88:91], v28 offset:128
    ds_read_b128 v[92:95], v28 offset:144
    ds_read_b128 v[96:99], v28 offset:256
    ds_read_b128 v[100:103], v28 offset:272
    ds_read_b128 v[104:107], v28 offset:25600
    ds_read_b128 v[108:111], v28 offset:25616
    ds_read_b128 v[112:115], v28 offset:25728
    ds_read_b128 v[116:119], v28 offset:25744
    ds_read_b128 v[120:123], v28 offset:25856
    ds_read_b128 v[124:127], v28 offset:25872
    s_mov_b32 s32, 0xffff0000
    s_waitcnt lgkmcnt(12)
    v_add_f32 v32, v32, v56
    v_add_f32 v33, v33, v57
    v_add_f32 v34, v34, v58
    v_add_f32 v35, v35, v59
    v_add_f32 v36, v36, v60
    v_add_f32 v37, v37, v61
    v_add_f32 v38, v38, v62
    v_add_f32 v39, v39, v63
    v_add_f32 v40, v40, v64
    v_add_f32 v41, v41, v65
    v_add_f32 v42, v42, v66
    v_add_f32 v43, v43, v67
    v_add_f32 v44, v44, v68
    v_add_f32 v45, v45, v69
    v_add_f32 v46, v46, v70
    v_add_f32 v47, v47, v71
    v_add_f32 v48, v48, v72
    v_add_f32 v49, v49, v73
    v_add_f32 v50, v50, v74
    v_add_f32 v51, v51, v75
    v_add_f32 v52, v52, v76
    v_add_f32 v53, v53, v77
    v_add_f32 v54, v54, v78
    v_add_f32 v55, v55, v79
    s_waitcnt lgkmcnt(0)
    v_add_f32 v80, v80, v104
    v_add_f32 v81, v81, v105
    v_add_f32 v82, v82, v106
    v_add_f32 v83, v83, v107
    v_add_f32 v84, v84, v108
    v_add_f32 v85, v85, v109
    v_add_f32 v86, v86, v110
    v_add_f32 v87, v87, v111
    v_add_f32 v88, v88, v112
    v_add_f32 v89, v89, v113
    v_add_f32 v90, v90, v114
    v_add_f32 v91, v91, v115
    v_add_f32 v92, v92, v116
    v_add_f32 v93, v93, v117
    v_add_f32 v94, v94, v118
    v_add_f32 v95, v95, v119
    v_add_f32 v96, v96, v120
    v_add_f32 v97, v97, v121
    v_add_f32 v98, v98, v122
    v_add_f32 v99, v99, v123
    v_add_f32 v100, v100, v124
    v_add_f32 v101, v101, v125
    v_add_f32 v102, v102, v126
    v_add_f32 v103, v103, v127
    v_add_f32 v32, v32, v80
    v_add_f32 v33, v33, v81
    v_add_f32 v34, v34, v82
    v_add_f32 v35, v35, v83
    v_add_f32 v36, v36, v84
    v_add_f32 v37, v37, v85
    v_add_f32 v38, v38, v86
    v_add_f32 v39, v39, v87
    v_add_f32 v40, v40, v88
    v_add_f32 v41, v41, v89
    v_add_f32 v42, v42, v90
    v_add_f32 v43, v43, v91
    v_add_f32 v44, v44, v92
    v_add_f32 v45, v45, v93
    v_add_f32 v46, v46, v94
    v_add_f32 v47, v47, v95
    v_add_f32 v48, v48, v96
    v_add_f32 v49, v49, v97
    v_add_f32 v50, v50, v98
    v_add_f32 v51, v51, v99
    v_add_f32 v52, v52, v100
    v_add_f32 v53, v53, v101
    v_add_f32 v54, v54, v102
    v_add_f32 v55, v55, v103
    s_waitcnt vmcnt(0)
    v_cvt_pk_bf16_f32 v80, v32, v33
    v_lshlrev_b32 v81, 16, v80
    v_and_b32 v82, s32, v80
    v_lshlrev_b32 v83, 16, v16
    v_and_b32 v84, s32, v16
    v_add_f32 v81, v81, v83
    v_add_f32 v82, v82, v84
    v_cvt_pk_bf16_f32 v128, v81, v82
    v_cvt_pk_bf16_f32 v80, v34, v35
    v_lshlrev_b32 v81, 16, v80
    v_and_b32 v82, s32, v80
    v_lshlrev_b32 v83, 16, v17
    v_and_b32 v84, s32, v17
    v_add_f32 v81, v81, v83
    v_add_f32 v82, v82, v84
    v_cvt_pk_bf16_f32 v129, v81, v82
    v_cvt_pk_bf16_f32 v80, v36, v37
    v_lshlrev_b32 v81, 16, v80
    v_and_b32 v82, s32, v80
    v_lshlrev_b32 v83, 16, v18
    v_and_b32 v84, s32, v18
    v_add_f32 v81, v81, v83
    v_add_f32 v82, v82, v84
    v_cvt_pk_bf16_f32 v130, v81, v82
    v_cvt_pk_bf16_f32 v80, v38, v39
    v_lshlrev_b32 v81, 16, v80
    v_and_b32 v82, s32, v80
    v_lshlrev_b32 v83, 16, v19
    v_and_b32 v84, s32, v19
    v_add_f32 v81, v81, v83
    v_add_f32 v82, v82, v84
    v_cvt_pk_bf16_f32 v131, v81, v82
    v_cvt_pk_bf16_f32 v80, v40, v41
    v_lshlrev_b32 v81, 16, v80
    v_and_b32 v82, s32, v80
    v_lshlrev_b32 v83, 16, v20
    v_and_b32 v84, s32, v20
    v_add_f32 v81, v81, v83
    v_add_f32 v82, v82, v84
    v_cvt_pk_bf16_f32 v132, v81, v82
    v_cvt_pk_bf16_f32 v80, v42, v43
    v_lshlrev_b32 v81, 16, v80
    v_and_b32 v82, s32, v80
    v_lshlrev_b32 v83, 16, v21
    v_and_b32 v84, s32, v21
    v_add_f32 v81, v81, v83
    v_add_f32 v82, v82, v84
    v_cvt_pk_bf16_f32 v133, v81, v82
    v_cvt_pk_bf16_f32 v80, v44, v45
    v_lshlrev_b32 v81, 16, v80
    v_and_b32 v82, s32, v80
    v_lshlrev_b32 v83, 16, v22
    v_and_b32 v84, s32, v22
    v_add_f32 v81, v81, v83
    v_add_f32 v82, v82, v84
    v_cvt_pk_bf16_f32 v134, v81, v82
    v_cvt_pk_bf16_f32 v80, v46, v47
    v_lshlrev_b32 v81, 16, v80
    v_and_b32 v82, s32, v80
    v_lshlrev_b32 v83, 16, v23
    v_and_b32 v84, s32, v23
    v_add_f32 v81, v81, v83
    v_add_f32 v82, v82, v84
    v_cvt_pk_bf16_f32 v135, v81, v82
    v_cvt_pk_bf16_f32 v80, v48, v49
    v_lshlrev_b32 v81, 16, v80
    v_and_b32 v82, s32, v80
    v_lshlrev_b32 v83, 16, v24
    v_and_b32 v84, s32, v24
    v_add_f32 v81, v81, v83
    v_add_f32 v82, v82, v84
    v_cvt_pk_bf16_f32 v136, v81, v82
    v_cvt_pk_bf16_f32 v80, v50, v51
    v_lshlrev_b32 v81, 16, v80
    v_and_b32 v82, s32, v80
    v_lshlrev_b32 v83, 16, v25
    v_and_b32 v84, s32, v25
    v_add_f32 v81, v81, v83
    v_add_f32 v82, v82, v84
    v_cvt_pk_bf16_f32 v137, v81, v82
    v_cvt_pk_bf16_f32 v80, v52, v53
    v_lshlrev_b32 v81, 16, v80
    v_and_b32 v82, s32, v80
    v_lshlrev_b32 v83, 16, v26
    v_and_b32 v84, s32, v26
    v_add_f32 v81, v81, v83
    v_add_f32 v82, v82, v84
    v_cvt_pk_bf16_f32 v138, v81, v82
    v_cvt_pk_bf16_f32 v80, v54, v55
    v_lshlrev_b32 v81, 16, v80
    v_and_b32 v82, s32, v80
    v_lshlrev_b32 v83, 16, v27
    v_and_b32 v84, s32, v27
    v_add_f32 v81, v81, v83
    v_add_f32 v82, v82, v84
    v_cvt_pk_bf16_f32 v139, v81, v82
    buffer_store_dwordx4 v[128:131], v5, s[16:19], s31 offen
    buffer_store_dwordx4 v[132:135], v5, s[16:19], s31 offen offset:2048
    v_add_u32 v6, 4096, v5
    buffer_store_dwordx4 v[136:139], v6, s[16:19], s31 offen
    v_lshlrev_b32 v140, 16, v128
    v_and_b32 v141, s32, v128
    v_lshlrev_b32 v142, 16, v129
    v_and_b32 v143, s32, v129
    v_lshlrev_b32 v144, 16, v130
    v_and_b32 v145, s32, v130
    v_lshlrev_b32 v146, 16, v131
    v_and_b32 v147, s32, v131
    v_lshlrev_b32 v148, 16, v132
    v_and_b32 v149, s32, v132
    v_lshlrev_b32 v150, 16, v133
    v_and_b32 v151, s32, v133
    v_lshlrev_b32 v152, 16, v134
    v_and_b32 v153, s32, v134
    v_lshlrev_b32 v154, 16, v135
    v_and_b32 v155, s32, v135
    v_lshlrev_b32 v156, 16, v136
    v_and_b32 v157, s32, v136
    v_lshlrev_b32 v158, 16, v137
    v_and_b32 v159, s32, v137
    v_lshlrev_b32 v160, 16, v138
    v_and_b32 v161, s32, v138
    v_lshlrev_b32 v162, 16, v139
    v_and_b32 v163, s32, v139
    v_add_f32 v28, v140, v141
    v_add_f32 v28, v28, v142
    v_add_f32 v28, v28, v143
    v_add_f32 v28, v28, v144
    v_add_f32 v28, v28, v145
    v_add_f32 v28, v28, v146
    v_add_f32 v28, v28, v147
    v_add_f32 v28, v28, v148
    v_add_f32 v28, v28, v149
    v_add_f32 v28, v28, v150
    v_add_f32 v28, v28, v151
    v_add_f32 v28, v28, v152
    v_add_f32 v28, v28, v153
    v_add_f32 v28, v28, v154
    v_add_f32 v28, v28, v155
    v_add_f32 v28, v28, v156
    v_add_f32 v28, v28, v157
    v_add_f32 v28, v28, v158
    v_add_f32 v28, v28, v159
    v_add_f32 v28, v28, v160
    v_add_f32 v28, v28, v161
    v_add_f32 v28, v28, v162
    v_add_f32 v28, v28, v163
    s_nop 1
    v_add_f32_dpp v28, v28, v28 quad_perm:[1,0,3,2] row_mask:0xf bank_mask:0xf
    s_nop 1
    v_add_f32_dpp v28, v28, v28 quad_perm:[2,3,0,1] row_mask:0xf bank_mask:0xf
    s_mov_b32 s33, 0x3c2aaaab
    v_mul_f32 v30, s33, v28
    v_mov_b32 v29, 0
    v_sub_f32 v31, v140, v30
    v_fma_f32 v29, v31, v31, v29
    v_sub_f32 v31, v141, v30
    v_fma_f32 v29, v31, v31, v29
    v_sub_f32 v31, v142, v30
    v_fma_f32 v29, v31, v31, v29
    v_sub_f32 v31, v143, v30
    v_fma_f32 v29, v31, v31, v29
    v_sub_f32 v31, v144, v30
    v_fma_f32 v29, v31, v31, v29
    v_sub_f32 v31, v145, v30
    v_fma_f32 v29, v31, v31, v29
    v_sub_f32 v31, v146, v30
    v_fma_f32 v29, v31, v31, v29
    v_sub_f32 v31, v147, v30
    v_fma_f32 v29, v31, v31, v29
    v_sub_f32 v31, v148, v30
    v_fma_f32 v29, v31, v31, v29
    v_sub_f32 v31, v149, v30
    v_fma_f32 v29, v31, v31, v29
    v_sub_f32 v31, v150, v30
    v_fma_f32 v29, v31, v31, v29
    v_sub_f32 v31, v151, v30
    v_fma_f32 v29, v31, v31, v29
    v_sub_f32 v31, v152, v30
    v_fma_f32 v29, v31, v31, v29
    v_sub_f32 v31, v153, v30
    v_fma_f32 v29, v31, v31, v29
    v_sub_f32 v31, v154, v30
    v_fma_f32 v29, v31, v31, v29
    v_sub_f32 v31, v155, v30
    v_fma_f32 v29, v31, v31, v29
    v_sub_f32 v31, v156, v30
    v_fma_f32 v29, v31, v31, v29
    v_sub_f32 v31, v157, v30
    v_fma_f32 v29, v31, v31, v29
    v_sub_f32 v31, v158, v30
    v_fma_f32 v29, v31, v31, v29
    v_sub_f32 v31, v159, v30
    v_fma_f32 v29, v31, v31, v29
    v_sub_f32 v31, v160, v30
    v_fma_f32 v29, v31, v31, v29
    v_sub_f32 v31, v161, v30
    v_fma_f32 v29, v31, v31, v29
    v_sub_f32 v31, v162, v30
    v_fma_f32 v29, v31, v31, v29
    v_sub_f32 v31, v163, v30
    v_fma_f32 v29, v31, v31, v29
    s_nop 1
    v_add_f32_dpp v29, v29, v29 quad_perm:[1,0,3,2] row_mask:0xf bank_mask:0xf
    s_nop 1
    v_add_f32_dpp v29, v29, v29 quad_perm:[2,3,0,1] row_mask:0xf bank_mask:0xf
    v_mul_u32_u24 v4, 48, v3
    s_lshl_b32 s30, s21, 3
    s_add_u32 s30, s30, 2359296
    v_cmp_eq_u32 vcc, 0, v2
    s_and_saveexec_b64 s[40:41], vcc
    buffer_store_dwordx2 v[28:29], v4, s[16:19], s30 offen
    s_mov_b64 exec, s[40:41]
k2b_kernel_end:
    s_endpgm
.globl k4b_kernel
.p2align 8
.type k4b_kernel,@function
k4b_kernel:
    s_cmp_ge_u32 s2, 256
    s_cbranch_scc1 k4b_kernel_end
    s_load_dwordx2 s[8:9], s[0:1], 72
    s_load_dwordx2 s[6:7], s[0:1], 56
    v_lshrrev_b32 v1, 6, v0
    v_and_b32 v0, 63, v0
    s_nop 0
    v_readfirstlane_b32 s20, v1
    s_bfe_u32 s21, s2, 0x30003
    s_and_b32 s22, s2, 7
    s_lshl_b32 s22, s22, 2
    s_lshr_b32 s23, s2, 6
    s_add_u32 s22, s22, s23
    s_mul_i32 s23, s22, 589824
    s_lshl_b32 s24, s20, 10
    s_add_u32 s23, s23, s24
    s_add_u32 s23, s23, 8388608
    s_mul_i32 s26, s21, 288
    s_add_u32 s26, s26, s20
    s_mul_i32 s26, s26, 2304
    s_add_u32 s26, s26, 75497472
    v_lshlrev_b32 v7, 4, v0
    v_lshrrev_b32 v6, 5, v0
    v_lshlrev_b32 v6, 3, v6
    v_and_b32 v5, 7, v0
    v_add_u32 v6, v6, v5
    v_lshlrev_b32 v6, 4, v6
    s_waitcnt lgkmcnt(0)
    s_mov_b32 s16, s8
    s_and_b32 s17, s9, 0xffff
    s_mov_b32 s18, 268435456
    s_mov_b32 s19, 0x00020000
    s_mov_b32 s36, s6
    s_and_b32 s37, s7, 0xffff
    s_mov_b32 s38, 2359296
    s_mov_b32 s39, 0x00020000
    s_add_u32 s25, s26, 0
    buffer_load_dwordx4 v[8:11], v7, s[16:19], s25 offen offset:0
    buffer_load_dwordx4 v[12:15], v7, s[16:19], s25 offen offset:1024
    buffer_load_dwordx4 v[16:19], v6, s[16:19], s25 offen offset:2048
    s_add_u32 s24, s23, 0
    buffer_load_dwordx4 v[20:23], v7, s[16:19], s24 offen
    s_add_u32 s24, s23, 294912
    buffer_load_dwordx4 v[24:27], v7, s[16:19], s24 offen
    s_add_u32 s25, s26, 9216
    buffer_load_dwordx4 v[28:31], v7, s[16:19], s25 offen offset:0
    buffer_load_dwordx4 v[32:35], v7, s[16:19], s25 offen offset:1024
    buffer_load_dwordx4 v[36:39], v6, s[16:19], s25 offen offset:2048
    s_add_u32 s24, s23, 4096
    buffer_load_dwordx4 v[40:43], v7, s[16:19], s24 offen
    s_add_u32 s24, s23, 299008
    buffer_load_dwordx4 v[44:47], v7, s[16:19], s24 offen
    s_add_u32 s25, s26, 18432
    buffer_load_dwordx4 v[48:51], v7, s[16:19], s25 offen offset:0
    buffer_load_dwordx4 v[52:55], v7, s[16:19], s25 offen offset:1024
    buffer_load_dwordx4 v[56:59], v6, s[16:19], s25 offen offset:2048
    s_add_u32 s24, s23, 8192
    buffer_load_dwordx4 v[60:63], v7, s[16:19], s24 offen
    s_add_u32 s24, s23, 303104
    buffer_load_dwordx4 v[64:67], v7, s[16:19], s24 offen
    s_add_u32 s25, s26, 27648
    buffer_load_dwordx4 v[68:71], v7, s[16:19], s25 offen offset:0
    buffer_load_dwordx4 v[72:75], v7, s[16:19], s25 offen offset:1024
    buffer_load_dwordx4 v[76:79], v6, s[16:19], s25 offen offset:2048
    s_add_u32 s24, s23, 12288
    buffer_load_dwordx4 v[80:83], v7, s[16:19], s24 offen
    s_add_u32 s24, s23, 307200
    buffer_load_dwordx4 v[84:87], v7, s[16:19], s24 offen
    s_add_u32 s25, s26, 36864
    buffer_load_dwordx4 v[88:91], v7, s[16:19], s25 offen offset:0
    buffer_load_dwordx4 v[92:95], v7, s[16:19], s25 offen offset:1024
    buffer_load_dwordx4 v[96:99], v6, s[16:19], s25 offen offset:2048
    s_add_u32 s24, s23, 16384
    buffer_load_dwordx4 v[100:103], v7, s[16:19], s24 offen
    s_add_u32 s24, s23, 311296
    buffer_load_dwordx4 v[104:107], v7, s[16:19], s24 offen
    v_accvgpr_write_b32 a0, 0
    v_accvgpr_write_b32 a1, 0
    v_accvgpr_write_b32 a2, 0
    v_accvgpr_write_b32 a3, 0
    v_accvgpr_write_b32 a4, 0
    v_accvgpr_write_b32 a5, 0
    v_accvgpr_write_b32 a6, 0
    v_accvgpr_write_b32 a7, 0
    v_accvgpr_write_b32 a8, 0
    v_accvgpr_write_b32 a9, 0
    v_accvgpr_write_b32 a10, 0
    v_accvgpr_write_b32 a11, 0
    v_accvgpr_write_b32 a12, 0
    v_accvgpr_write_b32 a13, 0
    v_accvgpr_write_b32 a14, 0
    v_accvgpr_write_b32 a15, 0
    v_accvgpr_write_b32 a16, 0
    v_accvgpr_write_b32 a17, 0
    v_accvgpr_write_b32 a18, 0
    v_accvgpr_write_b32 a19, 0
    v_accvgpr_write_b32 a20, 0
    v_accvgpr_write_b32 a21, 0
    v_accvgpr_write_b32 a22, 0
    v_accvgpr_write_b32 a23, 0
    v_accvgpr_write_b32 a24, 0
    v_accvgpr_write_b32 a25, 0
    v_accvgpr_write_b32 a26, 0
    v_accvgpr_write_b32 a27, 0
    v_accvgpr_write_b32 a28, 0
    v_accvgpr_write_b32 a29, 0
    v_accvgpr_write_b32 a30, 0
    v_accvgpr_write_b32 a31, 0
    v_accvgpr_write_b32 a32, 0
    v_accvgpr_write_b32 a33, 0
    v_accvgpr_write_b32 a34, 0
    v_accvgpr_write_b32 a35, 0
    v_accvgpr_write_b32 a36, 0
    v_accvgpr_write_b32 a37, 0
    v_accvgpr_write_b32 a38, 0
    v_accvgpr_write_b32 a39, 0
    v_accvgpr_write_b32 a40, 0
    v_accvgpr_write_b32 a41, 0
    v_accvgpr_write_b32 a42, 0
    v_accvgpr_write_b32 a43, 0
    v_accvgpr_write_b32 a44, 0
    v_accvgpr_write_b32 a45, 0
    v_accvgpr_write_b32 a46, 0
    v_accvgpr_write_b32 a47, 0
    v_accvgpr_write_b32 a48, 0
    v_accvgpr_write_b32 a49, 0
    v_accvgpr_write_b32 a50, 0
    v_accvgpr_write_b32 a51, 0
    v_accvgpr_write_b32 a52, 0
    v_accvgpr_write_b32 a53, 0
    v_accvgpr_write_b32 a54, 0
    v_accvgpr_write_b32 a55, 0
    v_accvgpr_write_b32 a56, 0
    v_accvgpr_write_b32 a57, 0
    v_accvgpr_write_b32 a58, 0
    v_accvgpr_write_b32 a59, 0
    v_accvgpr_write_b32 a60, 0
    v_accvgpr_write_b32 a61, 0
    v_accvgpr_write_b32 a62, 0
    v_accvgpr_write_b32 a63, 0
    v_accvgpr_write_b32 a64, 0
    v_accvgpr_write_b32 a65, 0
    v_accvgpr_write_b32 a66, 0
    v_accvgpr_write_b32 a67, 0
    v_accvgpr_write_b32 a68, 0
    v_accvgpr_write_b32 a69, 0
    v_accvgpr_write_b32 a70, 0
    v_accvgpr_write_b32 a71, 0
    v_accvgpr_write_b32 a72, 0
    v_accvgpr_write_b32 a73, 0
    v_accvgpr_write_b32 a74, 0
    v_accvgpr_write_b32 a75, 0
    v_accvgpr_write_b32 a76, 0
    v_accvgpr_write_b32 a77, 0
    v_accvgpr_write_b32 a78, 0
    v_accvgpr_write_b32 a79, 0
    v_accvgpr_write_b32 a80, 0
    v_accvgpr_write_b32 a81, 0
    v_accvgpr_write_b32 a82, 0
    v_accvgpr_write_b32 a83, 0
    v_accvgpr_write_b32 a84, 0
    v_accvgpr_write_b32 a85, 0
    v_accvgpr_write_b32 a86, 0
    v_accvgpr_write_b32 a87, 0
    v_accvgpr_write_b32 a88, 0
    v_accvgpr_write_b32 a89, 0
    v_accvgpr_write_b32 a90, 0
    v_accvgpr_write_b32 a91, 0
    v_accvgpr_write_b32 a92, 0
    v_accvgpr_write_b32 a93, 0
    v_accvgpr_write_b32 a94, 0
    v_accvgpr_write_b32 a95, 0
    s_mov_b32 s34, 0
k4b_kernel_loop:
    s_waitcnt vmcnt(20)
    v_mfma_f32_32x32x16_bf16 a[0:15], v[8:11], v[20:23], a[0:15]
    s_add_u32 s25, s26, 46080
    buffer_load_dwordx4 v[108:111], v7, s[16:19], s25 offen offset:0
    buffer_load_dwordx4 v[112:115], v7, s[16:19], s25 offen offset:1024
    buffer_load_dwordx4 v[116:119], v6, s[16:19], s25 offen offset:2048
    s_add_u32 s24, s23, 20480
    buffer_load_dwordx4 v[120:123], v7, s[16:19], s24 offen
    s_add_u32 s24, s23, 315392
    buffer_load_dwordx4 v[124:127], v7, s[16:19], s24 offen
    v_mfma_f32_32x32x16_bf16 a[16:31], v[8:11], v[24:27], a[16:31]
    v_mfma_f32_32x32x16_bf16 a[32:47], v[12:15], v[20:23], a[32:47]
    v_mfma_f32_32x32x16_bf16 a[48:63], v[12:15], v[24:27], a[48:63]
    v_mfma_f32_32x32x16_bf16 a[64:79], v[16:19], v[20:23], a[64:79]
    v_mfma_f32_32x32x16_bf16 a[80:95], v[16:19], v[24:27], a[80:95]
    s_waitcnt vmcnt(20)
    v_mfma_f32_32x32x16_bf16 a[0:15], v[28:31], v[40:43], a[0:15]
    s_add_u32 s25, s26, 55296
    buffer_load_dwordx4 v[8:11], v7, s[16:19], s25 offen offset:0
    buffer_load_dwordx4 v[12:15], v7, s[16:19], s25 offen offset:1024
    buffer_load_dwordx4 v[16:19], v6, s[16:19], s25 offen offset:2048
    s_add_u32 s24, s23, 24576
    buffer_load_dwordx4 v[20:23], v7, s[16:19], s24 offen
    s_add_u32 s24, s23, 319488
    buffer_load_dwordx4 v[24:27], v7, s[16:19], s24 offen
    v_mfma_f32_32x32x16_bf16 a[16:31], v[28:31], v[44:47], a[16:31]
    v_mfma_f32_32x32x16_bf16 a[32:47], v[32:35], v[40:43], a[32:47]
    v_mfma_f32_32x32x16_bf16 a[48:63], v[32:35], v[44:47], a[48:63]
    v_mfma_f32_32x32x16_bf16 a[64:79], v[36:39], v[40:43], a[64:79]
    v_mfma_f32_32x32x16_bf16 a[80:95], v[36:39], v[44:47], a[80:95]
    s_waitcnt vmcnt(20)
    v_mfma_f32_32x32x16_bf16 a[0:15], v[48:51], v[60:63], a[0:15]
    s_add_u32 s25, s26, 64512
    buffer_load_dwordx4 v[28:31], v7, s[16:19], s25 offen offset:0
    buffer_load_dwordx4 v[32:35], v7, s[16:19], s25 offen offset:1024
    buffer_load_dwordx4 v[36:39], v6, s[16:19], s25 offen offset:2048
    s_add_u32 s24, s23, 28672
    buffer_load_dwordx4 v[40:43], v7, s[16:19], s24 offen
    s_add_u32 s24, s23, 323584
    buffer_load_dwordx4 v[44:47], v7, s[16:19], s24 offen
    v_mfma_f32_32x32x16_bf16 a[16:31], v[48:51], v[64:67], a[16:31]
    v_mfma_f32_32x32x16_bf16 a[32:47], v[52:55], v[60:63], a[32:47]
    v_mfma_f32_32x32x16_bf16 a[48:63], v[52:55], v[64:67], a[48:63]
    v_mfma_f32_32x32x16_bf16 a[64:79], v[56:59], v[60:63], a[64:79]
    v_mfma_f32_32x32x16_bf16 a[80:95], v[56:59], v[64:67], a[80:95]
    s_waitcnt vmcnt(20)
    v_mfma_f32_32x32x16_bf16 a[0:15], v[68:71], v[80:83], a[0:15]
    s_add_u32 s25, s26, 73728
    buffer_load_dwordx4 v[48:51], v7, s[16:19], s25 offen offset:0
    buffer_load_dwordx4 v[52:55], v7, s[16:19], s25 offen offset:1024
    buffer_load_dwordx4 v[56:59], v6, s[16:19], s25 offen offset:2048
    s_add_u32 s24, s23, 32768
    buffer_load_dwordx4 v[60:63], v7, s[16:19], s24 offen
    s_add_u32 s24, s23, 327680
    buffer_load_dwordx4 v[64:67], v7, s[16:19], s24 offen
    v_mfma_f32_32x32x16_bf16 a[16:31], v[68:71], v[84:87], a[16:31]
    v_mfma_f32_32x32x16_bf16 a[32:47], v[72:75], v[80:83], a[32:47]
    v_mfma_f32_32x32x16_bf16 a[48:63], v[72:75], v[84:87], a[48:63]
    v_mfma_f32_32x32x16_bf16 a[64:79], v[76:79], v[80:83], a[64:79]
    v_mfma_f32_32x32x16_bf16 a[80:95], v[76:79], v[84:87], a[80:95]
    s_waitcnt vmcnt(20)
    v_mfma_f32_32x32x16_bf16 a[0:15], v[88:91], v[100:103], a[0:15]
    s_add_u32 s25, s26, 82944
    buffer_load_dwordx4 v[68:71], v7, s[16:19], s25 offen offset:0
    buffer_load_dwordx4 v[72:75], v7, s[16:19], s25 offen offset:1024
    buffer_load_dwordx4 v[76:79], v6, s[16:19], s25 offen offset:2048
    s_add_u32 s24, s23, 36864
    buffer_load_dwordx4 v[80:83], v7, s[16:19], s24 offen
    s_add_u32 s24, s23, 331776
    buffer_load_dwordx4 v[84:87], v7, s[16:19], s24 offen
    v_mfma_f32_32x32x16_bf16 a[16:31], v[88:91], v[104:107], a[16:31]
    v_mfma_f32_32x32x16_bf16 a[32:47], v[92:95], v[100:103], a[32:47]
    v_mfma_f32_32x32x16_bf16 a[48:63], v[92:95], v[104:107], a[48:63]
    v_mfma_f32_32x32x16_bf16 a[64:79], v[96:99], v[100:103], a[64:79]
    v_mfma_f32_32x32x16_bf16 a[80:95], v[96:99], v[104:107], a[80:95]
    s_waitcnt vmcnt(20)
    v_mfma_f32_32x32x16_bf16 a[0:15], v[108:111], v[120:123], a[0:15]
    s_add_u32 s25, s26, 92160
    buffer_load_dwordx4 v[88:91], v7, s[16:19], s25 offen offset:0
    buffer_load_dwordx4 v[92:95], v7, s[16:19], s25 offen offset:1024
    buffer_load_dwordx4 v[96:99], v6, s[16:19], s25 offen offset:2048
    s_add_u32 s24, s23, 40960
    buffer_load_dwordx4 v[100:103], v7, s[16:19], s24 offen
    s_add_u32 s24, s23, 335872
    buffer_load_dwordx4 v[104:107], v7, s[16:19], s24 offen
    v_mfma_f32_32x32x16_bf16 a[16:31], v[108:111], v[124:127], a[16:31]
    v_mfma_f32_32x32x16_bf16 a[32:47], v[112:115], v[120:123], a[32:47]
    v_mfma_f32_32x32x16_bf16 a[48:63], v[112:115], v[124:127], a[48:63]
    v_mfma_f32_32x32x16_bf16 a[64:79], v[116:119], v[120:123], a[64:79]
    v_mfma_f32_32x32x16_bf16 a[80:95], v[116:119], v[124:127], a[80:95]
    s_add_u32 s26, s26, 55296
    s_add_u32 s23, s23, 24576
    s_add_u32 s34, s34, 1
    s_cmp_lt_u32 s34, 11
    s_cbranch_scc1 k4b_kernel_loop
    s_waitcnt vmcnt(20)
    v_mfma_f32_32x32x16_bf16 a[0:15], v[8:11], v[20:23], a[0:15]
    s_add_u32 s25, s26, 46080
    buffer_load_dwordx4 v[108:111], v7, s[16:19], s25 offen offset:0
    buffer_load_dwordx4 v[112:115], v7, s[16:19], s25 offen offset:1024
    buffer_load_dwordx4 v[116:119], v6, s[16:19], s25 offen offset:2048
    s_add_u32 s24, s23, 20480
    buffer_load_dwordx4 v[120:123], v7, s[16:19], s24 offen
    s_add_u32 s24, s23, 315392
    buffer_load_dwordx4 v[124:127], v7, s[16:19], s24 offen
    v_mfma_f32_32x32x16_bf16 a[16:31], v[8:11], v[24:27], a[16:31]
    v_mfma_f32_32x32x16_bf16 a[32:47], v[12:15], v[20:23], a[32:47]
    v_mfma_f32_32x32x16_bf16 a[48:63], v[12:15], v[24:27], a[48:63]
    v_mfma_f32_32x32x16_bf16 a[64:79], v[16:19], v[20:23], a[64:79]
    v_mfma_f32_32x32x16_bf16 a[80:95], v[16:19], v[24:27], a[80:95]
    s_waitcnt vmcnt(20)
    v_mfma_f32_32x32x16_bf16 a[0:15], v[28:31], v[40:43], a[0:15]
    v_mfma_f32_32x32x16_bf16 a[16:31], v[28:31], v[44:47], a[16:31]
    v_mfma_f32_32x32x16_bf16 a[32:47], v[32:35], v[40:43], a[32:47]
    v_mfma_f32_32x32x16_bf16 a[48:63], v[32:35], v[44:47], a[48:63]
    v_mfma_f32_32x32x16_bf16 a[64:79], v[36:39], v[40:43], a[64:79]
    v_mfma_f32_32x32x16_bf16 a[80:95], v[36:39], v[44:47], a[80:95]
    s_waitcnt vmcnt(15)
    v_mfma_f32_32x32x16_bf16 a[0:15], v[48:51], v[60:63], a[0:15]
    v_mfma_f32_32x32x16_bf16 a[16:31], v[48:51], v[64:67], a[16:31]
    v_mfma_f32_32x32x16_bf16 a[32:47], v[52:55], v[60:63], a[32:47]
    v_mfma_f32_32x32x16_bf16 a[48:63], v[52:55], v[64:67], a[48:63]
    v_mfma_f32_32x32x16_bf16 a[64:79], v[56:59], v[60:63], a[64:79]
    v_mfma_f32_32x32x16_bf16 a[80:95], v[56:59], v[64:67], a[80:95]
    s_waitcnt vmcnt(10)
    v_mfma_f32_32x32x16_bf16 a[0:15], v[68:71], v[80:83], a[0:15]
    v_mfma_f32_32x32x16_bf16 a[16:31], v[68:71], v[84:87], a[16:31]
    v_mfma_f32_32x32x16_bf16 a[32:47], v[72:75], v[80:83], a[32:47]
    v_mfma_f32_32x32x16_bf16 a[48:63], v[72:75], v[84:87], a[48:63]
    v_mfma_f32_32x32x16_bf16 a[64:79], v[76:79], v[80:83], a[64:79]
    v_mfma_f32_32x32x16_bf16 a[80:95], v[76:79], v[84:87], a[80:95]
    s_waitcnt vmcnt(5)
    v_mfma_f32_32x32x16_bf16 a[0:15], v[88:91], v[100:103], a[0:15]
    v_mfma_f32_32x32x16_bf16 a[16:31], v[88:91], v[104:107], a[16:31]
    v_mfma_f32_32x32x16_bf16 a[32:47], v[92:95], v[100:103], a[32:47]
    v_mfma_f32_32x32x16_bf16 a[48:63], v[92:95], v[104:107], a[48:63]
    v_mfma_f32_32x32x16_bf16 a[64:79], v[96:99], v[100:103], a[64:79]
    v_mfma_f32_32x32x16_bf16 a[80:95], v[96:99], v[104:107], a[80:95]
    s_waitcnt vmcnt(0)
    v_mfma_f32_32x32x16_bf16 a[0:15], v[108:111], v[120:123], a[0:15]
    v_mfma_f32_32x32x16_bf16 a[16:31], v[108:111], v[124:127], a[16:31]
    v_mfma_f32_32x32x16_bf16 a[32:47], v[112:115], v[120:123], a[32:47]
    v_mfma_f32_32x32x16_bf16 a[48:63], v[112:115], v[124:127], a[48:63]
    v_mfma_f32_32x32x16_bf16 a[64:79], v[116:119], v[120:123], a[64:79]
    v_mfma_f32_32x32x16_bf16 a[80:95], v[116:119], v[124:127], a[80:95]
    s_lshl_b32 s30, s20, 6
    v_add_u32 v13, s30, v0
    v_lshrrev_b32 v1, 2, v13
    v_and_b32 v2, 3, v13
    s_lshl_b32 s30, s22, 6
    v_add_u32 v3, s30, v1
    s_mul_i32 s31, s21, 9
    v_lshrrev_b32 v8, 5, v3
    v_mul_u32_u24 v8, 36864, v8
    v_and_b32 v9, 31, v3
    v_lshlrev_b32 v9, 4, v9
    v_add_u32 v8, v8, v9
    v_mul_u32_u24 v9, 1152, v3
    s_mov_b32 s33, 0
    v_add_u32 v4, 0, v2
    v_add_u32 v4, s31, v4
    v_lshrrev_b32 v5, 1, v4
    v_lshlrev_b32 v5, 10, v5
    v_and_b32 v6, 1, v4
    v_lshlrev_b32 v6, 9, v6
    v_add3_u32 v5, v5, v6, v8
    buffer_load_dwordx4 v[16:19], v5, s[16:19], s33 offen
    v_lshlrev_b32 v4, 4, v4
    v_add_u32 v10, v9, v4
    v_add_u32 v4, 4, v2
    v_add_u32 v4, s31, v4
    v_lshrrev_b32 v5, 1, v4
    v_lshlrev_b32 v5, 10, v5
    v_and_b32 v6, 1, v4
    v_lshlrev_b32 v6, 9, v6
    v_add3_u32 v5, v5, v6, v8
    buffer_load_dwordx4 v[20:23], v5, s[16:19], s33 offen
    v_lshlrev_b32 v4, 4, v4
    v_add_u32 v11, v9, v4
    v_mov_b32 v4, 8
    v_add_u32 v4, s31, v4
    v_lshrrev_b32 v5, 1, v4
    v_lshlrev_b32 v5, 10, v5
    v_and_b32 v6, 1, v4
    v_lshlrev_b32 v6, 9, v6
    v_add3_u32 v5, v5, v6, v8
    buffer_load_dwordx4 v[24:27], v5, s[16:19], s33 offen
    v_lshlrev_b32 v4, 4, v4
    v_add_u32 v12, v9, v4
    v_and_b32 v7, 31, v0
    v_mul_u32_u24 v7, 304, v7
    v_lshrrev_b32 v28, 5, v0
    v_lshlrev_b32 v28, 4, v28
    s_mul_i32 s32, s20, 19456
    v_add3_u32 v7, v7, v28, s32
    ds_write_b128 v7, a[0:3] offset:0
    ds_write_b128 v7, a[4:7] offset:32
    ds_write_b128 v7, a[8:11] offset:64
    ds_write_b128 v7, a[12:15] offset:96
    ds_write_b128 v7, a[16:19] offset:9728
    ds_write_b128 v7, a[20:23] offset:9760
    ds_write_b128 v7, a[24:27] offset:9792
    ds_write_b128 v7, a[28:31] offset:9824
    ds_write_b128 v7, a[32:35] offset:128
    ds_write_b128 v7, a[36:39] offset:160
    ds_write_b128 v7, a[40:43] offset:192
    ds_write_b128 v7, a[44:47] offset:224
    ds_write_b128 v7, a[48:51] offset:9856
    ds_write_b128 v7, a[52:55] offset:9888
    ds_write_b128 v7, a[56:59] offset:9920
    ds_write_b128 v7, a[60:63] offset:9952
    ds_write_b128 v7, a[64:67] offset:256
    ds_write_b128 v7, a[80:83] offset:9984
    s_waitcnt lgkmcnt(0)
    s_barrier
    v_mul_u32_u24 v7, 304, v1
    v_lshlrev_b32 v28, 5, v2
    v_add_u32 v28, v7, v28
    ds_read_b128 v[32:35], v28 offset:0
    ds_read_b128 v[36:39], v28 offset:16
    ds_read_b128 v[40:43], v28 offset:128
    ds_read_b128 v[44:47], v28 offset:144
    ds_read_b128 v[48:51], v7 offset:256
    ds_read_b128 v[52:55], v7 offset:272
    ds_read_b128 v[56:59], v28 offset:19456
    ds_read_b128 v[60:63], v28 offset:19472
    ds_read_b128 v[64:67], v28 offset:19584
    ds_read_b128 v[68:71], v28 offset:19600
    ds_read_b128 v[72:75], v7 offset:19712
    ds_read_b128 v[76:79], v7 offset:19728
    ds_read_b128 v[80:83], v28 offset:38912
    ds_read_b128 v[84:87], v28 offset:38928
    ds_read_b128 v[88:91], v28 offset:39040
    ds_read_b128 v[92:95], v28 offset:39056
    ds_read_b128 v[96:99], v7 offset:39168
    ds_read_b128 v[100:103], v7 offset:39184
    ds_read_b128 v[104:107], v28 offset:58368
    ds_read_b128 v[108:111], v28 offset:58384
    ds_read_b128 v[112:115], v28 offset:58496
    ds_read_b128 v[116:119], v28 offset:58512
    ds_read_b128 v[120:123], v7 offset:58624
    ds_read_b128 v[124:127], v7 offset:58640
    s_mov_b32 s32, 0xffff0000
    s_waitcnt lgkmcnt(12)
    v_add_f32 v32, v32, v56
    v_add_f32 v33, v33, v57
    v_add_f32 v34, v34, v58
    v_add_f32 v35, v35, v59
    v_add_f32 v36, v36, v60
    v_add_f32 v37, v37, v61
    v_add_f32 v38, v38, v62
    v_add_f32 v39, v39, v63
    v_add_f32 v40, v40, v64
    v_add_f32 v41, v41, v65
    v_add_f32 v42, v42, v66
    v_add_f32 v43, v43, v67
    v_add_f32 v44, v44, v68
    v_add_f32 v45, v45, v69
    v_add_f32 v46, v46, v70
    v_add_f32 v47, v47, v71
    v_add_f32 v48, v48, v72
    v_add_f32 v49, v49, v73
    v_add_f32 v50, v50, v74
    v_add_f32 v51, v51, v75
    v_add_f32 v52, v52, v76
    v_add_f32 v53, v53, v77
    v_add_f32 v54, v54, v78
    v_add_f32 v55, v55, v79
    s_waitcnt lgkmcnt(0)
    v_add_f32 v80, v80, v104
    v_add_f32 v81, v81, v105
    v_add_f32 v82, v82, v106
    v_add_f32 v83, v83, v107
    v_add_f32 v84, v84, v108
    v_add_f32 v85, v85, v109
    v_add_f32 v86, v86, v110
    v_add_f32 v87, v87, v111
    v_add_f32 v88, v88, v112
    v_add_f32 v89, v89, v113
    v_add_f32 v90, v90, v114
    v_add_f32 v91, v91, v115
    v_add_f32 v92, v92, v116
    v_add_f32 v93, v93, v117
    v_add_f32 v94, v94, v118
    v_add_f32 v95, v95, v119
    v_add_f32 v96, v96, v120
    v_add_f32 v97, v97, v121
    v_add_f32 v98, v98, v122
    v_add_f32 v99, v99, v123
    v_add_f32 v100, v100, v124
    v_add_f32 v101, v101, v125
    v_add_f32 v102, v102, v126
    v_add_f32 v103, v103, v127
    v_add_f32 v32, v32, v80
    v_add_f32 v33, v33, v81
    v_add_f32 v34, v34, v82
    v_add_f32 v35, v35, v83
    v_add_f32 v36, v36, v84
    v_add_f32 v37, v37, v85
    v_add_f32 v38, v38, v86
    v_add_f32 v39, v39, v87
    v_add_f32 v40, v40, v88
    v_add_f32 v41, v41, v89
    v_add_f32 v42, v42, v90
    v_add_f32 v43, v43, v91
    v_add_f32 v44, v44, v92
    v_add_f32 v45, v45, v93
    v_add_f32 v46, v46, v94
    v_add_f32 v47, v47, v95
    v_add_f32 v48, v48, v96
    v_add_f32 v49, v49, v97
    v_add_f32 v50, v50, v98
    v_add_f32 v51, v51, v99
    v_add_f32 v52, v52, v100
    v_add_f32 v53, v53, v101
    v_add_f32 v54, v54, v102
    v_add_f32 v55, v55, v103
    s_waitcnt vmcnt(0)
    v_cvt_pk_bf16_f32 v80, v32, v33
    v_lshlrev_b32 v81, 16, v80
    v_and_b32 v82, s32, v80
    v_lshlrev_b32 v83, 16, v16
    v_and_b32 v84, s32, v16
    v_add_f32 v81, v81, v83
    v_add_f32 v82, v82, v84
    v_cvt_pk_bf16_f32 v128, v81, v82
    v_cvt_pk_bf16_f32 v80, v34, v35
    v_lshlrev_b32 v81, 16, v80
    v_and_b32 v82, s32, v80
    v_lshlrev_b32 v83, 16, v17
    v_and_b32 v84, s32, v17
    v_add_f32 v81, v81, v83
    v_add_f32 v82, v82, v84
    v_cvt_pk_bf16_f32 v129, v81, v82
    v_cvt_pk_bf16_f32 v80, v36, v37
    v_lshlrev_b32 v81, 16, v80
    v_and_b32 v82, s32, v80
    v_lshlrev_b32 v83, 16, v18
    v_and_b32 v84, s32, v18
    v_add_f32 v81, v81, v83
    v_add_f32 v82, v82, v84
    v_cvt_pk_bf16_f32 v130, v81, v82
    v_cvt_pk_bf16_f32 v80, v38, v39
    v_lshlrev_b32 v81, 16, v80
    v_and_b32 v82, s32, v80
    v_lshlrev_b32 v83, 16, v19
    v_and_b32 v84, s32, v19
    v_add_f32 v81, v81, v83
    v_add_f32 v82, v82, v84
    v_cvt_pk_bf16_f32 v131, v81, v82
    v_cvt_pk_bf16_f32 v80, v40, v41
    v_lshlrev_b32 v81, 16, v80
    v_and_b32 v82, s32, v80
    v_lshlrev_b32 v83, 16, v20
    v_and_b32 v84, s32, v20
    v_add_f32 v81, v81, v83
    v_add_f32 v82, v82, v84
    v_cvt_pk_bf16_f32 v132, v81, v82
    v_cvt_pk_bf16_f32 v80, v42, v43
    v_lshlrev_b32 v81, 16, v80
    v_and_b32 v82, s32, v80
    v_lshlrev_b32 v83, 16, v21
    v_and_b32 v84, s32, v21
    v_add_f32 v81, v81, v83
    v_add_f32 v82, v82, v84
    v_cvt_pk_bf16_f32 v133, v81, v82
    v_cvt_pk_bf16_f32 v80, v44, v45
    v_lshlrev_b32 v81, 16, v80
    v_and_b32 v82, s32, v80
    v_lshlrev_b32 v83, 16, v22
    v_and_b32 v84, s32, v22
    v_add_f32 v81, v81, v83
    v_add_f32 v82, v82, v84
    v_cvt_pk_bf16_f32 v134, v81, v82
    v_cvt_pk_bf16_f32 v80, v46, v47
    v_lshlrev_b32 v81, 16, v80
    v_and_b32 v82, s32, v80
    v_lshlrev_b32 v83, 16, v23
    v_and_b32 v84, s32, v23
    v_add_f32 v81, v81, v83
    v_add_f32 v82, v82, v84
    v_cvt_pk_bf16_f32 v135, v81, v82
    v_cvt_pk_bf16_f32 v80, v48, v49
    v_lshlrev_b32 v81, 16, v80
    v_and_b32 v82, s32, v80
    v_lshlrev_b32 v83, 16, v24
    v_and_b32 v84, s32, v24
    v_add_f32 v81, v81, v83
    v_add_f32 v82, v82, v84
    v_cvt_pk_bf16_f32 v136, v81, v82
    v_cvt_pk_bf16_f32 v80, v50, v51
    v_lshlrev_b32 v81, 16, v80
    v_and_b32 v82, s32, v80
    v_lshlrev_b32 v83, 16, v25
    v_and_b32 v84, s32, v25
    v_add_f32 v81, v81, v83
    v_add_f32 v82, v82, v84
    v_cvt_pk_bf16_f32 v137, v81, v82
    v_cvt_pk_bf16_f32 v80, v52, v53
    v_lshlrev_b32 v81, 16, v80
    v_and_b32 v82, s32, v80
    v_lshlrev_b32 v83, 16, v26
    v_and_b32 v84, s32, v26
    v_add_f32 v81, v81, v83
    v_add_f32 v82, v82, v84
    v_cvt_pk_bf16_f32 v138, v81, v82
    v_cvt_pk_bf16_f32 v80, v54, v55
    v_lshlrev_b32 v81, 16, v80
    v_and_b32 v82, s32, v80
    v_lshlrev_b32 v83, 16, v27
    v_and_b32 v84, s32, v27
    v_add_f32 v81, v81, v83
    v_add_f32 v82, v82, v84
    v_cvt_pk_bf16_f32 v139, v81, v82
    s_mov_b32 s30, 0
    buffer_store_dwordx4 v[128:131], v10, s[36:39], s30 offen
    buffer_store_dwordx4 v[132:135], v11, s[36:39], s30 offen
    v_cmp_eq_u32 vcc, 0, v2
    s_and_saveexec_b64 s[40:41], vcc
    buffer_store_dwordx4 v[136:139], v12, s[36:39], s30 offen
    s_mov_b64 exec, s[40:41]
k4b_kernel_end:
    s_endpgm
.section .rodata,"a"
.p2align 6
.amdhsa_kernel k1a_kernel
  .amdhsa_next_free_vgpr 256
  .amdhsa_next_free_sgpr 72
  .amdhsa_accum_offset 256
  .amdhsa_group_segment_fixed_size 0
  .amdhsa_kernarg_size 80
  .amdhsa_user_sgpr_count 2
  .amdhsa_user_sgpr_kernarg_segment_ptr 1
  .amdhsa_system_sgpr_workgroup_id_x 1
.end_amdhsa_kernel
.p2align 6
.amdhsa_kernel k2a_kernel
  .amdhsa_next_free_vgpr 224
  .amdhsa_next_free_sgpr 64
  .amdhsa_accum_offset 224
  .amdhsa_group_segment_fixed_size 0
  .amdhsa_kernarg_size 80
  .amdhsa_user_sgpr_count 2
  .amdhsa_user_sgpr_kernarg_segment_ptr 1
  .amdhsa_system_sgpr_workgroup_id_x 1
.end_amdhsa_kernel
.p2align 6
.amdhsa_kernel k3_kernel
  .amdhsa_next_free_vgpr 456
  .amdhsa_next_free_sgpr 64
  .amdhsa_accum_offset 256
  .amdhsa_group_segment_fixed_size 0
  .amdhsa_kernarg_size 80
  .amdhsa_user_sgpr_count 2
  .amdhsa_user_sgpr_kernarg_segment_ptr 1
  .amdhsa_system_sgpr_workgroup_id_x 1
.end_amdhsa_kernel
.p2align 6
.amdhsa_kernel k4a_kernel
  .amdhsa_next_free_vgpr 352
  .amdhsa_next_free_sgpr 48
  .amdhsa_accum_offset 256
  .amdhsa_group_segment_fixed_size 0
  .amdhsa_kernarg_size 80
  .amdhsa_user_sgpr_count 2
  .amdhsa_user_sgpr_kernarg_segment_ptr 1
  .amdhsa_system_sgpr_workgroup_id_x 1
.end_amdhsa_kernel
.p2align 6
.amdhsa_kernel k1b_kernel
  .amdhsa_next_free_vgpr 256
  .amdhsa_next_free_sgpr 72
  .amdhsa_accum_offset 256
  .amdhsa_group_segment_fixed_size 0
  .amdhsa_kernarg_size 80
  .amdhsa_user_sgpr_count 2
  .amdhsa_user_sgpr_kernarg_segment_ptr 1
  .amdhsa_system_sgpr_workgroup_id_x 1
.end_amdhsa_kernel
.p2align 6
.amdhsa_kernel k2b_kernel
  .amdhsa_next_free_vgpr 224
  .amdhsa_next_free_sgpr 64
  .amdhsa_accum_offset 224
  .amdhsa_group_segment_fixed_size 0
  .amdhsa_kernarg_size 80
  .amdhsa_user_sgpr_count 2
  .amdhsa_user_sgpr_kernarg_segment_ptr 1
  .amdhsa_system_sgpr_workgroup_id_x 1
.end_amdhsa_kernel
.p2align 6
.amdhsa_kernel k4b_kernel
  .amdhsa_next_free_vgpr 352
  .amdhsa_next_free_sgpr 48
  .amdhsa_accum_offset 256
  .amdhsa_group_segment_fixed_size 0
  .amdhsa_kernarg_size 80
  .amdhsa_user_sgpr_count 2
  .amdhsa_user_sgpr_kernarg_segment_ptr 1
  .amdhsa_system_sgpr_workgroup_id_x 1
.end_amdhsa_kernel
```
